```python
import torch

def _softmax(x, axis=-1):
    return torch.softmax(x, dim=axis)
def _gelu(x):
    return torch.nn.functional.gelu(x, approximate="tanh")
def _silu(x):
    return torch.nn.functional.silu(x)
def _sigmoid(x):
    return torch.sigmoid(x)
def _layernorm(x, axis=-1, eps=1e-5):
    m = x.mean(dim=axis, keepdim=True)
    v = x.var(dim=axis, keepdim=True, unbiased=False)
    return (x - m) / torch.sqrt(v + eps)
def _scatter_add(tgt, idx, src, axis=0):
    return tgt.clone().index_add_(axis, idx, src)
def _segment_sum(src, seg, n):
    out = torch.zeros((n,) + src.shape[1:], dtype=src.dtype)
    return out.index_add_(0, seg, src)
def _pad(x, pw):
    flat = tuple(v for pair in reversed(pw) for v in pair)
    return torch.nn.functional.pad(x, flat)

kernel_name = 'gated_mix__spectral_gfnet__swiglu_ffn__prompt'

def setup_inputs():

    _w = (lambda a: (lambda t: t.to(torch.bfloat16) if t.is_floating_point() else t)(torch.as_tensor(a)))
    def _A_setup():
        B, S, D = 1, 2048, 1024
        Df = D // 2 + 1
        return {
            "x": _w((lambda *s: torch.randn(*s, dtype=torch.bfloat16) * 0.05)(B, S, D)),
            "w_r": _w((lambda *s: torch.randn(*s, dtype=torch.bfloat16) * 1.6)(S, Df) * 0.02),
            "w_i": _w((lambda *s: torch.randn(*s, dtype=torch.bfloat16) * 1.6)(S, Df) * 0.02),
        }
    _A_in = _A_setup()

    def _B_setup():
        B, S, D, F = 1, 2048, 1024, 3584
        return {
            "x": _w((lambda *s: torch.randn(*s, dtype=torch.bfloat16) * 0.05)(B, S, D)),
            "w_gate": _w((lambda *s: torch.randn(*s, dtype=torch.bfloat16) * 0.05)(D, F)),
            "w_up": _w((lambda *s: torch.randn(*s, dtype=torch.bfloat16) * 0.05)(D, F)),
            "w_down": _w((lambda *s: torch.randn(*s, dtype=torch.bfloat16) * 0.05)(F, D)),
        }
    _B_in = _B_setup()

    return {
        "A_x": _A_in["x"],
        "A_w_r": _A_in["w_r"],
        "A_w_i": _A_in["w_i"],
        "B_x": _B_in["x"],
        "B_w_gate": _B_in["w_gate"],
        "B_w_up": _B_in["w_up"],
        "B_w_down": _B_in["w_down"],
        "gate_w": _w((lambda *s: torch.randn(*s, dtype=torch.bfloat16) * 0.05)(1024) * 16.0),
    }

def reference(A_x, A_w_r, A_w_i, B_x, B_w_gate, B_w_up, B_w_down, gate_w):
    def _A_ref(x, w_r, w_i):
        B, S, D = x.shape
        X = (lambda x, axes=(-2,-1): torch.fft.rfft2(x.float(), dim=axes))(x, axes=(-2, -1))
        W = w_r + 1j * w_i
        X = X * W
        y = (lambda x, s, axes=(-2,-1): torch.fft.irfft2(x, s=s, dim=axes).to(torch.bfloat16))(X, (S, D), axes=(-2, -1))
        return y

    def _B_ref(x, w_gate, w_up, w_down):
        g = _silu(x @ w_gate)
        u = x @ w_up
        return (g * u) @ w_down

    x = A_x
    g = _sigmoid((x * gate_w).sum(-1, keepdims=True))
    a = _A_ref(x, A_w_r, A_w_i)
    b = _B_ref(x, B_w_gate, B_w_up, B_w_down)
    return g * a + (1 - g) * b
```

```asm
; @launch grid=(256,1,1) block=(512,1,1) lds=163840
.amdgcn_target "amdgcn-amd-amdhsa--gfx950"
.text
.globl gated_mix__spectral_gfnet__swiglu_ffn__prompt_kernel
.p2align 8
.type gated_mix__spectral_gfnet__swiglu_ffn__prompt_kernel,@function
gated_mix__spectral_gfnet__swiglu_ffn__prompt_kernel:
    s_cmp_ge_u32 s2, 256
    s_cbranch_scc1 M_end
    s_load_dwordx2 s[4:5], s[0:1], 0
    s_load_dwordx4 s[40:43], s[0:1], 32
    s_load_dwordx4 s[36:39], s[0:1], 8
    s_load_dwordx4 s[48:51], s[0:1], 48
    s_load_dwordx2 s[6:7], s[0:1], 64
    s_load_dwordx4 s[44:47], s[0:1], 72

    v_lshrrev_b32 v1, 6, v0
    v_and_b32 v11, 63, v0
    s_and_b32 s28, s2, 7
    v_readfirstlane_b32 s3, v1
    s_lshr_b32 s29, s2, 3
    s_and_b32 s26, s28, 1
    s_lshl_b32 s26, s26, 2
    s_and_b32 s27, s29, 3
    s_add_u32 s26, s26, s27
    s_lshr_b32 s27, s28, 1
    s_mul_i32 s27, s27, 7
    s_lshr_b32 s25, s29, 2
    s_add_u32 s27, s27, s25
    s_lshl_b32 s24, s3, 10
    s_and_b32 s32, s28, 1
    s_mul_i32 s32, s32, 512
    s_lshr_b32 s33, s28, 1
    s_mul_i32 s33, s33, 128
    s_add_u32 s32, s32, s33
    s_lshl_b32 s33, s32, 1
    v_lshlrev_b32 v10, 4, v11
    s_lshl_b32 s56, s26, 8
    s_lshl_b32 s57, s3, 3
    s_add_u32 s56, s56, s57
    v_lshrrev_b32 v3, 3, v11
    v_add_u32 v4, s56, v3
    v_lshlrev_b32 v4, 11, v4
    s_and_b32 s52, s3, 1
    s_lshl_b32 s52, s52, 2
    v_lshrrev_b32 v5, 1, v3
    v_or_b32 v5, s52, v5
    v_and_b32 v6, 7, v11
    v_xor_b32 v5, v5, v6
    v_lshl_add_u32 v8, v5, 4, v4
    v_lshrrev_b32 v3, 4, v11
    s_and_b32 s52, s3, 2
    s_lshl_b32 s52, s52, 1
    v_or_b32 v5, s52, v3
    v_lshlrev_b32 v5, 1, v5
    v_and_b32 v4, 15, v11
    v_xor_b32 v4, v4, v5
    s_lshl_b32 s52, s3, 2
    v_add_u32 v3, s52, v3
    v_mul_u32_u24 v5, 7168, v3
    v_lshl_add_u32 v5, v4, 4, v5
    s_lshl_b32 s52, s27, 8
    v_add_u32 v9, s52, v5
    s_waitcnt lgkmcnt(0)

    s_mov_b32 s8, s4
    s_mov_b32 s9, s5
    s_mov_b32 s10, 4194304
    s_mov_b32 s11, 0x20000

    s_mov_b32 s12, s40
    s_mov_b32 s13, s41
    s_mov_b32 s14, 7340032
    s_mov_b32 s15, 0x20000

    s_mov_b32 s16, s42
    s_mov_b32 s17, s43
    s_mov_b32 s18, 7340032
    s_mov_b32 s19, 0x20000

    s_cmp_ge_u32 s29, 28
    s_cbranch_scc1 M_skip0
    s_add_u32 m0, s24, 65536
    s_add_u32 s31, s33, 0
    s_and_b32 s31, s31, 2047
    s_add_u32 s31, s31, 0
    buffer_load_dwordx4 v8, s[8:11], s31 offen lds
    s_add_u32 m0, s24, 73728
    s_add_u32 s31, s33, 0
    s_and_b32 s31, s31, 2047
    s_add_u32 s31, s31, 131072
    buffer_load_dwordx4 v8, s[8:11], s31 offen lds
    s_add_u32 m0, s24, 0
    s_add_u32 s30, s32, 0
    s_and_b32 s30, s30, 1023
    s_mul_i32 s30, s30, 7168
    buffer_load_dwordx4 v9, s[12:15], s30 offen lds
    s_add_u32 m0, s24, 8192
    s_nop 0
    buffer_load_dwordx4 v9, s[16:19], s30 offen lds
    s_add_u32 m0, s24, 81920
    s_add_u32 s31, s33, 0
    s_and_b32 s31, s31, 2047
    s_add_u32 s31, s31, 262144
    buffer_load_dwordx4 v8, s[8:11], s31 offen lds
    s_add_u32 m0, s24, 90112
    s_add_u32 s31, s33, 0
    s_and_b32 s31, s31, 2047
    s_add_u32 s31, s31, 393216
    buffer_load_dwordx4 v8, s[8:11], s31 offen lds
    s_add_u32 m0, s24, 16384
    s_add_u32 s30, s32, 32
    s_and_b32 s30, s30, 1023
    s_mul_i32 s30, s30, 7168
    buffer_load_dwordx4 v9, s[12:15], s30 offen lds
    s_add_u32 m0, s24, 24576
    s_nop 0
    buffer_load_dwordx4 v9, s[16:19], s30 offen lds
    s_add_u32 m0, s24, 98304
    s_add_u32 s31, s33, 128
    s_and_b32 s31, s31, 2047
    s_add_u32 s31, s31, 0
    buffer_load_dwordx4 v8, s[8:11], s31 offen lds
    s_add_u32 m0, s24, 106496
    s_add_u32 s31, s33, 128
    s_and_b32 s31, s31, 2047
    s_add_u32 s31, s31, 131072
    buffer_load_dwordx4 v8, s[8:11], s31 offen lds
    s_add_u32 m0, s24, 32768
    s_add_u32 s30, s32, 64
    s_and_b32 s30, s30, 1023
    s_mul_i32 s30, s30, 7168
    buffer_load_dwordx4 v9, s[12:15], s30 offen lds
    s_add_u32 m0, s24, 40960
    s_nop 0
    buffer_load_dwordx4 v9, s[16:19], s30 offen lds
    s_add_u32 m0, s24, 114688
    s_add_u32 s31, s33, 128
    s_and_b32 s31, s31, 2047
    s_add_u32 s31, s31, 262144
    buffer_load_dwordx4 v8, s[8:11], s31 offen lds
    s_add_u32 m0, s24, 122880
    s_add_u32 s31, s33, 128
    s_and_b32 s31, s31, 2047
    s_add_u32 s31, s31, 393216
    buffer_load_dwordx4 v8, s[8:11], s31 offen lds
    s_add_u32 m0, s24, 49152
    s_add_u32 s30, s32, 96
    s_and_b32 s30, s30, 1023
    s_mul_i32 s30, s30, 7168
    buffer_load_dwordx4 v9, s[12:15], s30 offen lds
    s_add_u32 m0, s24, 57344
    s_nop 0
    buffer_load_dwordx4 v9, s[16:19], s30 offen lds
    s_add_u32 m0, s24, 131072
    s_add_u32 s31, s33, 256
    s_and_b32 s31, s31, 2047
    s_add_u32 s31, s31, 0
    buffer_load_dwordx4 v8, s[8:11], s31 offen lds
    s_add_u32 m0, s24, 139264
    s_add_u32 s31, s33, 256
    s_and_b32 s31, s31, 2047
    s_add_u32 s31, s31, 131072
    buffer_load_dwordx4 v8, s[8:11], s31 offen lds
M_skip0:
    s_mov_b32 s20, s46
    s_mov_b32 s21, s47
    s_mov_b32 s22, 268435456
    s_mov_b32 s23, 0x20000

    s_mov_b32 s52, s50
    s_mov_b32 s53, s51
    s_mov_b32 s54, 2048
    s_mov_b32 s55, 0x20000

    s_mov_b32 s76, s36
    s_mov_b32 s77, s37
    s_mov_b32 s78, 2101248
    s_mov_b32 s79, 0x20000

    s_mov_b32 s80, s38
    s_mov_b32 s81, s39
    s_mov_b32 s82, 2101248
    s_mov_b32 s83, 0x20000

    s_mov_b32 s92, s44
    s_mov_b32 s93, s45
    s_mov_b32 s94, 256
    s_mov_b32 s95, 0x20000

    s_mov_b32 s96, s48
    s_mov_b32 s97, s49
    s_mov_b32 s98, 7340032
    s_mov_b32 s99, 0x20000

    s_and_b32 s44, s25, 1
    s_lshl_b32 s58, s26, 1
    s_add_u32 s44, s44, s58
    s_bfe_u32 s45, s28, 0x10001
    s_lshl_b32 s45, s45, 2
    s_lshr_b32 s58, s25, 1
    s_add_u32 s45, s45, s58
    s_lshr_b32 s46, s28, 2
    s_mov_b32 s100, 0
    s_cmp_ge_u32 s29, 28
    s_cselect_b32 s101, 1, 0
    s_mul_i32 s58, s46, 14
    s_bfe_u32 s5, s28, 0x10001
    s_mul_i32 s5, s5, 14
    s_sub_u32 s4, s27, s58
    s_lshl_b32 s4, s4, 1
    s_cmp_eq_u32 s101, 1
    s_cselect_b32 s4, s5, s4
    s_mov_b32 s1, s4
    s_mul_i32 s48, s44, 56
    s_lshl_b32 s58, s58, 1
    s_add_u32 s48, s48, s58
    s_lshl_b32 s48, s48, 14
    s_lshl_b32 s0, s58, 17
    s_lshl_b32 s59, s45, 8
    s_add_u32 s0, s0, s59
    s_lshl_b32 s50, s1, 14
    s_lshl_b32 s51, s1, 17
    s_add_u32 s50, s50, s48
    s_add_u32 s51, s51, s0
    s_lshl_b32 s49, s44, 1
    s_add_u32 s49, s49, s46
    s_lshl_b32 s49, s49, 8
    s_add_u32 s49, s49, 36700160
    s_lshl_b32 s58, s26, 1
    s_lshr_b32 s59, s3, 2
    s_add_u32 s58, s58, s59
    s_lshl_b32 s58, s58, 1
    s_add_u32 s58, s58, s46
    s_lshl_b32 s58, s58, 8
    s_mul_i32 s59, s46, 14
    s_sub_u32 s59, s27, s59
    s_lshl_b32 s59, s59, 4
    s_add_u32 s58, s58, s59
    s_and_b32 s59, s3, 3
    s_lshl_b32 s59, s59, 2
    s_add_u32 s58, s58, s59
    s_add_u32 s58, s58, 36700160
    s_lshl_b32 s59, s44, 3
    s_add_u32 s59, s59, s45
    s_lshl_b32 s59, s59, 6
    s_lshl_b32 s88, s46, 4
    s_add_u32 s59, s59, s88
    s_add_u32 s59, s59, 36708352
    s_lshl_b32 s88, s2, 4
    s_add_u32 s88, s88, 36716544
    s_cmp_ge_u32 s3, 4
    s_cselect_b32 s59, s88, s59
    s_and_b32 s88, s3, 3
    s_lshl_b32 s88, s88, 2
    s_add_u32 s59, s59, s88
    s_cmp_eq_u32 s101, 1
    s_cselect_b32 s58, s59, s58
    v_mov_b32 v21, s59
    v_writelane_b32 v21, s58, 0
    v_mov_b32 v20, 0
    v_and_b32 v23, 3, v11
    v_lshlrev_b32 v23, 6, v23
    v_mov_b32 v24, 1
    v_lshlrev_b32 v25, 2, v11
    v_cmp_gt_u32 vcc, 4, v11
    s_mul_i32 s35, s46, 224
    s_lshl_b32 s34, s29, 3
    s_add_u32 s34, s34, s3
    s_add_u32 s35, s35, s34
    s_lshl_b32 s35, s35, 14
    s_bfe_u32 s59, s28, 0x10001
    s_lshl_b32 s59, s59, 10
    s_add_u32 s35, s35, s59
    v_cndmask_b32 v26, 0, 1, vcc
    v_lshrrev_b32 v31, 3, v11
    v_lshlrev_b32 v31, 11, v31
    v_and_b32 v30, 7, v11
    v_lshl_add_u32 v31, v30, 7, v31
    s_cmp_eq_u32 s101, 1
    s_cbranch_scc1 M_fft

    v_mov_b32 v128, 0
    v_mov_b32 v129, 0
    v_mov_b32 v130, 0
    v_mov_b32 v131, 0
    v_mov_b32 v132, 0
    v_mov_b32 v133, 0
    v_mov_b32 v134, 0
    v_mov_b32 v135, 0
    v_mov_b32 v136, 0
    v_mov_b32 v137, 0
    v_mov_b32 v138, 0
    v_mov_b32 v139, 0
    v_mov_b32 v140, 0
    v_mov_b32 v141, 0
    v_mov_b32 v142, 0
    v_mov_b32 v143, 0
    v_mov_b32 v144, 0
    v_mov_b32 v145, 0
    v_mov_b32 v146, 0
    v_mov_b32 v147, 0
    v_mov_b32 v148, 0
    v_mov_b32 v149, 0
    v_mov_b32 v150, 0
    v_mov_b32 v151, 0
    v_mov_b32 v152, 0
    v_mov_b32 v153, 0
    v_mov_b32 v154, 0
    v_mov_b32 v155, 0
    v_mov_b32 v156, 0
    v_mov_b32 v157, 0
    v_mov_b32 v158, 0
    v_mov_b32 v159, 0
    v_mov_b32 v160, 0
    v_mov_b32 v161, 0
    v_mov_b32 v162, 0
    v_mov_b32 v163, 0
    v_mov_b32 v164, 0
    v_mov_b32 v165, 0
    v_mov_b32 v166, 0
    v_mov_b32 v167, 0
    v_mov_b32 v168, 0
    v_mov_b32 v169, 0
    v_mov_b32 v170, 0
    v_mov_b32 v171, 0
    v_mov_b32 v172, 0
    v_mov_b32 v173, 0
    v_mov_b32 v174, 0
    v_mov_b32 v175, 0
    v_mov_b32 v176, 0
    v_mov_b32 v177, 0
    v_mov_b32 v178, 0
    v_mov_b32 v179, 0
    v_mov_b32 v180, 0
    v_mov_b32 v181, 0
    v_mov_b32 v182, 0
    v_mov_b32 v183, 0
    v_mov_b32 v184, 0
    v_mov_b32 v185, 0
    v_mov_b32 v186, 0
    v_mov_b32 v187, 0
    v_mov_b32 v188, 0
    v_mov_b32 v189, 0
    v_mov_b32 v190, 0
    v_mov_b32 v191, 0
    v_mov_b32 v192, 0
    v_mov_b32 v193, 0
    v_mov_b32 v194, 0
    v_mov_b32 v195, 0
    v_mov_b32 v196, 0
    v_mov_b32 v197, 0
    v_mov_b32 v198, 0
    v_mov_b32 v199, 0
    v_mov_b32 v200, 0
    v_mov_b32 v201, 0
    v_mov_b32 v202, 0
    v_mov_b32 v203, 0
    v_mov_b32 v204, 0
    v_mov_b32 v205, 0
    v_mov_b32 v206, 0
    v_mov_b32 v207, 0
    v_mov_b32 v208, 0
    v_mov_b32 v209, 0
    v_mov_b32 v210, 0
    v_mov_b32 v211, 0
    v_mov_b32 v212, 0
    v_mov_b32 v213, 0
    v_mov_b32 v214, 0
    v_mov_b32 v215, 0
    v_mov_b32 v216, 0
    v_mov_b32 v217, 0
    v_mov_b32 v218, 0
    v_mov_b32 v219, 0
    v_mov_b32 v220, 0
    v_mov_b32 v221, 0
    v_mov_b32 v222, 0
    v_mov_b32 v223, 0
    v_mov_b32 v224, 0
    v_mov_b32 v225, 0
    v_mov_b32 v226, 0
    v_mov_b32 v227, 0
    v_mov_b32 v228, 0
    v_mov_b32 v229, 0
    v_mov_b32 v230, 0
    v_mov_b32 v231, 0
    v_mov_b32 v232, 0
    v_mov_b32 v233, 0
    v_mov_b32 v234, 0
    v_mov_b32 v235, 0
    v_mov_b32 v236, 0
    v_mov_b32 v237, 0
    v_mov_b32 v238, 0
    v_mov_b32 v239, 0
    v_mov_b32 v240, 0
    v_mov_b32 v241, 0
    v_mov_b32 v242, 0
    v_mov_b32 v243, 0
    v_mov_b32 v244, 0
    v_mov_b32 v245, 0
    v_mov_b32 v246, 0
    v_mov_b32 v247, 0
    v_mov_b32 v248, 0
    v_mov_b32 v249, 0
    v_mov_b32 v250, 0
    v_mov_b32 v251, 0
    v_mov_b32 v252, 0
    v_mov_b32 v253, 0
    v_mov_b32 v254, 0
    v_mov_b32 v255, 0
    v_and_b32 v32, 15, v11
    v_lshrrev_b32 v33, 4, v11
    s_lshr_b32 s58, s3, 2
    s_lshl_b32 s58, s58, 7
    v_add_u32 v34, s58, v32
    v_lshlrev_b32 v34, 7, v34
    v_add_u32 v34, 65536, v34
    v_lshrrev_b32 v35, 1, v32
    v_xor_b32 v35, v35, v33
    v_lshl_add_u32 v2, v35, 4, v34
    v_xor_b32 v3, 64, v2
    v_add_u32 v4, 65536, v2
    v_add_u32 v5, 65536, v3
    v_bfe_u32 v34, v11, 2, 2
    v_lshl_add_u32 v35, v33, 3, v34
    v_lshlrev_b32 v35, 8, v35
    v_and_b32 v33, 1, v33
    v_lshl_or_b32 v34, v33, 2, v34
    s_and_b32 s59, s3, 3
    s_lshl_b32 s59, s59, 1
    v_xor_b32 v34, s59, v34
    v_lshl_add_u32 v35, v34, 5, v35
    v_and_b32 v34, 3, v11
    v_lshl_add_u32 v6, v34, 3, v35
    v_xor_b32 v7, 32, v6
    s_waitcnt vmcnt(14)
    s_barrier
    s_cmp_ge_u32 s3, 4
    s_cbranch_scc1 M_loopB

    s_setprio 1
    ds_read_b128 v[32:35], v2 offset:0
    ds_read_b64_tr_b16 v[64:65], v6 offset:0
    ds_read_b64_tr_b16 v[66:67], v6 offset:1024
    ds_read_b64_tr_b16 v[68:69], v7 offset:0
    ds_read_b64_tr_b16 v[70:71], v7 offset:1024
    ds_read_b64_tr_b16 v[72:73], v6 offset:8192
    ds_read_b64_tr_b16 v[74:75], v6 offset:9216
    ds_read_b64_tr_b16 v[76:77], v7 offset:8192
    ds_read_b64_tr_b16 v[78:79], v7 offset:9216
    ds_read_b128 v[36:39], v2 offset:2048
    ds_read_b128 v[40:43], v2 offset:4096
    ds_read_b128 v[44:47], v2 offset:6144
    ds_read_b128 v[48:51], v2 offset:8192
    ds_read_b128 v[52:55], v2 offset:10240
    ds_read_b128 v[56:59], v2 offset:12288
    ds_read_b128 v[60:63], v2 offset:14336
    s_waitcnt lgkmcnt(0)
    v_mfma_f32_16x16x32_bf16 v[128:131], v[64:67], v[32:35], v[128:131]
    v_mfma_f32_16x16x32_bf16 v[132:135], v[68:71], v[32:35], v[132:135]
    v_mfma_f32_16x16x32_bf16 v[136:139], v[72:75], v[32:35], v[136:139]
    v_mfma_f32_16x16x32_bf16 v[140:143], v[76:79], v[32:35], v[140:143]
    v_mfma_f32_16x16x32_bf16 v[156:159], v[76:79], v[36:39], v[156:159]
    v_mfma_f32_16x16x32_bf16 v[152:155], v[72:75], v[36:39], v[152:155]
    v_mfma_f32_16x16x32_bf16 v[148:151], v[68:71], v[36:39], v[148:151]
    v_mfma_f32_16x16x32_bf16 v[144:147], v[64:67], v[36:39], v[144:147]
    v_mfma_f32_16x16x32_bf16 v[160:163], v[64:67], v[40:43], v[160:163]
    v_mfma_f32_16x16x32_bf16 v[164:167], v[68:71], v[40:43], v[164:167]
    v_mfma_f32_16x16x32_bf16 v[168:171], v[72:75], v[40:43], v[168:171]
    v_mfma_f32_16x16x32_bf16 v[172:175], v[76:79], v[40:43], v[172:175]
    v_mfma_f32_16x16x32_bf16 v[188:191], v[76:79], v[44:47], v[188:191]
    v_mfma_f32_16x16x32_bf16 v[184:187], v[72:75], v[44:47], v[184:187]
    v_mfma_f32_16x16x32_bf16 v[180:183], v[68:71], v[44:47], v[180:183]
    v_mfma_f32_16x16x32_bf16 v[176:179], v[64:67], v[44:47], v[176:179]
    v_mfma_f32_16x16x32_bf16 v[192:195], v[64:67], v[48:51], v[192:195]
    v_mfma_f32_16x16x32_bf16 v[196:199], v[68:71], v[48:51], v[196:199]
    v_mfma_f32_16x16x32_bf16 v[200:203], v[72:75], v[48:51], v[200:203]
    v_mfma_f32_16x16x32_bf16 v[204:207], v[76:79], v[48:51], v[204:207]
    v_mfma_f32_16x16x32_bf16 v[220:223], v[76:79], v[52:55], v[220:223]
    v_mfma_f32_16x16x32_bf16 v[216:219], v[72:75], v[52:55], v[216:219]
    v_mfma_f32_16x16x32_bf16 v[212:215], v[68:71], v[52:55], v[212:215]
    v_mfma_f32_16x16x32_bf16 v[208:211], v[64:67], v[52:55], v[208:211]
    v_mfma_f32_16x16x32_bf16 v[224:227], v[64:67], v[56:59], v[224:227]
    v_mfma_f32_16x16x32_bf16 v[228:231], v[68:71], v[56:59], v[228:231]
    v_mfma_f32_16x16x32_bf16 v[232:235], v[72:75], v[56:59], v[232:235]
    v_mfma_f32_16x16x32_bf16 v[236:239], v[76:79], v[56:59], v[236:239]
    v_mfma_f32_16x16x32_bf16 v[252:255], v[76:79], v[60:63], v[252:255]
    v_mfma_f32_16x16x32_bf16 v[248:251], v[72:75], v[60:63], v[248:251]
    v_mfma_f32_16x16x32_bf16 v[244:247], v[68:71], v[60:63], v[244:247]
    v_mfma_f32_16x16x32_bf16 v[240:243], v[64:67], v[60:63], v[240:243]
    s_waitcnt vmcnt(12)
    s_barrier
    s_waitcnt vmcnt(10)
    s_barrier
    ds_read_b128 v[80:83], v3 offset:0
    ds_read_b64_tr_b16 v[112:113], v6 offset:16384
    s_add_u32 m0, s24, 0
    s_add_u32 s30, s32, 128
    s_and_b32 s30, s30, 1023
    s_mul_i32 s30, s30, 7168
    buffer_load_dwordx4 v9, s[12:15], s30 offen lds
    ds_read_b64_tr_b16 v[114:115], v6 offset:17408
    ds_read_b64_tr_b16 v[116:117], v7 offset:16384
    ds_read_b64_tr_b16 v[118:119], v7 offset:17408
    ds_read_b64_tr_b16 v[120:121], v6 offset:24576
    s_add_u32 m0, s24, 8192
    s_nop 0
    buffer_load_dwordx4 v9, s[16:19], s30 offen lds
    ds_read_b64_tr_b16 v[122:123], v6 offset:25600
    ds_read_b64_tr_b16 v[124:125], v7 offset:24576
    ds_read_b64_tr_b16 v[126:127], v7 offset:25600
    ds_read_b128 v[84:87], v3 offset:2048
    s_add_u32 m0, s24, 147456
    s_add_u32 s31, s33, 256
    s_and_b32 s31, s31, 2047
    s_add_u32 s31, s31, 262144
    buffer_load_dwordx4 v8, s[8:11], s31 offen lds
    ds_read_b128 v[88:91], v3 offset:4096
    ds_read_b128 v[92:95], v3 offset:6144
    ds_read_b128 v[96:99], v3 offset:8192
    ds_read_b128 v[100:103], v3 offset:10240
    s_add_u32 m0, s24, 155648
    s_add_u32 s31, s33, 256
    s_and_b32 s31, s31, 2047
    s_add_u32 s31, s31, 393216
    buffer_load_dwordx4 v8, s[8:11], s31 offen lds
    ds_read_b128 v[104:107], v3 offset:12288
    ds_read_b128 v[108:111], v3 offset:14336
    s_mov_b64 exec, 3
    buffer_store_dword v20, v21, s[20:23], 0 offen sc1
    s_mov_b64 exec, -1
    s_waitcnt vmcnt(9) lgkmcnt(0)
    s_barrier
    v_mfma_f32_16x16x32_bf16 v[128:131], v[112:115], v[80:83], v[128:131]
    v_mfma_f32_16x16x32_bf16 v[132:135], v[116:119], v[80:83], v[132:135]
    v_mfma_f32_16x16x32_bf16 v[136:139], v[120:123], v[80:83], v[136:139]
    v_mfma_f32_16x16x32_bf16 v[140:143], v[124:127], v[80:83], v[140:143]
    v_mfma_f32_16x16x32_bf16 v[156:159], v[124:127], v[84:87], v[156:159]
    v_mfma_f32_16x16x32_bf16 v[152:155], v[120:123], v[84:87], v[152:155]
    v_mfma_f32_16x16x32_bf16 v[148:151], v[116:119], v[84:87], v[148:151]
    v_mfma_f32_16x16x32_bf16 v[144:147], v[112:115], v[84:87], v[144:147]
    v_mfma_f32_16x16x32_bf16 v[160:163], v[112:115], v[88:91], v[160:163]
    v_mfma_f32_16x16x32_bf16 v[164:167], v[116:119], v[88:91], v[164:167]
    v_mfma_f32_16x16x32_bf16 v[168:171], v[120:123], v[88:91], v[168:171]
    v_mfma_f32_16x16x32_bf16 v[172:175], v[124:127], v[88:91], v[172:175]
    v_mfma_f32_16x16x32_bf16 v[188:191], v[124:127], v[92:95], v[188:191]
    v_mfma_f32_16x16x32_bf16 v[184:187], v[120:123], v[92:95], v[184:187]
    v_mfma_f32_16x16x32_bf16 v[180:183], v[116:119], v[92:95], v[180:183]
    v_mfma_f32_16x16x32_bf16 v[176:179], v[112:115], v[92:95], v[176:179]
    v_mfma_f32_16x16x32_bf16 v[192:195], v[112:115], v[96:99], v[192:195]
    v_mfma_f32_16x16x32_bf16 v[196:199], v[116:119], v[96:99], v[196:199]
    v_mfma_f32_16x16x32_bf16 v[200:203], v[120:123], v[96:99], v[200:203]
    v_mfma_f32_16x16x32_bf16 v[204:207], v[124:127], v[96:99], v[204:207]
    v_mfma_f32_16x16x32_bf16 v[220:223], v[124:127], v[100:103], v[220:223]
    v_mfma_f32_16x16x32_bf16 v[216:219], v[120:123], v[100:103], v[216:219]
    v_mfma_f32_16x16x32_bf16 v[212:215], v[116:119], v[100:103], v[212:215]
    v_mfma_f32_16x16x32_bf16 v[208:211], v[112:115], v[100:103], v[208:211]
    v_mfma_f32_16x16x32_bf16 v[224:227], v[112:115], v[104:107], v[224:227]
    v_mfma_f32_16x16x32_bf16 v[228:231], v[116:119], v[104:107], v[228:231]
    v_mfma_f32_16x16x32_bf16 v[232:235], v[120:123], v[104:107], v[232:235]
    v_mfma_f32_16x16x32_bf16 v[236:239], v[124:127], v[104:107], v[236:239]
    v_mfma_f32_16x16x32_bf16 v[252:255], v[124:127], v[108:111], v[252:255]
    v_mfma_f32_16x16x32_bf16 v[248:251], v[120:123], v[108:111], v[248:251]
    v_mfma_f32_16x16x32_bf16 v[244:247], v[116:119], v[108:111], v[244:247]
    v_mfma_f32_16x16x32_bf16 v[240:243], v[112:115], v[108:111], v[240:243]
    ds_read_b128 v[32:35], v2 offset:32768
    ds_read_b64_tr_b16 v[64:65], v6 offset:32768
    s_add_u32 m0, s24, 16384
    s_add_u32 s30, s32, 160
    s_and_b32 s30, s30, 1023
    s_mul_i32 s30, s30, 7168
    buffer_load_dwordx4 v9, s[12:15], s30 offen lds
    ds_read_b64_tr_b16 v[66:67], v6 offset:33792
    ds_read_b64_tr_b16 v[68:69], v7 offset:32768
    ds_read_b64_tr_b16 v[70:71], v7 offset:33792
    ds_read_b64_tr_b16 v[72:73], v6 offset:40960
    s_add_u32 m0, s24, 24576
    s_nop 0
    buffer_load_dwordx4 v9, s[16:19], s30 offen lds
    ds_read_b64_tr_b16 v[74:75], v6 offset:41984
    ds_read_b64_tr_b16 v[76:77], v7 offset:40960
    ds_read_b64_tr_b16 v[78:79], v7 offset:41984
    ds_read_b128 v[36:39], v2 offset:34816
    s_add_u32 m0, s24, 65536
    s_add_u32 s31, s33, 384
    s_and_b32 s31, s31, 2047
    s_add_u32 s31, s31, 0
    buffer_load_dwordx4 v8, s[8:11], s31 offen lds
    ds_read_b128 v[40:43], v2 offset:36864
    ds_read_b128 v[44:47], v2 offset:38912
    ds_read_b128 v[48:51], v2 offset:40960
    ds_read_b128 v[52:55], v2 offset:43008
    s_add_u32 m0, s24, 73728
    s_add_u32 s31, s33, 384
    s_and_b32 s31, s31, 2047
    s_add_u32 s31, s31, 131072
    buffer_load_dwordx4 v8, s[8:11], s31 offen lds
    ds_read_b128 v[56:59], v2 offset:45056
    ds_read_b128 v[60:63], v2 offset:47104
    s_waitcnt vmcnt(9) lgkmcnt(0)
    s_barrier
    v_mfma_f32_16x16x32_bf16 v[128:131], v[64:67], v[32:35], v[128:131]
    v_mfma_f32_16x16x32_bf16 v[132:135], v[68:71], v[32:35], v[132:135]
    v_mfma_f32_16x16x32_bf16 v[136:139], v[72:75], v[32:35], v[136:139]
    v_mfma_f32_16x16x32_bf16 v[140:143], v[76:79], v[32:35], v[140:143]
    v_mfma_f32_16x16x32_bf16 v[156:159], v[76:79], v[36:39], v[156:159]
    v_mfma_f32_16x16x32_bf16 v[152:155], v[72:75], v[36:39], v[152:155]
    v_mfma_f32_16x16x32_bf16 v[148:151], v[68:71], v[36:39], v[148:151]
    v_mfma_f32_16x16x32_bf16 v[144:147], v[64:67], v[36:39], v[144:147]
    v_mfma_f32_16x16x32_bf16 v[160:163], v[64:67], v[40:43], v[160:163]
    v_mfma_f32_16x16x32_bf16 v[164:167], v[68:71], v[40:43], v[164:167]
    v_mfma_f32_16x16x32_bf16 v[168:171], v[72:75], v[40:43], v[168:171]
    v_mfma_f32_16x16x32_bf16 v[172:175], v[76:79], v[40:43], v[172:175]
    v_mfma_f32_16x16x32_bf16 v[188:191], v[76:79], v[44:47], v[188:191]
    v_mfma_f32_16x16x32_bf16 v[184:187], v[72:75], v[44:47], v[184:187]
    v_mfma_f32_16x16x32_bf16 v[180:183], v[68:71], v[44:47], v[180:183]
    v_mfma_f32_16x16x32_bf16 v[176:179], v[64:67], v[44:47], v[176:179]
    v_mfma_f32_16x16x32_bf16 v[192:195], v[64:67], v[48:51], v[192:195]
    v_mfma_f32_16x16x32_bf16 v[196:199], v[68:71], v[48:51], v[196:199]
    v_mfma_f32_16x16x32_bf16 v[200:203], v[72:75], v[48:51], v[200:203]
    v_mfma_f32_16x16x32_bf16 v[204:207], v[76:79], v[48:51], v[204:207]
    v_mfma_f32_16x16x32_bf16 v[220:223], v[76:79], v[52:55], v[220:223]
    v_mfma_f32_16x16x32_bf16 v[216:219], v[72:75], v[52:55], v[216:219]
    v_mfma_f32_16x16x32_bf16 v[212:215], v[68:71], v[52:55], v[212:215]
    v_mfma_f32_16x16x32_bf16 v[208:211], v[64:67], v[52:55], v[208:211]
    v_mfma_f32_16x16x32_bf16 v[224:227], v[64:67], v[56:59], v[224:227]
    v_mfma_f32_16x16x32_bf16 v[228:231], v[68:71], v[56:59], v[228:231]
    v_mfma_f32_16x16x32_bf16 v[232:235], v[72:75], v[56:59], v[232:235]
    v_mfma_f32_16x16x32_bf16 v[236:239], v[76:79], v[56:59], v[236:239]
    v_mfma_f32_16x16x32_bf16 v[252:255], v[76:79], v[60:63], v[252:255]
    v_mfma_f32_16x16x32_bf16 v[248:251], v[72:75], v[60:63], v[248:251]
    v_mfma_f32_16x16x32_bf16 v[244:247], v[68:71], v[60:63], v[244:247]
    v_mfma_f32_16x16x32_bf16 v[240:243], v[64:67], v[60:63], v[240:243]
    ds_read_b128 v[80:83], v3 offset:32768
    ds_read_b64_tr_b16 v[112:113], v6 offset:49152
    s_add_u32 m0, s24, 32768
    s_add_u32 s30, s32, 192
    s_and_b32 s30, s30, 1023
    s_mul_i32 s30, s30, 7168
    buffer_load_dwordx4 v9, s[12:15], s30 offen lds
    ds_read_b64_tr_b16 v[114:115], v6 offset:50176
    ds_read_b64_tr_b16 v[116:117], v7 offset:49152
    ds_read_b64_tr_b16 v[118:119], v7 offset:50176
    ds_read_b64_tr_b16 v[120:121], v6 offset:57344
    s_add_u32 m0, s24, 40960
    s_nop 0
    buffer_load_dwordx4 v9, s[16:19], s30 offen lds
    ds_read_b64_tr_b16 v[122:123], v6 offset:58368
    ds_read_b64_tr_b16 v[124:125], v7 offset:57344
    ds_read_b64_tr_b16 v[126:127], v7 offset:58368
    ds_read_b128 v[84:87], v3 offset:34816
    s_add_u32 m0, s24, 81920
    s_add_u32 s31, s33, 384
    s_and_b32 s31, s31, 2047
    s_add_u32 s31, s31, 262144
    buffer_load_dwordx4 v8, s[8:11], s31 offen lds
    ds_read_b128 v[88:91], v3 offset:36864
    ds_read_b128 v[92:95], v3 offset:38912
    ds_read_b128 v[96:99], v3 offset:40960
    ds_read_b128 v[100:103], v3 offset:43008
    s_add_u32 m0, s24, 90112
    s_add_u32 s31, s33, 384
    s_and_b32 s31, s31, 2047
    s_add_u32 s31, s31, 393216
    buffer_load_dwordx4 v8, s[8:11], s31 offen lds
    ds_read_b128 v[104:107], v3 offset:45056
    ds_read_b128 v[108:111], v3 offset:47104
    v_mov_b32 v12, -1
    v_mov_b32 v13, -1
    v_mov_b32 v14, -1
    v_mov_b32 v15, -1
    s_lshl_b32 s40, s44, 3
    s_add_u32 s40, s40, s45
    s_lshl_b32 s40, s40, 1
    s_add_u32 s40, s40, s46
    s_lshl_b32 s40, s40, 14
    s_lshl_b32 s41, s3, 11
    s_add_u32 s40, s40, s41
    s_add_u32 s40, s40, 37748736
    s_lshl_b32 s43, s2, 14
    s_add_u32 s41, s41, s43
    s_add_u32 s41, s41, 41943040
    buffer_store_dwordx4 v[12:15], v10, s[20:23], s40 offen offset:0 sc1
    s_waitcnt vmcnt(9) lgkmcnt(0)
    s_barrier
    v_mfma_f32_16x16x32_bf16 v[128:131], v[112:115], v[80:83], v[128:131]
    v_mfma_f32_16x16x32_bf16 v[132:135], v[116:119], v[80:83], v[132:135]
    v_mfma_f32_16x16x32_bf16 v[136:139], v[120:123], v[80:83], v[136:139]
    v_mfma_f32_16x16x32_bf16 v[140:143], v[124:127], v[80:83], v[140:143]
    v_mfma_f32_16x16x32_bf16 v[156:159], v[124:127], v[84:87], v[156:159]
    v_mfma_f32_16x16x32_bf16 v[152:155], v[120:123], v[84:87], v[152:155]
    v_mfma_f32_16x16x32_bf16 v[148:151], v[116:119], v[84:87], v[148:151]
    v_mfma_f32_16x16x32_bf16 v[144:147], v[112:115], v[84:87], v[144:147]
    v_mfma_f32_16x16x32_bf16 v[160:163], v[112:115], v[88:91], v[160:163]
    v_mfma_f32_16x16x32_bf16 v[164:167], v[116:119], v[88:91], v[164:167]
    v_mfma_f32_16x16x32_bf16 v[168:171], v[120:123], v[88:91], v[168:171]
    v_mfma_f32_16x16x32_bf16 v[172:175], v[124:127], v[88:91], v[172:175]
    v_mfma_f32_16x16x32_bf16 v[188:191], v[124:127], v[92:95], v[188:191]
    v_mfma_f32_16x16x32_bf16 v[184:187], v[120:123], v[92:95], v[184:187]
    v_mfma_f32_16x16x32_bf16 v[180:183], v[116:119], v[92:95], v[180:183]
    v_mfma_f32_16x16x32_bf16 v[176:179], v[112:115], v[92:95], v[176:179]
    v_mfma_f32_16x16x32_bf16 v[192:195], v[112:115], v[96:99], v[192:195]
    v_mfma_f32_16x16x32_bf16 v[196:199], v[116:119], v[96:99], v[196:199]
    v_mfma_f32_16x16x32_bf16 v[200:203], v[120:123], v[96:99], v[200:203]
    v_mfma_f32_16x16x32_bf16 v[204:207], v[124:127], v[96:99], v[204:207]
    v_mfma_f32_16x16x32_bf16 v[220:223], v[124:127], v[100:103], v[220:223]
    v_mfma_f32_16x16x32_bf16 v[216:219], v[120:123], v[100:103], v[216:219]
    v_mfma_f32_16x16x32_bf16 v[212:215], v[116:119], v[100:103], v[212:215]
    v_mfma_f32_16x16x32_bf16 v[208:211], v[112:115], v[100:103], v[208:211]
    v_mfma_f32_16x16x32_bf16 v[224:227], v[112:115], v[104:107], v[224:227]
    v_mfma_f32_16x16x32_bf16 v[228:231], v[116:119], v[104:107], v[228:231]
    v_mfma_f32_16x16x32_bf16 v[232:235], v[120:123], v[104:107], v[232:235]
    v_mfma_f32_16x16x32_bf16 v[236:239], v[124:127], v[104:107], v[236:239]
    v_mfma_f32_16x16x32_bf16 v[252:255], v[124:127], v[108:111], v[252:255]
    v_mfma_f32_16x16x32_bf16 v[248:251], v[120:123], v[108:111], v[248:251]
    v_mfma_f32_16x16x32_bf16 v[244:247], v[116:119], v[108:111], v[244:247]
    v_mfma_f32_16x16x32_bf16 v[240:243], v[112:115], v[108:111], v[240:243]
    ds_read_b128 v[32:35], v4 offset:0
    ds_read_b64_tr_b16 v[64:65], v6 offset:0
    s_add_u32 m0, s24, 49152
    s_add_u32 s30, s32, 224
    s_and_b32 s30, s30, 1023
    s_mul_i32 s30, s30, 7168
    buffer_load_dwordx4 v9, s[12:15], s30 offen lds
    ds_read_b64_tr_b16 v[66:67], v6 offset:1024
    ds_read_b64_tr_b16 v[68:69], v7 offset:0
    ds_read_b64_tr_b16 v[70:71], v7 offset:1024
    ds_read_b64_tr_b16 v[72:73], v6 offset:8192
    s_add_u32 m0, s24, 57344
    s_nop 0
    buffer_load_dwordx4 v9, s[16:19], s30 offen lds
    ds_read_b64_tr_b16 v[74:75], v6 offset:9216
    ds_read_b64_tr_b16 v[76:77], v7 offset:8192
    ds_read_b64_tr_b16 v[78:79], v7 offset:9216
    ds_read_b128 v[36:39], v4 offset:2048
    s_add_u32 m0, s24, 98304
    s_add_u32 s31, s33, 512
    s_and_b32 s31, s31, 2047
    s_add_u32 s31, s31, 0
    buffer_load_dwordx4 v8, s[8:11], s31 offen lds
    ds_read_b128 v[40:43], v4 offset:4096
    ds_read_b128 v[44:47], v4 offset:6144
    ds_read_b128 v[48:51], v4 offset:8192
    ds_read_b128 v[52:55], v4 offset:10240
    s_add_u32 m0, s24, 106496
    s_add_u32 s31, s33, 512
    s_and_b32 s31, s31, 2047
    s_add_u32 s31, s31, 131072
    buffer_load_dwordx4 v8, s[8:11], s31 offen lds
    ds_read_b128 v[56:59], v4 offset:12288
    ds_read_b128 v[60:63], v4 offset:14336
    s_waitcnt vmcnt(9) lgkmcnt(0)
    s_barrier
    v_mfma_f32_16x16x32_bf16 v[128:131], v[64:67], v[32:35], v[128:131]
    v_mfma_f32_16x16x32_bf16 v[132:135], v[68:71], v[32:35], v[132:135]
    v_mfma_f32_16x16x32_bf16 v[136:139], v[72:75], v[32:35], v[136:139]
    v_mfma_f32_16x16x32_bf16 v[140:143], v[76:79], v[32:35], v[140:143]
    v_mfma_f32_16x16x32_bf16 v[156:159], v[76:79], v[36:39], v[156:159]
    v_mfma_f32_16x16x32_bf16 v[152:155], v[72:75], v[36:39], v[152:155]
    v_mfma_f32_16x16x32_bf16 v[148:151], v[68:71], v[36:39], v[148:151]
    v_mfma_f32_16x16x32_bf16 v[144:147], v[64:67], v[36:39], v[144:147]
    v_mfma_f32_16x16x32_bf16 v[160:163], v[64:67], v[40:43], v[160:163]
    v_mfma_f32_16x16x32_bf16 v[164:167], v[68:71], v[40:43], v[164:167]
    v_mfma_f32_16x16x32_bf16 v[168:171], v[72:75], v[40:43], v[168:171]
    v_mfma_f32_16x16x32_bf16 v[172:175], v[76:79], v[40:43], v[172:175]
    v_mfma_f32_16x16x32_bf16 v[188:191], v[76:79], v[44:47], v[188:191]
    v_mfma_f32_16x16x32_bf16 v[184:187], v[72:75], v[44:47], v[184:187]
    v_mfma_f32_16x16x32_bf16 v[180:183], v[68:71], v[44:47], v[180:183]
    v_mfma_f32_16x16x32_bf16 v[176:179], v[64:67], v[44:47], v[176:179]
    v_mfma_f32_16x16x32_bf16 v[192:195], v[64:67], v[48:51], v[192:195]
    v_mfma_f32_16x16x32_bf16 v[196:199], v[68:71], v[48:51], v[196:199]
    v_mfma_f32_16x16x32_bf16 v[200:203], v[72:75], v[48:51], v[200:203]
    v_mfma_f32_16x16x32_bf16 v[204:207], v[76:79], v[48:51], v[204:207]
    v_mfma_f32_16x16x32_bf16 v[220:223], v[76:79], v[52:55], v[220:223]
    v_mfma_f32_16x16x32_bf16 v[216:219], v[72:75], v[52:55], v[216:219]
    v_mfma_f32_16x16x32_bf16 v[212:215], v[68:71], v[52:55], v[212:215]
    v_mfma_f32_16x16x32_bf16 v[208:211], v[64:67], v[52:55], v[208:211]
    v_mfma_f32_16x16x32_bf16 v[224:227], v[64:67], v[56:59], v[224:227]
    v_mfma_f32_16x16x32_bf16 v[228:231], v[68:71], v[56:59], v[228:231]
    v_mfma_f32_16x16x32_bf16 v[232:235], v[72:75], v[56:59], v[232:235]
    v_mfma_f32_16x16x32_bf16 v[236:239], v[76:79], v[56:59], v[236:239]
    v_mfma_f32_16x16x32_bf16 v[252:255], v[76:79], v[60:63], v[252:255]
    v_mfma_f32_16x16x32_bf16 v[248:251], v[72:75], v[60:63], v[248:251]
    v_mfma_f32_16x16x32_bf16 v[244:247], v[68:71], v[60:63], v[244:247]
    v_mfma_f32_16x16x32_bf16 v[240:243], v[64:67], v[60:63], v[240:243]
    ds_read_b128 v[80:83], v5 offset:0
    ds_read_b64_tr_b16 v[112:113], v6 offset:16384
    s_add_u32 m0, s24, 0
    s_add_u32 s30, s32, 256
    s_and_b32 s30, s30, 1023
    s_mul_i32 s30, s30, 7168
    buffer_load_dwordx4 v9, s[12:15], s30 offen lds
    ds_read_b64_tr_b16 v[114:115], v6 offset:17408
    ds_read_b64_tr_b16 v[116:117], v7 offset:16384
    ds_read_b64_tr_b16 v[118:119], v7 offset:17408
    ds_read_b64_tr_b16 v[120:121], v6 offset:24576
    s_add_u32 m0, s24, 8192
    s_nop 0
    buffer_load_dwordx4 v9, s[16:19], s30 offen lds
    ds_read_b64_tr_b16 v[122:123], v6 offset:25600
    ds_read_b64_tr_b16 v[124:125], v7 offset:24576
    ds_read_b64_tr_b16 v[126:127], v7 offset:25600
    ds_read_b128 v[84:87], v5 offset:2048
    s_add_u32 m0, s24, 114688
    s_add_u32 s31, s33, 512
    s_and_b32 s31, s31, 2047
    s_add_u32 s31, s31, 262144
    buffer_load_dwordx4 v8, s[8:11], s31 offen lds
    ds_read_b128 v[88:91], v5 offset:4096
    ds_read_b128 v[92:95], v5 offset:6144
    ds_read_b128 v[96:99], v5 offset:8192
    ds_read_b128 v[100:103], v5 offset:10240
    s_add_u32 m0, s24, 122880
    s_add_u32 s31, s33, 512
    s_and_b32 s31, s31, 2047
    s_add_u32 s31, s31, 393216
    buffer_load_dwordx4 v8, s[8:11], s31 offen lds
    ds_read_b128 v[104:107], v5 offset:12288
    ds_read_b128 v[108:111], v5 offset:14336
    s_cmp_lg_u32 s3, 0
    s_cbranch_scc1 M_pfA4
    buffer_load_dword v1, v31, s[96:99], s35 offen
M_pfA4:
    s_waitcnt vmcnt(8) lgkmcnt(0)
    s_barrier
    v_mfma_f32_16x16x32_bf16 v[128:131], v[112:115], v[80:83], v[128:131]
    v_mfma_f32_16x16x32_bf16 v[132:135], v[116:119], v[80:83], v[132:135]
    v_mfma_f32_16x16x32_bf16 v[136:139], v[120:123], v[80:83], v[136:139]
    v_mfma_f32_16x16x32_bf16 v[140:143], v[124:127], v[80:83], v[140:143]
    v_mfma_f32_16x16x32_bf16 v[156:159], v[124:127], v[84:87], v[156:159]
    v_mfma_f32_16x16x32_bf16 v[152:155], v[120:123], v[84:87], v[152:155]
    v_mfma_f32_16x16x32_bf16 v[148:151], v[116:119], v[84:87], v[148:151]
    v_mfma_f32_16x16x32_bf16 v[144:147], v[112:115], v[84:87], v[144:147]
    v_mfma_f32_16x16x32_bf16 v[160:163], v[112:115], v[88:91], v[160:163]
    v_mfma_f32_16x16x32_bf16 v[164:167], v[116:119], v[88:91], v[164:167]
    v_mfma_f32_16x16x32_bf16 v[168:171], v[120:123], v[88:91], v[168:171]
    v_mfma_f32_16x16x32_bf16 v[172:175], v[124:127], v[88:91], v[172:175]
    v_mfma_f32_16x16x32_bf16 v[188:191], v[124:127], v[92:95], v[188:191]
    v_mfma_f32_16x16x32_bf16 v[184:187], v[120:123], v[92:95], v[184:187]
    v_mfma_f32_16x16x32_bf16 v[180:183], v[116:119], v[92:95], v[180:183]
    v_mfma_f32_16x16x32_bf16 v[176:179], v[112:115], v[92:95], v[176:179]
    v_mfma_f32_16x16x32_bf16 v[192:195], v[112:115], v[96:99], v[192:195]
    v_mfma_f32_16x16x32_bf16 v[196:199], v[116:119], v[96:99], v[196:199]
    v_mfma_f32_16x16x32_bf16 v[200:203], v[120:123], v[96:99], v[200:203]
    v_mfma_f32_16x16x32_bf16 v[204:207], v[124:127], v[96:99], v[204:207]
    v_mfma_f32_16x16x32_bf16 v[220:223], v[124:127], v[100:103], v[220:223]
    v_mfma_f32_16x16x32_bf16 v[216:219], v[120:123], v[100:103], v[216:219]
    v_mfma_f32_16x16x32_bf16 v[212:215], v[116:119], v[100:103], v[212:215]
    v_mfma_f32_16x16x32_bf16 v[208:211], v[112:115], v[100:103], v[208:211]
    v_mfma_f32_16x16x32_bf16 v[224:227], v[112:115], v[104:107], v[224:227]
    v_mfma_f32_16x16x32_bf16 v[228:231], v[116:119], v[104:107], v[228:231]
    v_mfma_f32_16x16x32_bf16 v[232:235], v[120:123], v[104:107], v[232:235]
    v_mfma_f32_16x16x32_bf16 v[236:239], v[124:127], v[104:107], v[236:239]
    v_mfma_f32_16x16x32_bf16 v[252:255], v[124:127], v[108:111], v[252:255]
    v_mfma_f32_16x16x32_bf16 v[248:251], v[120:123], v[108:111], v[248:251]
    v_mfma_f32_16x16x32_bf16 v[244:247], v[116:119], v[108:111], v[244:247]
    v_mfma_f32_16x16x32_bf16 v[240:243], v[112:115], v[108:111], v[240:243]
    ds_read_b128 v[32:35], v2 offset:0
    ds_read_b64_tr_b16 v[64:65], v6 offset:32768
    s_add_u32 m0, s24, 16384
    s_add_u32 s30, s32, 288
    s_and_b32 s30, s30, 1023
    s_mul_i32 s30, s30, 7168
    buffer_load_dwordx4 v9, s[12:15], s30 offen lds
    ds_read_b64_tr_b16 v[66:67], v6 offset:33792
    ds_read_b64_tr_b16 v[68:69], v7 offset:32768
    ds_read_b64_tr_b16 v[70:71], v7 offset:33792
    ds_read_b64_tr_b16 v[72:73], v6 offset:40960
    s_add_u32 m0, s24, 24576
    s_nop 0
    buffer_load_dwordx4 v9, s[16:19], s30 offen lds
    ds_read_b64_tr_b16 v[74:75], v6 offset:41984
    ds_read_b64_tr_b16 v[76:77], v7 offset:40960
    ds_read_b64_tr_b16 v[78:79], v7 offset:41984
    ds_read_b128 v[36:39], v2 offset:2048
    s_add_u32 m0, s24, 131072
    s_add_u32 s31, s33, 640
    s_and_b32 s31, s31, 2047
    s_add_u32 s31, s31, 0
    buffer_load_dwordx4 v8, s[8:11], s31 offen lds
    ds_read_b128 v[40:43], v2 offset:4096
    ds_read_b128 v[44:47], v2 offset:6144
    ds_read_b128 v[48:51], v2 offset:8192
    ds_read_b128 v[52:55], v2 offset:10240
    s_add_u32 m0, s24, 139264
    s_add_u32 s31, s33, 640
    s_and_b32 s31, s31, 2047
    s_add_u32 s31, s31, 131072
    buffer_load_dwordx4 v8, s[8:11], s31 offen lds
    ds_read_b128 v[56:59], v2 offset:12288
    ds_read_b128 v[60:63], v2 offset:14336
    buffer_store_dwordx4 v[12:15], v10, s[20:23], s40 offen offset:1024 sc1
    s_waitcnt vmcnt(9) lgkmcnt(0)
    s_barrier
    v_mfma_f32_16x16x32_bf16 v[128:131], v[64:67], v[32:35], v[128:131]
    v_mfma_f32_16x16x32_bf16 v[132:135], v[68:71], v[32:35], v[132:135]
    v_mfma_f32_16x16x32_bf16 v[136:139], v[72:75], v[32:35], v[136:139]
    v_mfma_f32_16x16x32_bf16 v[140:143], v[76:79], v[32:35], v[140:143]
    v_mfma_f32_16x16x32_bf16 v[156:159], v[76:79], v[36:39], v[156:159]
    v_mfma_f32_16x16x32_bf16 v[152:155], v[72:75], v[36:39], v[152:155]
    v_mfma_f32_16x16x32_bf16 v[148:151], v[68:71], v[36:39], v[148:151]
    v_mfma_f32_16x16x32_bf16 v[144:147], v[64:67], v[36:39], v[144:147]
    v_mfma_f32_16x16x32_bf16 v[160:163], v[64:67], v[40:43], v[160:163]
    v_mfma_f32_16x16x32_bf16 v[164:167], v[68:71], v[40:43], v[164:167]
    v_mfma_f32_16x16x32_bf16 v[168:171], v[72:75], v[40:43], v[168:171]
    v_mfma_f32_16x16x32_bf16 v[172:175], v[76:79], v[40:43], v[172:175]
    v_mfma_f32_16x16x32_bf16 v[188:191], v[76:79], v[44:47], v[188:191]
    v_mfma_f32_16x16x32_bf16 v[184:187], v[72:75], v[44:47], v[184:187]
    v_mfma_f32_16x16x32_bf16 v[180:183], v[68:71], v[44:47], v[180:183]
    v_mfma_f32_16x16x32_bf16 v[176:179], v[64:67], v[44:47], v[176:179]
    v_mfma_f32_16x16x32_bf16 v[192:195], v[64:67], v[48:51], v[192:195]
    v_mfma_f32_16x16x32_bf16 v[196:199], v[68:71], v[48:51], v[196:199]
    v_mfma_f32_16x16x32_bf16 v[200:203], v[72:75], v[48:51], v[200:203]
    v_mfma_f32_16x16x32_bf16 v[204:207], v[76:79], v[48:51], v[204:207]
    v_mfma_f32_16x16x32_bf16 v[220:223], v[76:79], v[52:55], v[220:223]
    v_mfma_f32_16x16x32_bf16 v[216:219], v[72:75], v[52:55], v[216:219]
    v_mfma_f32_16x16x32_bf16 v[212:215], v[68:71], v[52:55], v[212:215]
    v_mfma_f32_16x16x32_bf16 v[208:211], v[64:67], v[52:55], v[208:211]
    v_mfma_f32_16x16x32_bf16 v[224:227], v[64:67], v[56:59], v[224:227]
    v_mfma_f32_16x16x32_bf16 v[228:231], v[68:71], v[56:59], v[228:231]
    v_mfma_f32_16x16x32_bf16 v[232:235], v[72:75], v[56:59], v[232:235]
    v_mfma_f32_16x16x32_bf16 v[236:239], v[76:79], v[56:59], v[236:239]
    v_mfma_f32_16x16x32_bf16 v[252:255], v[76:79], v[60:63], v[252:255]
    v_mfma_f32_16x16x32_bf16 v[248:251], v[72:75], v[60:63], v[248:251]
    v_mfma_f32_16x16x32_bf16 v[244:247], v[68:71], v[60:63], v[244:247]
    v_mfma_f32_16x16x32_bf16 v[240:243], v[64:67], v[60:63], v[240:243]
    ds_read_b128 v[80:83], v3 offset:0
    ds_read_b64_tr_b16 v[112:113], v6 offset:49152
    s_add_u32 m0, s24, 32768
    s_add_u32 s30, s32, 320
    s_and_b32 s30, s30, 1023
    s_mul_i32 s30, s30, 7168
    buffer_load_dwordx4 v9, s[12:15], s30 offen lds
    ds_read_b64_tr_b16 v[114:115], v6 offset:50176
    ds_read_b64_tr_b16 v[116:117], v7 offset:49152
    ds_read_b64_tr_b16 v[118:119], v7 offset:50176
    ds_read_b64_tr_b16 v[120:121], v6 offset:57344
    s_add_u32 m0, s24, 40960
    s_nop 0
    buffer_load_dwordx4 v9, s[16:19], s30 offen lds
    ds_read_b64_tr_b16 v[122:123], v6 offset:58368
    ds_read_b64_tr_b16 v[124:125], v7 offset:57344
    ds_read_b64_tr_b16 v[126:127], v7 offset:58368
    ds_read_b128 v[84:87], v3 offset:2048
    s_add_u32 m0, s24, 147456
    s_add_u32 s31, s33, 640
    s_and_b32 s31, s31, 2047
    s_add_u32 s31, s31, 262144
    buffer_load_dwordx4 v8, s[8:11], s31 offen lds
    ds_read_b128 v[88:91], v3 offset:4096
    ds_read_b128 v[92:95], v3 offset:6144
    ds_read_b128 v[96:99], v3 offset:8192
    ds_read_b128 v[100:103], v3 offset:10240
    s_add_u32 m0, s24, 155648
    s_add_u32 s31, s33, 640
    s_and_b32 s31, s31, 2047
    s_add_u32 s31, s31, 393216
    buffer_load_dwordx4 v8, s[8:11], s31 offen lds
    ds_read_b128 v[104:107], v3 offset:12288
    ds_read_b128 v[108:111], v3 offset:14336
    s_waitcnt vmcnt(9) lgkmcnt(0)
    s_barrier
    v_mfma_f32_16x16x32_bf16 v[128:131], v[112:115], v[80:83], v[128:131]
    v_mfma_f32_16x16x32_bf16 v[132:135], v[116:119], v[80:83], v[132:135]
    v_mfma_f32_16x16x32_bf16 v[136:139], v[120:123], v[80:83], v[136:139]
    v_mfma_f32_16x16x32_bf16 v[140:143], v[124:127], v[80:83], v[140:143]
    v_mfma_f32_16x16x32_bf16 v[156:159], v[124:127], v[84:87], v[156:159]
    v_mfma_f32_16x16x32_bf16 v[152:155], v[120:123], v[84:87], v[152:155]
    v_mfma_f32_16x16x32_bf16 v[148:151], v[116:119], v[84:87], v[148:151]
    v_mfma_f32_16x16x32_bf16 v[144:147], v[112:115], v[84:87], v[144:147]
    v_mfma_f32_16x16x32_bf16 v[160:163], v[112:115], v[88:91], v[160:163]
    v_mfma_f32_16x16x32_bf16 v[164:167], v[116:119], v[88:91], v[164:167]
    v_mfma_f32_16x16x32_bf16 v[168:171], v[120:123], v[88:91], v[168:171]
    v_mfma_f32_16x16x32_bf16 v[172:175], v[124:127], v[88:91], v[172:175]
    v_mfma_f32_16x16x32_bf16 v[188:191], v[124:127], v[92:95], v[188:191]
    v_mfma_f32_16x16x32_bf16 v[184:187], v[120:123], v[92:95], v[184:187]
    v_mfma_f32_16x16x32_bf16 v[180:183], v[116:119], v[92:95], v[180:183]
    v_mfma_f32_16x16x32_bf16 v[176:179], v[112:115], v[92:95], v[176:179]
    v_mfma_f32_16x16x32_bf16 v[192:195], v[112:115], v[96:99], v[192:195]
    v_mfma_f32_16x16x32_bf16 v[196:199], v[116:119], v[96:99], v[196:199]
    v_mfma_f32_16x16x32_bf16 v[200:203], v[120:123], v[96:99], v[200:203]
    v_mfma_f32_16x16x32_bf16 v[204:207], v[124:127], v[96:99], v[204:207]
    v_mfma_f32_16x16x32_bf16 v[220:223], v[124:127], v[100:103], v[220:223]
    v_mfma_f32_16x16x32_bf16 v[216:219], v[120:123], v[100:103], v[216:219]
    v_mfma_f32_16x16x32_bf16 v[212:215], v[116:119], v[100:103], v[212:215]
    v_mfma_f32_16x16x32_bf16 v[208:211], v[112:115], v[100:103], v[208:211]
    v_mfma_f32_16x16x32_bf16 v[224:227], v[112:115], v[104:107], v[224:227]
    v_mfma_f32_16x16x32_bf16 v[228:231], v[116:119], v[104:107], v[228:231]
    v_mfma_f32_16x16x32_bf16 v[232:235], v[120:123], v[104:107], v[232:235]
    v_mfma_f32_16x16x32_bf16 v[236:239], v[124:127], v[104:107], v[236:239]
    v_mfma_f32_16x16x32_bf16 v[252:255], v[124:127], v[108:111], v[252:255]
    v_mfma_f32_16x16x32_bf16 v[248:251], v[120:123], v[108:111], v[248:251]
    v_mfma_f32_16x16x32_bf16 v[244:247], v[116:119], v[108:111], v[244:247]
    v_mfma_f32_16x16x32_bf16 v[240:243], v[112:115], v[108:111], v[240:243]
    ds_read_b128 v[32:35], v2 offset:32768
    ds_read_b64_tr_b16 v[64:65], v6 offset:0
    s_add_u32 m0, s24, 49152
    s_add_u32 s30, s32, 352
    s_and_b32 s30, s30, 1023
    s_mul_i32 s30, s30, 7168
    buffer_load_dwordx4 v9, s[12:15], s30 offen lds
    ds_read_b64_tr_b16 v[66:67], v6 offset:1024
    ds_read_b64_tr_b16 v[68:69], v7 offset:0
    ds_read_b64_tr_b16 v[70:71], v7 offset:1024
    ds_read_b64_tr_b16 v[72:73], v6 offset:8192
    s_add_u32 m0, s24, 57344
    s_nop 0
    buffer_load_dwordx4 v9, s[16:19], s30 offen lds
    ds_read_b64_tr_b16 v[74:75], v6 offset:9216
    ds_read_b64_tr_b16 v[76:77], v7 offset:8192
    ds_read_b64_tr_b16 v[78:79], v7 offset:9216
    ds_read_b128 v[36:39], v2 offset:34816
    s_add_u32 m0, s24, 65536
    s_add_u32 s31, s33, 768
    s_and_b32 s31, s31, 2047
    s_add_u32 s31, s31, 0
    buffer_load_dwordx4 v8, s[8:11], s31 offen lds
    ds_read_b128 v[40:43], v2 offset:36864
    ds_read_b128 v[44:47], v2 offset:38912
    ds_read_b128 v[48:51], v2 offset:40960
    ds_read_b128 v[52:55], v2 offset:43008
    s_add_u32 m0, s24, 73728
    s_add_u32 s31, s33, 768
    s_and_b32 s31, s31, 2047
    s_add_u32 s31, s31, 131072
    buffer_load_dwordx4 v8, s[8:11], s31 offen lds
    ds_read_b128 v[56:59], v2 offset:45056
    ds_read_b128 v[60:63], v2 offset:47104
    s_cmp_lg_u32 s3, 1
    s_cbranch_scc1 M_pfA7
    buffer_load_dword v1, v31, s[96:99], s35 offen
M_pfA7:
    s_waitcnt vmcnt(8) lgkmcnt(0)
    s_barrier
    v_mfma_f32_16x16x32_bf16 v[128:131], v[64:67], v[32:35], v[128:131]
    v_mfma_f32_16x16x32_bf16 v[132:135], v[68:71], v[32:35], v[132:135]
    v_mfma_f32_16x16x32_bf16 v[136:139], v[72:75], v[32:35], v[136:139]
    v_mfma_f32_16x16x32_bf16 v[140:143], v[76:79], v[32:35], v[140:143]
    v_mfma_f32_16x16x32_bf16 v[156:159], v[76:79], v[36:39], v[156:159]
    v_mfma_f32_16x16x32_bf16 v[152:155], v[72:75], v[36:39], v[152:155]
    v_mfma_f32_16x16x32_bf16 v[148:151], v[68:71], v[36:39], v[148:151]
    v_mfma_f32_16x16x32_bf16 v[144:147], v[64:67], v[36:39], v[144:147]
    v_mfma_f32_16x16x32_bf16 v[160:163], v[64:67], v[40:43], v[160:163]
    v_mfma_f32_16x16x32_bf16 v[164:167], v[68:71], v[40:43], v[164:167]
    v_mfma_f32_16x16x32_bf16 v[168:171], v[72:75], v[40:43], v[168:171]
    v_mfma_f32_16x16x32_bf16 v[172:175], v[76:79], v[40:43], v[172:175]
    v_mfma_f32_16x16x32_bf16 v[188:191], v[76:79], v[44:47], v[188:191]
    v_mfma_f32_16x16x32_bf16 v[184:187], v[72:75], v[44:47], v[184:187]
    v_mfma_f32_16x16x32_bf16 v[180:183], v[68:71], v[44:47], v[180:183]
    v_mfma_f32_16x16x32_bf16 v[176:179], v[64:67], v[44:47], v[176:179]
    v_mfma_f32_16x16x32_bf16 v[192:195], v[64:67], v[48:51], v[192:195]
    v_mfma_f32_16x16x32_bf16 v[196:199], v[68:71], v[48:51], v[196:199]
    v_mfma_f32_16x16x32_bf16 v[200:203], v[72:75], v[48:51], v[200:203]
    v_mfma_f32_16x16x32_bf16 v[204:207], v[76:79], v[48:51], v[204:207]
    v_mfma_f32_16x16x32_bf16 v[220:223], v[76:79], v[52:55], v[220:223]
    v_mfma_f32_16x16x32_bf16 v[216:219], v[72:75], v[52:55], v[216:219]
    v_mfma_f32_16x16x32_bf16 v[212:215], v[68:71], v[52:55], v[212:215]
    v_mfma_f32_16x16x32_bf16 v[208:211], v[64:67], v[52:55], v[208:211]
    v_mfma_f32_16x16x32_bf16 v[224:227], v[64:67], v[56:59], v[224:227]
    v_mfma_f32_16x16x32_bf16 v[228:231], v[68:71], v[56:59], v[228:231]
    v_mfma_f32_16x16x32_bf16 v[232:235], v[72:75], v[56:59], v[232:235]
    v_mfma_f32_16x16x32_bf16 v[236:239], v[76:79], v[56:59], v[236:239]
    v_mfma_f32_16x16x32_bf16 v[252:255], v[76:79], v[60:63], v[252:255]
    v_mfma_f32_16x16x32_bf16 v[248:251], v[72:75], v[60:63], v[248:251]
    v_mfma_f32_16x16x32_bf16 v[244:247], v[68:71], v[60:63], v[244:247]
    v_mfma_f32_16x16x32_bf16 v[240:243], v[64:67], v[60:63], v[240:243]
    ds_read_b128 v[80:83], v3 offset:32768
    ds_read_b64_tr_b16 v[112:113], v6 offset:16384
    s_add_u32 m0, s24, 0
    s_add_u32 s30, s32, 384
    s_and_b32 s30, s30, 1023
    s_mul_i32 s30, s30, 7168
    buffer_load_dwordx4 v9, s[12:15], s30 offen lds
    ds_read_b64_tr_b16 v[114:115], v6 offset:17408
    ds_read_b64_tr_b16 v[116:117], v7 offset:16384
    ds_read_b64_tr_b16 v[118:119], v7 offset:17408
    ds_read_b64_tr_b16 v[120:121], v6 offset:24576
    s_add_u32 m0, s24, 8192
    s_nop 0
    buffer_load_dwordx4 v9, s[16:19], s30 offen lds
    ds_read_b64_tr_b16 v[122:123], v6 offset:25600
    ds_read_b64_tr_b16 v[124:125], v7 offset:24576
    ds_read_b64_tr_b16 v[126:127], v7 offset:25600
    ds_read_b128 v[84:87], v3 offset:34816
    s_add_u32 m0, s24, 81920
    s_add_u32 s31, s33, 768
    s_and_b32 s31, s31, 2047
    s_add_u32 s31, s31, 262144
    buffer_load_dwordx4 v8, s[8:11], s31 offen lds
    ds_read_b128 v[88:91], v3 offset:36864
    ds_read_b128 v[92:95], v3 offset:38912
    ds_read_b128 v[96:99], v3 offset:40960
    ds_read_b128 v[100:103], v3 offset:43008
    s_add_u32 m0, s24, 90112
    s_add_u32 s31, s33, 768
    s_and_b32 s31, s31, 2047
    s_add_u32 s31, s31, 393216
    buffer_load_dwordx4 v8, s[8:11], s31 offen lds
    ds_read_b128 v[104:107], v3 offset:45056
    ds_read_b128 v[108:111], v3 offset:47104
    buffer_store_dwordx4 v[12:15], v10, s[20:23], s41 offen offset:0 sc1
    s_waitcnt vmcnt(9) lgkmcnt(0)
    s_barrier
    v_mfma_f32_16x16x32_bf16 v[128:131], v[112:115], v[80:83], v[128:131]
    v_mfma_f32_16x16x32_bf16 v[132:135], v[116:119], v[80:83], v[132:135]
    v_mfma_f32_16x16x32_bf16 v[136:139], v[120:123], v[80:83], v[136:139]
    v_mfma_f32_16x16x32_bf16 v[140:143], v[124:127], v[80:83], v[140:143]
    v_mfma_f32_16x16x32_bf16 v[156:159], v[124:127], v[84:87], v[156:159]
    v_mfma_f32_16x16x32_bf16 v[152:155], v[120:123], v[84:87], v[152:155]
    v_mfma_f32_16x16x32_bf16 v[148:151], v[116:119], v[84:87], v[148:151]
    v_mfma_f32_16x16x32_bf16 v[144:147], v[112:115], v[84:87], v[144:147]
    v_mfma_f32_16x16x32_bf16 v[160:163], v[112:115], v[88:91], v[160:163]
    v_mfma_f32_16x16x32_bf16 v[164:167], v[116:119], v[88:91], v[164:167]
    v_mfma_f32_16x16x32_bf16 v[168:171], v[120:123], v[88:91], v[168:171]
    v_mfma_f32_16x16x32_bf16 v[172:175], v[124:127], v[88:91], v[172:175]
    v_mfma_f32_16x16x32_bf16 v[188:191], v[124:127], v[92:95], v[188:191]
    v_mfma_f32_16x16x32_bf16 v[184:187], v[120:123], v[92:95], v[184:187]
    v_mfma_f32_16x16x32_bf16 v[180:183], v[116:119], v[92:95], v[180:183]
    v_mfma_f32_16x16x32_bf16 v[176:179], v[112:115], v[92:95], v[176:179]
    v_mfma_f32_16x16x32_bf16 v[192:195], v[112:115], v[96:99], v[192:195]
    v_mfma_f32_16x16x32_bf16 v[196:199], v[116:119], v[96:99], v[196:199]
    v_mfma_f32_16x16x32_bf16 v[200:203], v[120:123], v[96:99], v[200:203]
    v_mfma_f32_16x16x32_bf16 v[204:207], v[124:127], v[96:99], v[204:207]
    v_mfma_f32_16x16x32_bf16 v[220:223], v[124:127], v[100:103], v[220:223]
    v_mfma_f32_16x16x32_bf16 v[216:219], v[120:123], v[100:103], v[216:219]
    v_mfma_f32_16x16x32_bf16 v[212:215], v[116:119], v[100:103], v[212:215]
    v_mfma_f32_16x16x32_bf16 v[208:211], v[112:115], v[100:103], v[208:211]
    v_mfma_f32_16x16x32_bf16 v[224:227], v[112:115], v[104:107], v[224:227]
    v_mfma_f32_16x16x32_bf16 v[228:231], v[116:119], v[104:107], v[228:231]
    v_mfma_f32_16x16x32_bf16 v[232:235], v[120:123], v[104:107], v[232:235]
    v_mfma_f32_16x16x32_bf16 v[236:239], v[124:127], v[104:107], v[236:239]
    v_mfma_f32_16x16x32_bf16 v[252:255], v[124:127], v[108:111], v[252:255]
    v_mfma_f32_16x16x32_bf16 v[248:251], v[120:123], v[108:111], v[248:251]
    v_mfma_f32_16x16x32_bf16 v[244:247], v[116:119], v[108:111], v[244:247]
    v_mfma_f32_16x16x32_bf16 v[240:243], v[112:115], v[108:111], v[240:243]
    ds_read_b128 v[32:35], v4 offset:0
    ds_read_b64_tr_b16 v[64:65], v6 offset:32768
    s_add_u32 m0, s24, 16384
    s_add_u32 s30, s32, 416
    s_and_b32 s30, s30, 1023
    s_mul_i32 s30, s30, 7168
    buffer_load_dwordx4 v9, s[12:15], s30 offen lds
    ds_read_b64_tr_b16 v[66:67], v6 offset:33792
    ds_read_b64_tr_b16 v[68:69], v7 offset:32768
    ds_read_b64_tr_b16 v[70:71], v7 offset:33792
    ds_read_b64_tr_b16 v[72:73], v6 offset:40960
    s_add_u32 m0, s24, 24576
    s_nop 0
    buffer_load_dwordx4 v9, s[16:19], s30 offen lds
    ds_read_b64_tr_b16 v[74:75], v6 offset:41984
    ds_read_b64_tr_b16 v[76:77], v7 offset:40960
    ds_read_b64_tr_b16 v[78:79], v7 offset:41984
    ds_read_b128 v[36:39], v4 offset:2048
    s_add_u32 m0, s24, 98304
    s_add_u32 s31, s33, 896
    s_and_b32 s31, s31, 2047
    s_add_u32 s31, s31, 0
    buffer_load_dwordx4 v8, s[8:11], s31 offen lds
    ds_read_b128 v[40:43], v4 offset:4096
    ds_read_b128 v[44:47], v4 offset:6144
    ds_read_b128 v[48:51], v4 offset:8192
    ds_read_b128 v[52:55], v4 offset:10240
    s_add_u32 m0, s24, 106496
    s_add_u32 s31, s33, 896
    s_and_b32 s31, s31, 2047
    s_add_u32 s31, s31, 131072
    buffer_load_dwordx4 v8, s[8:11], s31 offen lds
    ds_read_b128 v[56:59], v4 offset:12288
    ds_read_b128 v[60:63], v4 offset:14336
    s_waitcnt vmcnt(9) lgkmcnt(0)
    s_barrier
    v_mfma_f32_16x16x32_bf16 v[128:131], v[64:67], v[32:35], v[128:131]
    v_mfma_f32_16x16x32_bf16 v[132:135], v[68:71], v[32:35], v[132:135]
    v_mfma_f32_16x16x32_bf16 v[136:139], v[72:75], v[32:35], v[136:139]
    v_mfma_f32_16x16x32_bf16 v[140:143], v[76:79], v[32:35], v[140:143]
    v_mfma_f32_16x16x32_bf16 v[156:159], v[76:79], v[36:39], v[156:159]
    v_mfma_f32_16x16x32_bf16 v[152:155], v[72:75], v[36:39], v[152:155]
    v_mfma_f32_16x16x32_bf16 v[148:151], v[68:71], v[36:39], v[148:151]
    v_mfma_f32_16x16x32_bf16 v[144:147], v[64:67], v[36:39], v[144:147]
    v_mfma_f32_16x16x32_bf16 v[160:163], v[64:67], v[40:43], v[160:163]
    v_mfma_f32_16x16x32_bf16 v[164:167], v[68:71], v[40:43], v[164:167]
    v_mfma_f32_16x16x32_bf16 v[168:171], v[72:75], v[40:43], v[168:171]
    v_mfma_f32_16x16x32_bf16 v[172:175], v[76:79], v[40:43], v[172:175]
    v_mfma_f32_16x16x32_bf16 v[188:191], v[76:79], v[44:47], v[188:191]
    v_mfma_f32_16x16x32_bf16 v[184:187], v[72:75], v[44:47], v[184:187]
    v_mfma_f32_16x16x32_bf16 v[180:183], v[68:71], v[44:47], v[180:183]
    v_mfma_f32_16x16x32_bf16 v[176:179], v[64:67], v[44:47], v[176:179]
    v_mfma_f32_16x16x32_bf16 v[192:195], v[64:67], v[48:51], v[192:195]
    v_mfma_f32_16x16x32_bf16 v[196:199], v[68:71], v[48:51], v[196:199]
    v_mfma_f32_16x16x32_bf16 v[200:203], v[72:75], v[48:51], v[200:203]
    v_mfma_f32_16x16x32_bf16 v[204:207], v[76:79], v[48:51], v[204:207]
    v_mfma_f32_16x16x32_bf16 v[220:223], v[76:79], v[52:55], v[220:223]
    v_mfma_f32_16x16x32_bf16 v[216:219], v[72:75], v[52:55], v[216:219]
    v_mfma_f32_16x16x32_bf16 v[212:215], v[68:71], v[52:55], v[212:215]
    v_mfma_f32_16x16x32_bf16 v[208:211], v[64:67], v[52:55], v[208:211]
    v_mfma_f32_16x16x32_bf16 v[224:227], v[64:67], v[56:59], v[224:227]
    v_mfma_f32_16x16x32_bf16 v[228:231], v[68:71], v[56:59], v[228:231]
    v_mfma_f32_16x16x32_bf16 v[232:235], v[72:75], v[56:59], v[232:235]
    v_mfma_f32_16x16x32_bf16 v[236:239], v[76:79], v[56:59], v[236:239]
    v_mfma_f32_16x16x32_bf16 v[252:255], v[76:79], v[60:63], v[252:255]
    v_mfma_f32_16x16x32_bf16 v[248:251], v[72:75], v[60:63], v[248:251]
    v_mfma_f32_16x16x32_bf16 v[244:247], v[68:71], v[60:63], v[244:247]
    v_mfma_f32_16x16x32_bf16 v[240:243], v[64:67], v[60:63], v[240:243]
    ds_read_b128 v[80:83], v5 offset:0
    ds_read_b64_tr_b16 v[112:113], v6 offset:49152
    s_add_u32 m0, s24, 32768
    s_add_u32 s30, s32, 448
    s_and_b32 s30, s30, 1023
    s_mul_i32 s30, s30, 7168
    buffer_load_dwordx4 v9, s[12:15], s30 offen lds
    ds_read_b64_tr_b16 v[114:115], v6 offset:50176
    ds_read_b64_tr_b16 v[116:117], v7 offset:49152
    ds_read_b64_tr_b16 v[118:119], v7 offset:50176
    ds_read_b64_tr_b16 v[120:121], v6 offset:57344
    s_add_u32 m0, s24, 40960
    s_nop 0
    buffer_load_dwordx4 v9, s[16:19], s30 offen lds
    ds_read_b64_tr_b16 v[122:123], v6 offset:58368
    ds_read_b64_tr_b16 v[124:125], v7 offset:57344
    ds_read_b64_tr_b16 v[126:127], v7 offset:58368
    ds_read_b128 v[84:87], v5 offset:2048
    s_add_u32 m0, s24, 114688
    s_add_u32 s31, s33, 896
    s_and_b32 s31, s31, 2047
    s_add_u32 s31, s31, 262144
    buffer_load_dwordx4 v8, s[8:11], s31 offen lds
    ds_read_b128 v[88:91], v5 offset:4096
    ds_read_b128 v[92:95], v5 offset:6144
    ds_read_b128 v[96:99], v5 offset:8192
    ds_read_b128 v[100:103], v5 offset:10240
    s_add_u32 m0, s24, 122880
    s_add_u32 s31, s33, 896
    s_and_b32 s31, s31, 2047
    s_add_u32 s31, s31, 393216
    buffer_load_dwordx4 v8, s[8:11], s31 offen lds
    ds_read_b128 v[104:107], v5 offset:12288
    ds_read_b128 v[108:111], v5 offset:14336
    s_cmp_lg_u32 s3, 2
    s_cbranch_scc1 M_pfA10
    buffer_load_dword v1, v31, s[96:99], s35 offen
M_pfA10:
    s_waitcnt vmcnt(8) lgkmcnt(0)
    s_barrier
    v_mfma_f32_16x16x32_bf16 v[128:131], v[112:115], v[80:83], v[128:131]
    v_mfma_f32_16x16x32_bf16 v[132:135], v[116:119], v[80:83], v[132:135]
    v_mfma_f32_16x16x32_bf16 v[136:139], v[120:123], v[80:83], v[136:139]
    v_mfma_f32_16x16x32_bf16 v[140:143], v[124:127], v[80:83], v[140:143]
    v_mfma_f32_16x16x32_bf16 v[156:159], v[124:127], v[84:87], v[156:159]
    v_mfma_f32_16x16x32_bf16 v[152:155], v[120:123], v[84:87], v[152:155]
    v_mfma_f32_16x16x32_bf16 v[148:151], v[116:119], v[84:87], v[148:151]
    v_mfma_f32_16x16x32_bf16 v[144:147], v[112:115], v[84:87], v[144:147]
    v_mfma_f32_16x16x32_bf16 v[160:163], v[112:115], v[88:91], v[160:163]
    v_mfma_f32_16x16x32_bf16 v[164:167], v[116:119], v[88:91], v[164:167]
    v_mfma_f32_16x16x32_bf16 v[168:171], v[120:123], v[88:91], v[168:171]
    v_mfma_f32_16x16x32_bf16 v[172:175], v[124:127], v[88:91], v[172:175]
    v_mfma_f32_16x16x32_bf16 v[188:191], v[124:127], v[92:95], v[188:191]
    v_mfma_f32_16x16x32_bf16 v[184:187], v[120:123], v[92:95], v[184:187]
    v_mfma_f32_16x16x32_bf16 v[180:183], v[116:119], v[92:95], v[180:183]
    v_mfma_f32_16x16x32_bf16 v[176:179], v[112:115], v[92:95], v[176:179]
    v_mfma_f32_16x16x32_bf16 v[192:195], v[112:115], v[96:99], v[192:195]
    v_mfma_f32_16x16x32_bf16 v[196:199], v[116:119], v[96:99], v[196:199]
    v_mfma_f32_16x16x32_bf16 v[200:203], v[120:123], v[96:99], v[200:203]
    v_mfma_f32_16x16x32_bf16 v[204:207], v[124:127], v[96:99], v[204:207]
    v_mfma_f32_16x16x32_bf16 v[220:223], v[124:127], v[100:103], v[220:223]
    v_mfma_f32_16x16x32_bf16 v[216:219], v[120:123], v[100:103], v[216:219]
    v_mfma_f32_16x16x32_bf16 v[212:215], v[116:119], v[100:103], v[212:215]
    v_mfma_f32_16x16x32_bf16 v[208:211], v[112:115], v[100:103], v[208:211]
    v_mfma_f32_16x16x32_bf16 v[224:227], v[112:115], v[104:107], v[224:227]
    v_mfma_f32_16x16x32_bf16 v[228:231], v[116:119], v[104:107], v[228:231]
    v_mfma_f32_16x16x32_bf16 v[232:235], v[120:123], v[104:107], v[232:235]
    v_mfma_f32_16x16x32_bf16 v[236:239], v[124:127], v[104:107], v[236:239]
    v_mfma_f32_16x16x32_bf16 v[252:255], v[124:127], v[108:111], v[252:255]
    v_mfma_f32_16x16x32_bf16 v[248:251], v[120:123], v[108:111], v[248:251]
    v_mfma_f32_16x16x32_bf16 v[244:247], v[116:119], v[108:111], v[244:247]
    v_mfma_f32_16x16x32_bf16 v[240:243], v[112:115], v[108:111], v[240:243]
    ds_read_b128 v[32:35], v2 offset:0
    ds_read_b64_tr_b16 v[64:65], v6 offset:0
    s_add_u32 m0, s24, 49152
    s_add_u32 s30, s32, 480
    s_and_b32 s30, s30, 1023
    s_mul_i32 s30, s30, 7168
    buffer_load_dwordx4 v9, s[12:15], s30 offen lds
    ds_read_b64_tr_b16 v[66:67], v6 offset:1024
    ds_read_b64_tr_b16 v[68:69], v7 offset:0
    ds_read_b64_tr_b16 v[70:71], v7 offset:1024
    ds_read_b64_tr_b16 v[72:73], v6 offset:8192
    s_add_u32 m0, s24, 57344
    s_nop 0
    buffer_load_dwordx4 v9, s[16:19], s30 offen lds
    ds_read_b64_tr_b16 v[74:75], v6 offset:9216
    ds_read_b64_tr_b16 v[76:77], v7 offset:8192
    ds_read_b64_tr_b16 v[78:79], v7 offset:9216
    ds_read_b128 v[36:39], v2 offset:2048
    s_add_u32 m0, s24, 131072
    s_add_u32 s31, s33, 1024
    s_and_b32 s31, s31, 2047
    s_add_u32 s31, s31, 0
    buffer_load_dwordx4 v8, s[8:11], s31 offen lds
    ds_read_b128 v[40:43], v2 offset:4096
    ds_read_b128 v[44:47], v2 offset:6144
    ds_read_b128 v[48:51], v2 offset:8192
    ds_read_b128 v[52:55], v2 offset:10240
    s_add_u32 m0, s24, 139264
    s_add_u32 s31, s33, 1024
    s_and_b32 s31, s31, 2047
    s_add_u32 s31, s31, 131072
    buffer_load_dwordx4 v8, s[8:11], s31 offen lds
    ds_read_b128 v[56:59], v2 offset:12288
    ds_read_b128 v[60:63], v2 offset:14336
    buffer_store_dwordx4 v[12:15], v10, s[20:23], s41 offen offset:1024 sc1
    s_waitcnt vmcnt(9) lgkmcnt(0)
    s_barrier
    v_mfma_f32_16x16x32_bf16 v[128:131], v[64:67], v[32:35], v[128:131]
    v_mfma_f32_16x16x32_bf16 v[132:135], v[68:71], v[32:35], v[132:135]
    v_mfma_f32_16x16x32_bf16 v[136:139], v[72:75], v[32:35], v[136:139]
    v_mfma_f32_16x16x32_bf16 v[140:143], v[76:79], v[32:35], v[140:143]
    v_mfma_f32_16x16x32_bf16 v[156:159], v[76:79], v[36:39], v[156:159]
    v_mfma_f32_16x16x32_bf16 v[152:155], v[72:75], v[36:39], v[152:155]
    v_mfma_f32_16x16x32_bf16 v[148:151], v[68:71], v[36:39], v[148:151]
    v_mfma_f32_16x16x32_bf16 v[144:147], v[64:67], v[36:39], v[144:147]
    v_mfma_f32_16x16x32_bf16 v[160:163], v[64:67], v[40:43], v[160:163]
    v_mfma_f32_16x16x32_bf16 v[164:167], v[68:71], v[40:43], v[164:167]
    v_mfma_f32_16x16x32_bf16 v[168:171], v[72:75], v[40:43], v[168:171]
    v_mfma_f32_16x16x32_bf16 v[172:175], v[76:79], v[40:43], v[172:175]
    v_mfma_f32_16x16x32_bf16 v[188:191], v[76:79], v[44:47], v[188:191]
    v_mfma_f32_16x16x32_bf16 v[184:187], v[72:75], v[44:47], v[184:187]
    v_mfma_f32_16x16x32_bf16 v[180:183], v[68:71], v[44:47], v[180:183]
    v_mfma_f32_16x16x32_bf16 v[176:179], v[64:67], v[44:47], v[176:179]
    v_mfma_f32_16x16x32_bf16 v[192:195], v[64:67], v[48:51], v[192:195]
    v_mfma_f32_16x16x32_bf16 v[196:199], v[68:71], v[48:51], v[196:199]
    v_mfma_f32_16x16x32_bf16 v[200:203], v[72:75], v[48:51], v[200:203]
    v_mfma_f32_16x16x32_bf16 v[204:207], v[76:79], v[48:51], v[204:207]
    v_mfma_f32_16x16x32_bf16 v[220:223], v[76:79], v[52:55], v[220:223]
    v_mfma_f32_16x16x32_bf16 v[216:219], v[72:75], v[52:55], v[216:219]
    v_mfma_f32_16x16x32_bf16 v[212:215], v[68:71], v[52:55], v[212:215]
    v_mfma_f32_16x16x32_bf16 v[208:211], v[64:67], v[52:55], v[208:211]
    v_mfma_f32_16x16x32_bf16 v[224:227], v[64:67], v[56:59], v[224:227]
    v_mfma_f32_16x16x32_bf16 v[228:231], v[68:71], v[56:59], v[228:231]
    v_mfma_f32_16x16x32_bf16 v[232:235], v[72:75], v[56:59], v[232:235]
    v_mfma_f32_16x16x32_bf16 v[236:239], v[76:79], v[56:59], v[236:239]
    v_mfma_f32_16x16x32_bf16 v[252:255], v[76:79], v[60:63], v[252:255]
    v_mfma_f32_16x16x32_bf16 v[248:251], v[72:75], v[60:63], v[248:251]
    v_mfma_f32_16x16x32_bf16 v[244:247], v[68:71], v[60:63], v[244:247]
    v_mfma_f32_16x16x32_bf16 v[240:243], v[64:67], v[60:63], v[240:243]
    ds_read_b128 v[80:83], v3 offset:0
    ds_read_b64_tr_b16 v[112:113], v6 offset:16384
    s_add_u32 m0, s24, 0
    s_add_u32 s30, s32, 512
    s_and_b32 s30, s30, 1023
    s_mul_i32 s30, s30, 7168
    buffer_load_dwordx4 v9, s[12:15], s30 offen lds
    ds_read_b64_tr_b16 v[114:115], v6 offset:17408
    ds_read_b64_tr_b16 v[116:117], v7 offset:16384
    ds_read_b64_tr_b16 v[118:119], v7 offset:17408
    ds_read_b64_tr_b16 v[120:121], v6 offset:24576
    s_add_u32 m0, s24, 8192
    s_nop 0
    buffer_load_dwordx4 v9, s[16:19], s30 offen lds
    ds_read_b64_tr_b16 v[122:123], v6 offset:25600
    ds_read_b64_tr_b16 v[124:125], v7 offset:24576
    ds_read_b64_tr_b16 v[126:127], v7 offset:25600
    ds_read_b128 v[84:87], v3 offset:2048
    s_add_u32 m0, s24, 147456
    s_add_u32 s31, s33, 1024
    s_and_b32 s31, s31, 2047
    s_add_u32 s31, s31, 262144
    buffer_load_dwordx4 v8, s[8:11], s31 offen lds
    ds_read_b128 v[88:91], v3 offset:4096
    ds_read_b128 v[92:95], v3 offset:6144
    ds_read_b128 v[96:99], v3 offset:8192
    ds_read_b128 v[100:103], v3 offset:10240
    s_add_u32 m0, s24, 155648
    s_add_u32 s31, s33, 1024
    s_and_b32 s31, s31, 2047
    s_add_u32 s31, s31, 393216
    buffer_load_dwordx4 v8, s[8:11], s31 offen lds
    ds_read_b128 v[104:107], v3 offset:12288
    ds_read_b128 v[108:111], v3 offset:14336
    s_waitcnt vmcnt(9) lgkmcnt(0)
    s_barrier
    v_mfma_f32_16x16x32_bf16 v[128:131], v[112:115], v[80:83], v[128:131]
    v_mfma_f32_16x16x32_bf16 v[132:135], v[116:119], v[80:83], v[132:135]
    v_mfma_f32_16x16x32_bf16 v[136:139], v[120:123], v[80:83], v[136:139]
    v_mfma_f32_16x16x32_bf16 v[140:143], v[124:127], v[80:83], v[140:143]
    v_mfma_f32_16x16x32_bf16 v[156:159], v[124:127], v[84:87], v[156:159]
    v_mfma_f32_16x16x32_bf16 v[152:155], v[120:123], v[84:87], v[152:155]
    v_mfma_f32_16x16x32_bf16 v[148:151], v[116:119], v[84:87], v[148:151]
    v_mfma_f32_16x16x32_bf16 v[144:147], v[112:115], v[84:87], v[144:147]
    v_mfma_f32_16x16x32_bf16 v[160:163], v[112:115], v[88:91], v[160:163]
    v_mfma_f32_16x16x32_bf16 v[164:167], v[116:119], v[88:91], v[164:167]
    v_mfma_f32_16x16x32_bf16 v[168:171], v[120:123], v[88:91], v[168:171]
    v_mfma_f32_16x16x32_bf16 v[172:175], v[124:127], v[88:91], v[172:175]
    v_mfma_f32_16x16x32_bf16 v[188:191], v[124:127], v[92:95], v[188:191]
    v_mfma_f32_16x16x32_bf16 v[184:187], v[120:123], v[92:95], v[184:187]
    v_mfma_f32_16x16x32_bf16 v[180:183], v[116:119], v[92:95], v[180:183]
    v_mfma_f32_16x16x32_bf16 v[176:179], v[112:115], v[92:95], v[176:179]
    v_mfma_f32_16x16x32_bf16 v[192:195], v[112:115], v[96:99], v[192:195]
    v_mfma_f32_16x16x32_bf16 v[196:199], v[116:119], v[96:99], v[196:199]
    v_mfma_f32_16x16x32_bf16 v[200:203], v[120:123], v[96:99], v[200:203]
    v_mfma_f32_16x16x32_bf16 v[204:207], v[124:127], v[96:99], v[204:207]
    v_mfma_f32_16x16x32_bf16 v[220:223], v[124:127], v[100:103], v[220:223]
    v_mfma_f32_16x16x32_bf16 v[216:219], v[120:123], v[100:103], v[216:219]
    v_mfma_f32_16x16x32_bf16 v[212:215], v[116:119], v[100:103], v[212:215]
    v_mfma_f32_16x16x32_bf16 v[208:211], v[112:115], v[100:103], v[208:211]
    v_mfma_f32_16x16x32_bf16 v[224:227], v[112:115], v[104:107], v[224:227]
    v_mfma_f32_16x16x32_bf16 v[228:231], v[116:119], v[104:107], v[228:231]
    v_mfma_f32_16x16x32_bf16 v[232:235], v[120:123], v[104:107], v[232:235]
    v_mfma_f32_16x16x32_bf16 v[236:239], v[124:127], v[104:107], v[236:239]
    v_mfma_f32_16x16x32_bf16 v[252:255], v[124:127], v[108:111], v[252:255]
    v_mfma_f32_16x16x32_bf16 v[248:251], v[120:123], v[108:111], v[248:251]
    v_mfma_f32_16x16x32_bf16 v[244:247], v[116:119], v[108:111], v[244:247]
    v_mfma_f32_16x16x32_bf16 v[240:243], v[112:115], v[108:111], v[240:243]
    ds_read_b128 v[32:35], v2 offset:32768
    ds_read_b64_tr_b16 v[64:65], v6 offset:32768
    s_add_u32 m0, s24, 16384
    s_add_u32 s30, s32, 544
    s_and_b32 s30, s30, 1023
    s_mul_i32 s30, s30, 7168
    buffer_load_dwordx4 v9, s[12:15], s30 offen lds
    ds_read_b64_tr_b16 v[66:67], v6 offset:33792
    ds_read_b64_tr_b16 v[68:69], v7 offset:32768
    ds_read_b64_tr_b16 v[70:71], v7 offset:33792
    ds_read_b64_tr_b16 v[72:73], v6 offset:40960
    s_add_u32 m0, s24, 24576
    s_nop 0
    buffer_load_dwordx4 v9, s[16:19], s30 offen lds
    ds_read_b64_tr_b16 v[74:75], v6 offset:41984
    ds_read_b64_tr_b16 v[76:77], v7 offset:40960
    ds_read_b64_tr_b16 v[78:79], v7 offset:41984
    ds_read_b128 v[36:39], v2 offset:34816
    s_add_u32 m0, s24, 65536
    s_add_u32 s31, s33, 1152
    s_and_b32 s31, s31, 2047
    s_add_u32 s31, s31, 0
    buffer_load_dwordx4 v8, s[8:11], s31 offen lds
    ds_read_b128 v[40:43], v2 offset:36864
    ds_read_b128 v[44:47], v2 offset:38912
    ds_read_b128 v[48:51], v2 offset:40960
    ds_read_b128 v[52:55], v2 offset:43008
    s_add_u32 m0, s24, 73728
    s_add_u32 s31, s33, 1152
    s_and_b32 s31, s31, 2047
    s_add_u32 s31, s31, 131072
    buffer_load_dwordx4 v8, s[8:11], s31 offen lds
    ds_read_b128 v[56:59], v2 offset:45056
    ds_read_b128 v[60:63], v2 offset:47104
    s_cmp_lg_u32 s3, 3
    s_cbranch_scc1 M_pfA13
    buffer_load_dword v1, v31, s[96:99], s35 offen
M_pfA13:
    s_waitcnt vmcnt(8) lgkmcnt(0)
    s_barrier
    v_mfma_f32_16x16x32_bf16 v[128:131], v[64:67], v[32:35], v[128:131]
    v_mfma_f32_16x16x32_bf16 v[132:135], v[68:71], v[32:35], v[132:135]
    v_mfma_f32_16x16x32_bf16 v[136:139], v[72:75], v[32:35], v[136:139]
    v_mfma_f32_16x16x32_bf16 v[140:143], v[76:79], v[32:35], v[140:143]
    v_mfma_f32_16x16x32_bf16 v[156:159], v[76:79], v[36:39], v[156:159]
    v_mfma_f32_16x16x32_bf16 v[152:155], v[72:75], v[36:39], v[152:155]
    v_mfma_f32_16x16x32_bf16 v[148:151], v[68:71], v[36:39], v[148:151]
    v_mfma_f32_16x16x32_bf16 v[144:147], v[64:67], v[36:39], v[144:147]
    v_mfma_f32_16x16x32_bf16 v[160:163], v[64:67], v[40:43], v[160:163]
    v_mfma_f32_16x16x32_bf16 v[164:167], v[68:71], v[40:43], v[164:167]
    v_mfma_f32_16x16x32_bf16 v[168:171], v[72:75], v[40:43], v[168:171]
    v_mfma_f32_16x16x32_bf16 v[172:175], v[76:79], v[40:43], v[172:175]
    v_mfma_f32_16x16x32_bf16 v[188:191], v[76:79], v[44:47], v[188:191]
    v_mfma_f32_16x16x32_bf16 v[184:187], v[72:75], v[44:47], v[184:187]
    v_mfma_f32_16x16x32_bf16 v[180:183], v[68:71], v[44:47], v[180:183]
    v_mfma_f32_16x16x32_bf16 v[176:179], v[64:67], v[44:47], v[176:179]
    v_mfma_f32_16x16x32_bf16 v[192:195], v[64:67], v[48:51], v[192:195]
    v_mfma_f32_16x16x32_bf16 v[196:199], v[68:71], v[48:51], v[196:199]
    v_mfma_f32_16x16x32_bf16 v[200:203], v[72:75], v[48:51], v[200:203]
    v_mfma_f32_16x16x32_bf16 v[204:207], v[76:79], v[48:51], v[204:207]
    v_mfma_f32_16x16x32_bf16 v[220:223], v[76:79], v[52:55], v[220:223]
    v_mfma_f32_16x16x32_bf16 v[216:219], v[72:75], v[52:55], v[216:219]
    v_mfma_f32_16x16x32_bf16 v[212:215], v[68:71], v[52:55], v[212:215]
    v_mfma_f32_16x16x32_bf16 v[208:211], v[64:67], v[52:55], v[208:211]
    v_mfma_f32_16x16x32_bf16 v[224:227], v[64:67], v[56:59], v[224:227]
    v_mfma_f32_16x16x32_bf16 v[228:231], v[68:71], v[56:59], v[228:231]
    v_mfma_f32_16x16x32_bf16 v[232:235], v[72:75], v[56:59], v[232:235]
    v_mfma_f32_16x16x32_bf16 v[236:239], v[76:79], v[56:59], v[236:239]
    v_mfma_f32_16x16x32_bf16 v[252:255], v[76:79], v[60:63], v[252:255]
    v_mfma_f32_16x16x32_bf16 v[248:251], v[72:75], v[60:63], v[248:251]
    v_mfma_f32_16x16x32_bf16 v[244:247], v[68:71], v[60:63], v[244:247]
    v_mfma_f32_16x16x32_bf16 v[240:243], v[64:67], v[60:63], v[240:243]
    ds_read_b128 v[80:83], v3 offset:32768
    ds_read_b64_tr_b16 v[112:113], v6 offset:49152
    s_add_u32 m0, s24, 32768
    s_add_u32 s30, s32, 576
    s_and_b32 s30, s30, 1023
    s_mul_i32 s30, s30, 7168
    buffer_load_dwordx4 v9, s[12:15], s30 offen lds
    ds_read_b64_tr_b16 v[114:115], v6 offset:50176
    ds_read_b64_tr_b16 v[116:117], v7 offset:49152
    ds_read_b64_tr_b16 v[118:119], v7 offset:50176
    ds_read_b64_tr_b16 v[120:121], v6 offset:57344
    s_add_u32 m0, s24, 40960
    s_nop 0
    buffer_load_dwordx4 v9, s[16:19], s30 offen lds
    ds_read_b64_tr_b16 v[122:123], v6 offset:58368
    ds_read_b64_tr_b16 v[124:125], v7 offset:57344
    ds_read_b64_tr_b16 v[126:127], v7 offset:58368
    ds_read_b128 v[84:87], v3 offset:34816
    s_add_u32 m0, s24, 81920
    s_add_u32 s31, s33, 1152
    s_and_b32 s31, s31, 2047
    s_add_u32 s31, s31, 262144
    buffer_load_dwordx4 v8, s[8:11], s31 offen lds
    ds_read_b128 v[88:91], v3 offset:36864
    ds_read_b128 v[92:95], v3 offset:38912
    ds_read_b128 v[96:99], v3 offset:40960
    ds_read_b128 v[100:103], v3 offset:43008
    s_add_u32 m0, s24, 90112
    s_add_u32 s31, s33, 1152
    s_and_b32 s31, s31, 2047
    s_add_u32 s31, s31, 393216
    buffer_load_dwordx4 v8, s[8:11], s31 offen lds
    ds_read_b128 v[104:107], v3 offset:45056
    ds_read_b128 v[108:111], v3 offset:47104
    s_cmp_lg_u32 s3, 0
    s_cbranch_scc1 M_saA
    s_mov_b64 exec, 1
    s_and_b32 s58, s2, 3
    s_lshl_b32 s58, s58, 6
    buffer_atomic_add v24, v20, s[92:95], s58 offen sc1
    s_mov_b64 exec, -1
M_saA:
    s_waitcnt vmcnt(8) lgkmcnt(0)
    s_barrier
    v_mfma_f32_16x16x32_bf16 v[128:131], v[112:115], v[80:83], v[128:131]
    v_mfma_f32_16x16x32_bf16 v[132:135], v[116:119], v[80:83], v[132:135]
    v_mfma_f32_16x16x32_bf16 v[136:139], v[120:123], v[80:83], v[136:139]
    v_mfma_f32_16x16x32_bf16 v[140:143], v[124:127], v[80:83], v[140:143]
    v_mfma_f32_16x16x32_bf16 v[156:159], v[124:127], v[84:87], v[156:159]
    v_mfma_f32_16x16x32_bf16 v[152:155], v[120:123], v[84:87], v[152:155]
    v_mfma_f32_16x16x32_bf16 v[148:151], v[116:119], v[84:87], v[148:151]
    v_mfma_f32_16x16x32_bf16 v[144:147], v[112:115], v[84:87], v[144:147]
    v_mfma_f32_16x16x32_bf16 v[160:163], v[112:115], v[88:91], v[160:163]
    v_mfma_f32_16x16x32_bf16 v[164:167], v[116:119], v[88:91], v[164:167]
    v_mfma_f32_16x16x32_bf16 v[168:171], v[120:123], v[88:91], v[168:171]
    v_mfma_f32_16x16x32_bf16 v[172:175], v[124:127], v[88:91], v[172:175]
    v_mfma_f32_16x16x32_bf16 v[188:191], v[124:127], v[92:95], v[188:191]
    v_mfma_f32_16x16x32_bf16 v[184:187], v[120:123], v[92:95], v[184:187]
    v_mfma_f32_16x16x32_bf16 v[180:183], v[116:119], v[92:95], v[180:183]
    v_mfma_f32_16x16x32_bf16 v[176:179], v[112:115], v[92:95], v[176:179]
    v_mfma_f32_16x16x32_bf16 v[192:195], v[112:115], v[96:99], v[192:195]
    v_mfma_f32_16x16x32_bf16 v[196:199], v[116:119], v[96:99], v[196:199]
    v_mfma_f32_16x16x32_bf16 v[200:203], v[120:123], v[96:99], v[200:203]
    v_mfma_f32_16x16x32_bf16 v[204:207], v[124:127], v[96:99], v[204:207]
    v_mfma_f32_16x16x32_bf16 v[220:223], v[124:127], v[100:103], v[220:223]
    v_mfma_f32_16x16x32_bf16 v[216:219], v[120:123], v[100:103], v[216:219]
    v_mfma_f32_16x16x32_bf16 v[212:215], v[116:119], v[100:103], v[212:215]
    v_mfma_f32_16x16x32_bf16 v[208:211], v[112:115], v[100:103], v[208:211]
    v_mfma_f32_16x16x32_bf16 v[224:227], v[112:115], v[104:107], v[224:227]
    v_mfma_f32_16x16x32_bf16 v[228:231], v[116:119], v[104:107], v[228:231]
    v_mfma_f32_16x16x32_bf16 v[232:235], v[120:123], v[104:107], v[232:235]
    v_mfma_f32_16x16x32_bf16 v[236:239], v[124:127], v[104:107], v[236:239]
    v_mfma_f32_16x16x32_bf16 v[252:255], v[124:127], v[108:111], v[252:255]
    v_mfma_f32_16x16x32_bf16 v[248:251], v[120:123], v[108:111], v[248:251]
    v_mfma_f32_16x16x32_bf16 v[244:247], v[116:119], v[108:111], v[244:247]
    v_mfma_f32_16x16x32_bf16 v[240:243], v[112:115], v[108:111], v[240:243]
    ds_read_b128 v[32:35], v4 offset:0
    ds_read_b64_tr_b16 v[64:65], v6 offset:0
    s_add_u32 m0, s24, 49152
    s_add_u32 s30, s32, 608
    s_and_b32 s30, s30, 1023
    s_mul_i32 s30, s30, 7168
    buffer_load_dwordx4 v9, s[12:15], s30 offen lds
    ds_read_b64_tr_b16 v[66:67], v6 offset:1024
    ds_read_b64_tr_b16 v[68:69], v7 offset:0
    ds_read_b64_tr_b16 v[70:71], v7 offset:1024
    ds_read_b64_tr_b16 v[72:73], v6 offset:8192
    s_add_u32 m0, s24, 57344
    s_nop 0
    buffer_load_dwordx4 v9, s[16:19], s30 offen lds
    ds_read_b64_tr_b16 v[74:75], v6 offset:9216
    ds_read_b64_tr_b16 v[76:77], v7 offset:8192
    ds_read_b64_tr_b16 v[78:79], v7 offset:9216
    ds_read_b128 v[36:39], v4 offset:2048
    s_add_u32 m0, s24, 98304
    s_add_u32 s31, s33, 1280
    s_and_b32 s31, s31, 2047
    s_add_u32 s31, s31, 0
    buffer_load_dwordx4 v8, s[8:11], s31 offen lds
    ds_read_b128 v[40:43], v4 offset:4096
    ds_read_b128 v[44:47], v4 offset:6144
    ds_read_b128 v[48:51], v4 offset:8192
    ds_read_b128 v[52:55], v4 offset:10240
    s_add_u32 m0, s24, 106496
    s_add_u32 s31, s33, 1280
    s_and_b32 s31, s31, 2047
    s_add_u32 s31, s31, 131072
    buffer_load_dwordx4 v8, s[8:11], s31 offen lds
    ds_read_b128 v[56:59], v4 offset:12288
    ds_read_b128 v[60:63], v4 offset:14336
    s_waitcnt vmcnt(8) lgkmcnt(0)
    s_barrier
    v_mfma_f32_16x16x32_bf16 v[128:131], v[64:67], v[32:35], v[128:131]
    v_mfma_f32_16x16x32_bf16 v[132:135], v[68:71], v[32:35], v[132:135]
    v_mfma_f32_16x16x32_bf16 v[136:139], v[72:75], v[32:35], v[136:139]
    v_mfma_f32_16x16x32_bf16 v[140:143], v[76:79], v[32:35], v[140:143]
    v_mfma_f32_16x16x32_bf16 v[156:159], v[76:79], v[36:39], v[156:159]
    v_mfma_f32_16x16x32_bf16 v[152:155], v[72:75], v[36:39], v[152:155]
    v_mfma_f32_16x16x32_bf16 v[148:151], v[68:71], v[36:39], v[148:151]
    v_mfma_f32_16x16x32_bf16 v[144:147], v[64:67], v[36:39], v[144:147]
    v_mfma_f32_16x16x32_bf16 v[160:163], v[64:67], v[40:43], v[160:163]
    v_mfma_f32_16x16x32_bf16 v[164:167], v[68:71], v[40:43], v[164:167]
    v_mfma_f32_16x16x32_bf16 v[168:171], v[72:75], v[40:43], v[168:171]
    v_mfma_f32_16x16x32_bf16 v[172:175], v[76:79], v[40:43], v[172:175]
    v_mfma_f32_16x16x32_bf16 v[188:191], v[76:79], v[44:47], v[188:191]
    v_mfma_f32_16x16x32_bf16 v[184:187], v[72:75], v[44:47], v[184:187]
    v_mfma_f32_16x16x32_bf16 v[180:183], v[68:71], v[44:47], v[180:183]
    v_mfma_f32_16x16x32_bf16 v[176:179], v[64:67], v[44:47], v[176:179]
    v_mfma_f32_16x16x32_bf16 v[192:195], v[64:67], v[48:51], v[192:195]
    v_mfma_f32_16x16x32_bf16 v[196:199], v[68:71], v[48:51], v[196:199]
    v_mfma_f32_16x16x32_bf16 v[200:203], v[72:75], v[48:51], v[200:203]
    v_mfma_f32_16x16x32_bf16 v[204:207], v[76:79], v[48:51], v[204:207]
    v_mfma_f32_16x16x32_bf16 v[220:223], v[76:79], v[52:55], v[220:223]
    v_mfma_f32_16x16x32_bf16 v[216:219], v[72:75], v[52:55], v[216:219]
    v_mfma_f32_16x16x32_bf16 v[212:215], v[68:71], v[52:55], v[212:215]
    v_mfma_f32_16x16x32_bf16 v[208:211], v[64:67], v[52:55], v[208:211]
    v_mfma_f32_16x16x32_bf16 v[224:227], v[64:67], v[56:59], v[224:227]
    v_mfma_f32_16x16x32_bf16 v[228:231], v[68:71], v[56:59], v[228:231]
    v_mfma_f32_16x16x32_bf16 v[232:235], v[72:75], v[56:59], v[232:235]
    v_mfma_f32_16x16x32_bf16 v[236:239], v[76:79], v[56:59], v[236:239]
    v_mfma_f32_16x16x32_bf16 v[252:255], v[76:79], v[60:63], v[252:255]
    v_mfma_f32_16x16x32_bf16 v[248:251], v[72:75], v[60:63], v[248:251]
    v_mfma_f32_16x16x32_bf16 v[244:247], v[68:71], v[60:63], v[244:247]
    v_mfma_f32_16x16x32_bf16 v[240:243], v[64:67], v[60:63], v[240:243]
    ds_read_b128 v[80:83], v5 offset:0
    ds_read_b64_tr_b16 v[112:113], v6 offset:16384
    s_add_u32 m0, s24, 0
    s_add_u32 s30, s32, 640
    s_and_b32 s30, s30, 1023
    s_mul_i32 s30, s30, 7168
    buffer_load_dwordx4 v9, s[12:15], s30 offen lds
    ds_read_b64_tr_b16 v[114:115], v6 offset:17408
    ds_read_b64_tr_b16 v[116:117], v7 offset:16384
    ds_read_b64_tr_b16 v[118:119], v7 offset:17408
    ds_read_b64_tr_b16 v[120:121], v6 offset:24576
    s_add_u32 m0, s24, 8192
    s_nop 0
    buffer_load_dwordx4 v9, s[16:19], s30 offen lds
    ds_read_b64_tr_b16 v[122:123], v6 offset:25600
    ds_read_b64_tr_b16 v[124:125], v7 offset:24576
    ds_read_b64_tr_b16 v[126:127], v7 offset:25600
    ds_read_b128 v[84:87], v5 offset:2048
    s_add_u32 m0, s24, 114688
    s_add_u32 s31, s33, 1280
    s_and_b32 s31, s31, 2047
    s_add_u32 s31, s31, 262144
    buffer_load_dwordx4 v8, s[8:11], s31 offen lds
    ds_read_b128 v[88:91], v5 offset:4096
    ds_read_b128 v[92:95], v5 offset:6144
    ds_read_b128 v[96:99], v5 offset:8192
    ds_read_b128 v[100:103], v5 offset:10240
    s_add_u32 m0, s24, 122880
    s_add_u32 s31, s33, 1280
    s_and_b32 s31, s31, 2047
    s_add_u32 s31, s31, 393216
    buffer_load_dwordx4 v8, s[8:11], s31 offen lds
    ds_read_b128 v[104:107], v5 offset:12288
    ds_read_b128 v[108:111], v5 offset:14336
    s_cmp_lg_u32 s3, 4
    s_cbranch_scc1 M_pfA16
    buffer_load_dword v1, v31, s[96:99], s35 offen
M_pfA16:
    s_waitcnt vmcnt(8) lgkmcnt(0)
    s_barrier
    v_mfma_f32_16x16x32_bf16 v[128:131], v[112:115], v[80:83], v[128:131]
    v_mfma_f32_16x16x32_bf16 v[132:135], v[116:119], v[80:83], v[132:135]
    v_mfma_f32_16x16x32_bf16 v[136:139], v[120:123], v[80:83], v[136:139]
    v_mfma_f32_16x16x32_bf16 v[140:143], v[124:127], v[80:83], v[140:143]
    v_mfma_f32_16x16x32_bf16 v[156:159], v[124:127], v[84:87], v[156:159]
    v_mfma_f32_16x16x32_bf16 v[152:155], v[120:123], v[84:87], v[152:155]
    v_mfma_f32_16x16x32_bf16 v[148:151], v[116:119], v[84:87], v[148:151]
    v_mfma_f32_16x16x32_bf16 v[144:147], v[112:115], v[84:87], v[144:147]
    v_mfma_f32_16x16x32_bf16 v[160:163], v[112:115], v[88:91], v[160:163]
    v_mfma_f32_16x16x32_bf16 v[164:167], v[116:119], v[88:91], v[164:167]
    v_mfma_f32_16x16x32_bf16 v[168:171], v[120:123], v[88:91], v[168:171]
    v_mfma_f32_16x16x32_bf16 v[172:175], v[124:127], v[88:91], v[172:175]
    v_mfma_f32_16x16x32_bf16 v[188:191], v[124:127], v[92:95], v[188:191]
    v_mfma_f32_16x16x32_bf16 v[184:187], v[120:123], v[92:95], v[184:187]
    v_mfma_f32_16x16x32_bf16 v[180:183], v[116:119], v[92:95], v[180:183]
    v_mfma_f32_16x16x32_bf16 v[176:179], v[112:115], v[92:95], v[176:179]
    v_mfma_f32_16x16x32_bf16 v[192:195], v[112:115], v[96:99], v[192:195]
    v_mfma_f32_16x16x32_bf16 v[196:199], v[116:119], v[96:99], v[196:199]
    v_mfma_f32_16x16x32_bf16 v[200:203], v[120:123], v[96:99], v[200:203]
    v_mfma_f32_16x16x32_bf16 v[204:207], v[124:127], v[96:99], v[204:207]
    v_mfma_f32_16x16x32_bf16 v[220:223], v[124:127], v[100:103], v[220:223]
    v_mfma_f32_16x16x32_bf16 v[216:219], v[120:123], v[100:103], v[216:219]
    v_mfma_f32_16x16x32_bf16 v[212:215], v[116:119], v[100:103], v[212:215]
    v_mfma_f32_16x16x32_bf16 v[208:211], v[112:115], v[100:103], v[208:211]
    v_mfma_f32_16x16x32_bf16 v[224:227], v[112:115], v[104:107], v[224:227]
    v_mfma_f32_16x16x32_bf16 v[228:231], v[116:119], v[104:107], v[228:231]
    v_mfma_f32_16x16x32_bf16 v[232:235], v[120:123], v[104:107], v[232:235]
    v_mfma_f32_16x16x32_bf16 v[236:239], v[124:127], v[104:107], v[236:239]
    v_mfma_f32_16x16x32_bf16 v[252:255], v[124:127], v[108:111], v[252:255]
    v_mfma_f32_16x16x32_bf16 v[248:251], v[120:123], v[108:111], v[248:251]
    v_mfma_f32_16x16x32_bf16 v[244:247], v[116:119], v[108:111], v[244:247]
    v_mfma_f32_16x16x32_bf16 v[240:243], v[112:115], v[108:111], v[240:243]
    ds_read_b128 v[32:35], v2 offset:0
    ds_read_b64_tr_b16 v[64:65], v6 offset:32768
    s_add_u32 m0, s24, 16384
    s_add_u32 s30, s32, 672
    s_and_b32 s30, s30, 1023
    s_mul_i32 s30, s30, 7168
    buffer_load_dwordx4 v9, s[12:15], s30 offen lds
    ds_read_b64_tr_b16 v[66:67], v6 offset:33792
    ds_read_b64_tr_b16 v[68:69], v7 offset:32768
    ds_read_b64_tr_b16 v[70:71], v7 offset:33792
    ds_read_b64_tr_b16 v[72:73], v6 offset:40960
    s_add_u32 m0, s24, 24576
    s_nop 0
    buffer_load_dwordx4 v9, s[16:19], s30 offen lds
    ds_read_b64_tr_b16 v[74:75], v6 offset:41984
    ds_read_b64_tr_b16 v[76:77], v7 offset:40960
    ds_read_b64_tr_b16 v[78:79], v7 offset:41984
    ds_read_b128 v[36:39], v2 offset:2048
    s_add_u32 m0, s24, 131072
    s_add_u32 s31, s33, 1408
    s_and_b32 s31, s31, 2047
    s_add_u32 s31, s31, 0
    buffer_load_dwordx4 v8, s[8:11], s31 offen lds
    ds_read_b128 v[40:43], v2 offset:4096
    ds_read_b128 v[44:47], v2 offset:6144
    ds_read_b128 v[48:51], v2 offset:8192
    ds_read_b128 v[52:55], v2 offset:10240
    s_add_u32 m0, s24, 139264
    s_add_u32 s31, s33, 1408
    s_and_b32 s31, s31, 2047
    s_add_u32 s31, s31, 131072
    buffer_load_dwordx4 v8, s[8:11], s31 offen lds
    ds_read_b128 v[56:59], v2 offset:12288
    ds_read_b128 v[60:63], v2 offset:14336
    s_waitcnt vmcnt(8) lgkmcnt(0)
    s_barrier
    v_mfma_f32_16x16x32_bf16 v[128:131], v[64:67], v[32:35], v[128:131]
    v_mfma_f32_16x16x32_bf16 v[132:135], v[68:71], v[32:35], v[132:135]
    v_mfma_f32_16x16x32_bf16 v[136:139], v[72:75], v[32:35], v[136:139]
    v_mfma_f32_16x16x32_bf16 v[140:143], v[76:79], v[32:35], v[140:143]
    v_mfma_f32_16x16x32_bf16 v[156:159], v[76:79], v[36:39], v[156:159]
    v_mfma_f32_16x16x32_bf16 v[152:155], v[72:75], v[36:39], v[152:155]
    v_mfma_f32_16x16x32_bf16 v[148:151], v[68:71], v[36:39], v[148:151]
    v_mfma_f32_16x16x32_bf16 v[144:147], v[64:67], v[36:39], v[144:147]
    v_mfma_f32_16x16x32_bf16 v[160:163], v[64:67], v[40:43], v[160:163]
    v_mfma_f32_16x16x32_bf16 v[164:167], v[68:71], v[40:43], v[164:167]
    v_mfma_f32_16x16x32_bf16 v[168:171], v[72:75], v[40:43], v[168:171]
    v_mfma_f32_16x16x32_bf16 v[172:175], v[76:79], v[40:43], v[172:175]
    v_mfma_f32_16x16x32_bf16 v[188:191], v[76:79], v[44:47], v[188:191]
    v_mfma_f32_16x16x32_bf16 v[184:187], v[72:75], v[44:47], v[184:187]
    v_mfma_f32_16x16x32_bf16 v[180:183], v[68:71], v[44:47], v[180:183]
    v_mfma_f32_16x16x32_bf16 v[176:179], v[64:67], v[44:47], v[176:179]
    v_mfma_f32_16x16x32_bf16 v[192:195], v[64:67], v[48:51], v[192:195]
    v_mfma_f32_16x16x32_bf16 v[196:199], v[68:71], v[48:51], v[196:199]
    v_mfma_f32_16x16x32_bf16 v[200:203], v[72:75], v[48:51], v[200:203]
    v_mfma_f32_16x16x32_bf16 v[204:207], v[76:79], v[48:51], v[204:207]
    v_mfma_f32_16x16x32_bf16 v[220:223], v[76:79], v[52:55], v[220:223]
    v_mfma_f32_16x16x32_bf16 v[216:219], v[72:75], v[52:55], v[216:219]
    v_mfma_f32_16x16x32_bf16 v[212:215], v[68:71], v[52:55], v[212:215]
    v_mfma_f32_16x16x32_bf16 v[208:211], v[64:67], v[52:55], v[208:211]
    v_mfma_f32_16x16x32_bf16 v[224:227], v[64:67], v[56:59], v[224:227]
    v_mfma_f32_16x16x32_bf16 v[228:231], v[68:71], v[56:59], v[228:231]
    v_mfma_f32_16x16x32_bf16 v[232:235], v[72:75], v[56:59], v[232:235]
    v_mfma_f32_16x16x32_bf16 v[236:239], v[76:79], v[56:59], v[236:239]
    v_mfma_f32_16x16x32_bf16 v[252:255], v[76:79], v[60:63], v[252:255]
    v_mfma_f32_16x16x32_bf16 v[248:251], v[72:75], v[60:63], v[248:251]
    v_mfma_f32_16x16x32_bf16 v[244:247], v[68:71], v[60:63], v[244:247]
    v_mfma_f32_16x16x32_bf16 v[240:243], v[64:67], v[60:63], v[240:243]
    ds_read_b128 v[80:83], v3 offset:0
    ds_read_b64_tr_b16 v[112:113], v6 offset:49152
    s_add_u32 m0, s24, 32768
    s_add_u32 s30, s32, 704
    s_and_b32 s30, s30, 1023
    s_mul_i32 s30, s30, 7168
    buffer_load_dwordx4 v9, s[12:15], s30 offen lds
    ds_read_b64_tr_b16 v[114:115], v6 offset:50176
    ds_read_b64_tr_b16 v[116:117], v7 offset:49152
    ds_read_b64_tr_b16 v[118:119], v7 offset:50176
    ds_read_b64_tr_b16 v[120:121], v6 offset:57344
    s_add_u32 m0, s24, 40960
    s_nop 0
    buffer_load_dwordx4 v9, s[16:19], s30 offen lds
    ds_read_b64_tr_b16 v[122:123], v6 offset:58368
    ds_read_b64_tr_b16 v[124:125], v7 offset:57344
    ds_read_b64_tr_b16 v[126:127], v7 offset:58368
    ds_read_b128 v[84:87], v3 offset:2048
    s_add_u32 m0, s24, 147456
    s_add_u32 s31, s33, 1408
    s_and_b32 s31, s31, 2047
    s_add_u32 s31, s31, 262144
    buffer_load_dwordx4 v8, s[8:11], s31 offen lds
    ds_read_b128 v[88:91], v3 offset:4096
    ds_read_b128 v[92:95], v3 offset:6144
    ds_read_b128 v[96:99], v3 offset:8192
    ds_read_b128 v[100:103], v3 offset:10240
    s_add_u32 m0, s24, 155648
    s_add_u32 s31, s33, 1408
    s_and_b32 s31, s31, 2047
    s_add_u32 s31, s31, 393216
    buffer_load_dwordx4 v8, s[8:11], s31 offen lds
    ds_read_b128 v[104:107], v3 offset:12288
    ds_read_b128 v[108:111], v3 offset:14336
    s_waitcnt vmcnt(8) lgkmcnt(0)
    s_barrier
    v_mfma_f32_16x16x32_bf16 v[128:131], v[112:115], v[80:83], v[128:131]
    v_mfma_f32_16x16x32_bf16 v[132:135], v[116:119], v[80:83], v[132:135]
    v_mfma_f32_16x16x32_bf16 v[136:139], v[120:123], v[80:83], v[136:139]
    v_mfma_f32_16x16x32_bf16 v[140:143], v[124:127], v[80:83], v[140:143]
    v_mfma_f32_16x16x32_bf16 v[156:159], v[124:127], v[84:87], v[156:159]
    v_mfma_f32_16x16x32_bf16 v[152:155], v[120:123], v[84:87], v[152:155]
    v_mfma_f32_16x16x32_bf16 v[148:151], v[116:119], v[84:87], v[148:151]
    v_mfma_f32_16x16x32_bf16 v[144:147], v[112:115], v[84:87], v[144:147]
    v_mfma_f32_16x16x32_bf16 v[160:163], v[112:115], v[88:91], v[160:163]
    v_mfma_f32_16x16x32_bf16 v[164:167], v[116:119], v[88:91], v[164:167]
    v_mfma_f32_16x16x32_bf16 v[168:171], v[120:123], v[88:91], v[168:171]
    v_mfma_f32_16x16x32_bf16 v[172:175], v[124:127], v[88:91], v[172:175]
    v_mfma_f32_16x16x32_bf16 v[188:191], v[124:127], v[92:95], v[188:191]
    v_mfma_f32_16x16x32_bf16 v[184:187], v[120:123], v[92:95], v[184:187]
    v_mfma_f32_16x16x32_bf16 v[180:183], v[116:119], v[92:95], v[180:183]
    v_mfma_f32_16x16x32_bf16 v[176:179], v[112:115], v[92:95], v[176:179]
    v_mfma_f32_16x16x32_bf16 v[192:195], v[112:115], v[96:99], v[192:195]
    v_mfma_f32_16x16x32_bf16 v[196:199], v[116:119], v[96:99], v[196:199]
    v_mfma_f32_16x16x32_bf16 v[200:203], v[120:123], v[96:99], v[200:203]
    v_mfma_f32_16x16x32_bf16 v[204:207], v[124:127], v[96:99], v[204:207]
    v_mfma_f32_16x16x32_bf16 v[220:223], v[124:127], v[100:103], v[220:223]
    v_mfma_f32_16x16x32_bf16 v[216:219], v[120:123], v[100:103], v[216:219]
    v_mfma_f32_16x16x32_bf16 v[212:215], v[116:119], v[100:103], v[212:215]
    v_mfma_f32_16x16x32_bf16 v[208:211], v[112:115], v[100:103], v[208:211]
    v_mfma_f32_16x16x32_bf16 v[224:227], v[112:115], v[104:107], v[224:227]
    v_mfma_f32_16x16x32_bf16 v[228:231], v[116:119], v[104:107], v[228:231]
    v_mfma_f32_16x16x32_bf16 v[232:235], v[120:123], v[104:107], v[232:235]
    v_mfma_f32_16x16x32_bf16 v[236:239], v[124:127], v[104:107], v[236:239]
    v_mfma_f32_16x16x32_bf16 v[252:255], v[124:127], v[108:111], v[252:255]
    v_mfma_f32_16x16x32_bf16 v[248:251], v[120:123], v[108:111], v[248:251]
    v_mfma_f32_16x16x32_bf16 v[244:247], v[116:119], v[108:111], v[244:247]
    v_mfma_f32_16x16x32_bf16 v[240:243], v[112:115], v[108:111], v[240:243]
    ds_read_b128 v[32:35], v2 offset:32768
    ds_read_b64_tr_b16 v[64:65], v6 offset:0
    s_add_u32 m0, s24, 49152
    s_add_u32 s30, s32, 736
    s_and_b32 s30, s30, 1023
    s_mul_i32 s30, s30, 7168
    buffer_load_dwordx4 v9, s[12:15], s30 offen lds
    ds_read_b64_tr_b16 v[66:67], v6 offset:1024
    ds_read_b64_tr_b16 v[68:69], v7 offset:0
    ds_read_b64_tr_b16 v[70:71], v7 offset:1024
    ds_read_b64_tr_b16 v[72:73], v6 offset:8192
    s_add_u32 m0, s24, 57344
    s_nop 0
    buffer_load_dwordx4 v9, s[16:19], s30 offen lds
    ds_read_b64_tr_b16 v[74:75], v6 offset:9216
    ds_read_b64_tr_b16 v[76:77], v7 offset:8192
    ds_read_b64_tr_b16 v[78:79], v7 offset:9216
    ds_read_b128 v[36:39], v2 offset:34816
    s_add_u32 m0, s24, 65536
    s_add_u32 s31, s33, 1536
    s_and_b32 s31, s31, 2047
    s_add_u32 s31, s31, 0
    buffer_load_dwordx4 v8, s[8:11], s31 offen lds
    ds_read_b128 v[40:43], v2 offset:36864
    ds_read_b128 v[44:47], v2 offset:38912
    ds_read_b128 v[48:51], v2 offset:40960
    ds_read_b128 v[52:55], v2 offset:43008
    s_add_u32 m0, s24, 73728
    s_add_u32 s31, s33, 1536
    s_and_b32 s31, s31, 2047
    s_add_u32 s31, s31, 131072
    buffer_load_dwordx4 v8, s[8:11], s31 offen lds
    ds_read_b128 v[56:59], v2 offset:45056
    ds_read_b128 v[60:63], v2 offset:47104
    s_cmp_lg_u32 s3, 5
    s_cbranch_scc1 M_pfA19
    buffer_load_dword v1, v31, s[96:99], s35 offen
M_pfA19:
    s_waitcnt vmcnt(8) lgkmcnt(0)
    s_barrier
    v_mfma_f32_16x16x32_bf16 v[128:131], v[64:67], v[32:35], v[128:131]
    v_mfma_f32_16x16x32_bf16 v[132:135], v[68:71], v[32:35], v[132:135]
    v_mfma_f32_16x16x32_bf16 v[136:139], v[72:75], v[32:35], v[136:139]
    v_mfma_f32_16x16x32_bf16 v[140:143], v[76:79], v[32:35], v[140:143]
    v_mfma_f32_16x16x32_bf16 v[156:159], v[76:79], v[36:39], v[156:159]
    v_mfma_f32_16x16x32_bf16 v[152:155], v[72:75], v[36:39], v[152:155]
    v_mfma_f32_16x16x32_bf16 v[148:151], v[68:71], v[36:39], v[148:151]
    v_mfma_f32_16x16x32_bf16 v[144:147], v[64:67], v[36:39], v[144:147]
    v_mfma_f32_16x16x32_bf16 v[160:163], v[64:67], v[40:43], v[160:163]
    v_mfma_f32_16x16x32_bf16 v[164:167], v[68:71], v[40:43], v[164:167]
    v_mfma_f32_16x16x32_bf16 v[168:171], v[72:75], v[40:43], v[168:171]
    v_mfma_f32_16x16x32_bf16 v[172:175], v[76:79], v[40:43], v[172:175]
    v_mfma_f32_16x16x32_bf16 v[188:191], v[76:79], v[44:47], v[188:191]
    v_mfma_f32_16x16x32_bf16 v[184:187], v[72:75], v[44:47], v[184:187]
    v_mfma_f32_16x16x32_bf16 v[180:183], v[68:71], v[44:47], v[180:183]
    v_mfma_f32_16x16x32_bf16 v[176:179], v[64:67], v[44:47], v[176:179]
    v_mfma_f32_16x16x32_bf16 v[192:195], v[64:67], v[48:51], v[192:195]
    v_mfma_f32_16x16x32_bf16 v[196:199], v[68:71], v[48:51], v[196:199]
    v_mfma_f32_16x16x32_bf16 v[200:203], v[72:75], v[48:51], v[200:203]
    v_mfma_f32_16x16x32_bf16 v[204:207], v[76:79], v[48:51], v[204:207]
    v_mfma_f32_16x16x32_bf16 v[220:223], v[76:79], v[52:55], v[220:223]
    v_mfma_f32_16x16x32_bf16 v[216:219], v[72:75], v[52:55], v[216:219]
    v_mfma_f32_16x16x32_bf16 v[212:215], v[68:71], v[52:55], v[212:215]
    v_mfma_f32_16x16x32_bf16 v[208:211], v[64:67], v[52:55], v[208:211]
    v_mfma_f32_16x16x32_bf16 v[224:227], v[64:67], v[56:59], v[224:227]
    v_mfma_f32_16x16x32_bf16 v[228:231], v[68:71], v[56:59], v[228:231]
    v_mfma_f32_16x16x32_bf16 v[232:235], v[72:75], v[56:59], v[232:235]
    v_mfma_f32_16x16x32_bf16 v[236:239], v[76:79], v[56:59], v[236:239]
    v_mfma_f32_16x16x32_bf16 v[252:255], v[76:79], v[60:63], v[252:255]
    v_mfma_f32_16x16x32_bf16 v[248:251], v[72:75], v[60:63], v[248:251]
    v_mfma_f32_16x16x32_bf16 v[244:247], v[68:71], v[60:63], v[244:247]
    v_mfma_f32_16x16x32_bf16 v[240:243], v[64:67], v[60:63], v[240:243]
    ds_read_b128 v[80:83], v3 offset:32768
    ds_read_b64_tr_b16 v[112:113], v6 offset:16384
    s_add_u32 m0, s24, 0
    s_add_u32 s30, s32, 768
    s_and_b32 s30, s30, 1023
    s_mul_i32 s30, s30, 7168
    buffer_load_dwordx4 v9, s[12:15], s30 offen lds
    ds_read_b64_tr_b16 v[114:115], v6 offset:17408
    ds_read_b64_tr_b16 v[116:117], v7 offset:16384
    ds_read_b64_tr_b16 v[118:119], v7 offset:17408
    ds_read_b64_tr_b16 v[120:121], v6 offset:24576
    s_add_u32 m0, s24, 8192
    s_nop 0
    buffer_load_dwordx4 v9, s[16:19], s30 offen lds
    ds_read_b64_tr_b16 v[122:123], v6 offset:25600
    ds_read_b64_tr_b16 v[124:125], v7 offset:24576
    ds_read_b64_tr_b16 v[126:127], v7 offset:25600
    ds_read_b128 v[84:87], v3 offset:34816
    s_add_u32 m0, s24, 81920
    s_add_u32 s31, s33, 1536
    s_and_b32 s31, s31, 2047
    s_add_u32 s31, s31, 262144
    buffer_load_dwordx4 v8, s[8:11], s31 offen lds
    ds_read_b128 v[88:91], v3 offset:36864
    ds_read_b128 v[92:95], v3 offset:38912
    ds_read_b128 v[96:99], v3 offset:40960
    ds_read_b128 v[100:103], v3 offset:43008
    s_add_u32 m0, s24, 90112
    s_add_u32 s31, s33, 1536
    s_and_b32 s31, s31, 2047
    s_add_u32 s31, s31, 393216
    buffer_load_dwordx4 v8, s[8:11], s31 offen lds
    ds_read_b128 v[104:107], v3 offset:45056
    ds_read_b128 v[108:111], v3 offset:47104
    s_waitcnt vmcnt(8) lgkmcnt(0)
    s_barrier
    v_mfma_f32_16x16x32_bf16 v[128:131], v[112:115], v[80:83], v[128:131]
    v_mfma_f32_16x16x32_bf16 v[132:135], v[116:119], v[80:83], v[132:135]
    v_mfma_f32_16x16x32_bf16 v[136:139], v[120:123], v[80:83], v[136:139]
    v_mfma_f32_16x16x32_bf16 v[140:143], v[124:127], v[80:83], v[140:143]
    v_mfma_f32_16x16x32_bf16 v[156:159], v[124:127], v[84:87], v[156:159]
    v_mfma_f32_16x16x32_bf16 v[152:155], v[120:123], v[84:87], v[152:155]
    v_mfma_f32_16x16x32_bf16 v[148:151], v[116:119], v[84:87], v[148:151]
    v_mfma_f32_16x16x32_bf16 v[144:147], v[112:115], v[84:87], v[144:147]
    v_mfma_f32_16x16x32_bf16 v[160:163], v[112:115], v[88:91], v[160:163]
    v_mfma_f32_16x16x32_bf16 v[164:167], v[116:119], v[88:91], v[164:167]
    v_mfma_f32_16x16x32_bf16 v[168:171], v[120:123], v[88:91], v[168:171]
    v_mfma_f32_16x16x32_bf16 v[172:175], v[124:127], v[88:91], v[172:175]
    v_mfma_f32_16x16x32_bf16 v[188:191], v[124:127], v[92:95], v[188:191]
    v_mfma_f32_16x16x32_bf16 v[184:187], v[120:123], v[92:95], v[184:187]
    v_mfma_f32_16x16x32_bf16 v[180:183], v[116:119], v[92:95], v[180:183]
    v_mfma_f32_16x16x32_bf16 v[176:179], v[112:115], v[92:95], v[176:179]
    v_mfma_f32_16x16x32_bf16 v[192:195], v[112:115], v[96:99], v[192:195]
    v_mfma_f32_16x16x32_bf16 v[196:199], v[116:119], v[96:99], v[196:199]
    v_mfma_f32_16x16x32_bf16 v[200:203], v[120:123], v[96:99], v[200:203]
    v_mfma_f32_16x16x32_bf16 v[204:207], v[124:127], v[96:99], v[204:207]
    v_mfma_f32_16x16x32_bf16 v[220:223], v[124:127], v[100:103], v[220:223]
    v_mfma_f32_16x16x32_bf16 v[216:219], v[120:123], v[100:103], v[216:219]
    v_mfma_f32_16x16x32_bf16 v[212:215], v[116:119], v[100:103], v[212:215]
    v_mfma_f32_16x16x32_bf16 v[208:211], v[112:115], v[100:103], v[208:211]
    v_mfma_f32_16x16x32_bf16 v[224:227], v[112:115], v[104:107], v[224:227]
    v_mfma_f32_16x16x32_bf16 v[228:231], v[116:119], v[104:107], v[228:231]
    v_mfma_f32_16x16x32_bf16 v[232:235], v[120:123], v[104:107], v[232:235]
    v_mfma_f32_16x16x32_bf16 v[236:239], v[124:127], v[104:107], v[236:239]
    v_mfma_f32_16x16x32_bf16 v[252:255], v[124:127], v[108:111], v[252:255]
    v_mfma_f32_16x16x32_bf16 v[248:251], v[120:123], v[108:111], v[248:251]
    v_mfma_f32_16x16x32_bf16 v[244:247], v[116:119], v[108:111], v[244:247]
    v_mfma_f32_16x16x32_bf16 v[240:243], v[112:115], v[108:111], v[240:243]
    ds_read_b128 v[32:35], v4 offset:0
    ds_read_b64_tr_b16 v[64:65], v6 offset:32768
    s_add_u32 m0, s24, 16384
    s_add_u32 s30, s32, 800
    s_and_b32 s30, s30, 1023
    s_mul_i32 s30, s30, 7168
    buffer_load_dwordx4 v9, s[12:15], s30 offen lds
    ds_read_b64_tr_b16 v[66:67], v6 offset:33792
    ds_read_b64_tr_b16 v[68:69], v7 offset:32768
    ds_read_b64_tr_b16 v[70:71], v7 offset:33792
    ds_read_b64_tr_b16 v[72:73], v6 offset:40960
    s_add_u32 m0, s24, 24576
    s_nop 0
    buffer_load_dwordx4 v9, s[16:19], s30 offen lds
    ds_read_b64_tr_b16 v[74:75], v6 offset:41984
    ds_read_b64_tr_b16 v[76:77], v7 offset:40960
    ds_read_b64_tr_b16 v[78:79], v7 offset:41984
    ds_read_b128 v[36:39], v4 offset:2048
    s_add_u32 m0, s24, 98304
    s_add_u32 s31, s33, 1664
    s_and_b32 s31, s31, 2047
    s_add_u32 s31, s31, 0
    buffer_load_dwordx4 v8, s[8:11], s31 offen lds
    ds_read_b128 v[40:43], v4 offset:4096
    ds_read_b128 v[44:47], v4 offset:6144
    ds_read_b128 v[48:51], v4 offset:8192
    ds_read_b128 v[52:55], v4 offset:10240
    s_add_u32 m0, s24, 106496
    s_add_u32 s31, s33, 1664
    s_and_b32 s31, s31, 2047
    s_add_u32 s31, s31, 131072
    buffer_load_dwordx4 v8, s[8:11], s31 offen lds
    ds_read_b128 v[56:59], v4 offset:12288
    ds_read_b128 v[60:63], v4 offset:14336
    s_waitcnt vmcnt(8) lgkmcnt(0)
    s_barrier
    v_mfma_f32_16x16x32_bf16 v[128:131], v[64:67], v[32:35], v[128:131]
    v_mfma_f32_16x16x32_bf16 v[132:135], v[68:71], v[32:35], v[132:135]
    v_mfma_f32_16x16x32_bf16 v[136:139], v[72:75], v[32:35], v[136:139]
    v_mfma_f32_16x16x32_bf16 v[140:143], v[76:79], v[32:35], v[140:143]
    v_mfma_f32_16x16x32_bf16 v[156:159], v[76:79], v[36:39], v[156:159]
    v_mfma_f32_16x16x32_bf16 v[152:155], v[72:75], v[36:39], v[152:155]
    v_mfma_f32_16x16x32_bf16 v[148:151], v[68:71], v[36:39], v[148:151]
    v_mfma_f32_16x16x32_bf16 v[144:147], v[64:67], v[36:39], v[144:147]
    v_mfma_f32_16x16x32_bf16 v[160:163], v[64:67], v[40:43], v[160:163]
    v_mfma_f32_16x16x32_bf16 v[164:167], v[68:71], v[40:43], v[164:167]
    v_mfma_f32_16x16x32_bf16 v[168:171], v[72:75], v[40:43], v[168:171]
    v_mfma_f32_16x16x32_bf16 v[172:175], v[76:79], v[40:43], v[172:175]
    v_mfma_f32_16x16x32_bf16 v[188:191], v[76:79], v[44:47], v[188:191]
    v_mfma_f32_16x16x32_bf16 v[184:187], v[72:75], v[44:47], v[184:187]
    v_mfma_f32_16x16x32_bf16 v[180:183], v[68:71], v[44:47], v[180:183]
    v_mfma_f32_16x16x32_bf16 v[176:179], v[64:67], v[44:47], v[176:179]
    v_mfma_f32_16x16x32_bf16 v[192:195], v[64:67], v[48:51], v[192:195]
    v_mfma_f32_16x16x32_bf16 v[196:199], v[68:71], v[48:51], v[196:199]
    v_mfma_f32_16x16x32_bf16 v[200:203], v[72:75], v[48:51], v[200:203]
    v_mfma_f32_16x16x32_bf16 v[204:207], v[76:79], v[48:51], v[204:207]
    v_mfma_f32_16x16x32_bf16 v[220:223], v[76:79], v[52:55], v[220:223]
    v_mfma_f32_16x16x32_bf16 v[216:219], v[72:75], v[52:55], v[216:219]
    v_mfma_f32_16x16x32_bf16 v[212:215], v[68:71], v[52:55], v[212:215]
    v_mfma_f32_16x16x32_bf16 v[208:211], v[64:67], v[52:55], v[208:211]
    v_mfma_f32_16x16x32_bf16 v[224:227], v[64:67], v[56:59], v[224:227]
    v_mfma_f32_16x16x32_bf16 v[228:231], v[68:71], v[56:59], v[228:231]
    v_mfma_f32_16x16x32_bf16 v[232:235], v[72:75], v[56:59], v[232:235]
    v_mfma_f32_16x16x32_bf16 v[236:239], v[76:79], v[56:59], v[236:239]
    v_mfma_f32_16x16x32_bf16 v[252:255], v[76:79], v[60:63], v[252:255]
    v_mfma_f32_16x16x32_bf16 v[248:251], v[72:75], v[60:63], v[248:251]
    v_mfma_f32_16x16x32_bf16 v[244:247], v[68:71], v[60:63], v[244:247]
    v_mfma_f32_16x16x32_bf16 v[240:243], v[64:67], v[60:63], v[240:243]
    ds_read_b128 v[80:83], v5 offset:0
    ds_read_b64_tr_b16 v[112:113], v6 offset:49152
    s_add_u32 m0, s24, 32768
    s_add_u32 s30, s32, 832
    s_and_b32 s30, s30, 1023
    s_mul_i32 s30, s30, 7168
    buffer_load_dwordx4 v9, s[12:15], s30 offen lds
    ds_read_b64_tr_b16 v[114:115], v6 offset:50176
    ds_read_b64_tr_b16 v[116:117], v7 offset:49152
    ds_read_b64_tr_b16 v[118:119], v7 offset:50176
    ds_read_b64_tr_b16 v[120:121], v6 offset:57344
    s_add_u32 m0, s24, 40960
    s_nop 0
    buffer_load_dwordx4 v9, s[16:19], s30 offen lds
    ds_read_b64_tr_b16 v[122:123], v6 offset:58368
    ds_read_b64_tr_b16 v[124:125], v7 offset:57344
    ds_read_b64_tr_b16 v[126:127], v7 offset:58368
    ds_read_b128 v[84:87], v5 offset:2048
    s_add_u32 m0, s24, 114688
    s_add_u32 s31, s33, 1664
    s_and_b32 s31, s31, 2047
    s_add_u32 s31, s31, 262144
    buffer_load_dwordx4 v8, s[8:11], s31 offen lds
    ds_read_b128 v[88:91], v5 offset:4096
    ds_read_b128 v[92:95], v5 offset:6144
    ds_read_b128 v[96:99], v5 offset:8192
    ds_read_b128 v[100:103], v5 offset:10240
    s_add_u32 m0, s24, 122880
    s_add_u32 s31, s33, 1664
    s_and_b32 s31, s31, 2047
    s_add_u32 s31, s31, 393216
    buffer_load_dwordx4 v8, s[8:11], s31 offen lds
    ds_read_b128 v[104:107], v5 offset:12288
    ds_read_b128 v[108:111], v5 offset:14336
    s_cmp_lg_u32 s3, 6
    s_cbranch_scc1 M_pfA22
    buffer_load_dword v1, v31, s[96:99], s35 offen
M_pfA22:
    s_waitcnt vmcnt(8) lgkmcnt(0)
    s_barrier
    v_mfma_f32_16x16x32_bf16 v[128:131], v[112:115], v[80:83], v[128:131]
    v_mfma_f32_16x16x32_bf16 v[132:135], v[116:119], v[80:83], v[132:135]
    v_mfma_f32_16x16x32_bf16 v[136:139], v[120:123], v[80:83], v[136:139]
    v_mfma_f32_16x16x32_bf16 v[140:143], v[124:127], v[80:83], v[140:143]
    v_mfma_f32_16x16x32_bf16 v[156:159], v[124:127], v[84:87], v[156:159]
    v_mfma_f32_16x16x32_bf16 v[152:155], v[120:123], v[84:87], v[152:155]
    v_mfma_f32_16x16x32_bf16 v[148:151], v[116:119], v[84:87], v[148:151]
    v_mfma_f32_16x16x32_bf16 v[144:147], v[112:115], v[84:87], v[144:147]
    v_mfma_f32_16x16x32_bf16 v[160:163], v[112:115], v[88:91], v[160:163]
    v_mfma_f32_16x16x32_bf16 v[164:167], v[116:119], v[88:91], v[164:167]
    v_mfma_f32_16x16x32_bf16 v[168:171], v[120:123], v[88:91], v[168:171]
    v_mfma_f32_16x16x32_bf16 v[172:175], v[124:127], v[88:91], v[172:175]
    v_mfma_f32_16x16x32_bf16 v[188:191], v[124:127], v[92:95], v[188:191]
    v_mfma_f32_16x16x32_bf16 v[184:187], v[120:123], v[92:95], v[184:187]
    v_mfma_f32_16x16x32_bf16 v[180:183], v[116:119], v[92:95], v[180:183]
    v_mfma_f32_16x16x32_bf16 v[176:179], v[112:115], v[92:95], v[176:179]
    v_mfma_f32_16x16x32_bf16 v[192:195], v[112:115], v[96:99], v[192:195]
    v_mfma_f32_16x16x32_bf16 v[196:199], v[116:119], v[96:99], v[196:199]
    v_mfma_f32_16x16x32_bf16 v[200:203], v[120:123], v[96:99], v[200:203]
    v_mfma_f32_16x16x32_bf16 v[204:207], v[124:127], v[96:99], v[204:207]
    v_mfma_f32_16x16x32_bf16 v[220:223], v[124:127], v[100:103], v[220:223]
    v_mfma_f32_16x16x32_bf16 v[216:219], v[120:123], v[100:103], v[216:219]
    v_mfma_f32_16x16x32_bf16 v[212:215], v[116:119], v[100:103], v[212:215]
    v_mfma_f32_16x16x32_bf16 v[208:211], v[112:115], v[100:103], v[208:211]
    v_mfma_f32_16x16x32_bf16 v[224:227], v[112:115], v[104:107], v[224:227]
    v_mfma_f32_16x16x32_bf16 v[228:231], v[116:119], v[104:107], v[228:231]
    v_mfma_f32_16x16x32_bf16 v[232:235], v[120:123], v[104:107], v[232:235]
    v_mfma_f32_16x16x32_bf16 v[236:239], v[124:127], v[104:107], v[236:239]
    v_mfma_f32_16x16x32_bf16 v[252:255], v[124:127], v[108:111], v[252:255]
    v_mfma_f32_16x16x32_bf16 v[248:251], v[120:123], v[108:111], v[248:251]
    v_mfma_f32_16x16x32_bf16 v[244:247], v[116:119], v[108:111], v[244:247]
    v_mfma_f32_16x16x32_bf16 v[240:243], v[112:115], v[108:111], v[240:243]
    ds_read_b128 v[32:35], v2 offset:0
    ds_read_b64_tr_b16 v[64:65], v6 offset:0
    s_add_u32 m0, s24, 49152
    s_add_u32 s30, s32, 864
    s_and_b32 s30, s30, 1023
    s_mul_i32 s30, s30, 7168
    buffer_load_dwordx4 v9, s[12:15], s30 offen lds
    ds_read_b64_tr_b16 v[66:67], v6 offset:1024
    ds_read_b64_tr_b16 v[68:69], v7 offset:0
    ds_read_b64_tr_b16 v[70:71], v7 offset:1024
    ds_read_b64_tr_b16 v[72:73], v6 offset:8192
    s_add_u32 m0, s24, 57344
    s_nop 0
    buffer_load_dwordx4 v9, s[16:19], s30 offen lds
    ds_read_b64_tr_b16 v[74:75], v6 offset:9216
    ds_read_b64_tr_b16 v[76:77], v7 offset:8192
    ds_read_b64_tr_b16 v[78:79], v7 offset:9216
    ds_read_b128 v[36:39], v2 offset:2048
    s_add_u32 m0, s24, 131072
    s_add_u32 s31, s33, 1792
    s_and_b32 s31, s31, 2047
    s_add_u32 s31, s31, 0
    buffer_load_dwordx4 v8, s[8:11], s31 offen lds
    ds_read_b128 v[40:43], v2 offset:4096
    ds_read_b128 v[44:47], v2 offset:6144
    ds_read_b128 v[48:51], v2 offset:8192
    ds_read_b128 v[52:55], v2 offset:10240
    s_add_u32 m0, s24, 139264
    s_add_u32 s31, s33, 1792
    s_and_b32 s31, s31, 2047
    s_add_u32 s31, s31, 131072
    buffer_load_dwordx4 v8, s[8:11], s31 offen lds
    ds_read_b128 v[56:59], v2 offset:12288
    ds_read_b128 v[60:63], v2 offset:14336
    s_waitcnt vmcnt(8) lgkmcnt(0)
    s_barrier
    v_mfma_f32_16x16x32_bf16 v[128:131], v[64:67], v[32:35], v[128:131]
    v_mfma_f32_16x16x32_bf16 v[132:135], v[68:71], v[32:35], v[132:135]
    v_mfma_f32_16x16x32_bf16 v[136:139], v[72:75], v[32:35], v[136:139]
    v_mfma_f32_16x16x32_bf16 v[140:143], v[76:79], v[32:35], v[140:143]
    v_mfma_f32_16x16x32_bf16 v[156:159], v[76:79], v[36:39], v[156:159]
    v_mfma_f32_16x16x32_bf16 v[152:155], v[72:75], v[36:39], v[152:155]
    v_mfma_f32_16x16x32_bf16 v[148:151], v[68:71], v[36:39], v[148:151]
    v_mfma_f32_16x16x32_bf16 v[144:147], v[64:67], v[36:39], v[144:147]
    v_mfma_f32_16x16x32_bf16 v[160:163], v[64:67], v[40:43], v[160:163]
    v_mfma_f32_16x16x32_bf16 v[164:167], v[68:71], v[40:43], v[164:167]
    v_mfma_f32_16x16x32_bf16 v[168:171], v[72:75], v[40:43], v[168:171]
    v_mfma_f32_16x16x32_bf16 v[172:175], v[76:79], v[40:43], v[172:175]
    v_mfma_f32_16x16x32_bf16 v[188:191], v[76:79], v[44:47], v[188:191]
    v_mfma_f32_16x16x32_bf16 v[184:187], v[72:75], v[44:47], v[184:187]
    v_mfma_f32_16x16x32_bf16 v[180:183], v[68:71], v[44:47], v[180:183]
    v_mfma_f32_16x16x32_bf16 v[176:179], v[64:67], v[44:47], v[176:179]
    v_mfma_f32_16x16x32_bf16 v[192:195], v[64:67], v[48:51], v[192:195]
    v_mfma_f32_16x16x32_bf16 v[196:199], v[68:71], v[48:51], v[196:199]
    v_mfma_f32_16x16x32_bf16 v[200:203], v[72:75], v[48:51], v[200:203]
    v_mfma_f32_16x16x32_bf16 v[204:207], v[76:79], v[48:51], v[204:207]
    v_mfma_f32_16x16x32_bf16 v[220:223], v[76:79], v[52:55], v[220:223]
    v_mfma_f32_16x16x32_bf16 v[216:219], v[72:75], v[52:55], v[216:219]
    v_mfma_f32_16x16x32_bf16 v[212:215], v[68:71], v[52:55], v[212:215]
    v_mfma_f32_16x16x32_bf16 v[208:211], v[64:67], v[52:55], v[208:211]
    v_mfma_f32_16x16x32_bf16 v[224:227], v[64:67], v[56:59], v[224:227]
    v_mfma_f32_16x16x32_bf16 v[228:231], v[68:71], v[56:59], v[228:231]
    v_mfma_f32_16x16x32_bf16 v[232:235], v[72:75], v[56:59], v[232:235]
    v_mfma_f32_16x16x32_bf16 v[236:239], v[76:79], v[56:59], v[236:239]
    v_mfma_f32_16x16x32_bf16 v[252:255], v[76:79], v[60:63], v[252:255]
    v_mfma_f32_16x16x32_bf16 v[248:251], v[72:75], v[60:63], v[248:251]
    v_mfma_f32_16x16x32_bf16 v[244:247], v[68:71], v[60:63], v[244:247]
    v_mfma_f32_16x16x32_bf16 v[240:243], v[64:67], v[60:63], v[240:243]
    ds_read_b128 v[80:83], v3 offset:0
    ds_read_b64_tr_b16 v[112:113], v6 offset:16384
    s_add_u32 m0, s24, 0
    s_add_u32 s30, s32, 896
    s_and_b32 s30, s30, 1023
    s_mul_i32 s30, s30, 7168
    buffer_load_dwordx4 v9, s[12:15], s30 offen lds
    ds_read_b64_tr_b16 v[114:115], v6 offset:17408
    ds_read_b64_tr_b16 v[116:117], v7 offset:16384
    ds_read_b64_tr_b16 v[118:119], v7 offset:17408
    ds_read_b64_tr_b16 v[120:121], v6 offset:24576
    s_add_u32 m0, s24, 8192
    s_nop 0
    buffer_load_dwordx4 v9, s[16:19], s30 offen lds
    ds_read_b64_tr_b16 v[122:123], v6 offset:25600
    ds_read_b64_tr_b16 v[124:125], v7 offset:24576
    ds_read_b64_tr_b16 v[126:127], v7 offset:25600
    ds_read_b128 v[84:87], v3 offset:2048
    s_add_u32 m0, s24, 147456
    s_add_u32 s31, s33, 1792
    s_and_b32 s31, s31, 2047
    s_add_u32 s31, s31, 262144
    buffer_load_dwordx4 v8, s[8:11], s31 offen lds
    ds_read_b128 v[88:91], v3 offset:4096
    ds_read_b128 v[92:95], v3 offset:6144
    ds_read_b128 v[96:99], v3 offset:8192
    ds_read_b128 v[100:103], v3 offset:10240
    s_add_u32 m0, s24, 155648
    s_add_u32 s31, s33, 1792
    s_and_b32 s31, s31, 2047
    s_add_u32 s31, s31, 393216
    buffer_load_dwordx4 v8, s[8:11], s31 offen lds
    ds_read_b128 v[104:107], v3 offset:12288
    ds_read_b128 v[108:111], v3 offset:14336
    s_waitcnt vmcnt(8) lgkmcnt(0)
    s_barrier
    v_mfma_f32_16x16x32_bf16 v[128:131], v[112:115], v[80:83], v[128:131]
    v_mfma_f32_16x16x32_bf16 v[132:135], v[116:119], v[80:83], v[132:135]
    v_mfma_f32_16x16x32_bf16 v[136:139], v[120:123], v[80:83], v[136:139]
    v_mfma_f32_16x16x32_bf16 v[140:143], v[124:127], v[80:83], v[140:143]
    v_mfma_f32_16x16x32_bf16 v[156:159], v[124:127], v[84:87], v[156:159]
    v_mfma_f32_16x16x32_bf16 v[152:155], v[120:123], v[84:87], v[152:155]
    v_mfma_f32_16x16x32_bf16 v[148:151], v[116:119], v[84:87], v[148:151]
    v_mfma_f32_16x16x32_bf16 v[144:147], v[112:115], v[84:87], v[144:147]
    v_mfma_f32_16x16x32_bf16 v[160:163], v[112:115], v[88:91], v[160:163]
    v_mfma_f32_16x16x32_bf16 v[164:167], v[116:119], v[88:91], v[164:167]
    v_mfma_f32_16x16x32_bf16 v[168:171], v[120:123], v[88:91], v[168:171]
    v_mfma_f32_16x16x32_bf16 v[172:175], v[124:127], v[88:91], v[172:175]
    v_mfma_f32_16x16x32_bf16 v[188:191], v[124:127], v[92:95], v[188:191]
    v_mfma_f32_16x16x32_bf16 v[184:187], v[120:123], v[92:95], v[184:187]
    v_mfma_f32_16x16x32_bf16 v[180:183], v[116:119], v[92:95], v[180:183]
    v_mfma_f32_16x16x32_bf16 v[176:179], v[112:115], v[92:95], v[176:179]
    v_mfma_f32_16x16x32_bf16 v[192:195], v[112:115], v[96:99], v[192:195]
    v_mfma_f32_16x16x32_bf16 v[196:199], v[116:119], v[96:99], v[196:199]
    v_mfma_f32_16x16x32_bf16 v[200:203], v[120:123], v[96:99], v[200:203]
    v_mfma_f32_16x16x32_bf16 v[204:207], v[124:127], v[96:99], v[204:207]
    v_mfma_f32_16x16x32_bf16 v[220:223], v[124:127], v[100:103], v[220:223]
    v_mfma_f32_16x16x32_bf16 v[216:219], v[120:123], v[100:103], v[216:219]
    v_mfma_f32_16x16x32_bf16 v[212:215], v[116:119], v[100:103], v[212:215]
    v_mfma_f32_16x16x32_bf16 v[208:211], v[112:115], v[100:103], v[208:211]
    v_mfma_f32_16x16x32_bf16 v[224:227], v[112:115], v[104:107], v[224:227]
    v_mfma_f32_16x16x32_bf16 v[228:231], v[116:119], v[104:107], v[228:231]
    v_mfma_f32_16x16x32_bf16 v[232:235], v[120:123], v[104:107], v[232:235]
    v_mfma_f32_16x16x32_bf16 v[236:239], v[124:127], v[104:107], v[236:239]
    v_mfma_f32_16x16x32_bf16 v[252:255], v[124:127], v[108:111], v[252:255]
    v_mfma_f32_16x16x32_bf16 v[248:251], v[120:123], v[108:111], v[248:251]
    v_mfma_f32_16x16x32_bf16 v[244:247], v[116:119], v[108:111], v[244:247]
    v_mfma_f32_16x16x32_bf16 v[240:243], v[112:115], v[108:111], v[240:243]
    ds_read_b128 v[32:35], v2 offset:32768
    ds_read_b64_tr_b16 v[64:65], v6 offset:32768
    s_add_u32 m0, s24, 16384
    s_add_u32 s30, s32, 928
    s_and_b32 s30, s30, 1023
    s_mul_i32 s30, s30, 7168
    buffer_load_dwordx4 v9, s[12:15], s30 offen lds
    ds_read_b64_tr_b16 v[66:67], v6 offset:33792
    ds_read_b64_tr_b16 v[68:69], v7 offset:32768
    ds_read_b64_tr_b16 v[70:71], v7 offset:33792
    ds_read_b64_tr_b16 v[72:73], v6 offset:40960
    s_add_u32 m0, s24, 24576
    s_nop 0
    buffer_load_dwordx4 v9, s[16:19], s30 offen lds
    ds_read_b64_tr_b16 v[74:75], v6 offset:41984
    ds_read_b64_tr_b16 v[76:77], v7 offset:40960
    ds_read_b64_tr_b16 v[78:79], v7 offset:41984
    ds_read_b128 v[36:39], v2 offset:34816
    s_add_u32 m0, s24, 65536
    s_add_u32 s31, s33, 1920
    s_and_b32 s31, s31, 2047
    s_add_u32 s31, s31, 0
    buffer_load_dwordx4 v8, s[8:11], s31 offen lds
    ds_read_b128 v[40:43], v2 offset:36864
    ds_read_b128 v[44:47], v2 offset:38912
    ds_read_b128 v[48:51], v2 offset:40960
    ds_read_b128 v[52:55], v2 offset:43008
    s_add_u32 m0, s24, 73728
    s_add_u32 s31, s33, 1920
    s_and_b32 s31, s31, 2047
    s_add_u32 s31, s31, 131072
    buffer_load_dwordx4 v8, s[8:11], s31 offen lds
    ds_read_b128 v[56:59], v2 offset:45056
    ds_read_b128 v[60:63], v2 offset:47104
    s_cmp_lg_u32 s3, 7
    s_cbranch_scc1 M_pfA25
    buffer_load_dword v1, v31, s[96:99], s35 offen
M_pfA25:
    s_waitcnt vmcnt(8) lgkmcnt(0)
    s_barrier
    v_mfma_f32_16x16x32_bf16 v[128:131], v[64:67], v[32:35], v[128:131]
    v_mfma_f32_16x16x32_bf16 v[132:135], v[68:71], v[32:35], v[132:135]
    v_mfma_f32_16x16x32_bf16 v[136:139], v[72:75], v[32:35], v[136:139]
    v_mfma_f32_16x16x32_bf16 v[140:143], v[76:79], v[32:35], v[140:143]
    v_mfma_f32_16x16x32_bf16 v[156:159], v[76:79], v[36:39], v[156:159]
    v_mfma_f32_16x16x32_bf16 v[152:155], v[72:75], v[36:39], v[152:155]
    v_mfma_f32_16x16x32_bf16 v[148:151], v[68:71], v[36:39], v[148:151]
    v_mfma_f32_16x16x32_bf16 v[144:147], v[64:67], v[36:39], v[144:147]
    v_mfma_f32_16x16x32_bf16 v[160:163], v[64:67], v[40:43], v[160:163]
    v_mfma_f32_16x16x32_bf16 v[164:167], v[68:71], v[40:43], v[164:167]
    v_mfma_f32_16x16x32_bf16 v[168:171], v[72:75], v[40:43], v[168:171]
    v_mfma_f32_16x16x32_bf16 v[172:175], v[76:79], v[40:43], v[172:175]
    v_mfma_f32_16x16x32_bf16 v[188:191], v[76:79], v[44:47], v[188:191]
    v_mfma_f32_16x16x32_bf16 v[184:187], v[72:75], v[44:47], v[184:187]
    v_mfma_f32_16x16x32_bf16 v[180:183], v[68:71], v[44:47], v[180:183]
    v_mfma_f32_16x16x32_bf16 v[176:179], v[64:67], v[44:47], v[176:179]
    v_mfma_f32_16x16x32_bf16 v[192:195], v[64:67], v[48:51], v[192:195]
    v_mfma_f32_16x16x32_bf16 v[196:199], v[68:71], v[48:51], v[196:199]
    v_mfma_f32_16x16x32_bf16 v[200:203], v[72:75], v[48:51], v[200:203]
    v_mfma_f32_16x16x32_bf16 v[204:207], v[76:79], v[48:51], v[204:207]
    v_mfma_f32_16x16x32_bf16 v[220:223], v[76:79], v[52:55], v[220:223]
    v_mfma_f32_16x16x32_bf16 v[216:219], v[72:75], v[52:55], v[216:219]
    v_mfma_f32_16x16x32_bf16 v[212:215], v[68:71], v[52:55], v[212:215]
    v_mfma_f32_16x16x32_bf16 v[208:211], v[64:67], v[52:55], v[208:211]
    v_mfma_f32_16x16x32_bf16 v[224:227], v[64:67], v[56:59], v[224:227]
    v_mfma_f32_16x16x32_bf16 v[228:231], v[68:71], v[56:59], v[228:231]
    v_mfma_f32_16x16x32_bf16 v[232:235], v[72:75], v[56:59], v[232:235]
    v_mfma_f32_16x16x32_bf16 v[236:239], v[76:79], v[56:59], v[236:239]
    v_mfma_f32_16x16x32_bf16 v[252:255], v[76:79], v[60:63], v[252:255]
    v_mfma_f32_16x16x32_bf16 v[248:251], v[72:75], v[60:63], v[248:251]
    v_mfma_f32_16x16x32_bf16 v[244:247], v[68:71], v[60:63], v[244:247]
    v_mfma_f32_16x16x32_bf16 v[240:243], v[64:67], v[60:63], v[240:243]
    ds_read_b128 v[80:83], v3 offset:32768
    ds_read_b64_tr_b16 v[112:113], v6 offset:49152
    s_add_u32 m0, s24, 32768
    s_add_u32 s30, s32, 960
    s_and_b32 s30, s30, 1023
    s_mul_i32 s30, s30, 7168
    buffer_load_dwordx4 v9, s[12:15], s30 offen lds
    ds_read_b64_tr_b16 v[114:115], v6 offset:50176
    ds_read_b64_tr_b16 v[116:117], v7 offset:49152
    ds_read_b64_tr_b16 v[118:119], v7 offset:50176
    ds_read_b64_tr_b16 v[120:121], v6 offset:57344
    s_add_u32 m0, s24, 40960
    s_nop 0
    buffer_load_dwordx4 v9, s[16:19], s30 offen lds
    ds_read_b64_tr_b16 v[122:123], v6 offset:58368
    ds_read_b64_tr_b16 v[124:125], v7 offset:57344
    ds_read_b64_tr_b16 v[126:127], v7 offset:58368
    ds_read_b128 v[84:87], v3 offset:34816
    s_add_u32 m0, s24, 81920
    s_add_u32 s31, s33, 1920
    s_and_b32 s31, s31, 2047
    s_add_u32 s31, s31, 262144
    buffer_load_dwordx4 v8, s[8:11], s31 offen lds
    ds_read_b128 v[88:91], v3 offset:36864
    ds_read_b128 v[92:95], v3 offset:38912
    ds_read_b128 v[96:99], v3 offset:40960
    ds_read_b128 v[100:103], v3 offset:43008
    s_add_u32 m0, s24, 90112
    s_add_u32 s31, s33, 1920
    s_and_b32 s31, s31, 2047
    s_add_u32 s31, s31, 393216
    buffer_load_dwordx4 v8, s[8:11], s31 offen lds
    ds_read_b128 v[104:107], v3 offset:45056
    ds_read_b128 v[108:111], v3 offset:47104
    s_waitcnt vmcnt(8) lgkmcnt(0)
    s_barrier
    v_mfma_f32_16x16x32_bf16 v[128:131], v[112:115], v[80:83], v[128:131]
    v_mfma_f32_16x16x32_bf16 v[132:135], v[116:119], v[80:83], v[132:135]
    v_mfma_f32_16x16x32_bf16 v[136:139], v[120:123], v[80:83], v[136:139]
    v_mfma_f32_16x16x32_bf16 v[140:143], v[124:127], v[80:83], v[140:143]
    v_mfma_f32_16x16x32_bf16 v[156:159], v[124:127], v[84:87], v[156:159]
    v_mfma_f32_16x16x32_bf16 v[152:155], v[120:123], v[84:87], v[152:155]
    v_mfma_f32_16x16x32_bf16 v[148:151], v[116:119], v[84:87], v[148:151]
    v_mfma_f32_16x16x32_bf16 v[144:147], v[112:115], v[84:87], v[144:147]
    v_mfma_f32_16x16x32_bf16 v[160:163], v[112:115], v[88:91], v[160:163]
    v_mfma_f32_16x16x32_bf16 v[164:167], v[116:119], v[88:91], v[164:167]
    v_mfma_f32_16x16x32_bf16 v[168:171], v[120:123], v[88:91], v[168:171]
    v_mfma_f32_16x16x32_bf16 v[172:175], v[124:127], v[88:91], v[172:175]
    v_mfma_f32_16x16x32_bf16 v[188:191], v[124:127], v[92:95], v[188:191]
    v_mfma_f32_16x16x32_bf16 v[184:187], v[120:123], v[92:95], v[184:187]
    v_mfma_f32_16x16x32_bf16 v[180:183], v[116:119], v[92:95], v[180:183]
    v_mfma_f32_16x16x32_bf16 v[176:179], v[112:115], v[92:95], v[176:179]
    v_mfma_f32_16x16x32_bf16 v[192:195], v[112:115], v[96:99], v[192:195]
    v_mfma_f32_16x16x32_bf16 v[196:199], v[116:119], v[96:99], v[196:199]
    v_mfma_f32_16x16x32_bf16 v[200:203], v[120:123], v[96:99], v[200:203]
    v_mfma_f32_16x16x32_bf16 v[204:207], v[124:127], v[96:99], v[204:207]
    v_mfma_f32_16x16x32_bf16 v[220:223], v[124:127], v[100:103], v[220:223]
    v_mfma_f32_16x16x32_bf16 v[216:219], v[120:123], v[100:103], v[216:219]
    v_mfma_f32_16x16x32_bf16 v[212:215], v[116:119], v[100:103], v[212:215]
    v_mfma_f32_16x16x32_bf16 v[208:211], v[112:115], v[100:103], v[208:211]
    v_mfma_f32_16x16x32_bf16 v[224:227], v[112:115], v[104:107], v[224:227]
    v_mfma_f32_16x16x32_bf16 v[228:231], v[116:119], v[104:107], v[228:231]
    v_mfma_f32_16x16x32_bf16 v[232:235], v[120:123], v[104:107], v[232:235]
    v_mfma_f32_16x16x32_bf16 v[236:239], v[124:127], v[104:107], v[236:239]
    v_mfma_f32_16x16x32_bf16 v[252:255], v[124:127], v[108:111], v[252:255]
    v_mfma_f32_16x16x32_bf16 v[248:251], v[120:123], v[108:111], v[248:251]
    v_mfma_f32_16x16x32_bf16 v[244:247], v[116:119], v[108:111], v[244:247]
    v_mfma_f32_16x16x32_bf16 v[240:243], v[112:115], v[108:111], v[240:243]
    ds_read_b128 v[32:35], v4 offset:0
    ds_read_b64_tr_b16 v[64:65], v6 offset:0
    s_add_u32 m0, s24, 49152
    s_add_u32 s30, s32, 992
    s_and_b32 s30, s30, 1023
    s_mul_i32 s30, s30, 7168
    buffer_load_dwordx4 v9, s[12:15], s30 offen lds
    ds_read_b64_tr_b16 v[66:67], v6 offset:1024
    ds_read_b64_tr_b16 v[68:69], v7 offset:0
    ds_read_b64_tr_b16 v[70:71], v7 offset:1024
    ds_read_b64_tr_b16 v[72:73], v6 offset:8192
    s_add_u32 m0, s24, 57344
    s_nop 0
    buffer_load_dwordx4 v9, s[16:19], s30 offen lds
    ds_read_b64_tr_b16 v[74:75], v6 offset:9216
    ds_read_b64_tr_b16 v[76:77], v7 offset:8192
    ds_read_b64_tr_b16 v[78:79], v7 offset:9216
    ds_read_b128 v[36:39], v4 offset:2048
    ds_read_b128 v[40:43], v4 offset:4096
    ds_read_b128 v[44:47], v4 offset:6144
    ds_read_b128 v[48:51], v4 offset:8192
    ds_read_b128 v[52:55], v4 offset:10240
    ds_read_b128 v[56:59], v4 offset:12288
    ds_read_b128 v[60:63], v4 offset:14336
    s_waitcnt vmcnt(6) lgkmcnt(0)
    s_barrier
    v_mfma_f32_16x16x32_bf16 v[128:131], v[64:67], v[32:35], v[128:131]
    v_mfma_f32_16x16x32_bf16 v[132:135], v[68:71], v[32:35], v[132:135]
    v_mfma_f32_16x16x32_bf16 v[136:139], v[72:75], v[32:35], v[136:139]
    v_mfma_f32_16x16x32_bf16 v[140:143], v[76:79], v[32:35], v[140:143]
    v_mfma_f32_16x16x32_bf16 v[156:159], v[76:79], v[36:39], v[156:159]
    v_mfma_f32_16x16x32_bf16 v[152:155], v[72:75], v[36:39], v[152:155]
    v_mfma_f32_16x16x32_bf16 v[148:151], v[68:71], v[36:39], v[148:151]
    v_mfma_f32_16x16x32_bf16 v[144:147], v[64:67], v[36:39], v[144:147]
    v_mfma_f32_16x16x32_bf16 v[160:163], v[64:67], v[40:43], v[160:163]
    v_mfma_f32_16x16x32_bf16 v[164:167], v[68:71], v[40:43], v[164:167]
    v_mfma_f32_16x16x32_bf16 v[168:171], v[72:75], v[40:43], v[168:171]
    v_mfma_f32_16x16x32_bf16 v[172:175], v[76:79], v[40:43], v[172:175]
    v_mfma_f32_16x16x32_bf16 v[188:191], v[76:79], v[44:47], v[188:191]
    v_mfma_f32_16x16x32_bf16 v[184:187], v[72:75], v[44:47], v[184:187]
    v_mfma_f32_16x16x32_bf16 v[180:183], v[68:71], v[44:47], v[180:183]
    v_mfma_f32_16x16x32_bf16 v[176:179], v[64:67], v[44:47], v[176:179]
    v_mfma_f32_16x16x32_bf16 v[192:195], v[64:67], v[48:51], v[192:195]
    v_mfma_f32_16x16x32_bf16 v[196:199], v[68:71], v[48:51], v[196:199]
    v_mfma_f32_16x16x32_bf16 v[200:203], v[72:75], v[48:51], v[200:203]
    v_mfma_f32_16x16x32_bf16 v[204:207], v[76:79], v[48:51], v[204:207]
    v_mfma_f32_16x16x32_bf16 v[220:223], v[76:79], v[52:55], v[220:223]
    v_mfma_f32_16x16x32_bf16 v[216:219], v[72:75], v[52:55], v[216:219]
    v_mfma_f32_16x16x32_bf16 v[212:215], v[68:71], v[52:55], v[212:215]
    v_mfma_f32_16x16x32_bf16 v[208:211], v[64:67], v[52:55], v[208:211]
    v_mfma_f32_16x16x32_bf16 v[224:227], v[64:67], v[56:59], v[224:227]
    v_mfma_f32_16x16x32_bf16 v[228:231], v[68:71], v[56:59], v[228:231]
    v_mfma_f32_16x16x32_bf16 v[232:235], v[72:75], v[56:59], v[232:235]
    v_mfma_f32_16x16x32_bf16 v[236:239], v[76:79], v[56:59], v[236:239]
    v_mfma_f32_16x16x32_bf16 v[252:255], v[76:79], v[60:63], v[252:255]
    v_mfma_f32_16x16x32_bf16 v[248:251], v[72:75], v[60:63], v[248:251]
    v_mfma_f32_16x16x32_bf16 v[244:247], v[68:71], v[60:63], v[244:247]
    v_mfma_f32_16x16x32_bf16 v[240:243], v[64:67], v[60:63], v[240:243]
    ds_read_b128 v[80:83], v5 offset:0
    ds_read_b64_tr_b16 v[112:113], v6 offset:16384
    ds_read_b64_tr_b16 v[114:115], v6 offset:17408
    ds_read_b64_tr_b16 v[116:117], v7 offset:16384
    ds_read_b64_tr_b16 v[118:119], v7 offset:17408
    ds_read_b64_tr_b16 v[120:121], v6 offset:24576
    ds_read_b64_tr_b16 v[122:123], v6 offset:25600
    ds_read_b64_tr_b16 v[124:125], v7 offset:24576
    ds_read_b64_tr_b16 v[126:127], v7 offset:25600
    ds_read_b128 v[84:87], v5 offset:2048
    ds_read_b128 v[88:91], v5 offset:4096
    ds_read_b128 v[92:95], v5 offset:6144
    ds_read_b128 v[96:99], v5 offset:8192
    ds_read_b128 v[100:103], v5 offset:10240
    ds_read_b128 v[104:107], v5 offset:12288
    ds_read_b128 v[108:111], v5 offset:14336
    s_waitcnt vmcnt(2) lgkmcnt(0)
    s_barrier
    v_mfma_f32_16x16x32_bf16 v[128:131], v[112:115], v[80:83], v[128:131]
    v_mfma_f32_16x16x32_bf16 v[132:135], v[116:119], v[80:83], v[132:135]
    v_mfma_f32_16x16x32_bf16 v[136:139], v[120:123], v[80:83], v[136:139]
    v_mfma_f32_16x16x32_bf16 v[140:143], v[124:127], v[80:83], v[140:143]
    v_mfma_f32_16x16x32_bf16 v[156:159], v[124:127], v[84:87], v[156:159]
    v_mfma_f32_16x16x32_bf16 v[152:155], v[120:123], v[84:87], v[152:155]
    v_mfma_f32_16x16x32_bf16 v[148:151], v[116:119], v[84:87], v[148:151]
    v_mfma_f32_16x16x32_bf16 v[144:147], v[112:115], v[84:87], v[144:147]
    v_mfma_f32_16x16x32_bf16 v[160:163], v[112:115], v[88:91], v[160:163]
    v_mfma_f32_16x16x32_bf16 v[164:167], v[116:119], v[88:91], v[164:167]
    v_mfma_f32_16x16x32_bf16 v[168:171], v[120:123], v[88:91], v[168:171]
    v_mfma_f32_16x16x32_bf16 v[172:175], v[124:127], v[88:91], v[172:175]
    v_mfma_f32_16x16x32_bf16 v[188:191], v[124:127], v[92:95], v[188:191]
    v_mfma_f32_16x16x32_bf16 v[184:187], v[120:123], v[92:95], v[184:187]
    v_mfma_f32_16x16x32_bf16 v[180:183], v[116:119], v[92:95], v[180:183]
    v_mfma_f32_16x16x32_bf16 v[176:179], v[112:115], v[92:95], v[176:179]
    v_mfma_f32_16x16x32_bf16 v[192:195], v[112:115], v[96:99], v[192:195]
    v_mfma_f32_16x16x32_bf16 v[196:199], v[116:119], v[96:99], v[196:199]
    v_mfma_f32_16x16x32_bf16 v[200:203], v[120:123], v[96:99], v[200:203]
    v_mfma_f32_16x16x32_bf16 v[204:207], v[124:127], v[96:99], v[204:207]
    v_mfma_f32_16x16x32_bf16 v[220:223], v[124:127], v[100:103], v[220:223]
    v_mfma_f32_16x16x32_bf16 v[216:219], v[120:123], v[100:103], v[216:219]
    v_mfma_f32_16x16x32_bf16 v[212:215], v[116:119], v[100:103], v[212:215]
    v_mfma_f32_16x16x32_bf16 v[208:211], v[112:115], v[100:103], v[208:211]
    v_mfma_f32_16x16x32_bf16 v[224:227], v[112:115], v[104:107], v[224:227]
    v_mfma_f32_16x16x32_bf16 v[228:231], v[116:119], v[104:107], v[228:231]
    v_mfma_f32_16x16x32_bf16 v[232:235], v[120:123], v[104:107], v[232:235]
    v_mfma_f32_16x16x32_bf16 v[236:239], v[124:127], v[104:107], v[236:239]
    v_mfma_f32_16x16x32_bf16 v[252:255], v[124:127], v[108:111], v[252:255]
    v_mfma_f32_16x16x32_bf16 v[248:251], v[120:123], v[108:111], v[248:251]
    v_mfma_f32_16x16x32_bf16 v[244:247], v[116:119], v[108:111], v[244:247]
    v_mfma_f32_16x16x32_bf16 v[240:243], v[112:115], v[108:111], v[240:243]
    ds_read_b128 v[32:35], v2 offset:0
    ds_read_b64_tr_b16 v[64:65], v6 offset:32768
    ds_read_b64_tr_b16 v[66:67], v6 offset:33792
    ds_read_b64_tr_b16 v[68:69], v7 offset:32768
    ds_read_b64_tr_b16 v[70:71], v7 offset:33792
    ds_read_b64_tr_b16 v[72:73], v6 offset:40960
    ds_read_b64_tr_b16 v[74:75], v6 offset:41984
    ds_read_b64_tr_b16 v[76:77], v7 offset:40960
    ds_read_b64_tr_b16 v[78:79], v7 offset:41984
    ds_read_b128 v[36:39], v2 offset:2048
    ds_read_b128 v[40:43], v2 offset:4096
    ds_read_b128 v[44:47], v2 offset:6144
    ds_read_b128 v[48:51], v2 offset:8192
    ds_read_b128 v[52:55], v2 offset:10240
    ds_read_b128 v[56:59], v2 offset:12288
    ds_read_b128 v[60:63], v2 offset:14336
    s_setprio 0
    s_branch M_loopD
M_loopB:
    s_waitcnt vmcnt(12)
    s_barrier
    ds_read_b128 v[32:35], v2 offset:0
    ds_read_b64_tr_b16 v[64:65], v6 offset:0
    ds_read_b64_tr_b16 v[66:67], v6 offset:1024
    ds_read_b64_tr_b16 v[68:69], v7 offset:0
    ds_read_b64_tr_b16 v[70:71], v7 offset:1024
    ds_read_b64_tr_b16 v[72:73], v6 offset:8192
    ds_read_b64_tr_b16 v[74:75], v6 offset:9216
    ds_read_b64_tr_b16 v[76:77], v7 offset:8192
    ds_read_b64_tr_b16 v[78:79], v7 offset:9216
    ds_read_b128 v[36:39], v2 offset:2048
    ds_read_b128 v[40:43], v2 offset:4096
    ds_read_b128 v[44:47], v2 offset:6144
    ds_read_b128 v[48:51], v2 offset:8192
    ds_read_b128 v[52:55], v2 offset:10240
    ds_read_b128 v[56:59], v2 offset:12288
    ds_read_b128 v[60:63], v2 offset:14336
    s_waitcnt lgkmcnt(0)
    s_waitcnt vmcnt(10)
    s_barrier
    ds_read_b128 v[80:83], v3 offset:0
    ds_read_b64_tr_b16 v[112:113], v6 offset:16384
    s_add_u32 m0, s24, 0
    s_add_u32 s30, s32, 128
    s_and_b32 s30, s30, 1023
    s_mul_i32 s30, s30, 7168
    buffer_load_dwordx4 v9, s[12:15], s30 offen lds
    ds_read_b64_tr_b16 v[114:115], v6 offset:17408
    ds_read_b64_tr_b16 v[116:117], v7 offset:16384
    ds_read_b64_tr_b16 v[118:119], v7 offset:17408
    ds_read_b64_tr_b16 v[120:121], v6 offset:24576
    s_add_u32 m0, s24, 8192
    s_nop 0
    buffer_load_dwordx4 v9, s[16:19], s30 offen lds
    ds_read_b64_tr_b16 v[122:123], v6 offset:25600
    ds_read_b64_tr_b16 v[124:125], v7 offset:24576
    ds_read_b64_tr_b16 v[126:127], v7 offset:25600
    ds_read_b128 v[84:87], v3 offset:2048
    s_add_u32 m0, s24, 147456
    s_add_u32 s31, s33, 256
    s_and_b32 s31, s31, 2047
    s_add_u32 s31, s31, 262144
    buffer_load_dwordx4 v8, s[8:11], s31 offen lds
    ds_read_b128 v[88:91], v3 offset:4096
    ds_read_b128 v[92:95], v3 offset:6144
    ds_read_b128 v[96:99], v3 offset:8192
    ds_read_b128 v[100:103], v3 offset:10240
    s_add_u32 m0, s24, 155648
    s_add_u32 s31, s33, 256
    s_and_b32 s31, s31, 2047
    s_add_u32 s31, s31, 393216
    buffer_load_dwordx4 v8, s[8:11], s31 offen lds
    ds_read_b128 v[104:107], v3 offset:12288
    ds_read_b128 v[108:111], v3 offset:14336
    s_mov_b64 exec, 3
    buffer_store_dword v20, v21, s[20:23], 0 offen sc1
    s_mov_b64 exec, -1
    v_mfma_f32_16x16x32_bf16 v[128:131], v[64:67], v[32:35], v[128:131]
    v_mfma_f32_16x16x32_bf16 v[132:135], v[68:71], v[32:35], v[132:135]
    v_mfma_f32_16x16x32_bf16 v[136:139], v[72:75], v[32:35], v[136:139]
    v_mfma_f32_16x16x32_bf16 v[140:143], v[76:79], v[32:35], v[140:143]
    v_mfma_f32_16x16x32_bf16 v[156:159], v[76:79], v[36:39], v[156:159]
    v_mfma_f32_16x16x32_bf16 v[152:155], v[72:75], v[36:39], v[152:155]
    v_mfma_f32_16x16x32_bf16 v[148:151], v[68:71], v[36:39], v[148:151]
    v_mfma_f32_16x16x32_bf16 v[144:147], v[64:67], v[36:39], v[144:147]
    v_mfma_f32_16x16x32_bf16 v[160:163], v[64:67], v[40:43], v[160:163]
    v_mfma_f32_16x16x32_bf16 v[164:167], v[68:71], v[40:43], v[164:167]
    v_mfma_f32_16x16x32_bf16 v[168:171], v[72:75], v[40:43], v[168:171]
    v_mfma_f32_16x16x32_bf16 v[172:175], v[76:79], v[40:43], v[172:175]
    v_mfma_f32_16x16x32_bf16 v[188:191], v[76:79], v[44:47], v[188:191]
    v_mfma_f32_16x16x32_bf16 v[184:187], v[72:75], v[44:47], v[184:187]
    v_mfma_f32_16x16x32_bf16 v[180:183], v[68:71], v[44:47], v[180:183]
    v_mfma_f32_16x16x32_bf16 v[176:179], v[64:67], v[44:47], v[176:179]
    v_mfma_f32_16x16x32_bf16 v[192:195], v[64:67], v[48:51], v[192:195]
    v_mfma_f32_16x16x32_bf16 v[196:199], v[68:71], v[48:51], v[196:199]
    v_mfma_f32_16x16x32_bf16 v[200:203], v[72:75], v[48:51], v[200:203]
    v_mfma_f32_16x16x32_bf16 v[204:207], v[76:79], v[48:51], v[204:207]
    v_mfma_f32_16x16x32_bf16 v[220:223], v[76:79], v[52:55], v[220:223]
    v_mfma_f32_16x16x32_bf16 v[216:219], v[72:75], v[52:55], v[216:219]
    v_mfma_f32_16x16x32_bf16 v[212:215], v[68:71], v[52:55], v[212:215]
    v_mfma_f32_16x16x32_bf16 v[208:211], v[64:67], v[52:55], v[208:211]
    v_mfma_f32_16x16x32_bf16 v[224:227], v[64:67], v[56:59], v[224:227]
    v_mfma_f32_16x16x32_bf16 v[228:231], v[68:71], v[56:59], v[228:231]
    v_mfma_f32_16x16x32_bf16 v[232:235], v[72:75], v[56:59], v[232:235]
    v_mfma_f32_16x16x32_bf16 v[236:239], v[76:79], v[56:59], v[236:239]
    v_mfma_f32_16x16x32_bf16 v[252:255], v[76:79], v[60:63], v[252:255]
    v_mfma_f32_16x16x32_bf16 v[248:251], v[72:75], v[60:63], v[248:251]
    v_mfma_f32_16x16x32_bf16 v[244:247], v[68:71], v[60:63], v[244:247]
    v_mfma_f32_16x16x32_bf16 v[240:243], v[64:67], v[60:63], v[240:243]
    s_waitcnt vmcnt(9) lgkmcnt(0)
    s_barrier
    ds_read_b128 v[32:35], v2 offset:32768
    ds_read_b64_tr_b16 v[64:65], v6 offset:32768
    s_add_u32 m0, s24, 16384
    s_add_u32 s30, s32, 160
    s_and_b32 s30, s30, 1023
    s_mul_i32 s30, s30, 7168
    buffer_load_dwordx4 v9, s[12:15], s30 offen lds
    ds_read_b64_tr_b16 v[66:67], v6 offset:33792
    ds_read_b64_tr_b16 v[68:69], v7 offset:32768
    ds_read_b64_tr_b16 v[70:71], v7 offset:33792
    ds_read_b64_tr_b16 v[72:73], v6 offset:40960
    s_add_u32 m0, s24, 24576
    s_nop 0
    buffer_load_dwordx4 v9, s[16:19], s30 offen lds
    ds_read_b64_tr_b16 v[74:75], v6 offset:41984
    ds_read_b64_tr_b16 v[76:77], v7 offset:40960
    ds_read_b64_tr_b16 v[78:79], v7 offset:41984
    ds_read_b128 v[36:39], v2 offset:34816
    s_add_u32 m0, s24, 65536
    s_add_u32 s31, s33, 384
    s_and_b32 s31, s31, 2047
    s_add_u32 s31, s31, 0
    buffer_load_dwordx4 v8, s[8:11], s31 offen lds
    ds_read_b128 v[40:43], v2 offset:36864
    ds_read_b128 v[44:47], v2 offset:38912
    ds_read_b128 v[48:51], v2 offset:40960
    ds_read_b128 v[52:55], v2 offset:43008
    s_add_u32 m0, s24, 73728
    s_add_u32 s31, s33, 384
    s_and_b32 s31, s31, 2047
    s_add_u32 s31, s31, 131072
    buffer_load_dwordx4 v8, s[8:11], s31 offen lds
    ds_read_b128 v[56:59], v2 offset:45056
    ds_read_b128 v[60:63], v2 offset:47104
    v_mfma_f32_16x16x32_bf16 v[128:131], v[112:115], v[80:83], v[128:131]
    v_mfma_f32_16x16x32_bf16 v[132:135], v[116:119], v[80:83], v[132:135]
    v_mfma_f32_16x16x32_bf16 v[136:139], v[120:123], v[80:83], v[136:139]
    v_mfma_f32_16x16x32_bf16 v[140:143], v[124:127], v[80:83], v[140:143]
    v_mfma_f32_16x16x32_bf16 v[156:159], v[124:127], v[84:87], v[156:159]
    v_mfma_f32_16x16x32_bf16 v[152:155], v[120:123], v[84:87], v[152:155]
    v_mfma_f32_16x16x32_bf16 v[148:151], v[116:119], v[84:87], v[148:151]
    v_mfma_f32_16x16x32_bf16 v[144:147], v[112:115], v[84:87], v[144:147]
    v_mfma_f32_16x16x32_bf16 v[160:163], v[112:115], v[88:91], v[160:163]
    v_mfma_f32_16x16x32_bf16 v[164:167], v[116:119], v[88:91], v[164:167]
    v_mfma_f32_16x16x32_bf16 v[168:171], v[120:123], v[88:91], v[168:171]
    v_mfma_f32_16x16x32_bf16 v[172:175], v[124:127], v[88:91], v[172:175]
    v_mfma_f32_16x16x32_bf16 v[188:191], v[124:127], v[92:95], v[188:191]
    v_mfma_f32_16x16x32_bf16 v[184:187], v[120:123], v[92:95], v[184:187]
    v_mfma_f32_16x16x32_bf16 v[180:183], v[116:119], v[92:95], v[180:183]
    v_mfma_f32_16x16x32_bf16 v[176:179], v[112:115], v[92:95], v[176:179]
    v_mfma_f32_16x16x32_bf16 v[192:195], v[112:115], v[96:99], v[192:195]
    v_mfma_f32_16x16x32_bf16 v[196:199], v[116:119], v[96:99], v[196:199]
    v_mfma_f32_16x16x32_bf16 v[200:203], v[120:123], v[96:99], v[200:203]
    v_mfma_f32_16x16x32_bf16 v[204:207], v[124:127], v[96:99], v[204:207]
    v_mfma_f32_16x16x32_bf16 v[220:223], v[124:127], v[100:103], v[220:223]
    v_mfma_f32_16x16x32_bf16 v[216:219], v[120:123], v[100:103], v[216:219]
    v_mfma_f32_16x16x32_bf16 v[212:215], v[116:119], v[100:103], v[212:215]
    v_mfma_f32_16x16x32_bf16 v[208:211], v[112:115], v[100:103], v[208:211]
    v_mfma_f32_16x16x32_bf16 v[224:227], v[112:115], v[104:107], v[224:227]
    v_mfma_f32_16x16x32_bf16 v[228:231], v[116:119], v[104:107], v[228:231]
    v_mfma_f32_16x16x32_bf16 v[232:235], v[120:123], v[104:107], v[232:235]
    v_mfma_f32_16x16x32_bf16 v[236:239], v[124:127], v[104:107], v[236:239]
    v_mfma_f32_16x16x32_bf16 v[252:255], v[124:127], v[108:111], v[252:255]
    v_mfma_f32_16x16x32_bf16 v[248:251], v[120:123], v[108:111], v[248:251]
    v_mfma_f32_16x16x32_bf16 v[244:247], v[116:119], v[108:111], v[244:247]
    v_mfma_f32_16x16x32_bf16 v[240:243], v[112:115], v[108:111], v[240:243]
    s_waitcnt vmcnt(9) lgkmcnt(0)
    s_barrier
    ds_read_b128 v[80:83], v3 offset:32768
    ds_read_b64_tr_b16 v[112:113], v6 offset:49152
    s_add_u32 m0, s24, 32768
    s_add_u32 s30, s32, 192
    s_and_b32 s30, s30, 1023
    s_mul_i32 s30, s30, 7168
    buffer_load_dwordx4 v9, s[12:15], s30 offen lds
    ds_read_b64_tr_b16 v[114:115], v6 offset:50176
    ds_read_b64_tr_b16 v[116:117], v7 offset:49152
    ds_read_b64_tr_b16 v[118:119], v7 offset:50176
    ds_read_b64_tr_b16 v[120:121], v6 offset:57344
    s_add_u32 m0, s24, 40960
    s_nop 0
    buffer_load_dwordx4 v9, s[16:19], s30 offen lds
    ds_read_b64_tr_b16 v[122:123], v6 offset:58368
    ds_read_b64_tr_b16 v[124:125], v7 offset:57344
    ds_read_b64_tr_b16 v[126:127], v7 offset:58368
    ds_read_b128 v[84:87], v3 offset:34816
    s_add_u32 m0, s24, 81920
    s_add_u32 s31, s33, 384
    s_and_b32 s31, s31, 2047
    s_add_u32 s31, s31, 262144
    buffer_load_dwordx4 v8, s[8:11], s31 offen lds
    ds_read_b128 v[88:91], v3 offset:36864
    ds_read_b128 v[92:95], v3 offset:38912
    ds_read_b128 v[96:99], v3 offset:40960
    ds_read_b128 v[100:103], v3 offset:43008
    s_add_u32 m0, s24, 90112
    s_add_u32 s31, s33, 384
    s_and_b32 s31, s31, 2047
    s_add_u32 s31, s31, 393216
    buffer_load_dwordx4 v8, s[8:11], s31 offen lds
    ds_read_b128 v[104:107], v3 offset:45056
    ds_read_b128 v[108:111], v3 offset:47104
    v_mov_b32 v12, -1
    v_mov_b32 v13, -1
    v_mov_b32 v14, -1
    v_mov_b32 v15, -1
    s_lshl_b32 s40, s44, 3
    s_add_u32 s40, s40, s45
    s_lshl_b32 s40, s40, 1
    s_add_u32 s40, s40, s46
    s_lshl_b32 s40, s40, 14
    s_lshl_b32 s41, s3, 11
    s_add_u32 s40, s40, s41
    s_add_u32 s40, s40, 37748736
    s_lshl_b32 s43, s2, 14
    s_add_u32 s41, s41, s43
    s_add_u32 s41, s41, 41943040
    buffer_store_dwordx4 v[12:15], v10, s[20:23], s40 offen offset:0 sc1
    v_mfma_f32_16x16x32_bf16 v[128:131], v[64:67], v[32:35], v[128:131]
    v_mfma_f32_16x16x32_bf16 v[132:135], v[68:71], v[32:35], v[132:135]
    v_mfma_f32_16x16x32_bf16 v[136:139], v[72:75], v[32:35], v[136:139]
    v_mfma_f32_16x16x32_bf16 v[140:143], v[76:79], v[32:35], v[140:143]
    v_mfma_f32_16x16x32_bf16 v[156:159], v[76:79], v[36:39], v[156:159]
    v_mfma_f32_16x16x32_bf16 v[152:155], v[72:75], v[36:39], v[152:155]
    v_mfma_f32_16x16x32_bf16 v[148:151], v[68:71], v[36:39], v[148:151]
    v_mfma_f32_16x16x32_bf16 v[144:147], v[64:67], v[36:39], v[144:147]
    v_mfma_f32_16x16x32_bf16 v[160:163], v[64:67], v[40:43], v[160:163]
    v_mfma_f32_16x16x32_bf16 v[164:167], v[68:71], v[40:43], v[164:167]
    v_mfma_f32_16x16x32_bf16 v[168:171], v[72:75], v[40:43], v[168:171]
    v_mfma_f32_16x16x32_bf16 v[172:175], v[76:79], v[40:43], v[172:175]
    v_mfma_f32_16x16x32_bf16 v[188:191], v[76:79], v[44:47], v[188:191]
    v_mfma_f32_16x16x32_bf16 v[184:187], v[72:75], v[44:47], v[184:187]
    v_mfma_f32_16x16x32_bf16 v[180:183], v[68:71], v[44:47], v[180:183]
    v_mfma_f32_16x16x32_bf16 v[176:179], v[64:67], v[44:47], v[176:179]
    v_mfma_f32_16x16x32_bf16 v[192:195], v[64:67], v[48:51], v[192:195]
    v_mfma_f32_16x16x32_bf16 v[196:199], v[68:71], v[48:51], v[196:199]
    v_mfma_f32_16x16x32_bf16 v[200:203], v[72:75], v[48:51], v[200:203]
    v_mfma_f32_16x16x32_bf16 v[204:207], v[76:79], v[48:51], v[204:207]
    v_mfma_f32_16x16x32_bf16 v[220:223], v[76:79], v[52:55], v[220:223]
    v_mfma_f32_16x16x32_bf16 v[216:219], v[72:75], v[52:55], v[216:219]
    v_mfma_f32_16x16x32_bf16 v[212:215], v[68:71], v[52:55], v[212:215]
    v_mfma_f32_16x16x32_bf16 v[208:211], v[64:67], v[52:55], v[208:211]
    v_mfma_f32_16x16x32_bf16 v[224:227], v[64:67], v[56:59], v[224:227]
    v_mfma_f32_16x16x32_bf16 v[228:231], v[68:71], v[56:59], v[228:231]
    v_mfma_f32_16x16x32_bf16 v[232:235], v[72:75], v[56:59], v[232:235]
    v_mfma_f32_16x16x32_bf16 v[236:239], v[76:79], v[56:59], v[236:239]
    v_mfma_f32_16x16x32_bf16 v[252:255], v[76:79], v[60:63], v[252:255]
    v_mfma_f32_16x16x32_bf16 v[248:251], v[72:75], v[60:63], v[248:251]
    v_mfma_f32_16x16x32_bf16 v[244:247], v[68:71], v[60:63], v[244:247]
    v_mfma_f32_16x16x32_bf16 v[240:243], v[64:67], v[60:63], v[240:243]
    s_waitcnt vmcnt(9) lgkmcnt(0)
    s_barrier
    ds_read_b128 v[32:35], v4 offset:0
    ds_read_b64_tr_b16 v[64:65], v6 offset:0
    s_add_u32 m0, s24, 49152
    s_add_u32 s30, s32, 224
    s_and_b32 s30, s30, 1023
    s_mul_i32 s30, s30, 7168
    buffer_load_dwordx4 v9, s[12:15], s30 offen lds
    ds_read_b64_tr_b16 v[66:67], v6 offset:1024
    ds_read_b64_tr_b16 v[68:69], v7 offset:0
    ds_read_b64_tr_b16 v[70:71], v7 offset:1024
    ds_read_b64_tr_b16 v[72:73], v6 offset:8192
    s_add_u32 m0, s24, 57344
    s_nop 0
    buffer_load_dwordx4 v9, s[16:19], s30 offen lds
    ds_read_b64_tr_b16 v[74:75], v6 offset:9216
    ds_read_b64_tr_b16 v[76:77], v7 offset:8192
    ds_read_b64_tr_b16 v[78:79], v7 offset:9216
    ds_read_b128 v[36:39], v4 offset:2048
    s_add_u32 m0, s24, 98304
    s_add_u32 s31, s33, 512
    s_and_b32 s31, s31, 2047
    s_add_u32 s31, s31, 0
    buffer_load_dwordx4 v8, s[8:11], s31 offen lds
    ds_read_b128 v[40:43], v4 offset:4096
    ds_read_b128 v[44:47], v4 offset:6144
    ds_read_b128 v[48:51], v4 offset:8192
    ds_read_b128 v[52:55], v4 offset:10240
    s_add_u32 m0, s24, 106496
    s_add_u32 s31, s33, 512
    s_and_b32 s31, s31, 2047
    s_add_u32 s31, s31, 131072
    buffer_load_dwordx4 v8, s[8:11], s31 offen lds
    ds_read_b128 v[56:59], v4 offset:12288
    ds_read_b128 v[60:63], v4 offset:14336
    v_mfma_f32_16x16x32_bf16 v[128:131], v[112:115], v[80:83], v[128:131]
    v_mfma_f32_16x16x32_bf16 v[132:135], v[116:119], v[80:83], v[132:135]
    v_mfma_f32_16x16x32_bf16 v[136:139], v[120:123], v[80:83], v[136:139]
    v_mfma_f32_16x16x32_bf16 v[140:143], v[124:127], v[80:83], v[140:143]
    v_mfma_f32_16x16x32_bf16 v[156:159], v[124:127], v[84:87], v[156:159]
    v_mfma_f32_16x16x32_bf16 v[152:155], v[120:123], v[84:87], v[152:155]
    v_mfma_f32_16x16x32_bf16 v[148:151], v[116:119], v[84:87], v[148:151]
    v_mfma_f32_16x16x32_bf16 v[144:147], v[112:115], v[84:87], v[144:147]
    v_mfma_f32_16x16x32_bf16 v[160:163], v[112:115], v[88:91], v[160:163]
    v_mfma_f32_16x16x32_bf16 v[164:167], v[116:119], v[88:91], v[164:167]
    v_mfma_f32_16x16x32_bf16 v[168:171], v[120:123], v[88:91], v[168:171]
    v_mfma_f32_16x16x32_bf16 v[172:175], v[124:127], v[88:91], v[172:175]
    v_mfma_f32_16x16x32_bf16 v[188:191], v[124:127], v[92:95], v[188:191]
    v_mfma_f32_16x16x32_bf16 v[184:187], v[120:123], v[92:95], v[184:187]
    v_mfma_f32_16x16x32_bf16 v[180:183], v[116:119], v[92:95], v[180:183]
    v_mfma_f32_16x16x32_bf16 v[176:179], v[112:115], v[92:95], v[176:179]
    v_mfma_f32_16x16x32_bf16 v[192:195], v[112:115], v[96:99], v[192:195]
    v_mfma_f32_16x16x32_bf16 v[196:199], v[116:119], v[96:99], v[196:199]
    v_mfma_f32_16x16x32_bf16 v[200:203], v[120:123], v[96:99], v[200:203]
    v_mfma_f32_16x16x32_bf16 v[204:207], v[124:127], v[96:99], v[204:207]
    v_mfma_f32_16x16x32_bf16 v[220:223], v[124:127], v[100:103], v[220:223]
    v_mfma_f32_16x16x32_bf16 v[216:219], v[120:123], v[100:103], v[216:219]
    v_mfma_f32_16x16x32_bf16 v[212:215], v[116:119], v[100:103], v[212:215]
    v_mfma_f32_16x16x32_bf16 v[208:211], v[112:115], v[100:103], v[208:211]
    v_mfma_f32_16x16x32_bf16 v[224:227], v[112:115], v[104:107], v[224:227]
    v_mfma_f32_16x16x32_bf16 v[228:231], v[116:119], v[104:107], v[228:231]
    v_mfma_f32_16x16x32_bf16 v[232:235], v[120:123], v[104:107], v[232:235]
    v_mfma_f32_16x16x32_bf16 v[236:239], v[124:127], v[104:107], v[236:239]
    v_mfma_f32_16x16x32_bf16 v[252:255], v[124:127], v[108:111], v[252:255]
    v_mfma_f32_16x16x32_bf16 v[248:251], v[120:123], v[108:111], v[248:251]
    v_mfma_f32_16x16x32_bf16 v[244:247], v[116:119], v[108:111], v[244:247]
    v_mfma_f32_16x16x32_bf16 v[240:243], v[112:115], v[108:111], v[240:243]
    s_waitcnt vmcnt(9) lgkmcnt(0)
    s_barrier
    ds_read_b128 v[80:83], v5 offset:0
    ds_read_b64_tr_b16 v[112:113], v6 offset:16384
    s_add_u32 m0, s24, 0
    s_add_u32 s30, s32, 256
    s_and_b32 s30, s30, 1023
    s_mul_i32 s30, s30, 7168
    buffer_load_dwordx4 v9, s[12:15], s30 offen lds
    ds_read_b64_tr_b16 v[114:115], v6 offset:17408
    ds_read_b64_tr_b16 v[116:117], v7 offset:16384
    ds_read_b64_tr_b16 v[118:119], v7 offset:17408
    ds_read_b64_tr_b16 v[120:121], v6 offset:24576
    s_add_u32 m0, s24, 8192
    s_nop 0
    buffer_load_dwordx4 v9, s[16:19], s30 offen lds
    ds_read_b64_tr_b16 v[122:123], v6 offset:25600
    ds_read_b64_tr_b16 v[124:125], v7 offset:24576
    ds_read_b64_tr_b16 v[126:127], v7 offset:25600
    ds_read_b128 v[84:87], v5 offset:2048
    s_add_u32 m0, s24, 114688
    s_add_u32 s31, s33, 512
    s_and_b32 s31, s31, 2047
    s_add_u32 s31, s31, 262144
    buffer_load_dwordx4 v8, s[8:11], s31 offen lds
    ds_read_b128 v[88:91], v5 offset:4096
    ds_read_b128 v[92:95], v5 offset:6144
    ds_read_b128 v[96:99], v5 offset:8192
    ds_read_b128 v[100:103], v5 offset:10240
    s_add_u32 m0, s24, 122880
    s_add_u32 s31, s33, 512
    s_and_b32 s31, s31, 2047
    s_add_u32 s31, s31, 393216
    buffer_load_dwordx4 v8, s[8:11], s31 offen lds
    ds_read_b128 v[104:107], v5 offset:12288
    ds_read_b128 v[108:111], v5 offset:14336
    s_cmp_lg_u32 s3, 0
    s_cbranch_scc1 M_pfB4
    buffer_load_dword v1, v31, s[96:99], s35 offen
M_pfB4:
    v_mfma_f32_16x16x32_bf16 v[128:131], v[64:67], v[32:35], v[128:131]
    v_mfma_f32_16x16x32_bf16 v[132:135], v[68:71], v[32:35], v[132:135]
    v_mfma_f32_16x16x32_bf16 v[136:139], v[72:75], v[32:35], v[136:139]
    v_mfma_f32_16x16x32_bf16 v[140:143], v[76:79], v[32:35], v[140:143]
    v_mfma_f32_16x16x32_bf16 v[156:159], v[76:79], v[36:39], v[156:159]
    v_mfma_f32_16x16x32_bf16 v[152:155], v[72:75], v[36:39], v[152:155]
    v_mfma_f32_16x16x32_bf16 v[148:151], v[68:71], v[36:39], v[148:151]
    v_mfma_f32_16x16x32_bf16 v[144:147], v[64:67], v[36:39], v[144:147]
    v_mfma_f32_16x16x32_bf16 v[160:163], v[64:67], v[40:43], v[160:163]
    v_mfma_f32_16x16x32_bf16 v[164:167], v[68:71], v[40:43], v[164:167]
    v_mfma_f32_16x16x32_bf16 v[168:171], v[72:75], v[40:43], v[168:171]
    v_mfma_f32_16x16x32_bf16 v[172:175], v[76:79], v[40:43], v[172:175]
    v_mfma_f32_16x16x32_bf16 v[188:191], v[76:79], v[44:47], v[188:191]
    v_mfma_f32_16x16x32_bf16 v[184:187], v[72:75], v[44:47], v[184:187]
    v_mfma_f32_16x16x32_bf16 v[180:183], v[68:71], v[44:47], v[180:183]
    v_mfma_f32_16x16x32_bf16 v[176:179], v[64:67], v[44:47], v[176:179]
    v_mfma_f32_16x16x32_bf16 v[192:195], v[64:67], v[48:51], v[192:195]
    v_mfma_f32_16x16x32_bf16 v[196:199], v[68:71], v[48:51], v[196:199]
    v_mfma_f32_16x16x32_bf16 v[200:203], v[72:75], v[48:51], v[200:203]
    v_mfma_f32_16x16x32_bf16 v[204:207], v[76:79], v[48:51], v[204:207]
    v_mfma_f32_16x16x32_bf16 v[220:223], v[76:79], v[52:55], v[220:223]
    v_mfma_f32_16x16x32_bf16 v[216:219], v[72:75], v[52:55], v[216:219]
    v_mfma_f32_16x16x32_bf16 v[212:215], v[68:71], v[52:55], v[212:215]
    v_mfma_f32_16x16x32_bf16 v[208:211], v[64:67], v[52:55], v[208:211]
    v_mfma_f32_16x16x32_bf16 v[224:227], v[64:67], v[56:59], v[224:227]
    v_mfma_f32_16x16x32_bf16 v[228:231], v[68:71], v[56:59], v[228:231]
    v_mfma_f32_16x16x32_bf16 v[232:235], v[72:75], v[56:59], v[232:235]
    v_mfma_f32_16x16x32_bf16 v[236:239], v[76:79], v[56:59], v[236:239]
    v_mfma_f32_16x16x32_bf16 v[252:255], v[76:79], v[60:63], v[252:255]
    v_mfma_f32_16x16x32_bf16 v[248:251], v[72:75], v[60:63], v[248:251]
    v_mfma_f32_16x16x32_bf16 v[244:247], v[68:71], v[60:63], v[244:247]
    v_mfma_f32_16x16x32_bf16 v[240:243], v[64:67], v[60:63], v[240:243]
    s_waitcnt vmcnt(8) lgkmcnt(0)
    s_barrier
    ds_read_b128 v[32:35], v2 offset:0
    ds_read_b64_tr_b16 v[64:65], v6 offset:32768
    s_add_u32 m0, s24, 16384
    s_add_u32 s30, s32, 288
    s_and_b32 s30, s30, 1023
    s_mul_i32 s30, s30, 7168
    buffer_load_dwordx4 v9, s[12:15], s30 offen lds
    ds_read_b64_tr_b16 v[66:67], v6 offset:33792
    ds_read_b64_tr_b16 v[68:69], v7 offset:32768
    ds_read_b64_tr_b16 v[70:71], v7 offset:33792
    ds_read_b64_tr_b16 v[72:73], v6 offset:40960
    s_add_u32 m0, s24, 24576
    s_nop 0
    buffer_load_dwordx4 v9, s[16:19], s30 offen lds
    ds_read_b64_tr_b16 v[74:75], v6 offset:41984
    ds_read_b64_tr_b16 v[76:77], v7 offset:40960
    ds_read_b64_tr_b16 v[78:79], v7 offset:41984
    ds_read_b128 v[36:39], v2 offset:2048
    s_add_u32 m0, s24, 131072
    s_add_u32 s31, s33, 640
    s_and_b32 s31, s31, 2047
    s_add_u32 s31, s31, 0
    buffer_load_dwordx4 v8, s[8:11], s31 offen lds
    ds_read_b128 v[40:43], v2 offset:4096
    ds_read_b128 v[44:47], v2 offset:6144
    ds_read_b128 v[48:51], v2 offset:8192
    ds_read_b128 v[52:55], v2 offset:10240
    s_add_u32 m0, s24, 139264
    s_add_u32 s31, s33, 640
    s_and_b32 s31, s31, 2047
    s_add_u32 s31, s31, 131072
    buffer_load_dwordx4 v8, s[8:11], s31 offen lds
    ds_read_b128 v[56:59], v2 offset:12288
    ds_read_b128 v[60:63], v2 offset:14336
    buffer_store_dwordx4 v[12:15], v10, s[20:23], s40 offen offset:1024 sc1
    v_mfma_f32_16x16x32_bf16 v[128:131], v[112:115], v[80:83], v[128:131]
    v_mfma_f32_16x16x32_bf16 v[132:135], v[116:119], v[80:83], v[132:135]
    v_mfma_f32_16x16x32_bf16 v[136:139], v[120:123], v[80:83], v[136:139]
    v_mfma_f32_16x16x32_bf16 v[140:143], v[124:127], v[80:83], v[140:143]
    v_mfma_f32_16x16x32_bf16 v[156:159], v[124:127], v[84:87], v[156:159]
    v_mfma_f32_16x16x32_bf16 v[152:155], v[120:123], v[84:87], v[152:155]
    v_mfma_f32_16x16x32_bf16 v[148:151], v[116:119], v[84:87], v[148:151]
    v_mfma_f32_16x16x32_bf16 v[144:147], v[112:115], v[84:87], v[144:147]
    v_mfma_f32_16x16x32_bf16 v[160:163], v[112:115], v[88:91], v[160:163]
    v_mfma_f32_16x16x32_bf16 v[164:167], v[116:119], v[88:91], v[164:167]
    v_mfma_f32_16x16x32_bf16 v[168:171], v[120:123], v[88:91], v[168:171]
    v_mfma_f32_16x16x32_bf16 v[172:175], v[124:127], v[88:91], v[172:175]
    v_mfma_f32_16x16x32_bf16 v[188:191], v[124:127], v[92:95], v[188:191]
    v_mfma_f32_16x16x32_bf16 v[184:187], v[120:123], v[92:95], v[184:187]
    v_mfma_f32_16x16x32_bf16 v[180:183], v[116:119], v[92:95], v[180:183]
    v_mfma_f32_16x16x32_bf16 v[176:179], v[112:115], v[92:95], v[176:179]
    v_mfma_f32_16x16x32_bf16 v[192:195], v[112:115], v[96:99], v[192:195]
    v_mfma_f32_16x16x32_bf16 v[196:199], v[116:119], v[96:99], v[196:199]
    v_mfma_f32_16x16x32_bf16 v[200:203], v[120:123], v[96:99], v[200:203]
    v_mfma_f32_16x16x32_bf16 v[204:207], v[124:127], v[96:99], v[204:207]
    v_mfma_f32_16x16x32_bf16 v[220:223], v[124:127], v[100:103], v[220:223]
    v_mfma_f32_16x16x32_bf16 v[216:219], v[120:123], v[100:103], v[216:219]
    v_mfma_f32_16x16x32_bf16 v[212:215], v[116:119], v[100:103], v[212:215]
    v_mfma_f32_16x16x32_bf16 v[208:211], v[112:115], v[100:103], v[208:211]
    v_mfma_f32_16x16x32_bf16 v[224:227], v[112:115], v[104:107], v[224:227]
    v_mfma_f32_16x16x32_bf16 v[228:231], v[116:119], v[104:107], v[228:231]
    v_mfma_f32_16x16x32_bf16 v[232:235], v[120:123], v[104:107], v[232:235]
    v_mfma_f32_16x16x32_bf16 v[236:239], v[124:127], v[104:107], v[236:239]
    v_mfma_f32_16x16x32_bf16 v[252:255], v[124:127], v[108:111], v[252:255]
    v_mfma_f32_16x16x32_bf16 v[248:251], v[120:123], v[108:111], v[248:251]
    v_mfma_f32_16x16x32_bf16 v[244:247], v[116:119], v[108:111], v[244:247]
    v_mfma_f32_16x16x32_bf16 v[240:243], v[112:115], v[108:111], v[240:243]
    s_waitcnt vmcnt(9) lgkmcnt(0)
    s_barrier
    ds_read_b128 v[80:83], v3 offset:0
    ds_read_b64_tr_b16 v[112:113], v6 offset:49152
    s_add_u32 m0, s24, 32768
    s_add_u32 s30, s32, 320
    s_and_b32 s30, s30, 1023
    s_mul_i32 s30, s30, 7168
    buffer_load_dwordx4 v9, s[12:15], s30 offen lds
    ds_read_b64_tr_b16 v[114:115], v6 offset:50176
    ds_read_b64_tr_b16 v[116:117], v7 offset:49152
    ds_read_b64_tr_b16 v[118:119], v7 offset:50176
    ds_read_b64_tr_b16 v[120:121], v6 offset:57344
    s_add_u32 m0, s24, 40960
    s_nop 0
    buffer_load_dwordx4 v9, s[16:19], s30 offen lds
    ds_read_b64_tr_b16 v[122:123], v6 offset:58368
    ds_read_b64_tr_b16 v[124:125], v7 offset:57344
    ds_read_b64_tr_b16 v[126:127], v7 offset:58368
    ds_read_b128 v[84:87], v3 offset:2048
    s_add_u32 m0, s24, 147456
    s_add_u32 s31, s33, 640
    s_and_b32 s31, s31, 2047
    s_add_u32 s31, s31, 262144
    buffer_load_dwordx4 v8, s[8:11], s31 offen lds
    ds_read_b128 v[88:91], v3 offset:4096
    ds_read_b128 v[92:95], v3 offset:6144
    ds_read_b128 v[96:99], v3 offset:8192
    ds_read_b128 v[100:103], v3 offset:10240
    s_add_u32 m0, s24, 155648
    s_add_u32 s31, s33, 640
    s_and_b32 s31, s31, 2047
    s_add_u32 s31, s31, 393216
    buffer_load_dwordx4 v8, s[8:11], s31 offen lds
    ds_read_b128 v[104:107], v3 offset:12288
    ds_read_b128 v[108:111], v3 offset:14336
    v_mfma_f32_16x16x32_bf16 v[128:131], v[64:67], v[32:35], v[128:131]
    v_mfma_f32_16x16x32_bf16 v[132:135], v[68:71], v[32:35], v[132:135]
    v_mfma_f32_16x16x32_bf16 v[136:139], v[72:75], v[32:35], v[136:139]
    v_mfma_f32_16x16x32_bf16 v[140:143], v[76:79], v[32:35], v[140:143]
    v_mfma_f32_16x16x32_bf16 v[156:159], v[76:79], v[36:39], v[156:159]
    v_mfma_f32_16x16x32_bf16 v[152:155], v[72:75], v[36:39], v[152:155]
    v_mfma_f32_16x16x32_bf16 v[148:151], v[68:71], v[36:39], v[148:151]
    v_mfma_f32_16x16x32_bf16 v[144:147], v[64:67], v[36:39], v[144:147]
    v_mfma_f32_16x16x32_bf16 v[160:163], v[64:67], v[40:43], v[160:163]
    v_mfma_f32_16x16x32_bf16 v[164:167], v[68:71], v[40:43], v[164:167]
    v_mfma_f32_16x16x32_bf16 v[168:171], v[72:75], v[40:43], v[168:171]
    v_mfma_f32_16x16x32_bf16 v[172:175], v[76:79], v[40:43], v[172:175]
    v_mfma_f32_16x16x32_bf16 v[188:191], v[76:79], v[44:47], v[188:191]
    v_mfma_f32_16x16x32_bf16 v[184:187], v[72:75], v[44:47], v[184:187]
    v_mfma_f32_16x16x32_bf16 v[180:183], v[68:71], v[44:47], v[180:183]
    v_mfma_f32_16x16x32_bf16 v[176:179], v[64:67], v[44:47], v[176:179]
    v_mfma_f32_16x16x32_bf16 v[192:195], v[64:67], v[48:51], v[192:195]
    v_mfma_f32_16x16x32_bf16 v[196:199], v[68:71], v[48:51], v[196:199]
    v_mfma_f32_16x16x32_bf16 v[200:203], v[72:75], v[48:51], v[200:203]
    v_mfma_f32_16x16x32_bf16 v[204:207], v[76:79], v[48:51], v[204:207]
    v_mfma_f32_16x16x32_bf16 v[220:223], v[76:79], v[52:55], v[220:223]
    v_mfma_f32_16x16x32_bf16 v[216:219], v[72:75], v[52:55], v[216:219]
    v_mfma_f32_16x16x32_bf16 v[212:215], v[68:71], v[52:55], v[212:215]
    v_mfma_f32_16x16x32_bf16 v[208:211], v[64:67], v[52:55], v[208:211]
    v_mfma_f32_16x16x32_bf16 v[224:227], v[64:67], v[56:59], v[224:227]
    v_mfma_f32_16x16x32_bf16 v[228:231], v[68:71], v[56:59], v[228:231]
    v_mfma_f32_16x16x32_bf16 v[232:235], v[72:75], v[56:59], v[232:235]
    v_mfma_f32_16x16x32_bf16 v[236:239], v[76:79], v[56:59], v[236:239]
    v_mfma_f32_16x16x32_bf16 v[252:255], v[76:79], v[60:63], v[252:255]
    v_mfma_f32_16x16x32_bf16 v[248:251], v[72:75], v[60:63], v[248:251]
    v_mfma_f32_16x16x32_bf16 v[244:247], v[68:71], v[60:63], v[244:247]
    v_mfma_f32_16x16x32_bf16 v[240:243], v[64:67], v[60:63], v[240:243]
    s_waitcnt vmcnt(9) lgkmcnt(0)
    s_barrier
    ds_read_b128 v[32:35], v2 offset:32768
    ds_read_b64_tr_b16 v[64:65], v6 offset:0
    s_add_u32 m0, s24, 49152
    s_add_u32 s30, s32, 352
    s_and_b32 s30, s30, 1023
    s_mul_i32 s30, s30, 7168
    buffer_load_dwordx4 v9, s[12:15], s30 offen lds
    ds_read_b64_tr_b16 v[66:67], v6 offset:1024
    ds_read_b64_tr_b16 v[68:69], v7 offset:0
    ds_read_b64_tr_b16 v[70:71], v7 offset:1024
    ds_read_b64_tr_b16 v[72:73], v6 offset:8192
    s_add_u32 m0, s24, 57344
    s_nop 0
    buffer_load_dwordx4 v9, s[16:19], s30 offen lds
    ds_read_b64_tr_b16 v[74:75], v6 offset:9216
    ds_read_b64_tr_b16 v[76:77], v7 offset:8192
    ds_read_b64_tr_b16 v[78:79], v7 offset:9216
    ds_read_b128 v[36:39], v2 offset:34816
    s_add_u32 m0, s24, 65536
    s_add_u32 s31, s33, 768
    s_and_b32 s31, s31, 2047
    s_add_u32 s31, s31, 0
    buffer_load_dwordx4 v8, s[8:11], s31 offen lds
    ds_read_b128 v[40:43], v2 offset:36864
    ds_read_b128 v[44:47], v2 offset:38912
    ds_read_b128 v[48:51], v2 offset:40960
    ds_read_b128 v[52:55], v2 offset:43008
    s_add_u32 m0, s24, 73728
    s_add_u32 s31, s33, 768
    s_and_b32 s31, s31, 2047
    s_add_u32 s31, s31, 131072
    buffer_load_dwordx4 v8, s[8:11], s31 offen lds
    ds_read_b128 v[56:59], v2 offset:45056
    ds_read_b128 v[60:63], v2 offset:47104
    s_cmp_lg_u32 s3, 1
    s_cbranch_scc1 M_pfB7
    buffer_load_dword v1, v31, s[96:99], s35 offen
M_pfB7:
    v_mfma_f32_16x16x32_bf16 v[128:131], v[112:115], v[80:83], v[128:131]
    v_mfma_f32_16x16x32_bf16 v[132:135], v[116:119], v[80:83], v[132:135]
    v_mfma_f32_16x16x32_bf16 v[136:139], v[120:123], v[80:83], v[136:139]
    v_mfma_f32_16x16x32_bf16 v[140:143], v[124:127], v[80:83], v[140:143]
    v_mfma_f32_16x16x32_bf16 v[156:159], v[124:127], v[84:87], v[156:159]
    v_mfma_f32_16x16x32_bf16 v[152:155], v[120:123], v[84:87], v[152:155]
    v_mfma_f32_16x16x32_bf16 v[148:151], v[116:119], v[84:87], v[148:151]
    v_mfma_f32_16x16x32_bf16 v[144:147], v[112:115], v[84:87], v[144:147]
    v_mfma_f32_16x16x32_bf16 v[160:163], v[112:115], v[88:91], v[160:163]
    v_mfma_f32_16x16x32_bf16 v[164:167], v[116:119], v[88:91], v[164:167]
    v_mfma_f32_16x16x32_bf16 v[168:171], v[120:123], v[88:91], v[168:171]
    v_mfma_f32_16x16x32_bf16 v[172:175], v[124:127], v[88:91], v[172:175]
    v_mfma_f32_16x16x32_bf16 v[188:191], v[124:127], v[92:95], v[188:191]
    v_mfma_f32_16x16x32_bf16 v[184:187], v[120:123], v[92:95], v[184:187]
    v_mfma_f32_16x16x32_bf16 v[180:183], v[116:119], v[92:95], v[180:183]
    v_mfma_f32_16x16x32_bf16 v[176:179], v[112:115], v[92:95], v[176:179]
    v_mfma_f32_16x16x32_bf16 v[192:195], v[112:115], v[96:99], v[192:195]
    v_mfma_f32_16x16x32_bf16 v[196:199], v[116:119], v[96:99], v[196:199]
    v_mfma_f32_16x16x32_bf16 v[200:203], v[120:123], v[96:99], v[200:203]
    v_mfma_f32_16x16x32_bf16 v[204:207], v[124:127], v[96:99], v[204:207]
    v_mfma_f32_16x16x32_bf16 v[220:223], v[124:127], v[100:103], v[220:223]
    v_mfma_f32_16x16x32_bf16 v[216:219], v[120:123], v[100:103], v[216:219]
    v_mfma_f32_16x16x32_bf16 v[212:215], v[116:119], v[100:103], v[212:215]
    v_mfma_f32_16x16x32_bf16 v[208:211], v[112:115], v[100:103], v[208:211]
    v_mfma_f32_16x16x32_bf16 v[224:227], v[112:115], v[104:107], v[224:227]
    v_mfma_f32_16x16x32_bf16 v[228:231], v[116:119], v[104:107], v[228:231]
    v_mfma_f32_16x16x32_bf16 v[232:235], v[120:123], v[104:107], v[232:235]
    v_mfma_f32_16x16x32_bf16 v[236:239], v[124:127], v[104:107], v[236:239]
    v_mfma_f32_16x16x32_bf16 v[252:255], v[124:127], v[108:111], v[252:255]
    v_mfma_f32_16x16x32_bf16 v[248:251], v[120:123], v[108:111], v[248:251]
    v_mfma_f32_16x16x32_bf16 v[244:247], v[116:119], v[108:111], v[244:247]
    v_mfma_f32_16x16x32_bf16 v[240:243], v[112:115], v[108:111], v[240:243]
    s_waitcnt vmcnt(8) lgkmcnt(0)
    s_barrier
    ds_read_b128 v[80:83], v3 offset:32768
    ds_read_b64_tr_b16 v[112:113], v6 offset:16384
    s_add_u32 m0, s24, 0
    s_add_u32 s30, s32, 384
    s_and_b32 s30, s30, 1023
    s_mul_i32 s30, s30, 7168
    buffer_load_dwordx4 v9, s[12:15], s30 offen lds
    ds_read_b64_tr_b16 v[114:115], v6 offset:17408
    ds_read_b64_tr_b16 v[116:117], v7 offset:16384
    ds_read_b64_tr_b16 v[118:119], v7 offset:17408
    ds_read_b64_tr_b16 v[120:121], v6 offset:24576
    s_add_u32 m0, s24, 8192
    s_nop 0
    buffer_load_dwordx4 v9, s[16:19], s30 offen lds
    ds_read_b64_tr_b16 v[122:123], v6 offset:25600
    ds_read_b64_tr_b16 v[124:125], v7 offset:24576
    ds_read_b64_tr_b16 v[126:127], v7 offset:25600
    ds_read_b128 v[84:87], v3 offset:34816
    s_add_u32 m0, s24, 81920
    s_add_u32 s31, s33, 768
    s_and_b32 s31, s31, 2047
    s_add_u32 s31, s31, 262144
    buffer_load_dwordx4 v8, s[8:11], s31 offen lds
    ds_read_b128 v[88:91], v3 offset:36864
    ds_read_b128 v[92:95], v3 offset:38912
    ds_read_b128 v[96:99], v3 offset:40960
    ds_read_b128 v[100:103], v3 offset:43008
    s_add_u32 m0, s24, 90112
    s_add_u32 s31, s33, 768
    s_and_b32 s31, s31, 2047
    s_add_u32 s31, s31, 393216
    buffer_load_dwordx4 v8, s[8:11], s31 offen lds
    ds_read_b128 v[104:107], v3 offset:45056
    ds_read_b128 v[108:111], v3 offset:47104
    buffer_store_dwordx4 v[12:15], v10, s[20:23], s41 offen offset:0 sc1
    v_mfma_f32_16x16x32_bf16 v[128:131], v[64:67], v[32:35], v[128:131]
    v_mfma_f32_16x16x32_bf16 v[132:135], v[68:71], v[32:35], v[132:135]
    v_mfma_f32_16x16x32_bf16 v[136:139], v[72:75], v[32:35], v[136:139]
    v_mfma_f32_16x16x32_bf16 v[140:143], v[76:79], v[32:35], v[140:143]
    v_mfma_f32_16x16x32_bf16 v[156:159], v[76:79], v[36:39], v[156:159]
    v_mfma_f32_16x16x32_bf16 v[152:155], v[72:75], v[36:39], v[152:155]
    v_mfma_f32_16x16x32_bf16 v[148:151], v[68:71], v[36:39], v[148:151]
    v_mfma_f32_16x16x32_bf16 v[144:147], v[64:67], v[36:39], v[144:147]
    v_mfma_f32_16x16x32_bf16 v[160:163], v[64:67], v[40:43], v[160:163]
    v_mfma_f32_16x16x32_bf16 v[164:167], v[68:71], v[40:43], v[164:167]
    v_mfma_f32_16x16x32_bf16 v[168:171], v[72:75], v[40:43], v[168:171]
    v_mfma_f32_16x16x32_bf16 v[172:175], v[76:79], v[40:43], v[172:175]
    v_mfma_f32_16x16x32_bf16 v[188:191], v[76:79], v[44:47], v[188:191]
    v_mfma_f32_16x16x32_bf16 v[184:187], v[72:75], v[44:47], v[184:187]
    v_mfma_f32_16x16x32_bf16 v[180:183], v[68:71], v[44:47], v[180:183]
    v_mfma_f32_16x16x32_bf16 v[176:179], v[64:67], v[44:47], v[176:179]
    v_mfma_f32_16x16x32_bf16 v[192:195], v[64:67], v[48:51], v[192:195]
    v_mfma_f32_16x16x32_bf16 v[196:199], v[68:71], v[48:51], v[196:199]
    v_mfma_f32_16x16x32_bf16 v[200:203], v[72:75], v[48:51], v[200:203]
    v_mfma_f32_16x16x32_bf16 v[204:207], v[76:79], v[48:51], v[204:207]
    v_mfma_f32_16x16x32_bf16 v[220:223], v[76:79], v[52:55], v[220:223]
    v_mfma_f32_16x16x32_bf16 v[216:219], v[72:75], v[52:55], v[216:219]
    v_mfma_f32_16x16x32_bf16 v[212:215], v[68:71], v[52:55], v[212:215]
    v_mfma_f32_16x16x32_bf16 v[208:211], v[64:67], v[52:55], v[208:211]
    v_mfma_f32_16x16x32_bf16 v[224:227], v[64:67], v[56:59], v[224:227]
    v_mfma_f32_16x16x32_bf16 v[228:231], v[68:71], v[56:59], v[228:231]
    v_mfma_f32_16x16x32_bf16 v[232:235], v[72:75], v[56:59], v[232:235]
    v_mfma_f32_16x16x32_bf16 v[236:239], v[76:79], v[56:59], v[236:239]
    v_mfma_f32_16x16x32_bf16 v[252:255], v[76:79], v[60:63], v[252:255]
    v_mfma_f32_16x16x32_bf16 v[248:251], v[72:75], v[60:63], v[248:251]
    v_mfma_f32_16x16x32_bf16 v[244:247], v[68:71], v[60:63], v[244:247]
    v_mfma_f32_16x16x32_bf16 v[240:243], v[64:67], v[60:63], v[240:243]
    s_waitcnt vmcnt(9) lgkmcnt(0)
    s_barrier
    ds_read_b128 v[32:35], v4 offset:0
    ds_read_b64_tr_b16 v[64:65], v6 offset:32768
    s_add_u32 m0, s24, 16384
    s_add_u32 s30, s32, 416
    s_and_b32 s30, s30, 1023
    s_mul_i32 s30, s30, 7168
    buffer_load_dwordx4 v9, s[12:15], s30 offen lds
    ds_read_b64_tr_b16 v[66:67], v6 offset:33792
    ds_read_b64_tr_b16 v[68:69], v7 offset:32768
    ds_read_b64_tr_b16 v[70:71], v7 offset:33792
    ds_read_b64_tr_b16 v[72:73], v6 offset:40960
    s_add_u32 m0, s24, 24576
    s_nop 0
    buffer_load_dwordx4 v9, s[16:19], s30 offen lds
    ds_read_b64_tr_b16 v[74:75], v6 offset:41984
    ds_read_b64_tr_b16 v[76:77], v7 offset:40960
    ds_read_b64_tr_b16 v[78:79], v7 offset:41984
    ds_read_b128 v[36:39], v4 offset:2048
    s_add_u32 m0, s24, 98304
    s_add_u32 s31, s33, 896
    s_and_b32 s31, s31, 2047
    s_add_u32 s31, s31, 0
    buffer_load_dwordx4 v8, s[8:11], s31 offen lds
    ds_read_b128 v[40:43], v4 offset:4096
    ds_read_b128 v[44:47], v4 offset:6144
    ds_read_b128 v[48:51], v4 offset:8192
    ds_read_b128 v[52:55], v4 offset:10240
    s_add_u32 m0, s24, 106496
    s_add_u32 s31, s33, 896
    s_and_b32 s31, s31, 2047
    s_add_u32 s31, s31, 131072
    buffer_load_dwordx4 v8, s[8:11], s31 offen lds
    ds_read_b128 v[56:59], v4 offset:12288
    ds_read_b128 v[60:63], v4 offset:14336
    v_mfma_f32_16x16x32_bf16 v[128:131], v[112:115], v[80:83], v[128:131]
    v_mfma_f32_16x16x32_bf16 v[132:135], v[116:119], v[80:83], v[132:135]
    v_mfma_f32_16x16x32_bf16 v[136:139], v[120:123], v[80:83], v[136:139]
    v_mfma_f32_16x16x32_bf16 v[140:143], v[124:127], v[80:83], v[140:143]
    v_mfma_f32_16x16x32_bf16 v[156:159], v[124:127], v[84:87], v[156:159]
    v_mfma_f32_16x16x32_bf16 v[152:155], v[120:123], v[84:87], v[152:155]
    v_mfma_f32_16x16x32_bf16 v[148:151], v[116:119], v[84:87], v[148:151]
    v_mfma_f32_16x16x32_bf16 v[144:147], v[112:115], v[84:87], v[144:147]
    v_mfma_f32_16x16x32_bf16 v[160:163], v[112:115], v[88:91], v[160:163]
    v_mfma_f32_16x16x32_bf16 v[164:167], v[116:119], v[88:91], v[164:167]
    v_mfma_f32_16x16x32_bf16 v[168:171], v[120:123], v[88:91], v[168:171]
    v_mfma_f32_16x16x32_bf16 v[172:175], v[124:127], v[88:91], v[172:175]
    v_mfma_f32_16x16x32_bf16 v[188:191], v[124:127], v[92:95], v[188:191]
    v_mfma_f32_16x16x32_bf16 v[184:187], v[120:123], v[92:95], v[184:187]
    v_mfma_f32_16x16x32_bf16 v[180:183], v[116:119], v[92:95], v[180:183]
    v_mfma_f32_16x16x32_bf16 v[176:179], v[112:115], v[92:95], v[176:179]
    v_mfma_f32_16x16x32_bf16 v[192:195], v[112:115], v[96:99], v[192:195]
    v_mfma_f32_16x16x32_bf16 v[196:199], v[116:119], v[96:99], v[196:199]
    v_mfma_f32_16x16x32_bf16 v[200:203], v[120:123], v[96:99], v[200:203]
    v_mfma_f32_16x16x32_bf16 v[204:207], v[124:127], v[96:99], v[204:207]
    v_mfma_f32_16x16x32_bf16 v[220:223], v[124:127], v[100:103], v[220:223]
    v_mfma_f32_16x16x32_bf16 v[216:219], v[120:123], v[100:103], v[216:219]
    v_mfma_f32_16x16x32_bf16 v[212:215], v[116:119], v[100:103], v[212:215]
    v_mfma_f32_16x16x32_bf16 v[208:211], v[112:115], v[100:103], v[208:211]
    v_mfma_f32_16x16x32_bf16 v[224:227], v[112:115], v[104:107], v[224:227]
    v_mfma_f32_16x16x32_bf16 v[228:231], v[116:119], v[104:107], v[228:231]
    v_mfma_f32_16x16x32_bf16 v[232:235], v[120:123], v[104:107], v[232:235]
    v_mfma_f32_16x16x32_bf16 v[236:239], v[124:127], v[104:107], v[236:239]
    v_mfma_f32_16x16x32_bf16 v[252:255], v[124:127], v[108:111], v[252:255]
    v_mfma_f32_16x16x32_bf16 v[248:251], v[120:123], v[108:111], v[248:251]
    v_mfma_f32_16x16x32_bf16 v[244:247], v[116:119], v[108:111], v[244:247]
    v_mfma_f32_16x16x32_bf16 v[240:243], v[112:115], v[108:111], v[240:243]
    s_waitcnt vmcnt(9) lgkmcnt(0)
    s_barrier
    ds_read_b128 v[80:83], v5 offset:0
    ds_read_b64_tr_b16 v[112:113], v6 offset:49152
    s_add_u32 m0, s24, 32768
    s_add_u32 s30, s32, 448
    s_and_b32 s30, s30, 1023
    s_mul_i32 s30, s30, 7168
    buffer_load_dwordx4 v9, s[12:15], s30 offen lds
    ds_read_b64_tr_b16 v[114:115], v6 offset:50176
    ds_read_b64_tr_b16 v[116:117], v7 offset:49152
    ds_read_b64_tr_b16 v[118:119], v7 offset:50176
    ds_read_b64_tr_b16 v[120:121], v6 offset:57344
    s_add_u32 m0, s24, 40960
    s_nop 0
    buffer_load_dwordx4 v9, s[16:19], s30 offen lds
    ds_read_b64_tr_b16 v[122:123], v6 offset:58368
    ds_read_b64_tr_b16 v[124:125], v7 offset:57344
    ds_read_b64_tr_b16 v[126:127], v7 offset:58368
    ds_read_b128 v[84:87], v5 offset:2048
    s_add_u32 m0, s24, 114688
    s_add_u32 s31, s33, 896
    s_and_b32 s31, s31, 2047
    s_add_u32 s31, s31, 262144
    buffer_load_dwordx4 v8, s[8:11], s31 offen lds
    ds_read_b128 v[88:91], v5 offset:4096
    ds_read_b128 v[92:95], v5 offset:6144
    ds_read_b128 v[96:99], v5 offset:8192
    ds_read_b128 v[100:103], v5 offset:10240
    s_add_u32 m0, s24, 122880
    s_add_u32 s31, s33, 896
    s_and_b32 s31, s31, 2047
    s_add_u32 s31, s31, 393216
    buffer_load_dwordx4 v8, s[8:11], s31 offen lds
    ds_read_b128 v[104:107], v5 offset:12288
    ds_read_b128 v[108:111], v5 offset:14336
    s_cmp_lg_u32 s3, 2
    s_cbranch_scc1 M_pfB10
    buffer_load_dword v1, v31, s[96:99], s35 offen
M_pfB10:
    v_mfma_f32_16x16x32_bf16 v[128:131], v[64:67], v[32:35], v[128:131]
    v_mfma_f32_16x16x32_bf16 v[132:135], v[68:71], v[32:35], v[132:135]
    v_mfma_f32_16x16x32_bf16 v[136:139], v[72:75], v[32:35], v[136:139]
    v_mfma_f32_16x16x32_bf16 v[140:143], v[76:79], v[32:35], v[140:143]
    v_mfma_f32_16x16x32_bf16 v[156:159], v[76:79], v[36:39], v[156:159]
    v_mfma_f32_16x16x32_bf16 v[152:155], v[72:75], v[36:39], v[152:155]
    v_mfma_f32_16x16x32_bf16 v[148:151], v[68:71], v[36:39], v[148:151]
    v_mfma_f32_16x16x32_bf16 v[144:147], v[64:67], v[36:39], v[144:147]
    v_mfma_f32_16x16x32_bf16 v[160:163], v[64:67], v[40:43], v[160:163]
    v_mfma_f32_16x16x32_bf16 v[164:167], v[68:71], v[40:43], v[164:167]
    v_mfma_f32_16x16x32_bf16 v[168:171], v[72:75], v[40:43], v[168:171]
    v_mfma_f32_16x16x32_bf16 v[172:175], v[76:79], v[40:43], v[172:175]
    v_mfma_f32_16x16x32_bf16 v[188:191], v[76:79], v[44:47], v[188:191]
    v_mfma_f32_16x16x32_bf16 v[184:187], v[72:75], v[44:47], v[184:187]
    v_mfma_f32_16x16x32_bf16 v[180:183], v[68:71], v[44:47], v[180:183]
    v_mfma_f32_16x16x32_bf16 v[176:179], v[64:67], v[44:47], v[176:179]
    v_mfma_f32_16x16x32_bf16 v[192:195], v[64:67], v[48:51], v[192:195]
    v_mfma_f32_16x16x32_bf16 v[196:199], v[68:71], v[48:51], v[196:199]
    v_mfma_f32_16x16x32_bf16 v[200:203], v[72:75], v[48:51], v[200:203]
    v_mfma_f32_16x16x32_bf16 v[204:207], v[76:79], v[48:51], v[204:207]
    v_mfma_f32_16x16x32_bf16 v[220:223], v[76:79], v[52:55], v[220:223]
    v_mfma_f32_16x16x32_bf16 v[216:219], v[72:75], v[52:55], v[216:219]
    v_mfma_f32_16x16x32_bf16 v[212:215], v[68:71], v[52:55], v[212:215]
    v_mfma_f32_16x16x32_bf16 v[208:211], v[64:67], v[52:55], v[208:211]
    v_mfma_f32_16x16x32_bf16 v[224:227], v[64:67], v[56:59], v[224:227]
    v_mfma_f32_16x16x32_bf16 v[228:231], v[68:71], v[56:59], v[228:231]
    v_mfma_f32_16x16x32_bf16 v[232:235], v[72:75], v[56:59], v[232:235]
    v_mfma_f32_16x16x32_bf16 v[236:239], v[76:79], v[56:59], v[236:239]
    v_mfma_f32_16x16x32_bf16 v[252:255], v[76:79], v[60:63], v[252:255]
    v_mfma_f32_16x16x32_bf16 v[248:251], v[72:75], v[60:63], v[248:251]
    v_mfma_f32_16x16x32_bf16 v[244:247], v[68:71], v[60:63], v[244:247]
    v_mfma_f32_16x16x32_bf16 v[240:243], v[64:67], v[60:63], v[240:243]
    s_waitcnt vmcnt(8) lgkmcnt(0)
    s_barrier
    ds_read_b128 v[32:35], v2 offset:0
    ds_read_b64_tr_b16 v[64:65], v6 offset:0
    s_add_u32 m0, s24, 49152
    s_add_u32 s30, s32, 480
    s_and_b32 s30, s30, 1023
    s_mul_i32 s30, s30, 7168
    buffer_load_dwordx4 v9, s[12:15], s30 offen lds
    ds_read_b64_tr_b16 v[66:67], v6 offset:1024
    ds_read_b64_tr_b16 v[68:69], v7 offset:0
    ds_read_b64_tr_b16 v[70:71], v7 offset:1024
    ds_read_b64_tr_b16 v[72:73], v6 offset:8192
    s_add_u32 m0, s24, 57344
    s_nop 0
    buffer_load_dwordx4 v9, s[16:19], s30 offen lds
    ds_read_b64_tr_b16 v[74:75], v6 offset:9216
    ds_read_b64_tr_b16 v[76:77], v7 offset:8192
    ds_read_b64_tr_b16 v[78:79], v7 offset:9216
    ds_read_b128 v[36:39], v2 offset:2048
    s_add_u32 m0, s24, 131072
    s_add_u32 s31, s33, 1024
    s_and_b32 s31, s31, 2047
    s_add_u32 s31, s31, 0
    buffer_load_dwordx4 v8, s[8:11], s31 offen lds
    ds_read_b128 v[40:43], v2 offset:4096
    ds_read_b128 v[44:47], v2 offset:6144
    ds_read_b128 v[48:51], v2 offset:8192
    ds_read_b128 v[52:55], v2 offset:10240
    s_add_u32 m0, s24, 139264
    s_add_u32 s31, s33, 1024
    s_and_b32 s31, s31, 2047
    s_add_u32 s31, s31, 131072
    buffer_load_dwordx4 v8, s[8:11], s31 offen lds
    ds_read_b128 v[56:59], v2 offset:12288
    ds_read_b128 v[60:63], v2 offset:14336
    buffer_store_dwordx4 v[12:15], v10, s[20:23], s41 offen offset:1024 sc1
    v_mfma_f32_16x16x32_bf16 v[128:131], v[112:115], v[80:83], v[128:131]
    v_mfma_f32_16x16x32_bf16 v[132:135], v[116:119], v[80:83], v[132:135]
    v_mfma_f32_16x16x32_bf16 v[136:139], v[120:123], v[80:83], v[136:139]
    v_mfma_f32_16x16x32_bf16 v[140:143], v[124:127], v[80:83], v[140:143]
    v_mfma_f32_16x16x32_bf16 v[156:159], v[124:127], v[84:87], v[156:159]
    v_mfma_f32_16x16x32_bf16 v[152:155], v[120:123], v[84:87], v[152:155]
    v_mfma_f32_16x16x32_bf16 v[148:151], v[116:119], v[84:87], v[148:151]
    v_mfma_f32_16x16x32_bf16 v[144:147], v[112:115], v[84:87], v[144:147]
    v_mfma_f32_16x16x32_bf16 v[160:163], v[112:115], v[88:91], v[160:163]
    v_mfma_f32_16x16x32_bf16 v[164:167], v[116:119], v[88:91], v[164:167]
    v_mfma_f32_16x16x32_bf16 v[168:171], v[120:123], v[88:91], v[168:171]
    v_mfma_f32_16x16x32_bf16 v[172:175], v[124:127], v[88:91], v[172:175]
    v_mfma_f32_16x16x32_bf16 v[188:191], v[124:127], v[92:95], v[188:191]
    v_mfma_f32_16x16x32_bf16 v[184:187], v[120:123], v[92:95], v[184:187]
    v_mfma_f32_16x16x32_bf16 v[180:183], v[116:119], v[92:95], v[180:183]
    v_mfma_f32_16x16x32_bf16 v[176:179], v[112:115], v[92:95], v[176:179]
    v_mfma_f32_16x16x32_bf16 v[192:195], v[112:115], v[96:99], v[192:195]
    v_mfma_f32_16x16x32_bf16 v[196:199], v[116:119], v[96:99], v[196:199]
    v_mfma_f32_16x16x32_bf16 v[200:203], v[120:123], v[96:99], v[200:203]
    v_mfma_f32_16x16x32_bf16 v[204:207], v[124:127], v[96:99], v[204:207]
    v_mfma_f32_16x16x32_bf16 v[220:223], v[124:127], v[100:103], v[220:223]
    v_mfma_f32_16x16x32_bf16 v[216:219], v[120:123], v[100:103], v[216:219]
    v_mfma_f32_16x16x32_bf16 v[212:215], v[116:119], v[100:103], v[212:215]
    v_mfma_f32_16x16x32_bf16 v[208:211], v[112:115], v[100:103], v[208:211]
    v_mfma_f32_16x16x32_bf16 v[224:227], v[112:115], v[104:107], v[224:227]
    v_mfma_f32_16x16x32_bf16 v[228:231], v[116:119], v[104:107], v[228:231]
    v_mfma_f32_16x16x32_bf16 v[232:235], v[120:123], v[104:107], v[232:235]
    v_mfma_f32_16x16x32_bf16 v[236:239], v[124:127], v[104:107], v[236:239]
    v_mfma_f32_16x16x32_bf16 v[252:255], v[124:127], v[108:111], v[252:255]
    v_mfma_f32_16x16x32_bf16 v[248:251], v[120:123], v[108:111], v[248:251]
    v_mfma_f32_16x16x32_bf16 v[244:247], v[116:119], v[108:111], v[244:247]
    v_mfma_f32_16x16x32_bf16 v[240:243], v[112:115], v[108:111], v[240:243]
    s_waitcnt vmcnt(9) lgkmcnt(0)
    s_barrier
    ds_read_b128 v[80:83], v3 offset:0
    ds_read_b64_tr_b16 v[112:113], v6 offset:16384
    s_add_u32 m0, s24, 0
    s_add_u32 s30, s32, 512
    s_and_b32 s30, s30, 1023
    s_mul_i32 s30, s30, 7168
    buffer_load_dwordx4 v9, s[12:15], s30 offen lds
    ds_read_b64_tr_b16 v[114:115], v6 offset:17408
    ds_read_b64_tr_b16 v[116:117], v7 offset:16384
    ds_read_b64_tr_b16 v[118:119], v7 offset:17408
    ds_read_b64_tr_b16 v[120:121], v6 offset:24576
    s_add_u32 m0, s24, 8192
    s_nop 0
    buffer_load_dwordx4 v9, s[16:19], s30 offen lds
    ds_read_b64_tr_b16 v[122:123], v6 offset:25600
    ds_read_b64_tr_b16 v[124:125], v7 offset:24576
    ds_read_b64_tr_b16 v[126:127], v7 offset:25600
    ds_read_b128 v[84:87], v3 offset:2048
    s_add_u32 m0, s24, 147456
    s_add_u32 s31, s33, 1024
    s_and_b32 s31, s31, 2047
    s_add_u32 s31, s31, 262144
    buffer_load_dwordx4 v8, s[8:11], s31 offen lds
    ds_read_b128 v[88:91], v3 offset:4096
    ds_read_b128 v[92:95], v3 offset:6144
    ds_read_b128 v[96:99], v3 offset:8192
    ds_read_b128 v[100:103], v3 offset:10240
    s_add_u32 m0, s24, 155648
    s_add_u32 s31, s33, 1024
    s_and_b32 s31, s31, 2047
    s_add_u32 s31, s31, 393216
    buffer_load_dwordx4 v8, s[8:11], s31 offen lds
    ds_read_b128 v[104:107], v3 offset:12288
    ds_read_b128 v[108:111], v3 offset:14336
    v_mfma_f32_16x16x32_bf16 v[128:131], v[64:67], v[32:35], v[128:131]
    v_mfma_f32_16x16x32_bf16 v[132:135], v[68:71], v[32:35], v[132:135]
    v_mfma_f32_16x16x32_bf16 v[136:139], v[72:75], v[32:35], v[136:139]
    v_mfma_f32_16x16x32_bf16 v[140:143], v[76:79], v[32:35], v[140:143]
    v_mfma_f32_16x16x32_bf16 v[156:159], v[76:79], v[36:39], v[156:159]
    v_mfma_f32_16x16x32_bf16 v[152:155], v[72:75], v[36:39], v[152:155]
    v_mfma_f32_16x16x32_bf16 v[148:151], v[68:71], v[36:39], v[148:151]
    v_mfma_f32_16x16x32_bf16 v[144:147], v[64:67], v[36:39], v[144:147]
    v_mfma_f32_16x16x32_bf16 v[160:163], v[64:67], v[40:43], v[160:163]
    v_mfma_f32_16x16x32_bf16 v[164:167], v[68:71], v[40:43], v[164:167]
    v_mfma_f32_16x16x32_bf16 v[168:171], v[72:75], v[40:43], v[168:171]
    v_mfma_f32_16x16x32_bf16 v[172:175], v[76:79], v[40:43], v[172:175]
    v_mfma_f32_16x16x32_bf16 v[188:191], v[76:79], v[44:47], v[188:191]
    v_mfma_f32_16x16x32_bf16 v[184:187], v[72:75], v[44:47], v[184:187]
    v_mfma_f32_16x16x32_bf16 v[180:183], v[68:71], v[44:47], v[180:183]
    v_mfma_f32_16x16x32_bf16 v[176:179], v[64:67], v[44:47], v[176:179]
    v_mfma_f32_16x16x32_bf16 v[192:195], v[64:67], v[48:51], v[192:195]
    v_mfma_f32_16x16x32_bf16 v[196:199], v[68:71], v[48:51], v[196:199]
    v_mfma_f32_16x16x32_bf16 v[200:203], v[72:75], v[48:51], v[200:203]
    v_mfma_f32_16x16x32_bf16 v[204:207], v[76:79], v[48:51], v[204:207]
    v_mfma_f32_16x16x32_bf16 v[220:223], v[76:79], v[52:55], v[220:223]
    v_mfma_f32_16x16x32_bf16 v[216:219], v[72:75], v[52:55], v[216:219]
    v_mfma_f32_16x16x32_bf16 v[212:215], v[68:71], v[52:55], v[212:215]
    v_mfma_f32_16x16x32_bf16 v[208:211], v[64:67], v[52:55], v[208:211]
    v_mfma_f32_16x16x32_bf16 v[224:227], v[64:67], v[56:59], v[224:227]
    v_mfma_f32_16x16x32_bf16 v[228:231], v[68:71], v[56:59], v[228:231]
    v_mfma_f32_16x16x32_bf16 v[232:235], v[72:75], v[56:59], v[232:235]
    v_mfma_f32_16x16x32_bf16 v[236:239], v[76:79], v[56:59], v[236:239]
    v_mfma_f32_16x16x32_bf16 v[252:255], v[76:79], v[60:63], v[252:255]
    v_mfma_f32_16x16x32_bf16 v[248:251], v[72:75], v[60:63], v[248:251]
    v_mfma_f32_16x16x32_bf16 v[244:247], v[68:71], v[60:63], v[244:247]
    v_mfma_f32_16x16x32_bf16 v[240:243], v[64:67], v[60:63], v[240:243]
    s_waitcnt vmcnt(9) lgkmcnt(0)
    s_barrier
    ds_read_b128 v[32:35], v2 offset:32768
    ds_read_b64_tr_b16 v[64:65], v6 offset:32768
    s_add_u32 m0, s24, 16384
    s_add_u32 s30, s32, 544
    s_and_b32 s30, s30, 1023
    s_mul_i32 s30, s30, 7168
    buffer_load_dwordx4 v9, s[12:15], s30 offen lds
    ds_read_b64_tr_b16 v[66:67], v6 offset:33792
    ds_read_b64_tr_b16 v[68:69], v7 offset:32768
    ds_read_b64_tr_b16 v[70:71], v7 offset:33792
    ds_read_b64_tr_b16 v[72:73], v6 offset:40960
    s_add_u32 m0, s24, 24576
    s_nop 0
    buffer_load_dwordx4 v9, s[16:19], s30 offen lds
    ds_read_b64_tr_b16 v[74:75], v6 offset:41984
    ds_read_b64_tr_b16 v[76:77], v7 offset:40960
    ds_read_b64_tr_b16 v[78:79], v7 offset:41984
    ds_read_b128 v[36:39], v2 offset:34816
    s_add_u32 m0, s24, 65536
    s_add_u32 s31, s33, 1152
    s_and_b32 s31, s31, 2047
    s_add_u32 s31, s31, 0
    buffer_load_dwordx4 v8, s[8:11], s31 offen lds
    ds_read_b128 v[40:43], v2 offset:36864
    ds_read_b128 v[44:47], v2 offset:38912
    ds_read_b128 v[48:51], v2 offset:40960
    ds_read_b128 v[52:55], v2 offset:43008
    s_add_u32 m0, s24, 73728
    s_add_u32 s31, s33, 1152
    s_and_b32 s31, s31, 2047
    s_add_u32 s31, s31, 131072
    buffer_load_dwordx4 v8, s[8:11], s31 offen lds
    ds_read_b128 v[56:59], v2 offset:45056
    ds_read_b128 v[60:63], v2 offset:47104
    s_cmp_lg_u32 s3, 3
    s_cbranch_scc1 M_pfB13
    buffer_load_dword v1, v31, s[96:99], s35 offen
M_pfB13:
    v_mfma_f32_16x16x32_bf16 v[128:131], v[112:115], v[80:83], v[128:131]
    v_mfma_f32_16x16x32_bf16 v[132:135], v[116:119], v[80:83], v[132:135]
    v_mfma_f32_16x16x32_bf16 v[136:139], v[120:123], v[80:83], v[136:139]
    v_mfma_f32_16x16x32_bf16 v[140:143], v[124:127], v[80:83], v[140:143]
    v_mfma_f32_16x16x32_bf16 v[156:159], v[124:127], v[84:87], v[156:159]
    v_mfma_f32_16x16x32_bf16 v[152:155], v[120:123], v[84:87], v[152:155]
    v_mfma_f32_16x16x32_bf16 v[148:151], v[116:119], v[84:87], v[148:151]
    v_mfma_f32_16x16x32_bf16 v[144:147], v[112:115], v[84:87], v[144:147]
    v_mfma_f32_16x16x32_bf16 v[160:163], v[112:115], v[88:91], v[160:163]
    v_mfma_f32_16x16x32_bf16 v[164:167], v[116:119], v[88:91], v[164:167]
    v_mfma_f32_16x16x32_bf16 v[168:171], v[120:123], v[88:91], v[168:171]
    v_mfma_f32_16x16x32_bf16 v[172:175], v[124:127], v[88:91], v[172:175]
    v_mfma_f32_16x16x32_bf16 v[188:191], v[124:127], v[92:95], v[188:191]
    v_mfma_f32_16x16x32_bf16 v[184:187], v[120:123], v[92:95], v[184:187]
    v_mfma_f32_16x16x32_bf16 v[180:183], v[116:119], v[92:95], v[180:183]
    v_mfma_f32_16x16x32_bf16 v[176:179], v[112:115], v[92:95], v[176:179]
    v_mfma_f32_16x16x32_bf16 v[192:195], v[112:115], v[96:99], v[192:195]
    v_mfma_f32_16x16x32_bf16 v[196:199], v[116:119], v[96:99], v[196:199]
    v_mfma_f32_16x16x32_bf16 v[200:203], v[120:123], v[96:99], v[200:203]
    v_mfma_f32_16x16x32_bf16 v[204:207], v[124:127], v[96:99], v[204:207]
    v_mfma_f32_16x16x32_bf16 v[220:223], v[124:127], v[100:103], v[220:223]
    v_mfma_f32_16x16x32_bf16 v[216:219], v[120:123], v[100:103], v[216:219]
    v_mfma_f32_16x16x32_bf16 v[212:215], v[116:119], v[100:103], v[212:215]
    v_mfma_f32_16x16x32_bf16 v[208:211], v[112:115], v[100:103], v[208:211]
    v_mfma_f32_16x16x32_bf16 v[224:227], v[112:115], v[104:107], v[224:227]
    v_mfma_f32_16x16x32_bf16 v[228:231], v[116:119], v[104:107], v[228:231]
    v_mfma_f32_16x16x32_bf16 v[232:235], v[120:123], v[104:107], v[232:235]
    v_mfma_f32_16x16x32_bf16 v[236:239], v[124:127], v[104:107], v[236:239]
    v_mfma_f32_16x16x32_bf16 v[252:255], v[124:127], v[108:111], v[252:255]
    v_mfma_f32_16x16x32_bf16 v[248:251], v[120:123], v[108:111], v[248:251]
    v_mfma_f32_16x16x32_bf16 v[244:247], v[116:119], v[108:111], v[244:247]
    v_mfma_f32_16x16x32_bf16 v[240:243], v[112:115], v[108:111], v[240:243]
    s_waitcnt vmcnt(8) lgkmcnt(0)
    s_barrier
    ds_read_b128 v[80:83], v3 offset:32768
    ds_read_b64_tr_b16 v[112:113], v6 offset:49152
    s_add_u32 m0, s24, 32768
    s_add_u32 s30, s32, 576
    s_and_b32 s30, s30, 1023
    s_mul_i32 s30, s30, 7168
    buffer_load_dwordx4 v9, s[12:15], s30 offen lds
    ds_read_b64_tr_b16 v[114:115], v6 offset:50176
    ds_read_b64_tr_b16 v[116:117], v7 offset:49152
    ds_read_b64_tr_b16 v[118:119], v7 offset:50176
    ds_read_b64_tr_b16 v[120:121], v6 offset:57344
    s_add_u32 m0, s24, 40960
    s_nop 0
    buffer_load_dwordx4 v9, s[16:19], s30 offen lds
    ds_read_b64_tr_b16 v[122:123], v6 offset:58368
    ds_read_b64_tr_b16 v[124:125], v7 offset:57344
    ds_read_b64_tr_b16 v[126:127], v7 offset:58368
    ds_read_b128 v[84:87], v3 offset:34816
    s_add_u32 m0, s24, 81920
    s_add_u32 s31, s33, 1152
    s_and_b32 s31, s31, 2047
    s_add_u32 s31, s31, 262144
    buffer_load_dwordx4 v8, s[8:11], s31 offen lds
    ds_read_b128 v[88:91], v3 offset:36864
    ds_read_b128 v[92:95], v3 offset:38912
    ds_read_b128 v[96:99], v3 offset:40960
    ds_read_b128 v[100:103], v3 offset:43008
    s_add_u32 m0, s24, 90112
    s_add_u32 s31, s33, 1152
    s_and_b32 s31, s31, 2047
    s_add_u32 s31, s31, 393216
    buffer_load_dwordx4 v8, s[8:11], s31 offen lds
    ds_read_b128 v[104:107], v3 offset:45056
    ds_read_b128 v[108:111], v3 offset:47104
    s_cmp_lg_u32 s3, 0
    s_cbranch_scc1 M_saB
    s_mov_b64 exec, 1
    s_and_b32 s58, s2, 3
    s_lshl_b32 s58, s58, 6
    buffer_atomic_add v24, v20, s[92:95], s58 offen sc1
    s_mov_b64 exec, -1
M_saB:
    v_mfma_f32_16x16x32_bf16 v[128:131], v[64:67], v[32:35], v[128:131]
    v_mfma_f32_16x16x32_bf16 v[132:135], v[68:71], v[32:35], v[132:135]
    v_mfma_f32_16x16x32_bf16 v[136:139], v[72:75], v[32:35], v[136:139]
    v_mfma_f32_16x16x32_bf16 v[140:143], v[76:79], v[32:35], v[140:143]
    v_mfma_f32_16x16x32_bf16 v[156:159], v[76:79], v[36:39], v[156:159]
    v_mfma_f32_16x16x32_bf16 v[152:155], v[72:75], v[36:39], v[152:155]
    v_mfma_f32_16x16x32_bf16 v[148:151], v[68:71], v[36:39], v[148:151]
    v_mfma_f32_16x16x32_bf16 v[144:147], v[64:67], v[36:39], v[144:147]
    v_mfma_f32_16x16x32_bf16 v[160:163], v[64:67], v[40:43], v[160:163]
    v_mfma_f32_16x16x32_bf16 v[164:167], v[68:71], v[40:43], v[164:167]
    v_mfma_f32_16x16x32_bf16 v[168:171], v[72:75], v[40:43], v[168:171]
    v_mfma_f32_16x16x32_bf16 v[172:175], v[76:79], v[40:43], v[172:175]
    v_mfma_f32_16x16x32_bf16 v[188:191], v[76:79], v[44:47], v[188:191]
    v_mfma_f32_16x16x32_bf16 v[184:187], v[72:75], v[44:47], v[184:187]
    v_mfma_f32_16x16x32_bf16 v[180:183], v[68:71], v[44:47], v[180:183]
    v_mfma_f32_16x16x32_bf16 v[176:179], v[64:67], v[44:47], v[176:179]
    v_mfma_f32_16x16x32_bf16 v[192:195], v[64:67], v[48:51], v[192:195]
    v_mfma_f32_16x16x32_bf16 v[196:199], v[68:71], v[48:51], v[196:199]
    v_mfma_f32_16x16x32_bf16 v[200:203], v[72:75], v[48:51], v[200:203]
    v_mfma_f32_16x16x32_bf16 v[204:207], v[76:79], v[48:51], v[204:207]
    v_mfma_f32_16x16x32_bf16 v[220:223], v[76:79], v[52:55], v[220:223]
    v_mfma_f32_16x16x32_bf16 v[216:219], v[72:75], v[52:55], v[216:219]
    v_mfma_f32_16x16x32_bf16 v[212:215], v[68:71], v[52:55], v[212:215]
    v_mfma_f32_16x16x32_bf16 v[208:211], v[64:67], v[52:55], v[208:211]
    v_mfma_f32_16x16x32_bf16 v[224:227], v[64:67], v[56:59], v[224:227]
    v_mfma_f32_16x16x32_bf16 v[228:231], v[68:71], v[56:59], v[228:231]
    v_mfma_f32_16x16x32_bf16 v[232:235], v[72:75], v[56:59], v[232:235]
    v_mfma_f32_16x16x32_bf16 v[236:239], v[76:79], v[56:59], v[236:239]
    v_mfma_f32_16x16x32_bf16 v[252:255], v[76:79], v[60:63], v[252:255]
    v_mfma_f32_16x16x32_bf16 v[248:251], v[72:75], v[60:63], v[248:251]
    v_mfma_f32_16x16x32_bf16 v[244:247], v[68:71], v[60:63], v[244:247]
    v_mfma_f32_16x16x32_bf16 v[240:243], v[64:67], v[60:63], v[240:243]
    s_waitcnt vmcnt(8) lgkmcnt(0)
    s_barrier
    ds_read_b128 v[32:35], v4 offset:0
    ds_read_b64_tr_b16 v[64:65], v6 offset:0
    s_add_u32 m0, s24, 49152
    s_add_u32 s30, s32, 608
    s_and_b32 s30, s30, 1023
    s_mul_i32 s30, s30, 7168
    buffer_load_dwordx4 v9, s[12:15], s30 offen lds
    ds_read_b64_tr_b16 v[66:67], v6 offset:1024
    ds_read_b64_tr_b16 v[68:69], v7 offset:0
    ds_read_b64_tr_b16 v[70:71], v7 offset:1024
    ds_read_b64_tr_b16 v[72:73], v6 offset:8192
    s_add_u32 m0, s24, 57344
    s_nop 0
    buffer_load_dwordx4 v9, s[16:19], s30 offen lds
    ds_read_b64_tr_b16 v[74:75], v6 offset:9216
    ds_read_b64_tr_b16 v[76:77], v7 offset:8192
    ds_read_b64_tr_b16 v[78:79], v7 offset:9216
    ds_read_b128 v[36:39], v4 offset:2048
    s_add_u32 m0, s24, 98304
    s_add_u32 s31, s33, 1280
    s_and_b32 s31, s31, 2047
    s_add_u32 s31, s31, 0
    buffer_load_dwordx4 v8, s[8:11], s31 offen lds
    ds_read_b128 v[40:43], v4 offset:4096
    ds_read_b128 v[44:47], v4 offset:6144
    ds_read_b128 v[48:51], v4 offset:8192
    ds_read_b128 v[52:55], v4 offset:10240
    s_add_u32 m0, s24, 106496
    s_add_u32 s31, s33, 1280
    s_and_b32 s31, s31, 2047
    s_add_u32 s31, s31, 131072
    buffer_load_dwordx4 v8, s[8:11], s31 offen lds
    ds_read_b128 v[56:59], v4 offset:12288
    ds_read_b128 v[60:63], v4 offset:14336
    v_mfma_f32_16x16x32_bf16 v[128:131], v[112:115], v[80:83], v[128:131]
    v_mfma_f32_16x16x32_bf16 v[132:135], v[116:119], v[80:83], v[132:135]
    v_mfma_f32_16x16x32_bf16 v[136:139], v[120:123], v[80:83], v[136:139]
    v_mfma_f32_16x16x32_bf16 v[140:143], v[124:127], v[80:83], v[140:143]
    v_mfma_f32_16x16x32_bf16 v[156:159], v[124:127], v[84:87], v[156:159]
    v_mfma_f32_16x16x32_bf16 v[152:155], v[120:123], v[84:87], v[152:155]
    v_mfma_f32_16x16x32_bf16 v[148:151], v[116:119], v[84:87], v[148:151]
    v_mfma_f32_16x16x32_bf16 v[144:147], v[112:115], v[84:87], v[144:147]
    v_mfma_f32_16x16x32_bf16 v[160:163], v[112:115], v[88:91], v[160:163]
    v_mfma_f32_16x16x32_bf16 v[164:167], v[116:119], v[88:91], v[164:167]
    v_mfma_f32_16x16x32_bf16 v[168:171], v[120:123], v[88:91], v[168:171]
    v_mfma_f32_16x16x32_bf16 v[172:175], v[124:127], v[88:91], v[172:175]
    v_mfma_f32_16x16x32_bf16 v[188:191], v[124:127], v[92:95], v[188:191]
    v_mfma_f32_16x16x32_bf16 v[184:187], v[120:123], v[92:95], v[184:187]
    v_mfma_f32_16x16x32_bf16 v[180:183], v[116:119], v[92:95], v[180:183]
    v_mfma_f32_16x16x32_bf16 v[176:179], v[112:115], v[92:95], v[176:179]
    v_mfma_f32_16x16x32_bf16 v[192:195], v[112:115], v[96:99], v[192:195]
    v_mfma_f32_16x16x32_bf16 v[196:199], v[116:119], v[96:99], v[196:199]
    v_mfma_f32_16x16x32_bf16 v[200:203], v[120:123], v[96:99], v[200:203]
    v_mfma_f32_16x16x32_bf16 v[204:207], v[124:127], v[96:99], v[204:207]
    v_mfma_f32_16x16x32_bf16 v[220:223], v[124:127], v[100:103], v[220:223]
    v_mfma_f32_16x16x32_bf16 v[216:219], v[120:123], v[100:103], v[216:219]
    v_mfma_f32_16x16x32_bf16 v[212:215], v[116:119], v[100:103], v[212:215]
    v_mfma_f32_16x16x32_bf16 v[208:211], v[112:115], v[100:103], v[208:211]
    v_mfma_f32_16x16x32_bf16 v[224:227], v[112:115], v[104:107], v[224:227]
    v_mfma_f32_16x16x32_bf16 v[228:231], v[116:119], v[104:107], v[228:231]
    v_mfma_f32_16x16x32_bf16 v[232:235], v[120:123], v[104:107], v[232:235]
    v_mfma_f32_16x16x32_bf16 v[236:239], v[124:127], v[104:107], v[236:239]
    v_mfma_f32_16x16x32_bf16 v[252:255], v[124:127], v[108:111], v[252:255]
    v_mfma_f32_16x16x32_bf16 v[248:251], v[120:123], v[108:111], v[248:251]
    v_mfma_f32_16x16x32_bf16 v[244:247], v[116:119], v[108:111], v[244:247]
    v_mfma_f32_16x16x32_bf16 v[240:243], v[112:115], v[108:111], v[240:243]
    s_waitcnt vmcnt(8) lgkmcnt(0)
    s_barrier
    ds_read_b128 v[80:83], v5 offset:0
    ds_read_b64_tr_b16 v[112:113], v6 offset:16384
    s_add_u32 m0, s24, 0
    s_add_u32 s30, s32, 640
    s_and_b32 s30, s30, 1023
    s_mul_i32 s30, s30, 7168
    buffer_load_dwordx4 v9, s[12:15], s30 offen lds
    ds_read_b64_tr_b16 v[114:115], v6 offset:17408
    ds_read_b64_tr_b16 v[116:117], v7 offset:16384
    ds_read_b64_tr_b16 v[118:119], v7 offset:17408
    ds_read_b64_tr_b16 v[120:121], v6 offset:24576
    s_add_u32 m0, s24, 8192
    s_nop 0
    buffer_load_dwordx4 v9, s[16:19], s30 offen lds
    ds_read_b64_tr_b16 v[122:123], v6 offset:25600
    ds_read_b64_tr_b16 v[124:125], v7 offset:24576
    ds_read_b64_tr_b16 v[126:127], v7 offset:25600
    ds_read_b128 v[84:87], v5 offset:2048
    s_add_u32 m0, s24, 114688
    s_add_u32 s31, s33, 1280
    s_and_b32 s31, s31, 2047
    s_add_u32 s31, s31, 262144
    buffer_load_dwordx4 v8, s[8:11], s31 offen lds
    ds_read_b128 v[88:91], v5 offset:4096
    ds_read_b128 v[92:95], v5 offset:6144
    ds_read_b128 v[96:99], v5 offset:8192
    ds_read_b128 v[100:103], v5 offset:10240
    s_add_u32 m0, s24, 122880
    s_add_u32 s31, s33, 1280
    s_and_b32 s31, s31, 2047
    s_add_u32 s31, s31, 393216
    buffer_load_dwordx4 v8, s[8:11], s31 offen lds
    ds_read_b128 v[104:107], v5 offset:12288
    ds_read_b128 v[108:111], v5 offset:14336
    s_cmp_lg_u32 s3, 4
    s_cbranch_scc1 M_pfB16
    buffer_load_dword v1, v31, s[96:99], s35 offen
M_pfB16:
    v_mfma_f32_16x16x32_bf16 v[128:131], v[64:67], v[32:35], v[128:131]
    v_mfma_f32_16x16x32_bf16 v[132:135], v[68:71], v[32:35], v[132:135]
    v_mfma_f32_16x16x32_bf16 v[136:139], v[72:75], v[32:35], v[136:139]
    v_mfma_f32_16x16x32_bf16 v[140:143], v[76:79], v[32:35], v[140:143]
    v_mfma_f32_16x16x32_bf16 v[156:159], v[76:79], v[36:39], v[156:159]
    v_mfma_f32_16x16x32_bf16 v[152:155], v[72:75], v[36:39], v[152:155]
    v_mfma_f32_16x16x32_bf16 v[148:151], v[68:71], v[36:39], v[148:151]
    v_mfma_f32_16x16x32_bf16 v[144:147], v[64:67], v[36:39], v[144:147]
    v_mfma_f32_16x16x32_bf16 v[160:163], v[64:67], v[40:43], v[160:163]
    v_mfma_f32_16x16x32_bf16 v[164:167], v[68:71], v[40:43], v[164:167]
    v_mfma_f32_16x16x32_bf16 v[168:171], v[72:75], v[40:43], v[168:171]
    v_mfma_f32_16x16x32_bf16 v[172:175], v[76:79], v[40:43], v[172:175]
    v_mfma_f32_16x16x32_bf16 v[188:191], v[76:79], v[44:47], v[188:191]
    v_mfma_f32_16x16x32_bf16 v[184:187], v[72:75], v[44:47], v[184:187]
    v_mfma_f32_16x16x32_bf16 v[180:183], v[68:71], v[44:47], v[180:183]
    v_mfma_f32_16x16x32_bf16 v[176:179], v[64:67], v[44:47], v[176:179]
    v_mfma_f32_16x16x32_bf16 v[192:195], v[64:67], v[48:51], v[192:195]
    v_mfma_f32_16x16x32_bf16 v[196:199], v[68:71], v[48:51], v[196:199]
    v_mfma_f32_16x16x32_bf16 v[200:203], v[72:75], v[48:51], v[200:203]
    v_mfma_f32_16x16x32_bf16 v[204:207], v[76:79], v[48:51], v[204:207]
    v_mfma_f32_16x16x32_bf16 v[220:223], v[76:79], v[52:55], v[220:223]
    v_mfma_f32_16x16x32_bf16 v[216:219], v[72:75], v[52:55], v[216:219]
    v_mfma_f32_16x16x32_bf16 v[212:215], v[68:71], v[52:55], v[212:215]
    v_mfma_f32_16x16x32_bf16 v[208:211], v[64:67], v[52:55], v[208:211]
    v_mfma_f32_16x16x32_bf16 v[224:227], v[64:67], v[56:59], v[224:227]
    v_mfma_f32_16x16x32_bf16 v[228:231], v[68:71], v[56:59], v[228:231]
    v_mfma_f32_16x16x32_bf16 v[232:235], v[72:75], v[56:59], v[232:235]
    v_mfma_f32_16x16x32_bf16 v[236:239], v[76:79], v[56:59], v[236:239]
    v_mfma_f32_16x16x32_bf16 v[252:255], v[76:79], v[60:63], v[252:255]
    v_mfma_f32_16x16x32_bf16 v[248:251], v[72:75], v[60:63], v[248:251]
    v_mfma_f32_16x16x32_bf16 v[244:247], v[68:71], v[60:63], v[244:247]
    v_mfma_f32_16x16x32_bf16 v[240:243], v[64:67], v[60:63], v[240:243]
    s_waitcnt vmcnt(8) lgkmcnt(0)
    s_barrier
    ds_read_b128 v[32:35], v2 offset:0
    ds_read_b64_tr_b16 v[64:65], v6 offset:32768
    s_add_u32 m0, s24, 16384
    s_add_u32 s30, s32, 672
    s_and_b32 s30, s30, 1023
    s_mul_i32 s30, s30, 7168
    buffer_load_dwordx4 v9, s[12:15], s30 offen lds
    ds_read_b64_tr_b16 v[66:67], v6 offset:33792
    ds_read_b64_tr_b16 v[68:69], v7 offset:32768
    ds_read_b64_tr_b16 v[70:71], v7 offset:33792
    ds_read_b64_tr_b16 v[72:73], v6 offset:40960
    s_add_u32 m0, s24, 24576
    s_nop 0
    buffer_load_dwordx4 v9, s[16:19], s30 offen lds
    ds_read_b64_tr_b16 v[74:75], v6 offset:41984
    ds_read_b64_tr_b16 v[76:77], v7 offset:40960
    ds_read_b64_tr_b16 v[78:79], v7 offset:41984
    ds_read_b128 v[36:39], v2 offset:2048
    s_add_u32 m0, s24, 131072
    s_add_u32 s31, s33, 1408
    s_and_b32 s31, s31, 2047
    s_add_u32 s31, s31, 0
    buffer_load_dwordx4 v8, s[8:11], s31 offen lds
    ds_read_b128 v[40:43], v2 offset:4096
    ds_read_b128 v[44:47], v2 offset:6144
    ds_read_b128 v[48:51], v2 offset:8192
    ds_read_b128 v[52:55], v2 offset:10240
    s_add_u32 m0, s24, 139264
    s_add_u32 s31, s33, 1408
    s_and_b32 s31, s31, 2047
    s_add_u32 s31, s31, 131072
    buffer_load_dwordx4 v8, s[8:11], s31 offen lds
    ds_read_b128 v[56:59], v2 offset:12288
    ds_read_b128 v[60:63], v2 offset:14336
    v_mfma_f32_16x16x32_bf16 v[128:131], v[112:115], v[80:83], v[128:131]
    v_mfma_f32_16x16x32_bf16 v[132:135], v[116:119], v[80:83], v[132:135]
    v_mfma_f32_16x16x32_bf16 v[136:139], v[120:123], v[80:83], v[136:139]
    v_mfma_f32_16x16x32_bf16 v[140:143], v[124:127], v[80:83], v[140:143]
    v_mfma_f32_16x16x32_bf16 v[156:159], v[124:127], v[84:87], v[156:159]
    v_mfma_f32_16x16x32_bf16 v[152:155], v[120:123], v[84:87], v[152:155]
    v_mfma_f32_16x16x32_bf16 v[148:151], v[116:119], v[84:87], v[148:151]
    v_mfma_f32_16x16x32_bf16 v[144:147], v[112:115], v[84:87], v[144:147]
    v_mfma_f32_16x16x32_bf16 v[160:163], v[112:115], v[88:91], v[160:163]
    v_mfma_f32_16x16x32_bf16 v[164:167], v[116:119], v[88:91], v[164:167]
    v_mfma_f32_16x16x32_bf16 v[168:171], v[120:123], v[88:91], v[168:171]
    v_mfma_f32_16x16x32_bf16 v[172:175], v[124:127], v[88:91], v[172:175]
    v_mfma_f32_16x16x32_bf16 v[188:191], v[124:127], v[92:95], v[188:191]
    v_mfma_f32_16x16x32_bf16 v[184:187], v[120:123], v[92:95], v[184:187]
    v_mfma_f32_16x16x32_bf16 v[180:183], v[116:119], v[92:95], v[180:183]
    v_mfma_f32_16x16x32_bf16 v[176:179], v[112:115], v[92:95], v[176:179]
    v_mfma_f32_16x16x32_bf16 v[192:195], v[112:115], v[96:99], v[192:195]
    v_mfma_f32_16x16x32_bf16 v[196:199], v[116:119], v[96:99], v[196:199]
    v_mfma_f32_16x16x32_bf16 v[200:203], v[120:123], v[96:99], v[200:203]
    v_mfma_f32_16x16x32_bf16 v[204:207], v[124:127], v[96:99], v[204:207]
    v_mfma_f32_16x16x32_bf16 v[220:223], v[124:127], v[100:103], v[220:223]
    v_mfma_f32_16x16x32_bf16 v[216:219], v[120:123], v[100:103], v[216:219]
    v_mfma_f32_16x16x32_bf16 v[212:215], v[116:119], v[100:103], v[212:215]
    v_mfma_f32_16x16x32_bf16 v[208:211], v[112:115], v[100:103], v[208:211]
    v_mfma_f32_16x16x32_bf16 v[224:227], v[112:115], v[104:107], v[224:227]
    v_mfma_f32_16x16x32_bf16 v[228:231], v[116:119], v[104:107], v[228:231]
    v_mfma_f32_16x16x32_bf16 v[232:235], v[120:123], v[104:107], v[232:235]
    v_mfma_f32_16x16x32_bf16 v[236:239], v[124:127], v[104:107], v[236:239]
    v_mfma_f32_16x16x32_bf16 v[252:255], v[124:127], v[108:111], v[252:255]
    v_mfma_f32_16x16x32_bf16 v[248:251], v[120:123], v[108:111], v[248:251]
    v_mfma_f32_16x16x32_bf16 v[244:247], v[116:119], v[108:111], v[244:247]
    v_mfma_f32_16x16x32_bf16 v[240:243], v[112:115], v[108:111], v[240:243]
    s_waitcnt vmcnt(8) lgkmcnt(0)
    s_barrier
    ds_read_b128 v[80:83], v3 offset:0
    ds_read_b64_tr_b16 v[112:113], v6 offset:49152
    s_add_u32 m0, s24, 32768
    s_add_u32 s30, s32, 704
    s_and_b32 s30, s30, 1023
    s_mul_i32 s30, s30, 7168
    buffer_load_dwordx4 v9, s[12:15], s30 offen lds
    ds_read_b64_tr_b16 v[114:115], v6 offset:50176
    ds_read_b64_tr_b16 v[116:117], v7 offset:49152
    ds_read_b64_tr_b16 v[118:119], v7 offset:50176
    ds_read_b64_tr_b16 v[120:121], v6 offset:57344
    s_add_u32 m0, s24, 40960
    s_nop 0
    buffer_load_dwordx4 v9, s[16:19], s30 offen lds
    ds_read_b64_tr_b16 v[122:123], v6 offset:58368
    ds_read_b64_tr_b16 v[124:125], v7 offset:57344
    ds_read_b64_tr_b16 v[126:127], v7 offset:58368
    ds_read_b128 v[84:87], v3 offset:2048
    s_add_u32 m0, s24, 147456
    s_add_u32 s31, s33, 1408
    s_and_b32 s31, s31, 2047
    s_add_u32 s31, s31, 262144
    buffer_load_dwordx4 v8, s[8:11], s31 offen lds
    ds_read_b128 v[88:91], v3 offset:4096
    ds_read_b128 v[92:95], v3 offset:6144
    ds_read_b128 v[96:99], v3 offset:8192
    ds_read_b128 v[100:103], v3 offset:10240
    s_add_u32 m0, s24, 155648
    s_add_u32 s31, s33, 1408
    s_and_b32 s31, s31, 2047
    s_add_u32 s31, s31, 393216
    buffer_load_dwordx4 v8, s[8:11], s31 offen lds
    ds_read_b128 v[104:107], v3 offset:12288
    ds_read_b128 v[108:111], v3 offset:14336
    v_mfma_f32_16x16x32_bf16 v[128:131], v[64:67], v[32:35], v[128:131]
    v_mfma_f32_16x16x32_bf16 v[132:135], v[68:71], v[32:35], v[132:135]
    v_mfma_f32_16x16x32_bf16 v[136:139], v[72:75], v[32:35], v[136:139]
    v_mfma_f32_16x16x32_bf16 v[140:143], v[76:79], v[32:35], v[140:143]
    v_mfma_f32_16x16x32_bf16 v[156:159], v[76:79], v[36:39], v[156:159]
    v_mfma_f32_16x16x32_bf16 v[152:155], v[72:75], v[36:39], v[152:155]
    v_mfma_f32_16x16x32_bf16 v[148:151], v[68:71], v[36:39], v[148:151]
    v_mfma_f32_16x16x32_bf16 v[144:147], v[64:67], v[36:39], v[144:147]
    v_mfma_f32_16x16x32_bf16 v[160:163], v[64:67], v[40:43], v[160:163]
    v_mfma_f32_16x16x32_bf16 v[164:167], v[68:71], v[40:43], v[164:167]
    v_mfma_f32_16x16x32_bf16 v[168:171], v[72:75], v[40:43], v[168:171]
    v_mfma_f32_16x16x32_bf16 v[172:175], v[76:79], v[40:43], v[172:175]
    v_mfma_f32_16x16x32_bf16 v[188:191], v[76:79], v[44:47], v[188:191]
    v_mfma_f32_16x16x32_bf16 v[184:187], v[72:75], v[44:47], v[184:187]
    v_mfma_f32_16x16x32_bf16 v[180:183], v[68:71], v[44:47], v[180:183]
    v_mfma_f32_16x16x32_bf16 v[176:179], v[64:67], v[44:47], v[176:179]
    v_mfma_f32_16x16x32_bf16 v[192:195], v[64:67], v[48:51], v[192:195]
    v_mfma_f32_16x16x32_bf16 v[196:199], v[68:71], v[48:51], v[196:199]
    v_mfma_f32_16x16x32_bf16 v[200:203], v[72:75], v[48:51], v[200:203]
    v_mfma_f32_16x16x32_bf16 v[204:207], v[76:79], v[48:51], v[204:207]
    v_mfma_f32_16x16x32_bf16 v[220:223], v[76:79], v[52:55], v[220:223]
    v_mfma_f32_16x16x32_bf16 v[216:219], v[72:75], v[52:55], v[216:219]
    v_mfma_f32_16x16x32_bf16 v[212:215], v[68:71], v[52:55], v[212:215]
    v_mfma_f32_16x16x32_bf16 v[208:211], v[64:67], v[52:55], v[208:211]
    v_mfma_f32_16x16x32_bf16 v[224:227], v[64:67], v[56:59], v[224:227]
    v_mfma_f32_16x16x32_bf16 v[228:231], v[68:71], v[56:59], v[228:231]
    v_mfma_f32_16x16x32_bf16 v[232:235], v[72:75], v[56:59], v[232:235]
    v_mfma_f32_16x16x32_bf16 v[236:239], v[76:79], v[56:59], v[236:239]
    v_mfma_f32_16x16x32_bf16 v[252:255], v[76:79], v[60:63], v[252:255]
    v_mfma_f32_16x16x32_bf16 v[248:251], v[72:75], v[60:63], v[248:251]
    v_mfma_f32_16x16x32_bf16 v[244:247], v[68:71], v[60:63], v[244:247]
    v_mfma_f32_16x16x32_bf16 v[240:243], v[64:67], v[60:63], v[240:243]
    s_waitcnt vmcnt(8) lgkmcnt(0)
    s_barrier
    ds_read_b128 v[32:35], v2 offset:32768
    ds_read_b64_tr_b16 v[64:65], v6 offset:0
    s_add_u32 m0, s24, 49152
    s_add_u32 s30, s32, 736
    s_and_b32 s30, s30, 1023
    s_mul_i32 s30, s30, 7168
    buffer_load_dwordx4 v9, s[12:15], s30 offen lds
    ds_read_b64_tr_b16 v[66:67], v6 offset:1024
    ds_read_b64_tr_b16 v[68:69], v7 offset:0
    ds_read_b64_tr_b16 v[70:71], v7 offset:1024
    ds_read_b64_tr_b16 v[72:73], v6 offset:8192
    s_add_u32 m0, s24, 57344
    s_nop 0
    buffer_load_dwordx4 v9, s[16:19], s30 offen lds
    ds_read_b64_tr_b16 v[74:75], v6 offset:9216
    ds_read_b64_tr_b16 v[76:77], v7 offset:8192
    ds_read_b64_tr_b16 v[78:79], v7 offset:9216
    ds_read_b128 v[36:39], v2 offset:34816
    s_add_u32 m0, s24, 65536
    s_add_u32 s31, s33, 1536
    s_and_b32 s31, s31, 2047
    s_add_u32 s31, s31, 0
    buffer_load_dwordx4 v8, s[8:11], s31 offen lds
    ds_read_b128 v[40:43], v2 offset:36864
    ds_read_b128 v[44:47], v2 offset:38912
    ds_read_b128 v[48:51], v2 offset:40960
    ds_read_b128 v[52:55], v2 offset:43008
    s_add_u32 m0, s24, 73728
    s_add_u32 s31, s33, 1536
    s_and_b32 s31, s31, 2047
    s_add_u32 s31, s31, 131072
    buffer_load_dwordx4 v8, s[8:11], s31 offen lds
    ds_read_b128 v[56:59], v2 offset:45056
    ds_read_b128 v[60:63], v2 offset:47104
    s_cmp_lg_u32 s3, 5
    s_cbranch_scc1 M_pfB19
    buffer_load_dword v1, v31, s[96:99], s35 offen
M_pfB19:
    v_mfma_f32_16x16x32_bf16 v[128:131], v[112:115], v[80:83], v[128:131]
    v_mfma_f32_16x16x32_bf16 v[132:135], v[116:119], v[80:83], v[132:135]
    v_mfma_f32_16x16x32_bf16 v[136:139], v[120:123], v[80:83], v[136:139]
    v_mfma_f32_16x16x32_bf16 v[140:143], v[124:127], v[80:83], v[140:143]
    v_mfma_f32_16x16x32_bf16 v[156:159], v[124:127], v[84:87], v[156:159]
    v_mfma_f32_16x16x32_bf16 v[152:155], v[120:123], v[84:87], v[152:155]
    v_mfma_f32_16x16x32_bf16 v[148:151], v[116:119], v[84:87], v[148:151]
    v_mfma_f32_16x16x32_bf16 v[144:147], v[112:115], v[84:87], v[144:147]
    v_mfma_f32_16x16x32_bf16 v[160:163], v[112:115], v[88:91], v[160:163]
    v_mfma_f32_16x16x32_bf16 v[164:167], v[116:119], v[88:91], v[164:167]
    v_mfma_f32_16x16x32_bf16 v[168:171], v[120:123], v[88:91], v[168:171]
    v_mfma_f32_16x16x32_bf16 v[172:175], v[124:127], v[88:91], v[172:175]
    v_mfma_f32_16x16x32_bf16 v[188:191], v[124:127], v[92:95], v[188:191]
    v_mfma_f32_16x16x32_bf16 v[184:187], v[120:123], v[92:95], v[184:187]
    v_mfma_f32_16x16x32_bf16 v[180:183], v[116:119], v[92:95], v[180:183]
    v_mfma_f32_16x16x32_bf16 v[176:179], v[112:115], v[92:95], v[176:179]
    v_mfma_f32_16x16x32_bf16 v[192:195], v[112:115], v[96:99], v[192:195]
    v_mfma_f32_16x16x32_bf16 v[196:199], v[116:119], v[96:99], v[196:199]
    v_mfma_f32_16x16x32_bf16 v[200:203], v[120:123], v[96:99], v[200:203]
    v_mfma_f32_16x16x32_bf16 v[204:207], v[124:127], v[96:99], v[204:207]
    v_mfma_f32_16x16x32_bf16 v[220:223], v[124:127], v[100:103], v[220:223]
    v_mfma_f32_16x16x32_bf16 v[216:219], v[120:123], v[100:103], v[216:219]
    v_mfma_f32_16x16x32_bf16 v[212:215], v[116:119], v[100:103], v[212:215]
    v_mfma_f32_16x16x32_bf16 v[208:211], v[112:115], v[100:103], v[208:211]
    v_mfma_f32_16x16x32_bf16 v[224:227], v[112:115], v[104:107], v[224:227]
    v_mfma_f32_16x16x32_bf16 v[228:231], v[116:119], v[104:107], v[228:231]
    v_mfma_f32_16x16x32_bf16 v[232:235], v[120:123], v[104:107], v[232:235]
    v_mfma_f32_16x16x32_bf16 v[236:239], v[124:127], v[104:107], v[236:239]
    v_mfma_f32_16x16x32_bf16 v[252:255], v[124:127], v[108:111], v[252:255]
    v_mfma_f32_16x16x32_bf16 v[248:251], v[120:123], v[108:111], v[248:251]
    v_mfma_f32_16x16x32_bf16 v[244:247], v[116:119], v[108:111], v[244:247]
    v_mfma_f32_16x16x32_bf16 v[240:243], v[112:115], v[108:111], v[240:243]
    s_waitcnt vmcnt(8) lgkmcnt(0)
    s_barrier
    ds_read_b128 v[80:83], v3 offset:32768
    ds_read_b64_tr_b16 v[112:113], v6 offset:16384
    s_add_u32 m0, s24, 0
    s_add_u32 s30, s32, 768
    s_and_b32 s30, s30, 1023
    s_mul_i32 s30, s30, 7168
    buffer_load_dwordx4 v9, s[12:15], s30 offen lds
    ds_read_b64_tr_b16 v[114:115], v6 offset:17408
    ds_read_b64_tr_b16 v[116:117], v7 offset:16384
    ds_read_b64_tr_b16 v[118:119], v7 offset:17408
    ds_read_b64_tr_b16 v[120:121], v6 offset:24576
    s_add_u32 m0, s24, 8192
    s_nop 0
    buffer_load_dwordx4 v9, s[16:19], s30 offen lds
    ds_read_b64_tr_b16 v[122:123], v6 offset:25600
    ds_read_b64_tr_b16 v[124:125], v7 offset:24576
    ds_read_b64_tr_b16 v[126:127], v7 offset:25600
    ds_read_b128 v[84:87], v3 offset:34816
    s_add_u32 m0, s24, 81920
    s_add_u32 s31, s33, 1536
    s_and_b32 s31, s31, 2047
    s_add_u32 s31, s31, 262144
    buffer_load_dwordx4 v8, s[8:11], s31 offen lds
    ds_read_b128 v[88:91], v3 offset:36864
    ds_read_b128 v[92:95], v3 offset:38912
    ds_read_b128 v[96:99], v3 offset:40960
    ds_read_b128 v[100:103], v3 offset:43008
    s_add_u32 m0, s24, 90112
    s_add_u32 s31, s33, 1536
    s_and_b32 s31, s31, 2047
    s_add_u32 s31, s31, 393216
    buffer_load_dwordx4 v8, s[8:11], s31 offen lds
    ds_read_b128 v[104:107], v3 offset:45056
    ds_read_b128 v[108:111], v3 offset:47104
    v_mfma_f32_16x16x32_bf16 v[128:131], v[64:67], v[32:35], v[128:131]
    v_mfma_f32_16x16x32_bf16 v[132:135], v[68:71], v[32:35], v[132:135]
    v_mfma_f32_16x16x32_bf16 v[136:139], v[72:75], v[32:35], v[136:139]
    v_mfma_f32_16x16x32_bf16 v[140:143], v[76:79], v[32:35], v[140:143]
    v_mfma_f32_16x16x32_bf16 v[156:159], v[76:79], v[36:39], v[156:159]
    v_mfma_f32_16x16x32_bf16 v[152:155], v[72:75], v[36:39], v[152:155]
    v_mfma_f32_16x16x32_bf16 v[148:151], v[68:71], v[36:39], v[148:151]
    v_mfma_f32_16x16x32_bf16 v[144:147], v[64:67], v[36:39], v[144:147]
    v_mfma_f32_16x16x32_bf16 v[160:163], v[64:67], v[40:43], v[160:163]
    v_mfma_f32_16x16x32_bf16 v[164:167], v[68:71], v[40:43], v[164:167]
    v_mfma_f32_16x16x32_bf16 v[168:171], v[72:75], v[40:43], v[168:171]
    v_mfma_f32_16x16x32_bf16 v[172:175], v[76:79], v[40:43], v[172:175]
    v_mfma_f32_16x16x32_bf16 v[188:191], v[76:79], v[44:47], v[188:191]
    v_mfma_f32_16x16x32_bf16 v[184:187], v[72:75], v[44:47], v[184:187]
    v_mfma_f32_16x16x32_bf16 v[180:183], v[68:71], v[44:47], v[180:183]
    v_mfma_f32_16x16x32_bf16 v[176:179], v[64:67], v[44:47], v[176:179]
    v_mfma_f32_16x16x32_bf16 v[192:195], v[64:67], v[48:51], v[192:195]
    v_mfma_f32_16x16x32_bf16 v[196:199], v[68:71], v[48:51], v[196:199]
    v_mfma_f32_16x16x32_bf16 v[200:203], v[72:75], v[48:51], v[200:203]
    v_mfma_f32_16x16x32_bf16 v[204:207], v[76:79], v[48:51], v[204:207]
    v_mfma_f32_16x16x32_bf16 v[220:223], v[76:79], v[52:55], v[220:223]
    v_mfma_f32_16x16x32_bf16 v[216:219], v[72:75], v[52:55], v[216:219]
    v_mfma_f32_16x16x32_bf16 v[212:215], v[68:71], v[52:55], v[212:215]
    v_mfma_f32_16x16x32_bf16 v[208:211], v[64:67], v[52:55], v[208:211]
    v_mfma_f32_16x16x32_bf16 v[224:227], v[64:67], v[56:59], v[224:227]
    v_mfma_f32_16x16x32_bf16 v[228:231], v[68:71], v[56:59], v[228:231]
    v_mfma_f32_16x16x32_bf16 v[232:235], v[72:75], v[56:59], v[232:235]
    v_mfma_f32_16x16x32_bf16 v[236:239], v[76:79], v[56:59], v[236:239]
    v_mfma_f32_16x16x32_bf16 v[252:255], v[76:79], v[60:63], v[252:255]
    v_mfma_f32_16x16x32_bf16 v[248:251], v[72:75], v[60:63], v[248:251]
    v_mfma_f32_16x16x32_bf16 v[244:247], v[68:71], v[60:63], v[244:247]
    v_mfma_f32_16x16x32_bf16 v[240:243], v[64:67], v[60:63], v[240:243]
    s_waitcnt vmcnt(8) lgkmcnt(0)
    s_barrier
    ds_read_b128 v[32:35], v4 offset:0
    ds_read_b64_tr_b16 v[64:65], v6 offset:32768
    s_add_u32 m0, s24, 16384
    s_add_u32 s30, s32, 800
    s_and_b32 s30, s30, 1023
    s_mul_i32 s30, s30, 7168
    buffer_load_dwordx4 v9, s[12:15], s30 offen lds
    ds_read_b64_tr_b16 v[66:67], v6 offset:33792
    ds_read_b64_tr_b16 v[68:69], v7 offset:32768
    ds_read_b64_tr_b16 v[70:71], v7 offset:33792
    ds_read_b64_tr_b16 v[72:73], v6 offset:40960
    s_add_u32 m0, s24, 24576
    s_nop 0
    buffer_load_dwordx4 v9, s[16:19], s30 offen lds
    ds_read_b64_tr_b16 v[74:75], v6 offset:41984
    ds_read_b64_tr_b16 v[76:77], v7 offset:40960
    ds_read_b64_tr_b16 v[78:79], v7 offset:41984
    ds_read_b128 v[36:39], v4 offset:2048
    s_add_u32 m0, s24, 98304
    s_add_u32 s31, s33, 1664
    s_and_b32 s31, s31, 2047
    s_add_u32 s31, s31, 0
    buffer_load_dwordx4 v8, s[8:11], s31 offen lds
    ds_read_b128 v[40:43], v4 offset:4096
    ds_read_b128 v[44:47], v4 offset:6144
    ds_read_b128 v[48:51], v4 offset:8192
    ds_read_b128 v[52:55], v4 offset:10240
    s_add_u32 m0, s24, 106496
    s_add_u32 s31, s33, 1664
    s_and_b32 s31, s31, 2047
    s_add_u32 s31, s31, 131072
    buffer_load_dwordx4 v8, s[8:11], s31 offen lds
    ds_read_b128 v[56:59], v4 offset:12288
    ds_read_b128 v[60:63], v4 offset:14336
    v_mfma_f32_16x16x32_bf16 v[128:131], v[112:115], v[80:83], v[128:131]
    v_mfma_f32_16x16x32_bf16 v[132:135], v[116:119], v[80:83], v[132:135]
    v_mfma_f32_16x16x32_bf16 v[136:139], v[120:123], v[80:83], v[136:139]
    v_mfma_f32_16x16x32_bf16 v[140:143], v[124:127], v[80:83], v[140:143]
    v_mfma_f32_16x16x32_bf16 v[156:159], v[124:127], v[84:87], v[156:159]
    v_mfma_f32_16x16x32_bf16 v[152:155], v[120:123], v[84:87], v[152:155]
    v_mfma_f32_16x16x32_bf16 v[148:151], v[116:119], v[84:87], v[148:151]
    v_mfma_f32_16x16x32_bf16 v[144:147], v[112:115], v[84:87], v[144:147]
    v_mfma_f32_16x16x32_bf16 v[160:163], v[112:115], v[88:91], v[160:163]
    v_mfma_f32_16x16x32_bf16 v[164:167], v[116:119], v[88:91], v[164:167]
    v_mfma_f32_16x16x32_bf16 v[168:171], v[120:123], v[88:91], v[168:171]
    v_mfma_f32_16x16x32_bf16 v[172:175], v[124:127], v[88:91], v[172:175]
    v_mfma_f32_16x16x32_bf16 v[188:191], v[124:127], v[92:95], v[188:191]
    v_mfma_f32_16x16x32_bf16 v[184:187], v[120:123], v[92:95], v[184:187]
    v_mfma_f32_16x16x32_bf16 v[180:183], v[116:119], v[92:95], v[180:183]
    v_mfma_f32_16x16x32_bf16 v[176:179], v[112:115], v[92:95], v[176:179]
    v_mfma_f32_16x16x32_bf16 v[192:195], v[112:115], v[96:99], v[192:195]
    v_mfma_f32_16x16x32_bf16 v[196:199], v[116:119], v[96:99], v[196:199]
    v_mfma_f32_16x16x32_bf16 v[200:203], v[120:123], v[96:99], v[200:203]
    v_mfma_f32_16x16x32_bf16 v[204:207], v[124:127], v[96:99], v[204:207]
    v_mfma_f32_16x16x32_bf16 v[220:223], v[124:127], v[100:103], v[220:223]
    v_mfma_f32_16x16x32_bf16 v[216:219], v[120:123], v[100:103], v[216:219]
    v_mfma_f32_16x16x32_bf16 v[212:215], v[116:119], v[100:103], v[212:215]
    v_mfma_f32_16x16x32_bf16 v[208:211], v[112:115], v[100:103], v[208:211]
    v_mfma_f32_16x16x32_bf16 v[224:227], v[112:115], v[104:107], v[224:227]
    v_mfma_f32_16x16x32_bf16 v[228:231], v[116:119], v[104:107], v[228:231]
    v_mfma_f32_16x16x32_bf16 v[232:235], v[120:123], v[104:107], v[232:235]
    v_mfma_f32_16x16x32_bf16 v[236:239], v[124:127], v[104:107], v[236:239]
    v_mfma_f32_16x16x32_bf16 v[252:255], v[124:127], v[108:111], v[252:255]
    v_mfma_f32_16x16x32_bf16 v[248:251], v[120:123], v[108:111], v[248:251]
    v_mfma_f32_16x16x32_bf16 v[244:247], v[116:119], v[108:111], v[244:247]
    v_mfma_f32_16x16x32_bf16 v[240:243], v[112:115], v[108:111], v[240:243]
    s_waitcnt vmcnt(8) lgkmcnt(0)
    s_barrier
    ds_read_b128 v[80:83], v5 offset:0
    ds_read_b64_tr_b16 v[112:113], v6 offset:49152
    s_add_u32 m0, s24, 32768
    s_add_u32 s30, s32, 832
    s_and_b32 s30, s30, 1023
    s_mul_i32 s30, s30, 7168
    buffer_load_dwordx4 v9, s[12:15], s30 offen lds
    ds_read_b64_tr_b16 v[114:115], v6 offset:50176
    ds_read_b64_tr_b16 v[116:117], v7 offset:49152
    ds_read_b64_tr_b16 v[118:119], v7 offset:50176
    ds_read_b64_tr_b16 v[120:121], v6 offset:57344
    s_add_u32 m0, s24, 40960
    s_nop 0
    buffer_load_dwordx4 v9, s[16:19], s30 offen lds
    ds_read_b64_tr_b16 v[122:123], v6 offset:58368
    ds_read_b64_tr_b16 v[124:125], v7 offset:57344
    ds_read_b64_tr_b16 v[126:127], v7 offset:58368
    ds_read_b128 v[84:87], v5 offset:2048
    s_add_u32 m0, s24, 114688
    s_add_u32 s31, s33, 1664
    s_and_b32 s31, s31, 2047
    s_add_u32 s31, s31, 262144
    buffer_load_dwordx4 v8, s[8:11], s31 offen lds
    ds_read_b128 v[88:91], v5 offset:4096
    ds_read_b128 v[92:95], v5 offset:6144
    ds_read_b128 v[96:99], v5 offset:8192
    ds_read_b128 v[100:103], v5 offset:10240
    s_add_u32 m0, s24, 122880
    s_add_u32 s31, s33, 1664
    s_and_b32 s31, s31, 2047
    s_add_u32 s31, s31, 393216
    buffer_load_dwordx4 v8, s[8:11], s31 offen lds
    ds_read_b128 v[104:107], v5 offset:12288
    ds_read_b128 v[108:111], v5 offset:14336
    s_cmp_lg_u32 s3, 6
    s_cbranch_scc1 M_pfB22
    buffer_load_dword v1, v31, s[96:99], s35 offen
M_pfB22:
    v_mfma_f32_16x16x32_bf16 v[128:131], v[64:67], v[32:35], v[128:131]
    v_mfma_f32_16x16x32_bf16 v[132:135], v[68:71], v[32:35], v[132:135]
    v_mfma_f32_16x16x32_bf16 v[136:139], v[72:75], v[32:35], v[136:139]
    v_mfma_f32_16x16x32_bf16 v[140:143], v[76:79], v[32:35], v[140:143]
    v_mfma_f32_16x16x32_bf16 v[156:159], v[76:79], v[36:39], v[156:159]
    v_mfma_f32_16x16x32_bf16 v[152:155], v[72:75], v[36:39], v[152:155]
    v_mfma_f32_16x16x32_bf16 v[148:151], v[68:71], v[36:39], v[148:151]
    v_mfma_f32_16x16x32_bf16 v[144:147], v[64:67], v[36:39], v[144:147]
    v_mfma_f32_16x16x32_bf16 v[160:163], v[64:67], v[40:43], v[160:163]
    v_mfma_f32_16x16x32_bf16 v[164:167], v[68:71], v[40:43], v[164:167]
    v_mfma_f32_16x16x32_bf16 v[168:171], v[72:75], v[40:43], v[168:171]
    v_mfma_f32_16x16x32_bf16 v[172:175], v[76:79], v[40:43], v[172:175]
    v_mfma_f32_16x16x32_bf16 v[188:191], v[76:79], v[44:47], v[188:191]
    v_mfma_f32_16x16x32_bf16 v[184:187], v[72:75], v[44:47], v[184:187]
    v_mfma_f32_16x16x32_bf16 v[180:183], v[68:71], v[44:47], v[180:183]
    v_mfma_f32_16x16x32_bf16 v[176:179], v[64:67], v[44:47], v[176:179]
    v_mfma_f32_16x16x32_bf16 v[192:195], v[64:67], v[48:51], v[192:195]
    v_mfma_f32_16x16x32_bf16 v[196:199], v[68:71], v[48:51], v[196:199]
    v_mfma_f32_16x16x32_bf16 v[200:203], v[72:75], v[48:51], v[200:203]
    v_mfma_f32_16x16x32_bf16 v[204:207], v[76:79], v[48:51], v[204:207]
    v_mfma_f32_16x16x32_bf16 v[220:223], v[76:79], v[52:55], v[220:223]
    v_mfma_f32_16x16x32_bf16 v[216:219], v[72:75], v[52:55], v[216:219]
    v_mfma_f32_16x16x32_bf16 v[212:215], v[68:71], v[52:55], v[212:215]
    v_mfma_f32_16x16x32_bf16 v[208:211], v[64:67], v[52:55], v[208:211]
    v_mfma_f32_16x16x32_bf16 v[224:227], v[64:67], v[56:59], v[224:227]
    v_mfma_f32_16x16x32_bf16 v[228:231], v[68:71], v[56:59], v[228:231]
    v_mfma_f32_16x16x32_bf16 v[232:235], v[72:75], v[56:59], v[232:235]
    v_mfma_f32_16x16x32_bf16 v[236:239], v[76:79], v[56:59], v[236:239]
    v_mfma_f32_16x16x32_bf16 v[252:255], v[76:79], v[60:63], v[252:255]
    v_mfma_f32_16x16x32_bf16 v[248:251], v[72:75], v[60:63], v[248:251]
    v_mfma_f32_16x16x32_bf16 v[244:247], v[68:71], v[60:63], v[244:247]
    v_mfma_f32_16x16x32_bf16 v[240:243], v[64:67], v[60:63], v[240:243]
    s_waitcnt vmcnt(8) lgkmcnt(0)
    s_barrier
    ds_read_b128 v[32:35], v2 offset:0
    ds_read_b64_tr_b16 v[64:65], v6 offset:0
    s_add_u32 m0, s24, 49152
    s_add_u32 s30, s32, 864
    s_and_b32 s30, s30, 1023
    s_mul_i32 s30, s30, 7168
    buffer_load_dwordx4 v9, s[12:15], s30 offen lds
    ds_read_b64_tr_b16 v[66:67], v6 offset:1024
    ds_read_b64_tr_b16 v[68:69], v7 offset:0
    ds_read_b64_tr_b16 v[70:71], v7 offset:1024
    ds_read_b64_tr_b16 v[72:73], v6 offset:8192
    s_add_u32 m0, s24, 57344
    s_nop 0
    buffer_load_dwordx4 v9, s[16:19], s30 offen lds
    ds_read_b64_tr_b16 v[74:75], v6 offset:9216
    ds_read_b64_tr_b16 v[76:77], v7 offset:8192
    ds_read_b64_tr_b16 v[78:79], v7 offset:9216
    ds_read_b128 v[36:39], v2 offset:2048
    s_add_u32 m0, s24, 131072
    s_add_u32 s31, s33, 1792
    s_and_b32 s31, s31, 2047
    s_add_u32 s31, s31, 0
    buffer_load_dwordx4 v8, s[8:11], s31 offen lds
    ds_read_b128 v[40:43], v2 offset:4096
    ds_read_b128 v[44:47], v2 offset:6144
    ds_read_b128 v[48:51], v2 offset:8192
    ds_read_b128 v[52:55], v2 offset:10240
    s_add_u32 m0, s24, 139264
    s_add_u32 s31, s33, 1792
    s_and_b32 s31, s31, 2047
    s_add_u32 s31, s31, 131072
    buffer_load_dwordx4 v8, s[8:11], s31 offen lds
    ds_read_b128 v[56:59], v2 offset:12288
    ds_read_b128 v[60:63], v2 offset:14336
    v_mfma_f32_16x16x32_bf16 v[128:131], v[112:115], v[80:83], v[128:131]
    v_mfma_f32_16x16x32_bf16 v[132:135], v[116:119], v[80:83], v[132:135]
    v_mfma_f32_16x16x32_bf16 v[136:139], v[120:123], v[80:83], v[136:139]
    v_mfma_f32_16x16x32_bf16 v[140:143], v[124:127], v[80:83], v[140:143]
    v_mfma_f32_16x16x32_bf16 v[156:159], v[124:127], v[84:87], v[156:159]
    v_mfma_f32_16x16x32_bf16 v[152:155], v[120:123], v[84:87], v[152:155]
    v_mfma_f32_16x16x32_bf16 v[148:151], v[116:119], v[84:87], v[148:151]
    v_mfma_f32_16x16x32_bf16 v[144:147], v[112:115], v[84:87], v[144:147]
    v_mfma_f32_16x16x32_bf16 v[160:163], v[112:115], v[88:91], v[160:163]
    v_mfma_f32_16x16x32_bf16 v[164:167], v[116:119], v[88:91], v[164:167]
    v_mfma_f32_16x16x32_bf16 v[168:171], v[120:123], v[88:91], v[168:171]
    v_mfma_f32_16x16x32_bf16 v[172:175], v[124:127], v[88:91], v[172:175]
    v_mfma_f32_16x16x32_bf16 v[188:191], v[124:127], v[92:95], v[188:191]
    v_mfma_f32_16x16x32_bf16 v[184:187], v[120:123], v[92:95], v[184:187]
    v_mfma_f32_16x16x32_bf16 v[180:183], v[116:119], v[92:95], v[180:183]
    v_mfma_f32_16x16x32_bf16 v[176:179], v[112:115], v[92:95], v[176:179]
    v_mfma_f32_16x16x32_bf16 v[192:195], v[112:115], v[96:99], v[192:195]
    v_mfma_f32_16x16x32_bf16 v[196:199], v[116:119], v[96:99], v[196:199]
    v_mfma_f32_16x16x32_bf16 v[200:203], v[120:123], v[96:99], v[200:203]
    v_mfma_f32_16x16x32_bf16 v[204:207], v[124:127], v[96:99], v[204:207]
    v_mfma_f32_16x16x32_bf16 v[220:223], v[124:127], v[100:103], v[220:223]
    v_mfma_f32_16x16x32_bf16 v[216:219], v[120:123], v[100:103], v[216:219]
    v_mfma_f32_16x16x32_bf16 v[212:215], v[116:119], v[100:103], v[212:215]
    v_mfma_f32_16x16x32_bf16 v[208:211], v[112:115], v[100:103], v[208:211]
    v_mfma_f32_16x16x32_bf16 v[224:227], v[112:115], v[104:107], v[224:227]
    v_mfma_f32_16x16x32_bf16 v[228:231], v[116:119], v[104:107], v[228:231]
    v_mfma_f32_16x16x32_bf16 v[232:235], v[120:123], v[104:107], v[232:235]
    v_mfma_f32_16x16x32_bf16 v[236:239], v[124:127], v[104:107], v[236:239]
    v_mfma_f32_16x16x32_bf16 v[252:255], v[124:127], v[108:111], v[252:255]
    v_mfma_f32_16x16x32_bf16 v[248:251], v[120:123], v[108:111], v[248:251]
    v_mfma_f32_16x16x32_bf16 v[244:247], v[116:119], v[108:111], v[244:247]
    v_mfma_f32_16x16x32_bf16 v[240:243], v[112:115], v[108:111], v[240:243]
    s_waitcnt vmcnt(8) lgkmcnt(0)
    s_barrier
    ds_read_b128 v[80:83], v3 offset:0
    ds_read_b64_tr_b16 v[112:113], v6 offset:16384
    s_add_u32 m0, s24, 0
    s_add_u32 s30, s32, 896
    s_and_b32 s30, s30, 1023
    s_mul_i32 s30, s30, 7168
    buffer_load_dwordx4 v9, s[12:15], s30 offen lds
    ds_read_b64_tr_b16 v[114:115], v6 offset:17408
    ds_read_b64_tr_b16 v[116:117], v7 offset:16384
    ds_read_b64_tr_b16 v[118:119], v7 offset:17408
    ds_read_b64_tr_b16 v[120:121], v6 offset:24576
    s_add_u32 m0, s24, 8192
    s_nop 0
    buffer_load_dwordx4 v9, s[16:19], s30 offen lds
    ds_read_b64_tr_b16 v[122:123], v6 offset:25600
    ds_read_b64_tr_b16 v[124:125], v7 offset:24576
    ds_read_b64_tr_b16 v[126:127], v7 offset:25600
    ds_read_b128 v[84:87], v3 offset:2048
    s_add_u32 m0, s24, 147456
    s_add_u32 s31, s33, 1792
    s_and_b32 s31, s31, 2047
    s_add_u32 s31, s31, 262144
    buffer_load_dwordx4 v8, s[8:11], s31 offen lds
    ds_read_b128 v[88:91], v3 offset:4096
    ds_read_b128 v[92:95], v3 offset:6144
    ds_read_b128 v[96:99], v3 offset:8192
    ds_read_b128 v[100:103], v3 offset:10240
    s_add_u32 m0, s24, 155648
    s_add_u32 s31, s33, 1792
    s_and_b32 s31, s31, 2047
    s_add_u32 s31, s31, 393216
    buffer_load_dwordx4 v8, s[8:11], s31 offen lds
    ds_read_b128 v[104:107], v3 offset:12288
    ds_read_b128 v[108:111], v3 offset:14336
    v_mfma_f32_16x16x32_bf16 v[128:131], v[64:67], v[32:35], v[128:131]
    v_mfma_f32_16x16x32_bf16 v[132:135], v[68:71], v[32:35], v[132:135]
    v_mfma_f32_16x16x32_bf16 v[136:139], v[72:75], v[32:35], v[136:139]
    v_mfma_f32_16x16x32_bf16 v[140:143], v[76:79], v[32:35], v[140:143]
    v_mfma_f32_16x16x32_bf16 v[156:159], v[76:79], v[36:39], v[156:159]
    v_mfma_f32_16x16x32_bf16 v[152:155], v[72:75], v[36:39], v[152:155]
    v_mfma_f32_16x16x32_bf16 v[148:151], v[68:71], v[36:39], v[148:151]
    v_mfma_f32_16x16x32_bf16 v[144:147], v[64:67], v[36:39], v[144:147]
    v_mfma_f32_16x16x32_bf16 v[160:163], v[64:67], v[40:43], v[160:163]
    v_mfma_f32_16x16x32_bf16 v[164:167], v[68:71], v[40:43], v[164:167]
    v_mfma_f32_16x16x32_bf16 v[168:171], v[72:75], v[40:43], v[168:171]
    v_mfma_f32_16x16x32_bf16 v[172:175], v[76:79], v[40:43], v[172:175]
    v_mfma_f32_16x16x32_bf16 v[188:191], v[76:79], v[44:47], v[188:191]
    v_mfma_f32_16x16x32_bf16 v[184:187], v[72:75], v[44:47], v[184:187]
    v_mfma_f32_16x16x32_bf16 v[180:183], v[68:71], v[44:47], v[180:183]
    v_mfma_f32_16x16x32_bf16 v[176:179], v[64:67], v[44:47], v[176:179]
    v_mfma_f32_16x16x32_bf16 v[192:195], v[64:67], v[48:51], v[192:195]
    v_mfma_f32_16x16x32_bf16 v[196:199], v[68:71], v[48:51], v[196:199]
    v_mfma_f32_16x16x32_bf16 v[200:203], v[72:75], v[48:51], v[200:203]
    v_mfma_f32_16x16x32_bf16 v[204:207], v[76:79], v[48:51], v[204:207]
    v_mfma_f32_16x16x32_bf16 v[220:223], v[76:79], v[52:55], v[220:223]
    v_mfma_f32_16x16x32_bf16 v[216:219], v[72:75], v[52:55], v[216:219]
    v_mfma_f32_16x16x32_bf16 v[212:215], v[68:71], v[52:55], v[212:215]
    v_mfma_f32_16x16x32_bf16 v[208:211], v[64:67], v[52:55], v[208:211]
    v_mfma_f32_16x16x32_bf16 v[224:227], v[64:67], v[56:59], v[224:227]
    v_mfma_f32_16x16x32_bf16 v[228:231], v[68:71], v[56:59], v[228:231]
    v_mfma_f32_16x16x32_bf16 v[232:235], v[72:75], v[56:59], v[232:235]
    v_mfma_f32_16x16x32_bf16 v[236:239], v[76:79], v[56:59], v[236:239]
    v_mfma_f32_16x16x32_bf16 v[252:255], v[76:79], v[60:63], v[252:255]
    v_mfma_f32_16x16x32_bf16 v[248:251], v[72:75], v[60:63], v[248:251]
    v_mfma_f32_16x16x32_bf16 v[244:247], v[68:71], v[60:63], v[244:247]
    v_mfma_f32_16x16x32_bf16 v[240:243], v[64:67], v[60:63], v[240:243]
    s_waitcnt vmcnt(8) lgkmcnt(0)
    s_barrier
    ds_read_b128 v[32:35], v2 offset:32768
    ds_read_b64_tr_b16 v[64:65], v6 offset:32768
    s_add_u32 m0, s24, 16384
    s_add_u32 s30, s32, 928
    s_and_b32 s30, s30, 1023
    s_mul_i32 s30, s30, 7168
    buffer_load_dwordx4 v9, s[12:15], s30 offen lds
    ds_read_b64_tr_b16 v[66:67], v6 offset:33792
    ds_read_b64_tr_b16 v[68:69], v7 offset:32768
    ds_read_b64_tr_b16 v[70:71], v7 offset:33792
    ds_read_b64_tr_b16 v[72:73], v6 offset:40960
    s_add_u32 m0, s24, 24576
    s_nop 0
    buffer_load_dwordx4 v9, s[16:19], s30 offen lds
    ds_read_b64_tr_b16 v[74:75], v6 offset:41984
    ds_read_b64_tr_b16 v[76:77], v7 offset:40960
    ds_read_b64_tr_b16 v[78:79], v7 offset:41984
    ds_read_b128 v[36:39], v2 offset:34816
    s_add_u32 m0, s24, 65536
    s_add_u32 s31, s33, 1920
    s_and_b32 s31, s31, 2047
    s_add_u32 s31, s31, 0
    buffer_load_dwordx4 v8, s[8:11], s31 offen lds
    ds_read_b128 v[40:43], v2 offset:36864
    ds_read_b128 v[44:47], v2 offset:38912
    ds_read_b128 v[48:51], v2 offset:40960
    ds_read_b128 v[52:55], v2 offset:43008
    s_add_u32 m0, s24, 73728
    s_add_u32 s31, s33, 1920
    s_and_b32 s31, s31, 2047
    s_add_u32 s31, s31, 131072
    buffer_load_dwordx4 v8, s[8:11], s31 offen lds
    ds_read_b128 v[56:59], v2 offset:45056
    ds_read_b128 v[60:63], v2 offset:47104
    s_cmp_lg_u32 s3, 7
    s_cbranch_scc1 M_pfB25
    buffer_load_dword v1, v31, s[96:99], s35 offen
M_pfB25:
    v_mfma_f32_16x16x32_bf16 v[128:131], v[112:115], v[80:83], v[128:131]
    v_mfma_f32_16x16x32_bf16 v[132:135], v[116:119], v[80:83], v[132:135]
    v_mfma_f32_16x16x32_bf16 v[136:139], v[120:123], v[80:83], v[136:139]
    v_mfma_f32_16x16x32_bf16 v[140:143], v[124:127], v[80:83], v[140:143]
    v_mfma_f32_16x16x32_bf16 v[156:159], v[124:127], v[84:87], v[156:159]
    v_mfma_f32_16x16x32_bf16 v[152:155], v[120:123], v[84:87], v[152:155]
    v_mfma_f32_16x16x32_bf16 v[148:151], v[116:119], v[84:87], v[148:151]
    v_mfma_f32_16x16x32_bf16 v[144:147], v[112:115], v[84:87], v[144:147]
    v_mfma_f32_16x16x32_bf16 v[160:163], v[112:115], v[88:91], v[160:163]
    v_mfma_f32_16x16x32_bf16 v[164:167], v[116:119], v[88:91], v[164:167]
    v_mfma_f32_16x16x32_bf16 v[168:171], v[120:123], v[88:91], v[168:171]
    v_mfma_f32_16x16x32_bf16 v[172:175], v[124:127], v[88:91], v[172:175]
    v_mfma_f32_16x16x32_bf16 v[188:191], v[124:127], v[92:95], v[188:191]
    v_mfma_f32_16x16x32_bf16 v[184:187], v[120:123], v[92:95], v[184:187]
    v_mfma_f32_16x16x32_bf16 v[180:183], v[116:119], v[92:95], v[180:183]
    v_mfma_f32_16x16x32_bf16 v[176:179], v[112:115], v[92:95], v[176:179]
    v_mfma_f32_16x16x32_bf16 v[192:195], v[112:115], v[96:99], v[192:195]
    v_mfma_f32_16x16x32_bf16 v[196:199], v[116:119], v[96:99], v[196:199]
    v_mfma_f32_16x16x32_bf16 v[200:203], v[120:123], v[96:99], v[200:203]
    v_mfma_f32_16x16x32_bf16 v[204:207], v[124:127], v[96:99], v[204:207]
    v_mfma_f32_16x16x32_bf16 v[220:223], v[124:127], v[100:103], v[220:223]
    v_mfma_f32_16x16x32_bf16 v[216:219], v[120:123], v[100:103], v[216:219]
    v_mfma_f32_16x16x32_bf16 v[212:215], v[116:119], v[100:103], v[212:215]
    v_mfma_f32_16x16x32_bf16 v[208:211], v[112:115], v[100:103], v[208:211]
    v_mfma_f32_16x16x32_bf16 v[224:227], v[112:115], v[104:107], v[224:227]
    v_mfma_f32_16x16x32_bf16 v[228:231], v[116:119], v[104:107], v[228:231]
    v_mfma_f32_16x16x32_bf16 v[232:235], v[120:123], v[104:107], v[232:235]
    v_mfma_f32_16x16x32_bf16 v[236:239], v[124:127], v[104:107], v[236:239]
    v_mfma_f32_16x16x32_bf16 v[252:255], v[124:127], v[108:111], v[252:255]
    v_mfma_f32_16x16x32_bf16 v[248:251], v[120:123], v[108:111], v[248:251]
    v_mfma_f32_16x16x32_bf16 v[244:247], v[116:119], v[108:111], v[244:247]
    v_mfma_f32_16x16x32_bf16 v[240:243], v[112:115], v[108:111], v[240:243]
    s_waitcnt vmcnt(8) lgkmcnt(0)
    s_barrier
    ds_read_b128 v[80:83], v3 offset:32768
    ds_read_b64_tr_b16 v[112:113], v6 offset:49152
    s_add_u32 m0, s24, 32768
    s_add_u32 s30, s32, 960
    s_and_b32 s30, s30, 1023
    s_mul_i32 s30, s30, 7168
    buffer_load_dwordx4 v9, s[12:15], s30 offen lds
    ds_read_b64_tr_b16 v[114:115], v6 offset:50176
    ds_read_b64_tr_b16 v[116:117], v7 offset:49152
    ds_read_b64_tr_b16 v[118:119], v7 offset:50176
    ds_read_b64_tr_b16 v[120:121], v6 offset:57344
    s_add_u32 m0, s24, 40960
    s_nop 0
    buffer_load_dwordx4 v9, s[16:19], s30 offen lds
    ds_read_b64_tr_b16 v[122:123], v6 offset:58368
    ds_read_b64_tr_b16 v[124:125], v7 offset:57344
    ds_read_b64_tr_b16 v[126:127], v7 offset:58368
    ds_read_b128 v[84:87], v3 offset:34816
    s_add_u32 m0, s24, 81920
    s_add_u32 s31, s33, 1920
    s_and_b32 s31, s31, 2047
    s_add_u32 s31, s31, 262144
    buffer_load_dwordx4 v8, s[8:11], s31 offen lds
    ds_read_b128 v[88:91], v3 offset:36864
    ds_read_b128 v[92:95], v3 offset:38912
    ds_read_b128 v[96:99], v3 offset:40960
    ds_read_b128 v[100:103], v3 offset:43008
    s_add_u32 m0, s24, 90112
    s_add_u32 s31, s33, 1920
    s_and_b32 s31, s31, 2047
    s_add_u32 s31, s31, 393216
    buffer_load_dwordx4 v8, s[8:11], s31 offen lds
    ds_read_b128 v[104:107], v3 offset:45056
    ds_read_b128 v[108:111], v3 offset:47104
    v_mfma_f32_16x16x32_bf16 v[128:131], v[64:67], v[32:35], v[128:131]
    v_mfma_f32_16x16x32_bf16 v[132:135], v[68:71], v[32:35], v[132:135]
    v_mfma_f32_16x16x32_bf16 v[136:139], v[72:75], v[32:35], v[136:139]
    v_mfma_f32_16x16x32_bf16 v[140:143], v[76:79], v[32:35], v[140:143]
    v_mfma_f32_16x16x32_bf16 v[156:159], v[76:79], v[36:39], v[156:159]
    v_mfma_f32_16x16x32_bf16 v[152:155], v[72:75], v[36:39], v[152:155]
    v_mfma_f32_16x16x32_bf16 v[148:151], v[68:71], v[36:39], v[148:151]
    v_mfma_f32_16x16x32_bf16 v[144:147], v[64:67], v[36:39], v[144:147]
    v_mfma_f32_16x16x32_bf16 v[160:163], v[64:67], v[40:43], v[160:163]
    v_mfma_f32_16x16x32_bf16 v[164:167], v[68:71], v[40:43], v[164:167]
    v_mfma_f32_16x16x32_bf16 v[168:171], v[72:75], v[40:43], v[168:171]
    v_mfma_f32_16x16x32_bf16 v[172:175], v[76:79], v[40:43], v[172:175]
    v_mfma_f32_16x16x32_bf16 v[188:191], v[76:79], v[44:47], v[188:191]
    v_mfma_f32_16x16x32_bf16 v[184:187], v[72:75], v[44:47], v[184:187]
    v_mfma_f32_16x16x32_bf16 v[180:183], v[68:71], v[44:47], v[180:183]
    v_mfma_f32_16x16x32_bf16 v[176:179], v[64:67], v[44:47], v[176:179]
    v_mfma_f32_16x16x32_bf16 v[192:195], v[64:67], v[48:51], v[192:195]
    v_mfma_f32_16x16x32_bf16 v[196:199], v[68:71], v[48:51], v[196:199]
    v_mfma_f32_16x16x32_bf16 v[200:203], v[72:75], v[48:51], v[200:203]
    v_mfma_f32_16x16x32_bf16 v[204:207], v[76:79], v[48:51], v[204:207]
    v_mfma_f32_16x16x32_bf16 v[220:223], v[76:79], v[52:55], v[220:223]
    v_mfma_f32_16x16x32_bf16 v[216:219], v[72:75], v[52:55], v[216:219]
    v_mfma_f32_16x16x32_bf16 v[212:215], v[68:71], v[52:55], v[212:215]
    v_mfma_f32_16x16x32_bf16 v[208:211], v[64:67], v[52:55], v[208:211]
    v_mfma_f32_16x16x32_bf16 v[224:227], v[64:67], v[56:59], v[224:227]
    v_mfma_f32_16x16x32_bf16 v[228:231], v[68:71], v[56:59], v[228:231]
    v_mfma_f32_16x16x32_bf16 v[232:235], v[72:75], v[56:59], v[232:235]
    v_mfma_f32_16x16x32_bf16 v[236:239], v[76:79], v[56:59], v[236:239]
    v_mfma_f32_16x16x32_bf16 v[252:255], v[76:79], v[60:63], v[252:255]
    v_mfma_f32_16x16x32_bf16 v[248:251], v[72:75], v[60:63], v[248:251]
    v_mfma_f32_16x16x32_bf16 v[244:247], v[68:71], v[60:63], v[244:247]
    v_mfma_f32_16x16x32_bf16 v[240:243], v[64:67], v[60:63], v[240:243]
    s_waitcnt vmcnt(8) lgkmcnt(0)
    s_barrier
    ds_read_b128 v[32:35], v4 offset:0
    ds_read_b64_tr_b16 v[64:65], v6 offset:0
    s_add_u32 m0, s24, 49152
    s_add_u32 s30, s32, 992
    s_and_b32 s30, s30, 1023
    s_mul_i32 s30, s30, 7168
    buffer_load_dwordx4 v9, s[12:15], s30 offen lds
    ds_read_b64_tr_b16 v[66:67], v6 offset:1024
    ds_read_b64_tr_b16 v[68:69], v7 offset:0
    ds_read_b64_tr_b16 v[70:71], v7 offset:1024
    ds_read_b64_tr_b16 v[72:73], v6 offset:8192
    s_add_u32 m0, s24, 57344
    s_nop 0
    buffer_load_dwordx4 v9, s[16:19], s30 offen lds
    ds_read_b64_tr_b16 v[74:75], v6 offset:9216
    ds_read_b64_tr_b16 v[76:77], v7 offset:8192
    ds_read_b64_tr_b16 v[78:79], v7 offset:9216
    ds_read_b128 v[36:39], v4 offset:2048
    ds_read_b128 v[40:43], v4 offset:4096
    ds_read_b128 v[44:47], v4 offset:6144
    ds_read_b128 v[48:51], v4 offset:8192
    ds_read_b128 v[52:55], v4 offset:10240
    ds_read_b128 v[56:59], v4 offset:12288
    ds_read_b128 v[60:63], v4 offset:14336
    v_mfma_f32_16x16x32_bf16 v[128:131], v[112:115], v[80:83], v[128:131]
    v_mfma_f32_16x16x32_bf16 v[132:135], v[116:119], v[80:83], v[132:135]
    v_mfma_f32_16x16x32_bf16 v[136:139], v[120:123], v[80:83], v[136:139]
    v_mfma_f32_16x16x32_bf16 v[140:143], v[124:127], v[80:83], v[140:143]
    v_mfma_f32_16x16x32_bf16 v[156:159], v[124:127], v[84:87], v[156:159]
    v_mfma_f32_16x16x32_bf16 v[152:155], v[120:123], v[84:87], v[152:155]
    v_mfma_f32_16x16x32_bf16 v[148:151], v[116:119], v[84:87], v[148:151]
    v_mfma_f32_16x16x32_bf16 v[144:147], v[112:115], v[84:87], v[144:147]
    v_mfma_f32_16x16x32_bf16 v[160:163], v[112:115], v[88:91], v[160:163]
    v_mfma_f32_16x16x32_bf16 v[164:167], v[116:119], v[88:91], v[164:167]
    v_mfma_f32_16x16x32_bf16 v[168:171], v[120:123], v[88:91], v[168:171]
    v_mfma_f32_16x16x32_bf16 v[172:175], v[124:127], v[88:91], v[172:175]
    v_mfma_f32_16x16x32_bf16 v[188:191], v[124:127], v[92:95], v[188:191]
    v_mfma_f32_16x16x32_bf16 v[184:187], v[120:123], v[92:95], v[184:187]
    v_mfma_f32_16x16x32_bf16 v[180:183], v[116:119], v[92:95], v[180:183]
    v_mfma_f32_16x16x32_bf16 v[176:179], v[112:115], v[92:95], v[176:179]
    v_mfma_f32_16x16x32_bf16 v[192:195], v[112:115], v[96:99], v[192:195]
    v_mfma_f32_16x16x32_bf16 v[196:199], v[116:119], v[96:99], v[196:199]
    v_mfma_f32_16x16x32_bf16 v[200:203], v[120:123], v[96:99], v[200:203]
    v_mfma_f32_16x16x32_bf16 v[204:207], v[124:127], v[96:99], v[204:207]
    v_mfma_f32_16x16x32_bf16 v[220:223], v[124:127], v[100:103], v[220:223]
    v_mfma_f32_16x16x32_bf16 v[216:219], v[120:123], v[100:103], v[216:219]
    v_mfma_f32_16x16x32_bf16 v[212:215], v[116:119], v[100:103], v[212:215]
    v_mfma_f32_16x16x32_bf16 v[208:211], v[112:115], v[100:103], v[208:211]
    v_mfma_f32_16x16x32_bf16 v[224:227], v[112:115], v[104:107], v[224:227]
    v_mfma_f32_16x16x32_bf16 v[228:231], v[116:119], v[104:107], v[228:231]
    v_mfma_f32_16x16x32_bf16 v[232:235], v[120:123], v[104:107], v[232:235]
    v_mfma_f32_16x16x32_bf16 v[236:239], v[124:127], v[104:107], v[236:239]
    v_mfma_f32_16x16x32_bf16 v[252:255], v[124:127], v[108:111], v[252:255]
    v_mfma_f32_16x16x32_bf16 v[248:251], v[120:123], v[108:111], v[248:251]
    v_mfma_f32_16x16x32_bf16 v[244:247], v[116:119], v[108:111], v[244:247]
    v_mfma_f32_16x16x32_bf16 v[240:243], v[112:115], v[108:111], v[240:243]
    s_waitcnt vmcnt(6) lgkmcnt(0)
    s_barrier
    ds_read_b128 v[80:83], v5 offset:0
    ds_read_b64_tr_b16 v[112:113], v6 offset:16384
    ds_read_b64_tr_b16 v[114:115], v6 offset:17408
    ds_read_b64_tr_b16 v[116:117], v7 offset:16384
    ds_read_b64_tr_b16 v[118:119], v7 offset:17408
    ds_read_b64_tr_b16 v[120:121], v6 offset:24576
    ds_read_b64_tr_b16 v[122:123], v6 offset:25600
    ds_read_b64_tr_b16 v[124:125], v7 offset:24576
    ds_read_b64_tr_b16 v[126:127], v7 offset:25600
    ds_read_b128 v[84:87], v5 offset:2048
    ds_read_b128 v[88:91], v5 offset:4096
    ds_read_b128 v[92:95], v5 offset:6144
    ds_read_b128 v[96:99], v5 offset:8192
    ds_read_b128 v[100:103], v5 offset:10240
    ds_read_b128 v[104:107], v5 offset:12288
    ds_read_b128 v[108:111], v5 offset:14336
    v_mfma_f32_16x16x32_bf16 v[128:131], v[64:67], v[32:35], v[128:131]
    v_mfma_f32_16x16x32_bf16 v[132:135], v[68:71], v[32:35], v[132:135]
    v_mfma_f32_16x16x32_bf16 v[136:139], v[72:75], v[32:35], v[136:139]
    v_mfma_f32_16x16x32_bf16 v[140:143], v[76:79], v[32:35], v[140:143]
    v_mfma_f32_16x16x32_bf16 v[156:159], v[76:79], v[36:39], v[156:159]
    v_mfma_f32_16x16x32_bf16 v[152:155], v[72:75], v[36:39], v[152:155]
    v_mfma_f32_16x16x32_bf16 v[148:151], v[68:71], v[36:39], v[148:151]
    v_mfma_f32_16x16x32_bf16 v[144:147], v[64:67], v[36:39], v[144:147]
    v_mfma_f32_16x16x32_bf16 v[160:163], v[64:67], v[40:43], v[160:163]
    v_mfma_f32_16x16x32_bf16 v[164:167], v[68:71], v[40:43], v[164:167]
    v_mfma_f32_16x16x32_bf16 v[168:171], v[72:75], v[40:43], v[168:171]
    v_mfma_f32_16x16x32_bf16 v[172:175], v[76:79], v[40:43], v[172:175]
    v_mfma_f32_16x16x32_bf16 v[188:191], v[76:79], v[44:47], v[188:191]
    v_mfma_f32_16x16x32_bf16 v[184:187], v[72:75], v[44:47], v[184:187]
    v_mfma_f32_16x16x32_bf16 v[180:183], v[68:71], v[44:47], v[180:183]
    v_mfma_f32_16x16x32_bf16 v[176:179], v[64:67], v[44:47], v[176:179]
    v_mfma_f32_16x16x32_bf16 v[192:195], v[64:67], v[48:51], v[192:195]
    v_mfma_f32_16x16x32_bf16 v[196:199], v[68:71], v[48:51], v[196:199]
    v_mfma_f32_16x16x32_bf16 v[200:203], v[72:75], v[48:51], v[200:203]
    v_mfma_f32_16x16x32_bf16 v[204:207], v[76:79], v[48:51], v[204:207]
    v_mfma_f32_16x16x32_bf16 v[220:223], v[76:79], v[52:55], v[220:223]
    v_mfma_f32_16x16x32_bf16 v[216:219], v[72:75], v[52:55], v[216:219]
    v_mfma_f32_16x16x32_bf16 v[212:215], v[68:71], v[52:55], v[212:215]
    v_mfma_f32_16x16x32_bf16 v[208:211], v[64:67], v[52:55], v[208:211]
    v_mfma_f32_16x16x32_bf16 v[224:227], v[64:67], v[56:59], v[224:227]
    v_mfma_f32_16x16x32_bf16 v[228:231], v[68:71], v[56:59], v[228:231]
    v_mfma_f32_16x16x32_bf16 v[232:235], v[72:75], v[56:59], v[232:235]
    v_mfma_f32_16x16x32_bf16 v[236:239], v[76:79], v[56:59], v[236:239]
    v_mfma_f32_16x16x32_bf16 v[252:255], v[76:79], v[60:63], v[252:255]
    v_mfma_f32_16x16x32_bf16 v[248:251], v[72:75], v[60:63], v[248:251]
    v_mfma_f32_16x16x32_bf16 v[244:247], v[68:71], v[60:63], v[244:247]
    v_mfma_f32_16x16x32_bf16 v[240:243], v[64:67], v[60:63], v[240:243]
    s_waitcnt vmcnt(2) lgkmcnt(0)
    s_barrier
    ds_read_b128 v[32:35], v2 offset:0
    ds_read_b64_tr_b16 v[64:65], v6 offset:32768
    ds_read_b64_tr_b16 v[66:67], v6 offset:33792
    ds_read_b64_tr_b16 v[68:69], v7 offset:32768
    ds_read_b64_tr_b16 v[70:71], v7 offset:33792
    ds_read_b64_tr_b16 v[72:73], v6 offset:40960
    ds_read_b64_tr_b16 v[74:75], v6 offset:41984
    ds_read_b64_tr_b16 v[76:77], v7 offset:40960
    ds_read_b64_tr_b16 v[78:79], v7 offset:41984
    ds_read_b128 v[36:39], v2 offset:2048
    ds_read_b128 v[40:43], v2 offset:4096
    ds_read_b128 v[44:47], v2 offset:6144
    ds_read_b128 v[48:51], v2 offset:8192
    ds_read_b128 v[52:55], v2 offset:10240
    ds_read_b128 v[56:59], v2 offset:12288
    ds_read_b128 v[60:63], v2 offset:14336
    v_mfma_f32_16x16x32_bf16 v[128:131], v[112:115], v[80:83], v[128:131]
    v_mfma_f32_16x16x32_bf16 v[132:135], v[116:119], v[80:83], v[132:135]
    v_mfma_f32_16x16x32_bf16 v[136:139], v[120:123], v[80:83], v[136:139]
    v_mfma_f32_16x16x32_bf16 v[140:143], v[124:127], v[80:83], v[140:143]
    v_mfma_f32_16x16x32_bf16 v[156:159], v[124:127], v[84:87], v[156:159]
    v_mfma_f32_16x16x32_bf16 v[152:155], v[120:123], v[84:87], v[152:155]
    v_mfma_f32_16x16x32_bf16 v[148:151], v[116:119], v[84:87], v[148:151]
    v_mfma_f32_16x16x32_bf16 v[144:147], v[112:115], v[84:87], v[144:147]
    v_mfma_f32_16x16x32_bf16 v[160:163], v[112:115], v[88:91], v[160:163]
    v_mfma_f32_16x16x32_bf16 v[164:167], v[116:119], v[88:91], v[164:167]
    v_mfma_f32_16x16x32_bf16 v[168:171], v[120:123], v[88:91], v[168:171]
    v_mfma_f32_16x16x32_bf16 v[172:175], v[124:127], v[88:91], v[172:175]
    v_mfma_f32_16x16x32_bf16 v[188:191], v[124:127], v[92:95], v[188:191]
    v_mfma_f32_16x16x32_bf16 v[184:187], v[120:123], v[92:95], v[184:187]
    v_mfma_f32_16x16x32_bf16 v[180:183], v[116:119], v[92:95], v[180:183]
    v_mfma_f32_16x16x32_bf16 v[176:179], v[112:115], v[92:95], v[176:179]
    v_mfma_f32_16x16x32_bf16 v[192:195], v[112:115], v[96:99], v[192:195]
    v_mfma_f32_16x16x32_bf16 v[196:199], v[116:119], v[96:99], v[196:199]
    v_mfma_f32_16x16x32_bf16 v[200:203], v[120:123], v[96:99], v[200:203]
    v_mfma_f32_16x16x32_bf16 v[204:207], v[124:127], v[96:99], v[204:207]
    v_mfma_f32_16x16x32_bf16 v[220:223], v[124:127], v[100:103], v[220:223]
    v_mfma_f32_16x16x32_bf16 v[216:219], v[120:123], v[100:103], v[216:219]
    v_mfma_f32_16x16x32_bf16 v[212:215], v[116:119], v[100:103], v[212:215]
    v_mfma_f32_16x16x32_bf16 v[208:211], v[112:115], v[100:103], v[208:211]
    v_mfma_f32_16x16x32_bf16 v[224:227], v[112:115], v[104:107], v[224:227]
    v_mfma_f32_16x16x32_bf16 v[228:231], v[116:119], v[104:107], v[228:231]
    v_mfma_f32_16x16x32_bf16 v[232:235], v[120:123], v[104:107], v[232:235]
    v_mfma_f32_16x16x32_bf16 v[236:239], v[124:127], v[104:107], v[236:239]
    v_mfma_f32_16x16x32_bf16 v[252:255], v[124:127], v[108:111], v[252:255]
    v_mfma_f32_16x16x32_bf16 v[248:251], v[120:123], v[108:111], v[248:251]
    v_mfma_f32_16x16x32_bf16 v[244:247], v[116:119], v[108:111], v[244:247]
    v_mfma_f32_16x16x32_bf16 v[240:243], v[112:115], v[108:111], v[240:243]
M_loopD:
    s_waitcnt vmcnt(0) lgkmcnt(0)
    s_barrier
    ds_read_b128 v[80:83], v3 offset:0
    ds_read_b64_tr_b16 v[112:113], v6 offset:49152
    ds_read_b64_tr_b16 v[114:115], v6 offset:50176
    ds_read_b64_tr_b16 v[116:117], v7 offset:49152
    ds_read_b64_tr_b16 v[118:119], v7 offset:50176
    ds_read_b64_tr_b16 v[120:121], v6 offset:57344
    ds_read_b64_tr_b16 v[122:123], v6 offset:58368
    ds_read_b64_tr_b16 v[124:125], v7 offset:57344
    ds_read_b64_tr_b16 v[126:127], v7 offset:58368
    ds_read_b128 v[84:87], v3 offset:2048
    ds_read_b128 v[88:91], v3 offset:4096
    ds_read_b128 v[92:95], v3 offset:6144
    ds_read_b128 v[96:99], v3 offset:8192
    ds_read_b128 v[100:103], v3 offset:10240
    ds_read_b128 v[104:107], v3 offset:12288
    ds_read_b128 v[108:111], v3 offset:14336
    s_lshr_b32 s40, s3, 2
    s_lshl_b32 s41, s26, 1
    s_add_u32 s40, s40, s41
    s_mul_i32 s40, s40, 112
    s_lshl_b32 s41, s27, 2
    s_add_u32 s40, s40, s41
    s_and_b32 s41, s3, 3
    s_add_u32 s40, s40, s41
    s_lshl_b32 s40, s40, 13
    v_and_b32 v23, 3, v11
    v_lshlrev_b32 v23, 6, v23
    v_mov_b32 v0, 0xbfb8aa3b
    v_mov_b32 v1, 0xbfb8aa3b
    s_add_u32 s41, s40, 4096
    s_and_b32 s30, s3, 3
    s_lshr_b32 s31, s30, 1
    s_lshl_b32 s31, s31, 15
    s_and_b32 s30, s30, 1
    s_lshl_b32 s30, s30, 13
    s_add_u32 s30, s30, s31
    v_add_u32 v30, s30, v10
    s_lshr_b32 s30, s3, 2
    s_xor_b32 s30, s30, s44
    s_and_b32 s30, s30, 1
    v_mfma_f32_16x16x32_bf16 v[128:131], v[64:67], v[32:35], v[128:131]
    v_mfma_f32_16x16x32_bf16 v[132:135], v[68:71], v[32:35], v[132:135]
    v_mfma_f32_16x16x32_bf16 v[136:139], v[72:75], v[32:35], v[136:139]
    v_mfma_f32_16x16x32_bf16 v[140:143], v[76:79], v[32:35], v[140:143]
    v_mfma_f32_16x16x32_bf16 v[156:159], v[76:79], v[36:39], v[156:159]
    v_mfma_f32_16x16x32_bf16 v[152:155], v[72:75], v[36:39], v[152:155]
    v_mfma_f32_16x16x32_bf16 v[148:151], v[68:71], v[36:39], v[148:151]
    v_mfma_f32_16x16x32_bf16 v[144:147], v[64:67], v[36:39], v[144:147]
    s_waitcnt lgkmcnt(0)
    s_barrier
    v_mfma_f32_16x16x32_bf16 v[128:131], v[112:115], v[80:83], v[128:131]
    v_lshrrev_b32 v27, 4, v11
    v_and_b32 v28, 15, v11
    v_lshlrev_b32 v29, 1, v27
    v_xor_b32 v28, v28, v29
    v_lshlrev_b32 v28, 4, v28
    v_lshl_add_u32 v28, v27, 11, v28
    v_xor_b32 v29, 128, v28
    s_lshl_b32 s32, s3, 11
    s_add_u32 m0, s32, 16384
    s_lshl_b32 s33, s32, 3
    s_add_u32 s33, s33, s51
    buffer_load_dwordx4 v28, s[96:99], s33 offen lds
    s_add_u32 m0, s32, 17408
    s_add_u32 s33, s33, 8192
    buffer_load_dwordx4 v29, s[96:99], s33 offen lds
    s_add_u32 s1, s1, 1
    s_lshl_b32 s50, s1, 14
    s_lshl_b32 s51, s1, 17
    s_add_u32 s50, s50, s48
    s_add_u32 s51, s51, s0
    s_lshl_b32 s32, s3, 11
    s_add_u32 m0, s32, 49152
    s_lshl_b32 s33, s32, 3
    s_add_u32 s33, s33, s51
    buffer_load_dwordx4 v28, s[96:99], s33 offen lds
    s_add_u32 m0, s32, 50176
    s_add_u32 s33, s33, 8192
    buffer_load_dwordx4 v29, s[96:99], s33 offen lds
    s_mov_b32 s1, s5
    s_cmp_eq_u32 s1, 28
    s_cselect_b32 s1, 0, s1
    s_add_u32 s33, s1, 2
    s_cmp_eq_u32 s1, s4
    s_cselect_b32 s1, s33, s1
    s_cmp_eq_u32 s1, 28
    s_cselect_b32 s1, 0, s1
    s_lshl_b32 s50, s1, 14
    s_lshl_b32 s51, s1, 17
    s_add_u32 s50, s50, s48
    s_add_u32 s51, s51, s0
    buffer_load_dword v22, v23, s[92:95], 0 offen sc1
    v_mfma_f32_16x16x32_bf16 v[132:135], v[116:119], v[80:83], v[132:135]
    v_mfma_f32_16x16x32_bf16 v[136:139], v[120:123], v[80:83], v[136:139]
    v_mfma_f32_16x16x32_bf16 v[140:143], v[124:127], v[80:83], v[140:143]
    v_mfma_f32_16x16x32_bf16 v[156:159], v[124:127], v[84:87], v[156:159]
    v_mfma_f32_16x16x32_bf16 v[152:155], v[120:123], v[84:87], v[152:155]
    v_mfma_f32_16x16x32_bf16 v[148:151], v[116:119], v[84:87], v[148:151]
    s_nop 5
    v_pk_mul_f32 v[2:3], v[128:129], v[0:1]
    v_pk_mul_f32 v[4:5], v[130:131], v[0:1]
    v_pk_mul_f32 v[6:7], v[132:133], v[0:1]
    v_pk_mul_f32 v[8:9], v[134:135], v[0:1]
    v_mfma_f32_16x16x32_bf16 v[144:147], v[112:115], v[84:87], v[144:147]
    v_exp_f32 v2, v2
    v_exp_f32 v3, v3
    v_exp_f32 v4, v4
    v_exp_f32 v5, v5
    v_exp_f32 v6, v6
    v_mfma_f32_16x16x32_bf16 v[160:163], v[64:67], v[40:43], v[160:163]
    v_exp_f32 v7, v7
    v_exp_f32 v8, v8
    v_exp_f32 v9, v9
    v_pk_mul_f32 v[136:137], v[128:129], v[136:137]
    v_pk_mul_f32 v[138:139], v[130:131], v[138:139]
    v_mfma_f32_16x16x32_bf16 v[164:167], v[68:71], v[40:43], v[164:167]
    v_pk_mul_f32 v[140:141], v[132:133], v[140:141]
    v_pk_mul_f32 v[142:143], v[134:135], v[142:143]
    v_pk_add_f32 v[2:3], v[2:3], 1.0 op_sel_hi:[1,0]
    v_pk_add_f32 v[4:5], v[4:5], 1.0 op_sel_hi:[1,0]
    v_pk_add_f32 v[6:7], v[6:7], 1.0 op_sel_hi:[1,0]
    v_mfma_f32_16x16x32_bf16 v[168:171], v[72:75], v[40:43], v[168:171]
    v_pk_add_f32 v[8:9], v[8:9], 1.0 op_sel_hi:[1,0]
    v_rcp_f32 v2, v2
    v_rcp_f32 v3, v3
    v_rcp_f32 v4, v4
    v_rcp_f32 v5, v5
    v_mfma_f32_16x16x32_bf16 v[172:175], v[76:79], v[40:43], v[172:175]
    v_rcp_f32 v6, v6
    v_rcp_f32 v7, v7
    v_rcp_f32 v8, v8
    v_rcp_f32 v9, v9
    v_pk_mul_f32 v[136:137], v[2:3], v[136:137]
    v_mfma_f32_16x16x32_bf16 v[160:163], v[112:115], v[88:91], v[160:163]
    v_pk_mul_f32 v[138:139], v[4:5], v[138:139]
    v_pk_mul_f32 v[140:141], v[6:7], v[140:141]
    v_pk_mul_f32 v[142:143], v[8:9], v[142:143]
    v_cvt_pk_bf16_f32 v136, v136, v137
    v_cvt_pk_bf16_f32 v137, v138, v139
    v_mfma_f32_16x16x32_bf16 v[164:167], v[116:119], v[88:91], v[164:167]
    v_cvt_pk_bf16_f32 v138, v140, v141
    v_cvt_pk_bf16_f32 v139, v142, v143
    buffer_store_dwordx4 v[136:139], v10, s[20:23], s40 offen offset:0 sc1
    s_cmp_eq_u32 s30, 0
    s_cbranch_scc0 M_nl0
    ds_write_b128 v30, v[136:139] offset:0
M_nl0:
    v_mfma_f32_16x16x32_bf16 v[168:171], v[120:123], v[88:91], v[168:171]
    v_pk_mul_f32 v[2:3], v[144:145], v[0:1]
    v_pk_mul_f32 v[4:5], v[146:147], v[0:1]
    v_pk_mul_f32 v[6:7], v[148:149], v[0:1]
    v_pk_mul_f32 v[8:9], v[150:151], v[0:1]
    v_exp_f32 v2, v2
    v_mfma_f32_16x16x32_bf16 v[172:175], v[124:127], v[88:91], v[172:175]
    v_exp_f32 v3, v3
    v_exp_f32 v4, v4
    v_exp_f32 v5, v5
    v_exp_f32 v6, v6
    v_exp_f32 v7, v7
    v_mfma_f32_16x16x32_bf16 v[188:191], v[76:79], v[44:47], v[188:191]
    v_exp_f32 v8, v8
    v_exp_f32 v9, v9
    v_pk_mul_f32 v[152:153], v[144:145], v[152:153]
    v_pk_mul_f32 v[154:155], v[146:147], v[154:155]
    v_pk_mul_f32 v[156:157], v[148:149], v[156:157]
    v_mfma_f32_16x16x32_bf16 v[184:187], v[72:75], v[44:47], v[184:187]
    v_pk_mul_f32 v[158:159], v[150:151], v[158:159]
    v_pk_add_f32 v[2:3], v[2:3], 1.0 op_sel_hi:[1,0]
    v_pk_add_f32 v[4:5], v[4:5], 1.0 op_sel_hi:[1,0]
    v_pk_add_f32 v[6:7], v[6:7], 1.0 op_sel_hi:[1,0]
    v_pk_add_f32 v[8:9], v[8:9], 1.0 op_sel_hi:[1,0]
    v_mfma_f32_16x16x32_bf16 v[180:183], v[68:71], v[44:47], v[180:183]
    v_rcp_f32 v2, v2
    v_rcp_f32 v3, v3
    v_rcp_f32 v4, v4
    v_rcp_f32 v5, v5
    v_rcp_f32 v6, v6
    v_mfma_f32_16x16x32_bf16 v[176:179], v[64:67], v[44:47], v[176:179]
    v_rcp_f32 v7, v7
    v_rcp_f32 v8, v8
    v_rcp_f32 v9, v9
    v_pk_mul_f32 v[152:153], v[2:3], v[152:153]
    v_pk_mul_f32 v[154:155], v[4:5], v[154:155]
    v_mfma_f32_16x16x32_bf16 v[188:191], v[124:127], v[92:95], v[188:191]
    v_pk_mul_f32 v[156:157], v[6:7], v[156:157]
    v_pk_mul_f32 v[158:159], v[8:9], v[158:159]
    v_cvt_pk_bf16_f32 v152, v152, v153
    v_cvt_pk_bf16_f32 v153, v154, v155
    v_cvt_pk_bf16_f32 v154, v156, v157
    v_mfma_f32_16x16x32_bf16 v[184:187], v[120:123], v[92:95], v[184:187]
    v_cvt_pk_bf16_f32 v155, v158, v159
    buffer_store_dwordx4 v[152:155], v10, s[20:23], s40 offen offset:1024 sc1
    s_cmp_eq_u32 s30, 0
    s_cbranch_scc0 M_nl1
    ds_write_b128 v30, v[152:155] offset:1024
M_nl1:
    s_waitcnt vmcnt(2)
    v_cmp_le_u32 vcc, 64, v22
    s_cmp_eq_u64 vcc, -1
    s_cbranch_scc0 M_nx
    s_and_b32 s86, s3, 3
    s_lshr_b32 s87, s3, 2
    s_lshl_b32 s85, s2, 1
    s_add_u32 s85, s85, s87
    v_lshrrev_b32 v16, 4, v11
    v_lshlrev_b32 v17, 19, v16
    v_bfe_u32 v18, v11, 3, 1
    v_lshl_add_u32 v18, v18, 17, v17
    v_and_b32 v19, 7, v11
    v_lshl_add_u32 v18, v19, 4, v18
    s_lshl_b32 s58, s85, 8
    s_bfe_u32 s59, s3, 0x10001
    s_lshl_b32 s59, s59, 7
    s_add_u32 s58, s58, s59
    s_and_b32 s59, s3, 1
    s_lshl_b32 s59, s59, 18
    s_add_u32 s58, s58, s59
    s_add_u32 s58, s58, 16777216
    s_lshl_b32 s59, s3, 11
    s_add_u32 m0, s59, 147456
    v_and_b32 v19, 15, v11
    buffer_load_dwordx4 v18, s[20:23], s58 offen lds
    s_add_u32 m0, s59, 148480
    s_add_u32 s58, s58, 2097152
    buffer_load_dwordx4 v18, s[20:23], s58 offen lds
    v_lshl_add_u32 v17, v19, 4, v17
    s_lshl_b32 s84, s85, 8
    s_lshl_b32 s58, s86, 17
    s_add_u32 s84, s84, s58
    s_add_u32 s84, s84, 20971520
    s_add_u32 s58, s84, 2097152
    s_cmp_eq_u32 s85, 0
    s_cbranch_scc0 M_xwa
    s_lshl_b32 s84, s86, 11
    s_add_u32 s84, s84, 25174016
    s_add_u32 s58, s84, 1024
    v_mov_b32 v17, v10
M_xwa:
    buffer_load_dwordx4 v[12:15], v17, s[20:23], s84 offen
    buffer_load_dwordx4 v[16:19], v17, s[20:23], s58 offen
    s_mul_i32 s59, s3, 5120
    s_add_u32 m0, s59, 65536
    s_add_u32 s58, s59, 34668544
    buffer_load_dwordx4 v10, s[20:23], s58 offen lds
    buffer_load_dwordx4 v10, s[20:23], s58 offen offset:1024 lds
    buffer_load_dwordx4 v10, s[20:23], s58 offen offset:2048 lds
    buffer_load_dwordx4 v10, s[20:23], s58 offen offset:3072 lds
    s_add_u32 m0, s59, 69632
    s_add_u32 s58, s58, 4096
    buffer_load_dwordx4 v10, s[20:23], s58 offen lds
    s_and_b32 s59, s3, 1
    s_lshl_b32 s59, s59, 10
    s_add_u32 m0, s59, 106496
    s_add_u32 s58, s59, 34709504
    buffer_load_dwordx4 v10, s[20:23], s58 offen lds
    s_mov_b32 s100, 1
M_nx:
    v_mfma_f32_16x16x32_bf16 v[180:183], v[116:119], v[92:95], v[180:183]
    v_pk_mul_f32 v[2:3], v[160:161], v[0:1]
    v_pk_mul_f32 v[4:5], v[162:163], v[0:1]
    v_pk_mul_f32 v[6:7], v[164:165], v[0:1]
    v_pk_mul_f32 v[8:9], v[166:167], v[0:1]
    v_exp_f32 v2, v2
    v_mfma_f32_16x16x32_bf16 v[176:179], v[112:115], v[92:95], v[176:179]
    v_exp_f32 v3, v3
    v_exp_f32 v4, v4
    v_exp_f32 v5, v5
    v_exp_f32 v6, v6
    v_exp_f32 v7, v7
    v_mfma_f32_16x16x32_bf16 v[192:195], v[64:67], v[48:51], v[192:195]
    v_exp_f32 v8, v8
    v_exp_f32 v9, v9
    v_pk_mul_f32 v[168:169], v[160:161], v[168:169]
    v_pk_mul_f32 v[170:171], v[162:163], v[170:171]
    v_pk_mul_f32 v[172:173], v[164:165], v[172:173]
    v_mfma_f32_16x16x32_bf16 v[196:199], v[68:71], v[48:51], v[196:199]
    v_pk_mul_f32 v[174:175], v[166:167], v[174:175]
    v_pk_add_f32 v[2:3], v[2:3], 1.0 op_sel_hi:[1,0]
    v_pk_add_f32 v[4:5], v[4:5], 1.0 op_sel_hi:[1,0]
    v_pk_add_f32 v[6:7], v[6:7], 1.0 op_sel_hi:[1,0]
    v_pk_add_f32 v[8:9], v[8:9], 1.0 op_sel_hi:[1,0]
    v_mfma_f32_16x16x32_bf16 v[200:203], v[72:75], v[48:51], v[200:203]
    v_rcp_f32 v2, v2
    v_rcp_f32 v3, v3
    v_rcp_f32 v4, v4
    v_rcp_f32 v5, v5
    v_rcp_f32 v6, v6
    v_mfma_f32_16x16x32_bf16 v[204:207], v[76:79], v[48:51], v[204:207]
    v_rcp_f32 v7, v7
    v_rcp_f32 v8, v8
    v_rcp_f32 v9, v9
    v_pk_mul_f32 v[168:169], v[2:3], v[168:169]
    v_pk_mul_f32 v[170:171], v[4:5], v[170:171]
    v_mfma_f32_16x16x32_bf16 v[192:195], v[112:115], v[96:99], v[192:195]
    v_pk_mul_f32 v[172:173], v[6:7], v[172:173]
    v_pk_mul_f32 v[174:175], v[8:9], v[174:175]
    v_cvt_pk_bf16_f32 v168, v168, v169
    v_cvt_pk_bf16_f32 v169, v170, v171
    v_cvt_pk_bf16_f32 v170, v172, v173
    v_mfma_f32_16x16x32_bf16 v[196:199], v[116:119], v[96:99], v[196:199]
    v_cvt_pk_bf16_f32 v171, v174, v175
    buffer_store_dwordx4 v[168:171], v10, s[20:23], s40 offen offset:2048 sc1
    s_cmp_eq_u32 s30, 0
    s_cbranch_scc0 M_nl2
    ds_write_b128 v30, v[168:171] offset:2048
M_nl2:
    v_pk_mul_f32 v[2:3], v[176:177], v[0:1]
    v_mfma_f32_16x16x32_bf16 v[200:203], v[120:123], v[96:99], v[200:203]
    v_pk_mul_f32 v[4:5], v[178:179], v[0:1]
    v_pk_mul_f32 v[6:7], v[180:181], v[0:1]
    v_pk_mul_f32 v[8:9], v[182:183], v[0:1]
    v_exp_f32 v2, v2
    v_exp_f32 v3, v3
    v_mfma_f32_16x16x32_bf16 v[204:207], v[124:127], v[96:99], v[204:207]
    v_exp_f32 v4, v4
    v_exp_f32 v5, v5
    v_exp_f32 v6, v6
    v_exp_f32 v7, v7
    v_exp_f32 v8, v8
    v_mfma_f32_16x16x32_bf16 v[220:223], v[76:79], v[52:55], v[220:223]
    v_exp_f32 v9, v9
    v_pk_mul_f32 v[184:185], v[176:177], v[184:185]
    v_pk_mul_f32 v[186:187], v[178:179], v[186:187]
    v_pk_mul_f32 v[188:189], v[180:181], v[188:189]
    v_pk_mul_f32 v[190:191], v[182:183], v[190:191]
    v_mfma_f32_16x16x32_bf16 v[216:219], v[72:75], v[52:55], v[216:219]
    v_pk_add_f32 v[2:3], v[2:3], 1.0 op_sel_hi:[1,0]
    v_pk_add_f32 v[4:5], v[4:5], 1.0 op_sel_hi:[1,0]
    v_pk_add_f32 v[6:7], v[6:7], 1.0 op_sel_hi:[1,0]
    v_pk_add_f32 v[8:9], v[8:9], 1.0 op_sel_hi:[1,0]
    v_rcp_f32 v2, v2
    v_mfma_f32_16x16x32_bf16 v[212:215], v[68:71], v[52:55], v[212:215]
    v_rcp_f32 v3, v3
    v_rcp_f32 v4, v4
    v_rcp_f32 v5, v5
    v_rcp_f32 v6, v6
    v_rcp_f32 v7, v7
    v_mfma_f32_16x16x32_bf16 v[208:211], v[64:67], v[52:55], v[208:211]
    v_rcp_f32 v8, v8
    v_rcp_f32 v9, v9
    v_pk_mul_f32 v[184:185], v[2:3], v[184:185]
    v_pk_mul_f32 v[186:187], v[4:5], v[186:187]
    v_pk_mul_f32 v[188:189], v[6:7], v[188:189]
    v_mfma_f32_16x16x32_bf16 v[220:223], v[124:127], v[100:103], v[220:223]
    v_pk_mul_f32 v[190:191], v[8:9], v[190:191]
    v_cvt_pk_bf16_f32 v184, v184, v185
    v_cvt_pk_bf16_f32 v185, v186, v187
    v_cvt_pk_bf16_f32 v186, v188, v189
    v_cvt_pk_bf16_f32 v187, v190, v191
    v_mfma_f32_16x16x32_bf16 v[216:219], v[120:123], v[100:103], v[216:219]
    buffer_store_dwordx4 v[184:187], v10, s[20:23], s40 offen offset:3072 sc1
    s_cmp_eq_u32 s30, 0
    s_cbranch_scc0 M_nl3
    ds_write_b128 v30, v[184:187] offset:3072
M_nl3:
    v_pk_mul_f32 v[2:3], v[192:193], v[0:1]
    v_pk_mul_f32 v[4:5], v[194:195], v[0:1]
    v_mfma_f32_16x16x32_bf16 v[212:215], v[116:119], v[100:103], v[212:215]
    v_pk_mul_f32 v[6:7], v[196:197], v[0:1]
    v_pk_mul_f32 v[8:9], v[198:199], v[0:1]
    v_exp_f32 v2, v2
    v_exp_f32 v3, v3
    v_exp_f32 v4, v4
    v_mfma_f32_16x16x32_bf16 v[208:211], v[112:115], v[100:103], v[208:211]
    v_exp_f32 v5, v5
    v_exp_f32 v6, v6
    v_exp_f32 v7, v7
    v_exp_f32 v8, v8
    v_exp_f32 v9, v9
    v_mfma_f32_16x16x32_bf16 v[224:227], v[64:67], v[56:59], v[224:227]
    v_pk_mul_f32 v[200:201], v[192:193], v[200:201]
    v_pk_mul_f32 v[202:203], v[194:195], v[202:203]
    v_pk_mul_f32 v[204:205], v[196:197], v[204:205]
    v_pk_mul_f32 v[206:207], v[198:199], v[206:207]
    v_pk_add_f32 v[2:3], v[2:3], 1.0 op_sel_hi:[1,0]
    v_mfma_f32_16x16x32_bf16 v[228:231], v[68:71], v[56:59], v[228:231]
    v_pk_add_f32 v[4:5], v[4:5], 1.0 op_sel_hi:[1,0]
    v_pk_add_f32 v[6:7], v[6:7], 1.0 op_sel_hi:[1,0]
    v_pk_add_f32 v[8:9], v[8:9], 1.0 op_sel_hi:[1,0]
    v_rcp_f32 v2, v2
    v_rcp_f32 v3, v3
    v_mfma_f32_16x16x32_bf16 v[232:235], v[72:75], v[56:59], v[232:235]
    v_rcp_f32 v4, v4
    v_rcp_f32 v5, v5
    v_rcp_f32 v6, v6
    v_rcp_f32 v7, v7
    v_rcp_f32 v8, v8
    v_mfma_f32_16x16x32_bf16 v[236:239], v[76:79], v[56:59], v[236:239]
    v_rcp_f32 v9, v9
    v_pk_mul_f32 v[200:201], v[2:3], v[200:201]
    v_pk_mul_f32 v[202:203], v[4:5], v[202:203]
    v_pk_mul_f32 v[204:205], v[6:7], v[204:205]
    v_pk_mul_f32 v[206:207], v[8:9], v[206:207]
    v_mfma_f32_16x16x32_bf16 v[224:227], v[112:115], v[104:107], v[224:227]
    v_cvt_pk_bf16_f32 v200, v200, v201
    v_cvt_pk_bf16_f32 v201, v202, v203
    v_cvt_pk_bf16_f32 v202, v204, v205
    v_cvt_pk_bf16_f32 v203, v206, v207
    buffer_store_dwordx4 v[200:203], v10, s[20:23], s41 offen offset:0 sc1
    v_mfma_f32_16x16x32_bf16 v[228:231], v[116:119], v[104:107], v[228:231]
    s_cmp_eq_u32 s30, 0
    s_cbranch_scc0 M_nl4
    ds_write_b128 v30, v[200:203] offset:4096
M_nl4:
    v_pk_mul_f32 v[2:3], v[208:209], v[0:1]
    v_pk_mul_f32 v[4:5], v[210:211], v[0:1]
    v_pk_mul_f32 v[6:7], v[212:213], v[0:1]
    v_mfma_f32_16x16x32_bf16 v[232:235], v[120:123], v[104:107], v[232:235]
    v_pk_mul_f32 v[8:9], v[214:215], v[0:1]
    v_exp_f32 v2, v2
    v_exp_f32 v3, v3
    v_exp_f32 v4, v4
    v_exp_f32 v5, v5
    v_mfma_f32_16x16x32_bf16 v[236:239], v[124:127], v[104:107], v[236:239]
    v_exp_f32 v6, v6
    v_exp_f32 v7, v7
    v_exp_f32 v8, v8
    v_exp_f32 v9, v9
    v_pk_mul_f32 v[216:217], v[208:209], v[216:217]
    v_mfma_f32_16x16x32_bf16 v[252:255], v[76:79], v[60:63], v[252:255]
    v_pk_mul_f32 v[218:219], v[210:211], v[218:219]
    v_pk_mul_f32 v[220:221], v[212:213], v[220:221]
    v_pk_mul_f32 v[222:223], v[214:215], v[222:223]
    v_pk_add_f32 v[2:3], v[2:3], 1.0 op_sel_hi:[1,0]
    v_pk_add_f32 v[4:5], v[4:5], 1.0 op_sel_hi:[1,0]
    v_mfma_f32_16x16x32_bf16 v[248:251], v[72:75], v[60:63], v[248:251]
    v_pk_add_f32 v[6:7], v[6:7], 1.0 op_sel_hi:[1,0]
    v_pk_add_f32 v[8:9], v[8:9], 1.0 op_sel_hi:[1,0]
    v_rcp_f32 v2, v2
    v_rcp_f32 v3, v3
    v_rcp_f32 v4, v4
    v_mfma_f32_16x16x32_bf16 v[244:247], v[68:71], v[60:63], v[244:247]
    v_rcp_f32 v5, v5
    v_rcp_f32 v6, v6
    v_rcp_f32 v7, v7
    v_rcp_f32 v8, v8
    v_rcp_f32 v9, v9
    v_mfma_f32_16x16x32_bf16 v[240:243], v[64:67], v[60:63], v[240:243]
    v_pk_mul_f32 v[216:217], v[2:3], v[216:217]
    v_pk_mul_f32 v[218:219], v[4:5], v[218:219]
    v_pk_mul_f32 v[220:221], v[6:7], v[220:221]
    v_pk_mul_f32 v[222:223], v[8:9], v[222:223]
    v_cvt_pk_bf16_f32 v216, v216, v217
    v_mfma_f32_16x16x32_bf16 v[252:255], v[124:127], v[108:111], v[252:255]
    v_cvt_pk_bf16_f32 v217, v218, v219
    v_cvt_pk_bf16_f32 v218, v220, v221
    v_cvt_pk_bf16_f32 v219, v222, v223
    buffer_store_dwordx4 v[216:219], v10, s[20:23], s41 offen offset:1024 sc1
    s_cmp_eq_u32 s30, 0
    s_cbranch_scc0 M_nl5
    ds_write_b128 v30, v[216:219] offset:5120
M_nl5:
    v_mfma_f32_16x16x32_bf16 v[248:251], v[120:123], v[108:111], v[248:251]
    v_pk_mul_f32 v[2:3], v[224:225], v[0:1]
    v_pk_mul_f32 v[4:5], v[226:227], v[0:1]
    v_pk_mul_f32 v[6:7], v[228:229], v[0:1]
    v_pk_mul_f32 v[8:9], v[230:231], v[0:1]
    v_mfma_f32_16x16x32_bf16 v[244:247], v[116:119], v[108:111], v[244:247]
    v_exp_f32 v2, v2
    v_exp_f32 v3, v3
    v_exp_f32 v4, v4
    v_exp_f32 v5, v5
    v_exp_f32 v6, v6
    v_mfma_f32_16x16x32_bf16 v[240:243], v[112:115], v[108:111], v[240:243]
    v_exp_f32 v7, v7
    v_exp_f32 v8, v8
    v_exp_f32 v9, v9
    v_pk_mul_f32 v[232:233], v[224:225], v[232:233]
    v_pk_mul_f32 v[234:235], v[226:227], v[234:235]
    v_pk_mul_f32 v[236:237], v[228:229], v[236:237]
    v_pk_mul_f32 v[238:239], v[230:231], v[238:239]
    v_pk_add_f32 v[2:3], v[2:3], 1.0 op_sel_hi:[1,0]
    v_pk_add_f32 v[4:5], v[4:5], 1.0 op_sel_hi:[1,0]
    v_pk_add_f32 v[6:7], v[6:7], 1.0 op_sel_hi:[1,0]
    v_pk_add_f32 v[8:9], v[8:9], 1.0 op_sel_hi:[1,0]
    v_rcp_f32 v2, v2
    v_rcp_f32 v3, v3
    v_rcp_f32 v4, v4
    v_rcp_f32 v5, v5
    v_rcp_f32 v6, v6
    v_rcp_f32 v7, v7
    v_rcp_f32 v8, v8
    v_rcp_f32 v9, v9
    v_pk_mul_f32 v[232:233], v[2:3], v[232:233]
    v_pk_mul_f32 v[234:235], v[4:5], v[234:235]
    v_pk_mul_f32 v[236:237], v[6:7], v[236:237]
    v_pk_mul_f32 v[238:239], v[8:9], v[238:239]
    v_cvt_pk_bf16_f32 v232, v232, v233
    v_cvt_pk_bf16_f32 v233, v234, v235
    v_cvt_pk_bf16_f32 v234, v236, v237
    v_cvt_pk_bf16_f32 v235, v238, v239
    buffer_store_dwordx4 v[232:235], v10, s[20:23], s41 offen offset:2048 sc1
    s_cmp_eq_u32 s30, 0
    s_cbranch_scc0 M_nl6
    ds_write_b128 v30, v[232:235] offset:6144
M_nl6:
    v_pk_mul_f32 v[2:3], v[240:241], v[0:1]
    v_pk_mul_f32 v[4:5], v[242:243], v[0:1]
    v_pk_mul_f32 v[6:7], v[244:245], v[0:1]
    v_pk_mul_f32 v[8:9], v[246:247], v[0:1]
    v_exp_f32 v2, v2
    v_exp_f32 v3, v3
    v_exp_f32 v4, v4
    v_exp_f32 v5, v5
    v_exp_f32 v6, v6
    v_exp_f32 v7, v7
    v_exp_f32 v8, v8
    v_exp_f32 v9, v9
    v_pk_mul_f32 v[248:249], v[240:241], v[248:249]
    v_pk_mul_f32 v[250:251], v[242:243], v[250:251]
    v_pk_mul_f32 v[252:253], v[244:245], v[252:253]
    v_pk_mul_f32 v[254:255], v[246:247], v[254:255]
    v_pk_add_f32 v[2:3], v[2:3], 1.0 op_sel_hi:[1,0]
    v_pk_add_f32 v[4:5], v[4:5], 1.0 op_sel_hi:[1,0]
    v_pk_add_f32 v[6:7], v[6:7], 1.0 op_sel_hi:[1,0]
    v_pk_add_f32 v[8:9], v[8:9], 1.0 op_sel_hi:[1,0]
    v_rcp_f32 v2, v2
    v_rcp_f32 v3, v3
    v_rcp_f32 v4, v4
    v_rcp_f32 v5, v5
    v_rcp_f32 v6, v6
    v_rcp_f32 v7, v7
    v_rcp_f32 v8, v8
    v_rcp_f32 v9, v9
    v_pk_mul_f32 v[248:249], v[2:3], v[248:249]
    v_pk_mul_f32 v[250:251], v[4:5], v[250:251]
    v_pk_mul_f32 v[252:253], v[6:7], v[252:253]
    v_pk_mul_f32 v[254:255], v[8:9], v[254:255]
    v_cvt_pk_bf16_f32 v248, v248, v249
    v_cvt_pk_bf16_f32 v249, v250, v251
    v_cvt_pk_bf16_f32 v250, v252, v253
    v_cvt_pk_bf16_f32 v251, v254, v255
    buffer_store_dwordx4 v[248:251], v10, s[20:23], s41 offen offset:3072 sc1
    s_cmp_eq_u32 s30, 0
    s_cbranch_scc0 M_nl7
    ds_write_b128 v30, v[248:251] offset:7168
M_nl7:
    s_branch M_tr1
M_tr:
    v_lshrrev_b32 v27, 4, v11
    v_and_b32 v28, 15, v11
    v_lshlrev_b32 v29, 1, v27
    v_xor_b32 v28, v28, v29
    v_lshlrev_b32 v28, 4, v28
    v_lshl_add_u32 v28, v27, 11, v28
    v_xor_b32 v29, 128, v28

M_tr1:
    s_mov_b32 s36, s101
    s_mov_b32 s41, s40
    v_lshlrev_b32 v31, 7, v11
    s_mov_b32 s37, 0
    s_cmp_eq_u32 s100, 1
    s_cbranch_scc1 M_havex
    s_cmp_eq_u32 s100, 0
    s_cbranch_scc1 M_slow
    s_waitcnt vmcnt(8)
    s_branch M_havex
M_slow:

    s_mov_b32 s90, 0
M_wa:
    buffer_load_dword v22, v23, s[92:95], 0 offen sc1
    s_add_u32 s90, s90, 1
    s_waitcnt vmcnt(0)
    v_cmp_le_u32 vcc, 64, v22
    s_cmp_eq_u64 vcc, -1
    s_cbranch_scc1 M_wa_ok
    s_sleep 6
    s_cmp_lt_u32 s90, 0x10000
    s_cbranch_scc1 M_wa
M_wa_ok:

    s_and_b32 s86, s3, 3
    s_lshr_b32 s87, s3, 2
    s_lshl_b32 s85, s2, 1
    s_add_u32 s85, s85, s87
    v_lshrrev_b32 v16, 4, v11
    v_lshlrev_b32 v17, 19, v16
    v_bfe_u32 v18, v11, 3, 1
    v_lshl_add_u32 v18, v18, 17, v17
    v_and_b32 v19, 7, v11
    v_lshl_add_u32 v18, v19, 4, v18
    s_lshl_b32 s58, s85, 8
    s_bfe_u32 s59, s3, 0x10001
    s_lshl_b32 s59, s59, 7
    s_add_u32 s58, s58, s59
    s_and_b32 s59, s3, 1
    s_lshl_b32 s59, s59, 18
    s_add_u32 s58, s58, s59
    s_add_u32 s58, s58, 16777216
    s_lshl_b32 s59, s3, 11
    s_add_u32 m0, s59, 147456
    v_and_b32 v19, 15, v11
    buffer_load_dwordx4 v18, s[20:23], s58 offen lds
    s_add_u32 m0, s59, 148480
    s_add_u32 s58, s58, 2097152
    buffer_load_dwordx4 v18, s[20:23], s58 offen lds
    v_lshl_add_u32 v17, v19, 4, v17
    s_lshl_b32 s84, s85, 8
    s_lshl_b32 s58, s86, 17
    s_add_u32 s84, s84, s58
    s_add_u32 s84, s84, 20971520
    s_add_u32 s58, s84, 2097152
    s_cmp_eq_u32 s85, 0
    s_cbranch_scc0 M_xwb
    s_lshl_b32 s84, s86, 11
    s_add_u32 s84, s84, 25174016
    s_add_u32 s58, s84, 1024
    v_mov_b32 v17, v10
M_xwb:
    buffer_load_dwordx4 v[12:15], v17, s[20:23], s84 offen
    buffer_load_dwordx4 v[16:19], v17, s[20:23], s58 offen
    s_mul_i32 s59, s3, 5120
    s_add_u32 m0, s59, 65536
    s_add_u32 s58, s59, 34668544
    buffer_load_dwordx4 v10, s[20:23], s58 offen lds
    buffer_load_dwordx4 v10, s[20:23], s58 offen offset:1024 lds
    buffer_load_dwordx4 v10, s[20:23], s58 offen offset:2048 lds
    buffer_load_dwordx4 v10, s[20:23], s58 offen offset:3072 lds
    s_add_u32 m0, s59, 69632
    s_add_u32 s58, s58, 4096
    buffer_load_dwordx4 v10, s[20:23], s58 offen lds
    s_and_b32 s59, s3, 1
    s_lshl_b32 s59, s59, 10
    s_add_u32 m0, s59, 106496
    s_add_u32 s58, s59, 34709504
    buffer_load_dwordx4 v10, s[20:23], s58 offen lds
    s_mov_b32 s100, 1
    s_waitcnt vmcnt(0)
M_havex:
    s_waitcnt vmcnt(6)
    s_lshl_b32 s58, s87, 13
    v_add_u32 v2, s58, v10
    v_add_u32 v9, 147456, v2
    v_add_u32 v2, 147456, v2
    s_mul_i32 s58, s86, 10240
    s_add_u32 s58, s58, 67584
    v_add_u32 v7, s58, v10
    v_add_u32 v8, 65536, v10
    s_barrier

    ds_read_b128 v[32:35], v7
    ds_read_b128 v[40:43], v7 offset:1024
    ds_read_b128 v[128:131], v2 offset:0
    ds_read_b128 v[132:135], v2 offset:1024
    ds_read_b128 v[136:139], v2 offset:2048
    ds_read_b128 v[140:143], v2 offset:3072
    ds_read_b128 v[144:147], v2 offset:4096
    ds_read_b128 v[148:151], v2 offset:5120
    ds_read_b128 v[152:155], v2 offset:6144
    ds_read_b128 v[156:159], v2 offset:7168
    ds_read_b128 v[80:83], v7 offset:2048
    ds_read_b128 v[84:87], v7 offset:3072
    ds_read_b128 v[88:91], v7 offset:4096
    ds_read_b128 v[92:95], v7 offset:5120
    v_and_b32 v6, 1, v11
    v_sub_u32 v6, 0, v6
    v_and_b32 v6, 0x80008000, v6
    s_waitcnt lgkmcnt(12)

    v_xor_b32 v48, 0x80008000, v40
    v_xor_b32 v36, v6, v32
    v_xor_b32 v44, v6, v40
    v_xor_b32 v52, v6, v48
    v_xor_b32 v49, 0x80008000, v41
    v_xor_b32 v37, v6, v33
    v_xor_b32 v45, v6, v41
    v_xor_b32 v53, v6, v49
    v_xor_b32 v50, 0x80008000, v42
    v_xor_b32 v38, v6, v34
    v_xor_b32 v46, v6, v42
    v_xor_b32 v54, v6, v50
    v_xor_b32 v51, 0x80008000, v43
    v_xor_b32 v39, v6, v35
    v_xor_b32 v47, v6, v43
    v_xor_b32 v55, v6, v51
    s_lshr_b32 s58, s86, 1
    s_lshl_b32 s58, s58, 10
    s_and_b32 s59, s86, 1
    s_lshl_b32 s59, s59, 3
    s_add_u32 s58, s58, s59
    v_add_u32 v3, s58, v9
    v_and_b32 v4, 15, v11
    v_lshrrev_b32 v5, 4, v11
    v_lshl_add_u32 v6, v4, 2, v5
    v_lshlrev_b32 v6, 6, v6
    v_bfe_u32 v4, v11, 1, 2
    s_lshl_b32 s58, s87, 1
    v_xor_b32 v4, s58, v4
    v_lshl_add_u32 v4, v4, 4, v6
    s_lshl_b32 s58, s86, 12
    s_add_u32 s58, s58, 131072
    v_add_u32 v4, s58, v4
    v_xor_b32 v1, 16, v4
    s_waitcnt lgkmcnt(4)
    ds_read_b128 v[56:59], v8
    ds_read_b128 v[64:67], v8 offset:1024

    ds_read_b128 v[96:99], v7 offset:6144
    ds_read_b128 v[100:103], v7 offset:7168
    ds_read_b128 v[104:107], v7 offset:8192
    ds_read_b128 v[108:111], v7 offset:9216
    v_mfma_f32_16x16x32_bf16 v[160:163], v[128:131], v[32:35], 0
    v_mfma_f32_16x16x32_bf16 v[164:167], v[128:131], v[40:43], 0
    v_mfma_f32_16x16x32_bf16 v[168:171], v[136:139], v[32:35], 0
    v_mfma_f32_16x16x32_bf16 v[172:175], v[136:139], v[40:43], 0
    v_mfma_f32_16x16x32_bf16 v[160:163], v[144:147], v[48:51], v[160:163]
    v_mfma_f32_16x16x32_bf16 v[164:167], v[144:147], v[32:35], v[164:167]
    v_mfma_f32_16x16x32_bf16 v[168:171], v[152:155], v[48:51], v[168:171]
    v_mfma_f32_16x16x32_bf16 v[172:175], v[152:155], v[32:35], v[172:175]
    v_mfma_f32_16x16x32_bf16 v[160:163], v[132:135], v[36:39], v[160:163]
    v_mfma_f32_16x16x32_bf16 v[164:167], v[132:135], v[44:47], v[164:167]
    v_mfma_f32_16x16x32_bf16 v[168:171], v[140:143], v[36:39], v[168:171]
    v_mfma_f32_16x16x32_bf16 v[172:175], v[140:143], v[44:47], v[172:175]
    v_mfma_f32_16x16x32_bf16 v[160:163], v[148:151], v[52:55], v[160:163]
    v_mfma_f32_16x16x32_bf16 v[164:167], v[148:151], v[36:39], v[164:167]
    v_mfma_f32_16x16x32_bf16 v[168:171], v[156:159], v[52:55], v[168:171]
    v_mfma_f32_16x16x32_bf16 v[172:175], v[156:159], v[36:39], v[172:175]
    s_waitcnt lgkmcnt(0)

    s_cmp_eq_u32 s36, 1
    s_cbranch_scc1 P2_nh_1

    s_getreg_b32 s58, hwreg(HW_REG_IB_STS)
    s_and_b32 s58, s58, 0xc0000f
    s_cmp_gt_u32 s58, s37
    s_cbranch_scc1 P2_nh_1

    s_waitcnt vmcnt(0)
    s_mov_b64 exec, 1
    buffer_store_dword v24, v21, s[20:23], 0 offen sc1
    s_mov_b64 exec, -1
    s_mov_b32 s36, 1

P2_nh_1:
    s_barrier

    v_xor_b32 v72, 0x80008000, v64
    v_xor_b32 v60, 0x80000000, v56
    v_xor_b32 v68, 0x80000000, v64
    v_xor_b32 v76, 0x80000000, v72
    v_xor_b32 v73, 0x80008000, v65
    v_xor_b32 v61, 0x80000000, v57
    v_xor_b32 v69, 0x80000000, v65
    v_xor_b32 v77, 0x80000000, v73
    v_xor_b32 v74, 0x80008000, v66
    v_xor_b32 v62, 0x80000000, v58
    v_xor_b32 v70, 0x80000000, v66
    v_xor_b32 v78, 0x80000000, v74
    v_xor_b32 v75, 0x80008000, v67
    v_xor_b32 v63, 0x80000000, v59
    v_xor_b32 v71, 0x80000000, v67
    v_xor_b32 v79, 0x80000000, v75
    s_cmp_eq_u32 s36, 1
    s_cbranch_scc1 P2_nh_2

    s_getreg_b32 s58, hwreg(HW_REG_IB_STS)
    s_and_b32 s58, s58, 0xc0000f
    s_cmp_gt_u32 s58, s37
    s_cbranch_scc1 P2_nh_2

    s_waitcnt vmcnt(1)
    s_cmp_eq_u32 s37, 1
    s_cbranch_scc1 P2_nh_2_w
    s_waitcnt vmcnt(0)
P2_nh_2_w:

    s_mov_b64 exec, 1
    buffer_store_dword v24, v21, s[20:23], 0 offen sc1
    s_mov_b64 exec, -1
    s_mov_b32 s36, 1

P2_nh_2:
    s_cmp_lt_u32 s3, 4
    s_cbranch_scc1 P2_q1
    buffer_load_dword v27, v25, s[20:23], s49 offen sc1
    s_mov_b32 s37, 1
    s_xor_b32 s40, s36, 1
    s_lshl_b32 s40, s40, 0
P2_q1:

    s_nop 5
    v_pk_mul_f32 v[240:241], v[160:161], v[80:81]
    v_pk_mul_f32 v[160:161], v[160:161], v[82:83]
    v_pk_fma_f32 v[240:241], v[164:165], v[82:83], v[240:241] neg_lo:[1,0,0] neg_hi:[1,0,0]
    v_pk_fma_f32 v[160:161], v[164:165], v[80:81], v[160:161]
    v_cvt_pk_bf16_f32 v176, v240, v241
    v_cvt_pk_bf16_f32 v180, v160, v161
    v_pk_mul_f32 v[242:243], v[162:163], v[84:85]
    v_pk_mul_f32 v[162:163], v[162:163], v[86:87]
    v_pk_fma_f32 v[242:243], v[166:167], v[86:87], v[242:243] neg_lo:[1,0,0] neg_hi:[1,0,0]
    v_pk_fma_f32 v[162:163], v[166:167], v[84:85], v[162:163]
    v_cvt_pk_bf16_f32 v177, v242, v243
    v_cvt_pk_bf16_f32 v181, v162, v163
    v_pk_mul_f32 v[240:241], v[168:169], v[88:89]
    v_pk_mul_f32 v[168:169], v[168:169], v[90:91]
    v_pk_fma_f32 v[240:241], v[172:173], v[90:91], v[240:241] neg_lo:[1,0,0] neg_hi:[1,0,0]
    v_pk_fma_f32 v[168:169], v[172:173], v[88:89], v[168:169]
    v_cvt_pk_bf16_f32 v178, v240, v241
    v_cvt_pk_bf16_f32 v182, v168, v169
    v_pk_mul_f32 v[242:243], v[170:171], v[92:93]
    v_pk_mul_f32 v[170:171], v[170:171], v[94:95]
    v_pk_fma_f32 v[242:243], v[174:175], v[94:95], v[242:243] neg_lo:[1,0,0] neg_hi:[1,0,0]
    v_pk_fma_f32 v[170:171], v[174:175], v[92:93], v[170:171]
    v_cvt_pk_bf16_f32 v179, v242, v243
    v_cvt_pk_bf16_f32 v183, v170, v171
    s_nop 1
    v_mfma_f32_16x16x32_bf16 v[160:163], v[56:59], v[176:179], 0
    v_mfma_f32_16x16x32_bf16 v[164:167], v[64:67], v[176:179], 0
    v_mfma_f32_16x16x32_bf16 v[168:171], v[60:63], v[176:179], 0
    v_mfma_f32_16x16x32_bf16 v[172:175], v[68:71], v[176:179], 0
    v_mfma_f32_16x16x32_bf16 v[160:163], v[72:75], v[180:183], v[160:163]
    v_mfma_f32_16x16x32_bf16 v[164:167], v[56:59], v[180:183], v[164:167]
    v_mfma_f32_16x16x32_bf16 v[168:171], v[76:79], v[180:183], v[168:171]
    v_mfma_f32_16x16x32_bf16 v[172:175], v[60:63], v[180:183], v[172:175]
    s_cmp_eq_u32 s36, 1
    s_cbranch_scc1 P2_nh_3

    s_getreg_b32 s58, hwreg(HW_REG_IB_STS)
    s_and_b32 s58, s58, 0xc0000f
    s_cmp_gt_u32 s58, s37
    s_cbranch_scc1 P2_nh_3

    s_waitcnt vmcnt(1)
    s_cmp_eq_u32 s37, 1
    s_cbranch_scc1 P2_nh_3_w
    s_waitcnt vmcnt(0)
P2_nh_3_w:

    s_mov_b64 exec, 1
    buffer_store_dword v24, v21, s[20:23], 0 offen sc1
    s_mov_b64 exec, -1
    s_mov_b32 s36, 1

P2_nh_3:
    s_cmp_eq_u32 s2, 0
    s_cbranch_scc1 P2_packed
    s_nop 3
P2_wmul:
    v_lshlrev_b32 v244, 16, v12
    v_lshlrev_b32 v245, 16, v13
    v_and_b32 v246, 0xffff0000, v12
    v_and_b32 v247, 0xffff0000, v13

    v_pk_mul_f32 v[240:241], v[160:161], v[244:245]
    v_pk_mul_f32 v[160:161], v[160:161], v[246:247]
    v_pk_fma_f32 v[240:241], v[164:165], v[246:247], v[240:241] neg_lo:[1,0,0] neg_hi:[1,0,0]
    v_pk_fma_f32 v[160:161], v[164:165], v[244:245], v[160:161]
    v_cvt_pk_bf16_f32 v176, v240, v241
    v_cvt_pk_bf16_f32 v180, v160, v161
    v_lshlrev_b32 v248, 16, v14
    v_lshlrev_b32 v249, 16, v15
    v_and_b32 v250, 0xffff0000, v14
    v_and_b32 v251, 0xffff0000, v15

    v_pk_mul_f32 v[242:243], v[162:163], v[248:249]
    v_pk_mul_f32 v[162:163], v[162:163], v[250:251]
    v_pk_fma_f32 v[242:243], v[166:167], v[250:251], v[242:243] neg_lo:[1,0,0] neg_hi:[1,0,0]
    v_pk_fma_f32 v[162:163], v[166:167], v[248:249], v[162:163]
    v_cvt_pk_bf16_f32 v177, v242, v243
    v_cvt_pk_bf16_f32 v181, v162, v163
    v_lshlrev_b32 v244, 16, v16
    v_lshlrev_b32 v245, 16, v17
    v_and_b32 v246, 0xffff0000, v16
    v_and_b32 v247, 0xffff0000, v17

    v_pk_mul_f32 v[240:241], v[168:169], v[244:245]
    v_pk_mul_f32 v[168:169], v[168:169], v[246:247]
    v_pk_fma_f32 v[240:241], v[172:173], v[246:247], v[240:241] neg_lo:[1,0,0] neg_hi:[1,0,0]
    v_pk_fma_f32 v[168:169], v[172:173], v[244:245], v[168:169]
    v_cvt_pk_bf16_f32 v178, v240, v241
    v_cvt_pk_bf16_f32 v182, v168, v169
    v_lshlrev_b32 v248, 16, v18
    v_lshlrev_b32 v249, 16, v19
    v_and_b32 v250, 0xffff0000, v18
    v_and_b32 v251, 0xffff0000, v19

    v_pk_mul_f32 v[242:243], v[170:171], v[248:249]
    v_pk_mul_f32 v[170:171], v[170:171], v[250:251]
    v_pk_fma_f32 v[242:243], v[174:175], v[250:251], v[242:243] neg_lo:[1,0,0] neg_hi:[1,0,0]
    v_pk_fma_f32 v[170:171], v[174:175], v[248:249], v[170:171]
    v_cvt_pk_bf16_f32 v179, v242, v243
    v_cvt_pk_bf16_f32 v183, v170, v171
P2_wdone:
    s_nop 1
    v_mfma_f32_16x16x32_bf16 v[160:163], v[176:179], v[56:59], 0
    v_mfma_f32_16x16x32_bf16 v[164:167], v[180:183], v[56:59], 0
    v_mfma_f32_16x16x32_bf16 v[168:171], v[176:179], v[60:63], 0
    v_mfma_f32_16x16x32_bf16 v[172:175], v[180:183], v[60:63], 0
    v_mfma_f32_16x16x32_bf16 v[160:163], v[180:183], v[64:67], v[160:163]
    v_mfma_f32_16x16x32_bf16 v[164:167], v[176:179], v[72:75], v[164:167]
    v_mfma_f32_16x16x32_bf16 v[168:171], v[180:183], v[68:71], v[168:171]
    v_mfma_f32_16x16x32_bf16 v[172:175], v[176:179], v[76:79], v[172:175]
    s_cmp_eq_u32 s36, 1
    s_cbranch_scc1 P2_nh_4

    s_getreg_b32 s58, hwreg(HW_REG_IB_STS)
    s_and_b32 s58, s58, 0xc0000f
    s_cmp_gt_u32 s58, s37
    s_cbranch_scc1 P2_nh_4

    s_waitcnt vmcnt(1)
    s_cmp_eq_u32 s37, 1
    s_cbranch_scc1 P2_nh_4_w
    s_waitcnt vmcnt(0)
P2_nh_4_w:

    s_mov_b64 exec, 1
    buffer_store_dword v24, v21, s[20:23], 0 offen sc1
    s_mov_b64 exec, -1
    s_mov_b32 s36, 1

P2_nh_4:
    s_nop 5
    v_pk_mul_f32 v[240:241], v[160:161], v[96:97]
    v_pk_mul_f32 v[160:161], v[160:161], v[98:99]
    v_pk_fma_f32 v[240:241], v[164:165], v[98:99], v[240:241] neg_lo:[1,0,0] neg_hi:[1,0,0]
    v_pk_fma_f32 v[160:161], v[164:165], v[96:97], v[160:161]
    v_cvt_pk_bf16_f32 v176, v240, v241
    v_cvt_pk_bf16_f32 v180, v160, v161
    v_pk_mul_f32 v[242:243], v[162:163], v[100:101]
    v_pk_mul_f32 v[162:163], v[162:163], v[102:103]
    v_pk_fma_f32 v[242:243], v[166:167], v[102:103], v[242:243] neg_lo:[1,0,0] neg_hi:[1,0,0]
    v_pk_fma_f32 v[162:163], v[166:167], v[100:101], v[162:163]
    v_cvt_pk_bf16_f32 v177, v242, v243
    v_cvt_pk_bf16_f32 v181, v162, v163
    ds_write_b64 v3, v[176:177] offset:0
    ds_write_b64 v3, v[180:181] offset:4096
    v_pk_mul_f32 v[240:241], v[168:169], v[104:105]
    v_pk_mul_f32 v[168:169], v[168:169], v[106:107]
    v_pk_fma_f32 v[240:241], v[172:173], v[106:107], v[240:241] neg_lo:[1,0,0] neg_hi:[1,0,0]
    v_pk_fma_f32 v[168:169], v[172:173], v[104:105], v[168:169]
    v_cvt_pk_bf16_f32 v178, v240, v241
    v_cvt_pk_bf16_f32 v182, v168, v169
    v_pk_mul_f32 v[242:243], v[170:171], v[108:109]
    v_pk_mul_f32 v[170:171], v[170:171], v[110:111]
    v_pk_fma_f32 v[242:243], v[174:175], v[110:111], v[242:243] neg_lo:[1,0,0] neg_hi:[1,0,0]
    v_pk_fma_f32 v[170:171], v[174:175], v[108:109], v[170:171]
    v_cvt_pk_bf16_f32 v179, v242, v243
    v_cvt_pk_bf16_f32 v183, v170, v171
    ds_write_b64 v3, v[178:179] offset:2048
    ds_write_b64 v3, v[182:183] offset:6144
    s_cmp_eq_u32 s36, 1
    s_cbranch_scc1 P2_nh_5

    s_getreg_b32 s58, hwreg(HW_REG_IB_STS)
    s_and_b32 s58, s58, 0xc0000f
    s_cmp_gt_u32 s58, s37
    s_cbranch_scc1 P2_nh_5

    s_waitcnt vmcnt(1)
    s_cmp_eq_u32 s37, 1
    s_cbranch_scc1 P2_nh_5_w
    s_waitcnt vmcnt(0)
P2_nh_5_w:

    s_mov_b64 exec, 1
    buffer_store_dword v24, v21, s[20:23], 0 offen sc1
    s_mov_b64 exec, -1
    s_mov_b32 s36, 1

P2_nh_5:
    s_waitcnt lgkmcnt(0)
    s_barrier
    ds_read_b128 v[128:131], v9 offset:0
    ds_read_b128 v[132:135], v9 offset:1024
    ds_read_b128 v[136:139], v9 offset:2048
    ds_read_b128 v[140:143], v9 offset:3072
    ds_read_b128 v[144:147], v9 offset:4096
    ds_read_b128 v[148:151], v9 offset:5120
    ds_read_b128 v[152:155], v9 offset:6144
    ds_read_b128 v[156:159], v9 offset:7168
    s_cmp_eq_u32 s36, 1
    s_cbranch_scc1 P2_nh_6

    s_waitcnt vmcnt(1)
    s_cmp_eq_u32 s37, 1
    s_cbranch_scc1 P2_nh_6_w
    s_waitcnt vmcnt(0)
P2_nh_6_w:

    s_mov_b64 exec, 1
    buffer_store_dword v24, v21, s[20:23], 0 offen sc1
    s_mov_b64 exec, -1
    s_mov_b32 s36, 1

P2_nh_6:
    s_cmp_lt_u32 s3, 4
    s_cbranch_scc1 P2_ne
    s_lshl_b32 s24, s86, 12
    s_mul_i32 s58, s101, 262144
    s_add_u32 s58, s51, s58
    s_add_u32 s59, s58, 131072

    s_lshl_b32 s32, s24, 3
    s_add_u32 s32, s32, s58
    s_add_u32 m0, s24, 81920
    s_add_u32 s33, s32, 0
    buffer_load_dwordx4 v28, s[96:99], s33 offen lds
    s_add_u32 m0, s24, 82944
    s_add_u32 s33, s32, 8192
    buffer_load_dwordx4 v29, s[96:99], s33 offen lds
    s_add_u32 m0, s24, 83968
    s_add_u32 s33, s32, 16384
    buffer_load_dwordx4 v28, s[96:99], s33 offen lds
    s_add_u32 m0, s24, 84992
    s_add_u32 s33, s32, 24576
    buffer_load_dwordx4 v29, s[96:99], s33 offen lds
    s_lshl_b32 s32, s24, 3
    s_add_u32 s32, s32, s59
    s_add_u32 m0, s24, 114688
    s_add_u32 s33, s32, 0
    buffer_load_dwordx4 v28, s[96:99], s33 offen lds
    s_add_u32 m0, s24, 115712
    s_add_u32 s33, s32, 8192
    buffer_load_dwordx4 v29, s[96:99], s33 offen lds
    s_add_u32 m0, s24, 116736
    s_add_u32 s33, s32, 16384
    buffer_load_dwordx4 v28, s[96:99], s33 offen lds
    s_add_u32 m0, s24, 117760
    s_add_u32 s33, s32, 24576
    buffer_load_dwordx4 v29, s[96:99], s33 offen lds
    s_lshr_b32 s47, s86, 1
    s_mov_b32 s43, 0

    s_getreg_b32 s58, hwreg(HW_REG_IB_STS)
    s_and_b32 s58, s58, 0xc0000f
    s_add_u32 s59, s40, 8
    s_cmp_gt_u32 s58, s59
    s_cbranch_scc1 P2_a1
    s_cmp_eq_u32 s101, 1
    s_cbranch_scc1 P2_a1
    v_cmp_le_u32 vcc, 1, v27
    s_mov_b64 s[38:39], vcc
    s_lshl_b32 s58, s1, 1
    s_add_u32 s58, s58, s47
    s_lshr_b64 s[58:59], vcc, s58
    s_and_b32 s58, s58, 5
    s_cmp_eq_u32 s58, 5
    s_cbranch_scc0 P2_a1

    s_add_u32 m0, s24, 65536
    s_add_u32 s33, s50, s24
    buffer_load_dwordx4 v10, s[20:23], s33 offen offset:0 lds
    buffer_load_dwordx4 v10, s[20:23], s33 offen offset:1024 lds
    buffer_load_dwordx4 v10, s[20:23], s33 offen offset:2048 lds
    buffer_load_dwordx4 v10, s[20:23], s33 offen offset:3072 lds
    s_add_u32 m0, s24, 98304
    s_add_u32 s33, s50, s24
    s_add_u32 s33, s33, 16384
    buffer_load_dwordx4 v10, s[20:23], s33 offen offset:0 lds
    buffer_load_dwordx4 v10, s[20:23], s33 offen offset:1024 lds
    buffer_load_dwordx4 v10, s[20:23], s33 offen offset:2048 lds
    buffer_load_dwordx4 v10, s[20:23], s33 offen offset:3072 lds
    s_mov_b32 s43, 1
    s_branch P2_a2
P2_a1:
    buffer_load_dword v26, v25, s[20:23], s49 offen sc1
P2_a2:
P2_ne:
    s_waitcnt lgkmcnt(0)
    v_mfma_f32_16x16x32_bf16 v[160:163], v[128:131], v[32:35], 0
    v_mfma_f32_16x16x32_bf16 v[164:167], v[144:147], v[32:35], 0
    v_mfma_f32_16x16x32_bf16 v[168:171], v[136:139], v[32:35], 0
    v_mfma_f32_16x16x32_bf16 v[172:175], v[152:155], v[32:35], 0
    v_mfma_f32_16x16x32_bf16 v[160:163], v[144:147], v[40:43], v[160:163]
    v_mfma_f32_16x16x32_bf16 v[164:167], v[128:131], v[48:51], v[164:167]
    v_mfma_f32_16x16x32_bf16 v[168:171], v[152:155], v[40:43], v[168:171]
    v_mfma_f32_16x16x32_bf16 v[172:175], v[136:139], v[48:51], v[172:175]
    v_mfma_f32_16x16x32_bf16 v[160:163], v[132:135], v[36:39], v[160:163]
    v_mfma_f32_16x16x32_bf16 v[164:167], v[148:151], v[36:39], v[164:167]
    v_mfma_f32_16x16x32_bf16 v[168:171], v[140:143], v[36:39], v[168:171]
    v_mfma_f32_16x16x32_bf16 v[172:175], v[156:159], v[36:39], v[172:175]
    v_mfma_f32_16x16x32_bf16 v[160:163], v[148:151], v[44:47], v[160:163]
    v_mfma_f32_16x16x32_bf16 v[164:167], v[132:135], v[52:55], v[164:167]
    v_mfma_f32_16x16x32_bf16 v[168:171], v[156:159], v[44:47], v[168:171]
    v_mfma_f32_16x16x32_bf16 v[172:175], v[140:143], v[52:55], v[172:175]
    s_nop 7
    v_cvt_pk_bf16_f32 v176, v160, v161
    v_cvt_pk_bf16_f32 v177, v162, v163
    v_cvt_pk_bf16_f32 v178, v168, v169
    v_cvt_pk_bf16_f32 v179, v170, v171
    ds_write_b128 v4, v[176:179]
    v_cvt_pk_bf16_f32 v180, v164, v165
    v_cvt_pk_bf16_f32 v181, v166, v167
    v_cvt_pk_bf16_f32 v182, v172, v173
    v_cvt_pk_bf16_f32 v183, v174, v175
    ds_write_b128 v1, v[180:183]
    s_cmp_eq_u32 s101, 0
    s_cbranch_scc1 M_go2
    v_lshrrev_b32 v22, 2, v11
    s_lshr_b32 s58, s4, 1
    v_cmp_eq_u32 vcc, s58, v22
    s_waitcnt vmcnt(0)
    s_nop 0
    v_cndmask_b32 v22, 0, 1, vcc
    s_mov_b32 s90, 0
M_whf:
    buffer_load_dword v26, v25, s[20:23], s49 offen sc1
    s_add_u32 s90, s90, 1
    s_waitcnt vmcnt(0)
    v_cmp_le_u32 vcc, v22, v26
    s_cmp_eq_u64 vcc, -1
    s_cbranch_scc1 M_whf_ok
    s_sleep 16
    s_cmp_lt_u32 s90, 0x10000
    s_cbranch_scc1 M_whf
M_whf_ok:

    s_lshl_b32 s32, s3, 11
    s_add_u32 m0, s32, 0
    s_add_u32 s33, s50, s32
    buffer_load_dwordx4 v10, s[20:23], s33 offen lds
    buffer_load_dwordx4 v10, s[20:23], s33 offen offset:1024 lds

    s_add_u32 m0, s32, 16384
    s_lshl_b32 s33, s32, 3
    s_add_u32 s33, s33, s51
    buffer_load_dwordx4 v28, s[96:99], s33 offen lds
    s_add_u32 m0, s32, 17408
    s_add_u32 s33, s33, 8192
    buffer_load_dwordx4 v29, s[96:99], s33 offen lds

    s_add_u32 s1, s1, 1
    s_lshl_b32 s50, s1, 14
    s_lshl_b32 s51, s1, 17
    s_add_u32 s50, s50, s48
    s_add_u32 s51, s51, s0

    s_lshl_b32 s32, s3, 11
    s_add_u32 m0, s32, 32768
    s_add_u32 s33, s50, s32
    buffer_load_dwordx4 v10, s[20:23], s33 offen lds
    buffer_load_dwordx4 v10, s[20:23], s33 offen offset:1024 lds

    s_add_u32 m0, s32, 49152
    s_lshl_b32 s33, s32, 3
    s_add_u32 s33, s33, s51
    buffer_load_dwordx4 v28, s[96:99], s33 offen lds
    s_add_u32 m0, s32, 50176
    s_add_u32 s33, s33, 8192
    buffer_load_dwordx4 v29, s[96:99], s33 offen lds

    s_mov_b32 s1, s5
    s_cmp_eq_u32 s1, 28
    s_cselect_b32 s1, 0, s1

    s_add_u32 s33, s1, 2
    s_cmp_eq_u32 s1, s4
    s_cselect_b32 s1, s33, s1
    s_cmp_eq_u32 s1, 28
    s_cselect_b32 s1, 0, s1

    s_lshl_b32 s50, s1, 14
    s_lshl_b32 s51, s1, 17
    s_add_u32 s50, s50, s48
    s_add_u32 s51, s51, s0

    s_waitcnt vmcnt(0)
M_go2:
    s_waitcnt lgkmcnt(0)
    s_cmp_lt_u32 s3, 4
    s_cbranch_scc1 M_comp
    s_setprio 1
    s_lshl_b32 s24, s86, 12
    s_and_b32 s33, s3, 1
    s_lshl_b32 s33, s33, 6
    v_xor_b32 v36, s33, v10
    v_xor_b32 v37, 16, v36
    v_xor_b32 v38, 32, v36
    v_xor_b32 v39, 48, v36
    v_and_b32 v40, 3, v11
    v_lshlrev_b32 v40, 6, v40
    v_mov_b32 v8, v28
    v_mov_b32 v9, v29
    s_lshl_b32 s30, s86, 12
    s_add_u32 s30, s30, 131072
    v_add_u32 v44, s30, v10
    v_lshrrev_b32 v45, 2, v11
    v_lshlrev_b32 v45, 14, v45
    v_lshrrev_b32 v4, 5, v11
    v_and_b32 v5, 3, v11
    v_xor_b32 v4, v4, v5
    v_lshl_add_u32 v45, v4, 4, v45
    v_xor_b32 v46, 32, v45
    s_lshl_b32 s30, s86, 20
    s_lshl_b32 s31, s2, 6
    s_add_u32 s30, s30, s31
    s_add_u32 s30, s30, 27262976
    s_barrier

    ds_read_b128 v[80:83], v44 offset:0
    ds_read_b128 v[84:87], v44 offset:1024
    ds_read_b128 v[88:91], v44 offset:2048
    ds_read_b128 v[92:95], v44 offset:3072
    s_waitcnt lgkmcnt(3)
    buffer_store_dwordx4 v[80:83], v45, s[20:23], s30 offen sc1
    s_add_u32 s30, s30, 262144
    s_waitcnt lgkmcnt(2)
    buffer_store_dwordx4 v[84:87], v46, s[20:23], s30 offen sc1
    s_add_u32 s30, s30, 262144
    s_waitcnt lgkmcnt(1)
    buffer_store_dwordx4 v[88:91], v45, s[20:23], s30 offen sc1
    s_add_u32 s30, s30, 262144
    s_waitcnt lgkmcnt(0)
    buffer_store_dwordx4 v[92:95], v46, s[20:23], s30 offen sc1
    s_add_u32 s30, s30, 262144
    s_barrier
    s_cmp_eq_u32 s43, 0
    s_cbranch_scc1 M_i23

    s_add_u32 s1, s1, 1
    s_lshl_b32 s50, s1, 14
    s_lshl_b32 s51, s1, 17
    s_add_u32 s50, s50, s48
    s_add_u32 s51, s51, s0

    s_add_u32 s1, s1, 1
    s_cmp_eq_u32 s1, 28
    s_cselect_b32 s1, 0, s1

    s_add_u32 s33, s1, 2
    s_cmp_eq_u32 s1, s4
    s_cselect_b32 s1, s33, s1
    s_cmp_eq_u32 s1, 28
    s_cselect_b32 s1, 0, s1

    s_lshl_b32 s50, s1, 14
    s_lshl_b32 s51, s1, 17
    s_add_u32 s50, s50, s48
    s_add_u32 s51, s51, s0

    s_branch M_i23d
M_i23:
    s_waitcnt vmcnt(4)
    v_cmp_le_u32 vcc, 1, v26
    s_mov_b64 s[38:39], vcc

    s_lshl_b32 s37, s1, 1
    s_add_u32 s37, s37, s47
    s_bitcmp1_b64 s[38:39], s37
    s_cbranch_scc1 M_hc_7_ok
    s_mov_b32 s90, 0
M_hc_7:
    buffer_load_dword v27, v25, s[20:23], s49 offen sc1
    s_add_u32 s90, s90, 1
    s_waitcnt vmcnt(0)
    v_cmp_le_u32 vcc, 1, v27
    s_mov_b64 s[38:39], vcc
    s_bitcmp1_b64 s[38:39], s37
    s_cbranch_scc1 M_hc_7_ok
    s_sleep 4
    s_cmp_lt_u32 s90, 0x10000
    s_cbranch_scc1 M_hc_7
M_hc_7_ok:

    s_add_u32 m0, s24, 65536
    s_add_u32 s33, s50, s24
    buffer_load_dwordx4 v10, s[20:23], s33 offen offset:0 lds
    buffer_load_dwordx4 v10, s[20:23], s33 offen offset:1024 lds
    buffer_load_dwordx4 v10, s[20:23], s33 offen offset:2048 lds
    buffer_load_dwordx4 v10, s[20:23], s33 offen offset:3072 lds
    s_add_u32 s1, s1, 1
    s_lshl_b32 s50, s1, 14
    s_lshl_b32 s51, s1, 17
    s_add_u32 s50, s50, s48
    s_add_u32 s51, s51, s0

    s_lshl_b32 s37, s1, 1
    s_add_u32 s37, s37, s47
    s_bitcmp1_b64 s[38:39], s37
    s_cbranch_scc1 M_hc_8_ok
    s_mov_b32 s90, 0
M_hc_8:
    buffer_load_dword v27, v25, s[20:23], s49 offen sc1
    s_add_u32 s90, s90, 1
    s_waitcnt vmcnt(0)
    v_cmp_le_u32 vcc, 1, v27
    s_mov_b64 s[38:39], vcc
    s_bitcmp1_b64 s[38:39], s37
    s_cbranch_scc1 M_hc_8_ok
    s_sleep 4
    s_cmp_lt_u32 s90, 0x10000
    s_cbranch_scc1 M_hc_8
M_hc_8_ok:

    s_add_u32 m0, s24, 98304
    s_add_u32 s33, s50, s24
    buffer_load_dwordx4 v10, s[20:23], s33 offen offset:0 lds
    buffer_load_dwordx4 v10, s[20:23], s33 offen offset:1024 lds
    buffer_load_dwordx4 v10, s[20:23], s33 offen offset:2048 lds
    buffer_load_dwordx4 v10, s[20:23], s33 offen offset:3072 lds
    s_add_u32 s1, s1, 1
    s_cmp_eq_u32 s1, 28
    s_cselect_b32 s1, 0, s1

    s_add_u32 s33, s1, 2
    s_cmp_eq_u32 s1, s4
    s_cselect_b32 s1, s33, s1
    s_cmp_eq_u32 s1, 28
    s_cselect_b32 s1, 0, s1

    s_lshl_b32 s50, s1, 14
    s_lshl_b32 s51, s1, 17
    s_add_u32 s50, s50, s48
    s_add_u32 s51, s51, s0

M_i23d:
    s_lshl_b32 s37, s1, 1
    s_add_u32 s37, s37, s47
    s_bitcmp1_b64 s[38:39], s37
    s_cbranch_scc1 M_hc_9_ok
    s_mov_b32 s90, 0
M_hc_9:
    buffer_load_dword v27, v25, s[20:23], s49 offen sc1
    s_add_u32 s90, s90, 1
    s_waitcnt vmcnt(0)
    v_cmp_le_u32 vcc, 1, v27
    s_mov_b64 s[38:39], vcc
    s_bitcmp1_b64 s[38:39], s37
    s_cbranch_scc1 M_hc_9_ok
    s_sleep 4
    s_cmp_lt_u32 s90, 0x10000
    s_cbranch_scc1 M_hc_9
M_hc_9_ok:

    s_add_u32 m0, s24, 0
    s_add_u32 s33, s50, s24
    buffer_load_dwordx4 v10, s[20:23], s33 offen offset:0 lds
    buffer_load_dwordx4 v10, s[20:23], s33 offen offset:1024 lds
    buffer_load_dwordx4 v10, s[20:23], s33 offen offset:2048 lds
    buffer_load_dwordx4 v10, s[20:23], s33 offen offset:3072 lds
    s_lshl_b32 s32, s24, 3
    s_add_u32 s32, s32, s51
    s_add_u32 m0, s24, 16384
    s_add_u32 s33, s32, 0
    buffer_load_dwordx4 v8, s[96:99], s33 offen lds
    s_add_u32 m0, s24, 17408
    s_add_u32 s33, s32, 8192
    buffer_load_dwordx4 v9, s[96:99], s33 offen lds
    s_add_u32 m0, s24, 18432
    s_add_u32 s33, s32, 16384
    buffer_load_dwordx4 v8, s[96:99], s33 offen lds
    s_add_u32 m0, s24, 19456
    s_add_u32 s33, s32, 24576
    buffer_load_dwordx4 v9, s[96:99], s33 offen lds
    s_add_u32 s1, s1, 1
    s_lshl_b32 s50, s1, 14
    s_lshl_b32 s51, s1, 17
    s_add_u32 s50, s50, s48
    s_add_u32 s51, s51, s0

    s_waitcnt vmcnt(12) lgkmcnt(0)
    s_barrier
    s_lshl_b32 s37, s1, 1
    s_add_u32 s37, s37, s47
    s_bitcmp1_b64 s[38:39], s37
    s_cbranch_scc1 M_hc_10_ok
    s_mov_b32 s90, 0
M_hc_10:
    buffer_load_dword v27, v25, s[20:23], s49 offen sc1
    s_add_u32 s90, s90, 1
    s_waitcnt vmcnt(0)
    v_cmp_le_u32 vcc, 1, v27
    s_mov_b64 s[38:39], vcc
    s_bitcmp1_b64 s[38:39], s37
    s_cbranch_scc1 M_hc_10_ok
    s_sleep 4
    s_cmp_lt_u32 s90, 0x10000
    s_cbranch_scc1 M_hc_10
M_hc_10_ok:

    s_add_u32 m0, s24, 32768
    s_add_u32 s33, s50, s24
    buffer_load_dwordx4 v10, s[20:23], s33 offen offset:0 lds
    buffer_load_dwordx4 v10, s[20:23], s33 offen offset:1024 lds
    buffer_load_dwordx4 v10, s[20:23], s33 offen offset:2048 lds
    buffer_load_dwordx4 v10, s[20:23], s33 offen offset:3072 lds
    s_lshl_b32 s32, s24, 3
    s_add_u32 s32, s32, s51
    s_add_u32 m0, s24, 49152
    s_add_u32 s33, s32, 0
    buffer_load_dwordx4 v8, s[96:99], s33 offen lds
    s_add_u32 m0, s24, 50176
    s_add_u32 s33, s32, 8192
    buffer_load_dwordx4 v9, s[96:99], s33 offen lds
    s_add_u32 m0, s24, 51200
    s_add_u32 s33, s32, 16384
    buffer_load_dwordx4 v8, s[96:99], s33 offen lds
    s_add_u32 m0, s24, 52224
    s_add_u32 s33, s32, 24576
    buffer_load_dwordx4 v9, s[96:99], s33 offen lds
    s_add_u32 s1, s1, 1
    s_cmp_eq_u32 s1, 28
    s_cselect_b32 s1, 0, s1

    s_add_u32 s33, s1, 2
    s_cmp_eq_u32 s1, s4
    s_cselect_b32 s1, s33, s1
    s_cmp_eq_u32 s1, 28
    s_cselect_b32 s1, 0, s1

    s_lshl_b32 s50, s1, 14
    s_lshl_b32 s51, s1, 17
    s_add_u32 s50, s50, s48
    s_add_u32 s51, s51, s0

    s_waitcnt vmcnt(16) lgkmcnt(0)
    s_barrier
    s_lshl_b32 s37, s1, 1
    s_add_u32 s37, s37, s47
    s_bitcmp1_b64 s[38:39], s37
    s_cbranch_scc1 M_hc_11_ok
    s_mov_b32 s90, 0
M_hc_11:
    buffer_load_dword v27, v25, s[20:23], s49 offen sc1
    s_add_u32 s90, s90, 1
    s_waitcnt vmcnt(0)
    v_cmp_le_u32 vcc, 1, v27
    s_mov_b64 s[38:39], vcc
    s_bitcmp1_b64 s[38:39], s37
    s_cbranch_scc1 M_hc_11_ok
    s_sleep 4
    s_cmp_lt_u32 s90, 0x10000
    s_cbranch_scc1 M_hc_11
M_hc_11_ok:

    s_add_u32 m0, s24, 65536
    s_add_u32 s33, s50, s24
    buffer_load_dwordx4 v10, s[20:23], s33 offen offset:0 lds
    buffer_load_dwordx4 v10, s[20:23], s33 offen offset:1024 lds
    buffer_load_dwordx4 v10, s[20:23], s33 offen offset:2048 lds
    buffer_load_dwordx4 v10, s[20:23], s33 offen offset:3072 lds
    s_lshl_b32 s32, s24, 3
    s_add_u32 s32, s32, s51
    s_add_u32 m0, s24, 81920
    s_add_u32 s33, s32, 0
    buffer_load_dwordx4 v8, s[96:99], s33 offen lds
    s_add_u32 m0, s24, 82944
    s_add_u32 s33, s32, 8192
    buffer_load_dwordx4 v9, s[96:99], s33 offen lds
    s_add_u32 m0, s24, 83968
    s_add_u32 s33, s32, 16384
    buffer_load_dwordx4 v8, s[96:99], s33 offen lds
    s_add_u32 m0, s24, 84992
    s_add_u32 s33, s32, 24576
    buffer_load_dwordx4 v9, s[96:99], s33 offen lds
    s_add_u32 s1, s1, 1
    s_lshl_b32 s50, s1, 14
    s_lshl_b32 s51, s1, 17
    s_add_u32 s50, s50, s48
    s_add_u32 s51, s51, s0

    s_cmp_lg_u32 s3, 4
    s_cbranch_scc1 M_sz
    s_mov_b64 exec, 1
    s_and_b32 s58, s2, 3
    s_lshl_b32 s58, s58, 6
    buffer_atomic_add v24, v20, s[92:95], s58 offen offset:32 sc1
    s_mov_b64 exec, -1
M_sz:

    s_waitcnt vmcnt(16) lgkmcnt(0)
    s_barrier
    s_lshl_b32 s37, s1, 1
    s_add_u32 s37, s37, s47
    s_bitcmp1_b64 s[38:39], s37
    s_cbranch_scc1 M_hc_12_ok
    s_mov_b32 s90, 0
M_hc_12:
    buffer_load_dword v27, v25, s[20:23], s49 offen sc1
    s_add_u32 s90, s90, 1
    s_waitcnt vmcnt(0)
    v_cmp_le_u32 vcc, 1, v27
    s_mov_b64 s[38:39], vcc
    s_bitcmp1_b64 s[38:39], s37
    s_cbranch_scc1 M_hc_12_ok
    s_sleep 4
    s_cmp_lt_u32 s90, 0x10000
    s_cbranch_scc1 M_hc_12
M_hc_12_ok:

    s_add_u32 m0, s24, 98304
    s_add_u32 s33, s50, s24
    buffer_load_dwordx4 v10, s[20:23], s33 offen offset:0 lds
    buffer_load_dwordx4 v10, s[20:23], s33 offen offset:1024 lds
    buffer_load_dwordx4 v10, s[20:23], s33 offen offset:2048 lds
    buffer_load_dwordx4 v10, s[20:23], s33 offen offset:3072 lds
    s_lshl_b32 s32, s24, 3
    s_add_u32 s32, s32, s51
    s_add_u32 m0, s24, 114688
    s_add_u32 s33, s32, 0
    buffer_load_dwordx4 v8, s[96:99], s33 offen lds
    s_add_u32 m0, s24, 115712
    s_add_u32 s33, s32, 8192
    buffer_load_dwordx4 v9, s[96:99], s33 offen lds
    s_add_u32 m0, s24, 116736
    s_add_u32 s33, s32, 16384
    buffer_load_dwordx4 v8, s[96:99], s33 offen lds
    s_add_u32 m0, s24, 117760
    s_add_u32 s33, s32, 24576
    buffer_load_dwordx4 v9, s[96:99], s33 offen lds
    s_add_u32 s1, s1, 1
    s_cmp_eq_u32 s1, 28
    s_cselect_b32 s1, 0, s1

    s_add_u32 s33, s1, 2
    s_cmp_eq_u32 s1, s4
    s_cselect_b32 s1, s33, s1
    s_cmp_eq_u32 s1, 28
    s_cselect_b32 s1, 0, s1

    s_lshl_b32 s50, s1, 14
    s_lshl_b32 s51, s1, 17
    s_add_u32 s50, s50, s48
    s_add_u32 s51, s51, s0

    s_waitcnt vmcnt(16) lgkmcnt(0)
    s_barrier
    s_lshl_b32 s37, s1, 1
    s_add_u32 s37, s37, s47
    s_bitcmp1_b64 s[38:39], s37
    s_cbranch_scc1 M_hc_13_ok
    s_mov_b32 s90, 0
M_hc_13:
    buffer_load_dword v27, v25, s[20:23], s49 offen sc1
    s_add_u32 s90, s90, 1
    s_waitcnt vmcnt(0)
    v_cmp_le_u32 vcc, 1, v27
    s_mov_b64 s[38:39], vcc
    s_bitcmp1_b64 s[38:39], s37
    s_cbranch_scc1 M_hc_13_ok
    s_sleep 4
    s_cmp_lt_u32 s90, 0x10000
    s_cbranch_scc1 M_hc_13
M_hc_13_ok:

    s_add_u32 m0, s24, 0
    s_add_u32 s33, s50, s24
    buffer_load_dwordx4 v10, s[20:23], s33 offen offset:0 lds
    buffer_load_dwordx4 v10, s[20:23], s33 offen offset:1024 lds
    buffer_load_dwordx4 v10, s[20:23], s33 offen offset:2048 lds
    buffer_load_dwordx4 v10, s[20:23], s33 offen offset:3072 lds
    s_lshl_b32 s32, s24, 3
    s_add_u32 s32, s32, s51
    s_add_u32 m0, s24, 16384
    s_add_u32 s33, s32, 0
    buffer_load_dwordx4 v8, s[96:99], s33 offen lds
    s_add_u32 m0, s24, 17408
    s_add_u32 s33, s32, 8192
    buffer_load_dwordx4 v9, s[96:99], s33 offen lds
    s_add_u32 m0, s24, 18432
    s_add_u32 s33, s32, 16384
    buffer_load_dwordx4 v8, s[96:99], s33 offen lds
    s_add_u32 m0, s24, 19456
    s_add_u32 s33, s32, 24576
    buffer_load_dwordx4 v9, s[96:99], s33 offen lds
    s_add_u32 s1, s1, 1
    s_lshl_b32 s50, s1, 14
    s_lshl_b32 s51, s1, 17
    s_add_u32 s50, s50, s48
    s_add_u32 s51, s51, s0

    s_setprio 3
    s_and_b32 s25, s3, 1
    s_bfe_u32 s26, s3, 0x10001
    v_and_b32 v6, 15, v11
    v_lshrrev_b32 v7, 4, v11
    s_cmp_eq_u32 s26, 0
    s_cselect_b64 s[56:57], -1, 0
    v_cndmask_b32 v12, v60, v56, s[56:57]
    v_cndmask_b32 v14, v68, v64, s[56:57]
    v_cndmask_b32 v16, v76, v72, s[56:57]
    v_mov_b32 v18, v12
    v_cndmask_b32 v13, v61, v57, s[56:57]
    v_cndmask_b32 v15, v69, v65, s[56:57]
    v_cndmask_b32 v17, v77, v73, s[56:57]
    v_mov_b32 v19, v13
    v_lshrrev_b32 v4, 2, v11
    v_lshlrev_b32 v5, 6, v4
    v_and_b32 v4, 7, v4
    v_add_u32 v5, v5, v4
    v_and_b32 v4, 3, v11
    s_setprio 1
    s_waitcnt vmcnt(16) lgkmcnt(0)
    s_barrier
    s_lshl_b32 s37, s1, 1
    s_add_u32 s37, s37, s47
    s_bitcmp1_b64 s[38:39], s37
    s_cbranch_scc1 M_hc_14_ok
    s_mov_b32 s90, 0
M_hc_14:
    buffer_load_dword v27, v25, s[20:23], s49 offen sc1
    s_add_u32 s90, s90, 1
    s_waitcnt vmcnt(0)
    v_cmp_le_u32 vcc, 1, v27
    s_mov_b64 s[38:39], vcc
    s_bitcmp1_b64 s[38:39], s37
    s_cbranch_scc1 M_hc_14_ok
    s_sleep 4
    s_cmp_lt_u32 s90, 0x10000
    s_cbranch_scc1 M_hc_14
M_hc_14_ok:

    s_add_u32 m0, s24, 32768
    s_add_u32 s33, s50, s24
    buffer_load_dwordx4 v10, s[20:23], s33 offen offset:0 lds
    buffer_load_dwordx4 v10, s[20:23], s33 offen offset:1024 lds
    buffer_load_dwordx4 v10, s[20:23], s33 offen offset:2048 lds
    buffer_load_dwordx4 v10, s[20:23], s33 offen offset:3072 lds
    s_lshl_b32 s32, s24, 3
    s_add_u32 s32, s32, s51
    s_add_u32 m0, s24, 49152
    s_add_u32 s33, s32, 0
    buffer_load_dwordx4 v8, s[96:99], s33 offen lds
    s_add_u32 m0, s24, 50176
    s_add_u32 s33, s32, 8192
    buffer_load_dwordx4 v9, s[96:99], s33 offen lds
    s_add_u32 m0, s24, 51200
    s_add_u32 s33, s32, 16384
    buffer_load_dwordx4 v8, s[96:99], s33 offen lds
    s_add_u32 m0, s24, 52224
    s_add_u32 s33, s32, 24576
    buffer_load_dwordx4 v9, s[96:99], s33 offen lds
    s_add_u32 s1, s1, 1
    s_cmp_eq_u32 s1, 28
    s_cselect_b32 s1, 0, s1

    s_add_u32 s33, s1, 2
    s_cmp_eq_u32 s1, s4
    s_cselect_b32 s1, s33, s1
    s_cmp_eq_u32 s1, 28
    s_cselect_b32 s1, 0, s1

    s_lshl_b32 s50, s1, 14
    s_lshl_b32 s51, s1, 17
    s_add_u32 s50, s50, s48
    s_add_u32 s51, s51, s0

    s_setprio 3
    v_lshl_add_u32 v5, v4, 3, v5
    v_lshlrev_b32 v5, 4, v5
    s_lshl_b32 s30, s25, 3
    s_add_u32 s30, s30, 131072
    v_add_u32 v28, s30, v5
    v_mov_b32 v5, s30
    v_xor_b32 v29, 16, v28
    v_xor_b32 v30, 32, v28
    v_xor_b32 v31, 48, v28
    v_xor_b32 v32, 64, v28
    v_xor_b32 v33, 80, v28
    v_xor_b32 v34, 96, v28
    v_xor_b32 v35, 112, v28
    s_lshl_b32 s30, s26, 4
    v_add_u32 v4, s30, v6
    v_cvt_f32_u32 v4, v4
    v_mul_f32 v47, 0x3a800000, v4
    v_lshlrev_b32 v4, 2, v7
    v_cvt_f32_u32 v4, v4
    s_setprio 1
    s_waitcnt vmcnt(16) lgkmcnt(0)
    s_barrier
    s_lshl_b32 s37, s1, 1
    s_add_u32 s37, s37, s47
    s_bitcmp1_b64 s[38:39], s37
    s_cbranch_scc1 M_hc_15_ok
    s_mov_b32 s90, 0
M_hc_15:
    buffer_load_dword v27, v25, s[20:23], s49 offen sc1
    s_add_u32 s90, s90, 1
    s_waitcnt vmcnt(0)
    v_cmp_le_u32 vcc, 1, v27
    s_mov_b64 s[38:39], vcc
    s_bitcmp1_b64 s[38:39], s37
    s_cbranch_scc1 M_hc_15_ok
    s_sleep 4
    s_cmp_lt_u32 s90, 0x10000
    s_cbranch_scc1 M_hc_15
M_hc_15_ok:

    s_add_u32 m0, s24, 65536
    s_add_u32 s33, s50, s24
    buffer_load_dwordx4 v10, s[20:23], s33 offen offset:0 lds
    buffer_load_dwordx4 v10, s[20:23], s33 offen offset:1024 lds
    buffer_load_dwordx4 v10, s[20:23], s33 offen offset:2048 lds
    buffer_load_dwordx4 v10, s[20:23], s33 offen offset:3072 lds
    s_lshl_b32 s32, s24, 3
    s_add_u32 s32, s32, s51
    s_add_u32 m0, s24, 81920
    s_add_u32 s33, s32, 0
    buffer_load_dwordx4 v8, s[96:99], s33 offen lds
    s_add_u32 m0, s24, 82944
    s_add_u32 s33, s32, 8192
    buffer_load_dwordx4 v9, s[96:99], s33 offen lds
    s_add_u32 m0, s24, 83968
    s_add_u32 s33, s32, 16384
    buffer_load_dwordx4 v8, s[96:99], s33 offen lds
    s_add_u32 m0, s24, 84992
    s_add_u32 s33, s32, 24576
    buffer_load_dwordx4 v9, s[96:99], s33 offen lds
    s_add_u32 s1, s1, 1
    s_lshl_b32 s50, s1, 14
    s_lshl_b32 s51, s1, 17
    s_add_u32 s50, s50, s48
    s_add_u32 s51, s51, s0

    s_setprio 3
    v_add_f32 v48, 0.0, v4
    v_mul_f32 v48, v48, v47
    v_cos_f32 v224, v48
    v_sin_f32 v225, v48
    v_add_f32 v48, 1.0, v4
    v_mul_f32 v48, v48, v47
    v_cos_f32 v226, v48
    v_sin_f32 v227, v48
    v_add_f32 v48, 2.0, v4
    v_mul_f32 v48, v48, v47
    v_cos_f32 v228, v48
    v_sin_f32 v229, v48
    v_add_f32 v48, 3.0, v4
    v_mul_f32 v48, v48, v47
    v_cos_f32 v230, v48
    v_sin_f32 v231, v48
    v_add_f32 v48, 16.0, v4
    v_mul_f32 v48, v48, v47
    v_cos_f32 v232, v48
    s_setprio 1
    s_waitcnt vmcnt(16) lgkmcnt(0)
    s_barrier
    s_lshl_b32 s37, s1, 1
    s_add_u32 s37, s37, s47
    s_bitcmp1_b64 s[38:39], s37
    s_cbranch_scc1 M_hc_16_ok
    s_mov_b32 s90, 0
M_hc_16:
    buffer_load_dword v27, v25, s[20:23], s49 offen sc1
    s_add_u32 s90, s90, 1
    s_waitcnt vmcnt(0)
    v_cmp_le_u32 vcc, 1, v27
    s_mov_b64 s[38:39], vcc
    s_bitcmp1_b64 s[38:39], s37
    s_cbranch_scc1 M_hc_16_ok
    s_sleep 4
    s_cmp_lt_u32 s90, 0x10000
    s_cbranch_scc1 M_hc_16
M_hc_16_ok:

    s_add_u32 m0, s24, 98304
    s_add_u32 s33, s50, s24
    buffer_load_dwordx4 v10, s[20:23], s33 offen offset:0 lds
    buffer_load_dwordx4 v10, s[20:23], s33 offen offset:1024 lds
    buffer_load_dwordx4 v10, s[20:23], s33 offen offset:2048 lds
    buffer_load_dwordx4 v10, s[20:23], s33 offen offset:3072 lds
    s_lshl_b32 s32, s24, 3
    s_add_u32 s32, s32, s51
    s_add_u32 m0, s24, 114688
    s_add_u32 s33, s32, 0
    buffer_load_dwordx4 v8, s[96:99], s33 offen lds
    s_add_u32 m0, s24, 115712
    s_add_u32 s33, s32, 8192
    buffer_load_dwordx4 v9, s[96:99], s33 offen lds
    s_add_u32 m0, s24, 116736
    s_add_u32 s33, s32, 16384
    buffer_load_dwordx4 v8, s[96:99], s33 offen lds
    s_add_u32 m0, s24, 117760
    s_add_u32 s33, s32, 24576
    buffer_load_dwordx4 v9, s[96:99], s33 offen lds
    s_add_u32 s1, s1, 1
    s_cmp_eq_u32 s1, 28
    s_cselect_b32 s1, 0, s1

    s_add_u32 s33, s1, 2
    s_cmp_eq_u32 s1, s4
    s_cselect_b32 s1, s33, s1
    s_cmp_eq_u32 s1, 28
    s_cselect_b32 s1, 0, s1

    s_lshl_b32 s50, s1, 14
    s_lshl_b32 s51, s1, 17
    s_add_u32 s50, s50, s48
    s_add_u32 s51, s51, s0

    s_setprio 3
    v_sin_f32 v233, v48
    v_add_f32 v48, 17.0, v4
    v_mul_f32 v48, v48, v47
    v_cos_f32 v234, v48
    v_sin_f32 v235, v48
    v_add_f32 v48, 18.0, v4
    v_mul_f32 v48, v48, v47
    v_cos_f32 v236, v48
    v_sin_f32 v237, v48
    v_add_f32 v48, 19.0, v4
    v_mul_f32 v48, v48, v47
    v_cos_f32 v238, v48
    v_sin_f32 v239, v48
    v_lshlrev_b32 v2, 5, v6
    v_and_b32 v3, 1, v7
    v_lshl_add_u32 v2, v3, 9, v2
    v_lshrrev_b32 v3, 1, v7
    v_lshl_add_u32 v2, v3, 4, v2
    s_lshl_b32 s34, s2, 14
    s_setprio 1
    s_waitcnt vmcnt(16) lgkmcnt(0)
    s_barrier
    s_lshl_b32 s37, s1, 1
    s_add_u32 s37, s37, s47
    s_bitcmp1_b64 s[38:39], s37
    s_cbranch_scc1 M_hc_17_ok
    s_mov_b32 s90, 0
M_hc_17:
    buffer_load_dword v27, v25, s[20:23], s49 offen sc1
    s_add_u32 s90, s90, 1
    s_waitcnt vmcnt(0)
    v_cmp_le_u32 vcc, 1, v27
    s_mov_b64 s[38:39], vcc
    s_bitcmp1_b64 s[38:39], s37
    s_cbranch_scc1 M_hc_17_ok
    s_sleep 4
    s_cmp_lt_u32 s90, 0x10000
    s_cbranch_scc1 M_hc_17
M_hc_17_ok:

    s_add_u32 m0, s24, 0
    s_add_u32 s33, s50, s24
    buffer_load_dwordx4 v10, s[20:23], s33 offen offset:0 lds
    buffer_load_dwordx4 v10, s[20:23], s33 offen offset:1024 lds
    buffer_load_dwordx4 v10, s[20:23], s33 offen offset:2048 lds
    buffer_load_dwordx4 v10, s[20:23], s33 offen offset:3072 lds
    s_lshl_b32 s32, s24, 3
    s_add_u32 s32, s32, s51
    s_add_u32 m0, s24, 16384
    s_add_u32 s33, s32, 0
    buffer_load_dwordx4 v8, s[96:99], s33 offen lds
    s_add_u32 m0, s24, 17408
    s_add_u32 s33, s32, 8192
    buffer_load_dwordx4 v9, s[96:99], s33 offen lds
    s_add_u32 m0, s24, 18432
    s_add_u32 s33, s32, 16384
    buffer_load_dwordx4 v8, s[96:99], s33 offen lds
    s_add_u32 m0, s24, 19456
    s_add_u32 s33, s32, 24576
    buffer_load_dwordx4 v9, s[96:99], s33 offen lds
    s_add_u32 s1, s1, 1
    s_lshl_b32 s50, s1, 14
    s_lshl_b32 s51, s1, 17
    s_add_u32 s50, s50, s48
    s_add_u32 s51, s51, s0

    s_setprio 3
    s_lshl_b32 s30, s25, 13
    s_add_u32 s34, s34, s30
    s_lshl_b32 s30, s26, 10
    s_add_u32 s34, s34, s30
    s_add_u32 s34, s34, 41943040
    s_add_u32 s35, s34, 4096
    s_lshr_b32 s31, s2, 2
    s_lshl_b32 s31, s31, 5
    s_and_b32 s30, s2, 3
    s_lshl_b32 s30, s30, 2
    s_add_u32 s31, s31, s30
    s_lshl_b32 s30, s25, 4
    s_add_u32 s31, s31, s30
    s_lshl_b32 s31, s31, 2
    s_add_u32 s31, s31, 34603008
    s_setprio 1
    s_waitcnt vmcnt(16) lgkmcnt(0)
    s_barrier
    s_lshl_b32 s37, s1, 1
    s_add_u32 s37, s37, s47
    s_bitcmp1_b64 s[38:39], s37
    s_cbranch_scc1 M_hc_18_ok
    s_mov_b32 s90, 0
M_hc_18:
    buffer_load_dword v27, v25, s[20:23], s49 offen sc1
    s_add_u32 s90, s90, 1
    s_waitcnt vmcnt(0)
    v_cmp_le_u32 vcc, 1, v27
    s_mov_b64 s[38:39], vcc
    s_bitcmp1_b64 s[38:39], s37
    s_cbranch_scc1 M_hc_18_ok
    s_sleep 4
    s_cmp_lt_u32 s90, 0x10000
    s_cbranch_scc1 M_hc_18
M_hc_18_ok:

    s_add_u32 m0, s24, 32768
    s_add_u32 s33, s50, s24
    buffer_load_dwordx4 v10, s[20:23], s33 offen offset:0 lds
    buffer_load_dwordx4 v10, s[20:23], s33 offen offset:1024 lds
    buffer_load_dwordx4 v10, s[20:23], s33 offen offset:2048 lds
    buffer_load_dwordx4 v10, s[20:23], s33 offen offset:3072 lds
    s_lshl_b32 s32, s24, 3
    s_add_u32 s32, s32, s51
    s_add_u32 m0, s24, 49152
    s_add_u32 s33, s32, 0
    buffer_load_dwordx4 v8, s[96:99], s33 offen lds
    s_add_u32 m0, s24, 50176
    s_add_u32 s33, s32, 8192
    buffer_load_dwordx4 v9, s[96:99], s33 offen lds
    s_add_u32 m0, s24, 51200
    s_add_u32 s33, s32, 16384
    buffer_load_dwordx4 v8, s[96:99], s33 offen lds
    s_add_u32 m0, s24, 52224
    s_add_u32 s33, s32, 24576
    buffer_load_dwordx4 v9, s[96:99], s33 offen lds
    s_add_u32 s1, s1, 1
    s_cmp_eq_u32 s1, 28
    s_cselect_b32 s1, 0, s1

    s_add_u32 s33, s1, 2
    s_cmp_eq_u32 s1, s4
    s_cselect_b32 s1, s33, s1
    s_cmp_eq_u32 s1, 28
    s_cselect_b32 s1, 0, s1

    s_lshl_b32 s50, s1, 14
    s_lshl_b32 s51, s1, 17
    s_add_u32 s50, s50, s48
    s_add_u32 s51, s51, s0

    s_waitcnt vmcnt(16) lgkmcnt(0)
    s_barrier
    s_lshl_b32 s37, s1, 1
    s_add_u32 s37, s37, s47
    s_bitcmp1_b64 s[38:39], s37
    s_cbranch_scc1 M_hc_19_ok
    s_mov_b32 s90, 0
M_hc_19:
    buffer_load_dword v27, v25, s[20:23], s49 offen sc1
    s_add_u32 s90, s90, 1
    s_waitcnt vmcnt(0)
    v_cmp_le_u32 vcc, 1, v27
    s_mov_b64 s[38:39], vcc
    s_bitcmp1_b64 s[38:39], s37
    s_cbranch_scc1 M_hc_19_ok
    s_sleep 4
    s_cmp_lt_u32 s90, 0x10000
    s_cbranch_scc1 M_hc_19
M_hc_19_ok:

    s_add_u32 m0, s24, 65536
    s_add_u32 s33, s50, s24
    buffer_load_dwordx4 v10, s[20:23], s33 offen offset:0 lds
    buffer_load_dwordx4 v10, s[20:23], s33 offen offset:1024 lds
    buffer_load_dwordx4 v10, s[20:23], s33 offen offset:2048 lds
    buffer_load_dwordx4 v10, s[20:23], s33 offen offset:3072 lds
    s_lshl_b32 s32, s24, 3
    s_add_u32 s32, s32, s51
    s_add_u32 m0, s24, 81920
    s_add_u32 s33, s32, 0
    buffer_load_dwordx4 v8, s[96:99], s33 offen lds
    s_add_u32 m0, s24, 82944
    s_add_u32 s33, s32, 8192
    buffer_load_dwordx4 v9, s[96:99], s33 offen lds
    s_add_u32 m0, s24, 83968
    s_add_u32 s33, s32, 16384
    buffer_load_dwordx4 v8, s[96:99], s33 offen lds
    s_add_u32 m0, s24, 84992
    s_add_u32 s33, s32, 24576
    buffer_load_dwordx4 v9, s[96:99], s33 offen lds
    s_add_u32 s1, s1, 1
    s_lshl_b32 s50, s1, 14
    s_lshl_b32 s51, s1, 17
    s_add_u32 s50, s50, s48
    s_add_u32 s51, s51, s0

    s_waitcnt vmcnt(16) lgkmcnt(0)
    s_barrier
    s_lshl_b32 s37, s1, 1
    s_add_u32 s37, s37, s47
    s_bitcmp1_b64 s[38:39], s37
    s_cbranch_scc1 M_hc_20_ok
    s_mov_b32 s90, 0
M_hc_20:
    buffer_load_dword v27, v25, s[20:23], s49 offen sc1
    s_add_u32 s90, s90, 1
    s_waitcnt vmcnt(0)
    v_cmp_le_u32 vcc, 1, v27
    s_mov_b64 s[38:39], vcc
    s_bitcmp1_b64 s[38:39], s37
    s_cbranch_scc1 M_hc_20_ok
    s_sleep 4
    s_cmp_lt_u32 s90, 0x10000
    s_cbranch_scc1 M_hc_20
M_hc_20_ok:

    s_add_u32 m0, s24, 98304
    s_add_u32 s33, s50, s24
    buffer_load_dwordx4 v10, s[20:23], s33 offen offset:0 lds
    buffer_load_dwordx4 v10, s[20:23], s33 offen offset:1024 lds
    buffer_load_dwordx4 v10, s[20:23], s33 offen offset:2048 lds
    buffer_load_dwordx4 v10, s[20:23], s33 offen offset:3072 lds
    s_lshl_b32 s32, s24, 3
    s_add_u32 s32, s32, s51
    s_add_u32 m0, s24, 114688
    s_add_u32 s33, s32, 0
    buffer_load_dwordx4 v8, s[96:99], s33 offen lds
    s_add_u32 m0, s24, 115712
    s_add_u32 s33, s32, 8192
    buffer_load_dwordx4 v9, s[96:99], s33 offen lds
    s_add_u32 m0, s24, 116736
    s_add_u32 s33, s32, 16384
    buffer_load_dwordx4 v8, s[96:99], s33 offen lds
    s_add_u32 m0, s24, 117760
    s_add_u32 s33, s32, 24576
    buffer_load_dwordx4 v9, s[96:99], s33 offen lds
    s_add_u32 s1, s1, 1
    s_cmp_eq_u32 s1, 28
    s_cselect_b32 s1, 0, s1

    s_add_u32 s33, s1, 2
    s_cmp_eq_u32 s1, s4
    s_cselect_b32 s1, s33, s1
    s_cmp_eq_u32 s1, 28
    s_cselect_b32 s1, 0, s1

    s_lshl_b32 s50, s1, 14
    s_lshl_b32 s51, s1, 17
    s_add_u32 s50, s50, s48
    s_add_u32 s51, s51, s0

    s_waitcnt vmcnt(16) lgkmcnt(0)
    s_barrier
    s_lshl_b32 s37, s1, 1
    s_add_u32 s37, s37, s47
    s_bitcmp1_b64 s[38:39], s37
    s_cbranch_scc1 M_hc_21_ok
    s_mov_b32 s90, 0
M_hc_21:
    buffer_load_dword v27, v25, s[20:23], s49 offen sc1
    s_add_u32 s90, s90, 1
    s_waitcnt vmcnt(0)
    v_cmp_le_u32 vcc, 1, v27
    s_mov_b64 s[38:39], vcc
    s_bitcmp1_b64 s[38:39], s37
    s_cbranch_scc1 M_hc_21_ok
    s_sleep 4
    s_cmp_lt_u32 s90, 0x10000
    s_cbranch_scc1 M_hc_21
M_hc_21_ok:

    s_add_u32 m0, s24, 0
    s_add_u32 s33, s50, s24
    buffer_load_dwordx4 v10, s[20:23], s33 offen offset:0 lds
    buffer_load_dwordx4 v10, s[20:23], s33 offen offset:1024 lds
    buffer_load_dwordx4 v10, s[20:23], s33 offen offset:2048 lds
    buffer_load_dwordx4 v10, s[20:23], s33 offen offset:3072 lds
    s_lshl_b32 s32, s24, 3
    s_add_u32 s32, s32, s51
    s_add_u32 m0, s24, 16384
    s_add_u32 s33, s32, 0
    buffer_load_dwordx4 v8, s[96:99], s33 offen lds
    s_add_u32 m0, s24, 17408
    s_add_u32 s33, s32, 8192
    buffer_load_dwordx4 v9, s[96:99], s33 offen lds
    s_add_u32 m0, s24, 18432
    s_add_u32 s33, s32, 16384
    buffer_load_dwordx4 v8, s[96:99], s33 offen lds
    s_add_u32 m0, s24, 19456
    s_add_u32 s33, s32, 24576
    buffer_load_dwordx4 v9, s[96:99], s33 offen lds
    s_add_u32 s1, s1, 1
    s_lshl_b32 s50, s1, 14
    s_lshl_b32 s51, s1, 17
    s_add_u32 s50, s50, s48
    s_add_u32 s51, s51, s0

    s_waitcnt vmcnt(16) lgkmcnt(0)
    s_barrier
    s_lshl_b32 s37, s1, 1
    s_add_u32 s37, s37, s47
    s_bitcmp1_b64 s[38:39], s37
    s_cbranch_scc1 M_hc_22_ok
    s_mov_b32 s90, 0
M_hc_22:
    buffer_load_dword v27, v25, s[20:23], s49 offen sc1
    s_add_u32 s90, s90, 1
    s_waitcnt vmcnt(0)
    v_cmp_le_u32 vcc, 1, v27
    s_mov_b64 s[38:39], vcc
    s_bitcmp1_b64 s[38:39], s37
    s_cbranch_scc1 M_hc_22_ok
    s_sleep 4
    s_cmp_lt_u32 s90, 0x10000
    s_cbranch_scc1 M_hc_22
M_hc_22_ok:

    s_add_u32 m0, s24, 32768
    s_add_u32 s33, s50, s24
    buffer_load_dwordx4 v10, s[20:23], s33 offen offset:0 lds
    buffer_load_dwordx4 v10, s[20:23], s33 offen offset:1024 lds
    buffer_load_dwordx4 v10, s[20:23], s33 offen offset:2048 lds
    buffer_load_dwordx4 v10, s[20:23], s33 offen offset:3072 lds
    s_lshl_b32 s32, s24, 3
    s_add_u32 s32, s32, s51
    s_add_u32 m0, s24, 49152
    s_add_u32 s33, s32, 0
    buffer_load_dwordx4 v8, s[96:99], s33 offen lds
    s_add_u32 m0, s24, 50176
    s_add_u32 s33, s32, 8192
    buffer_load_dwordx4 v9, s[96:99], s33 offen lds
    s_add_u32 m0, s24, 51200
    s_add_u32 s33, s32, 16384
    buffer_load_dwordx4 v8, s[96:99], s33 offen lds
    s_add_u32 m0, s24, 52224
    s_add_u32 s33, s32, 24576
    buffer_load_dwordx4 v9, s[96:99], s33 offen lds
    s_add_u32 s1, s1, 1
    s_cmp_eq_u32 s1, 28
    s_cselect_b32 s1, 0, s1

    s_add_u32 s33, s1, 2
    s_cmp_eq_u32 s1, s4
    s_cselect_b32 s1, s33, s1
    s_cmp_eq_u32 s1, 28
    s_cselect_b32 s1, 0, s1

    s_lshl_b32 s50, s1, 14
    s_lshl_b32 s51, s1, 17
    s_add_u32 s50, s50, s48
    s_add_u32 s51, s51, s0

    s_waitcnt vmcnt(16) lgkmcnt(0)
    s_barrier
    s_lshl_b32 s37, s1, 1
    s_add_u32 s37, s37, s47
    s_bitcmp1_b64 s[38:39], s37
    s_cbranch_scc1 M_hc_23_ok
    s_mov_b32 s90, 0
M_hc_23:
    buffer_load_dword v27, v25, s[20:23], s49 offen sc1
    s_add_u32 s90, s90, 1
    s_waitcnt vmcnt(0)
    v_cmp_le_u32 vcc, 1, v27
    s_mov_b64 s[38:39], vcc
    s_bitcmp1_b64 s[38:39], s37
    s_cbranch_scc1 M_hc_23_ok
    s_sleep 4
    s_cmp_lt_u32 s90, 0x10000
    s_cbranch_scc1 M_hc_23
M_hc_23_ok:

    s_add_u32 m0, s24, 65536
    s_add_u32 s33, s50, s24
    buffer_load_dwordx4 v10, s[20:23], s33 offen offset:0 lds
    buffer_load_dwordx4 v10, s[20:23], s33 offen offset:1024 lds
    buffer_load_dwordx4 v10, s[20:23], s33 offen offset:2048 lds
    buffer_load_dwordx4 v10, s[20:23], s33 offen offset:3072 lds
    s_lshl_b32 s32, s24, 3
    s_add_u32 s32, s32, s51
    s_add_u32 m0, s24, 81920
    s_add_u32 s33, s32, 0
    buffer_load_dwordx4 v8, s[96:99], s33 offen lds
    s_add_u32 m0, s24, 82944
    s_add_u32 s33, s32, 8192
    buffer_load_dwordx4 v9, s[96:99], s33 offen lds
    s_add_u32 m0, s24, 83968
    s_add_u32 s33, s32, 16384
    buffer_load_dwordx4 v8, s[96:99], s33 offen lds
    s_add_u32 m0, s24, 84992
    s_add_u32 s33, s32, 24576
    buffer_load_dwordx4 v9, s[96:99], s33 offen lds
    s_add_u32 s1, s1, 1
    s_lshl_b32 s50, s1, 14
    s_lshl_b32 s51, s1, 17
    s_add_u32 s50, s50, s48
    s_add_u32 s51, s51, s0

    s_waitcnt vmcnt(16) lgkmcnt(0)
    s_barrier
    s_lshl_b32 s37, s1, 1
    s_add_u32 s37, s37, s47
    s_bitcmp1_b64 s[38:39], s37
    s_cbranch_scc1 M_hc_24_ok
    s_mov_b32 s90, 0
M_hc_24:
    buffer_load_dword v27, v25, s[20:23], s49 offen sc1
    s_add_u32 s90, s90, 1
    s_waitcnt vmcnt(0)
    v_cmp_le_u32 vcc, 1, v27
    s_mov_b64 s[38:39], vcc
    s_bitcmp1_b64 s[38:39], s37
    s_cbranch_scc1 M_hc_24_ok
    s_sleep 4
    s_cmp_lt_u32 s90, 0x10000
    s_cbranch_scc1 M_hc_24
M_hc_24_ok:

    s_add_u32 m0, s24, 98304
    s_add_u32 s33, s50, s24
    buffer_load_dwordx4 v10, s[20:23], s33 offen offset:0 lds
    buffer_load_dwordx4 v10, s[20:23], s33 offen offset:1024 lds
    buffer_load_dwordx4 v10, s[20:23], s33 offen offset:2048 lds
    buffer_load_dwordx4 v10, s[20:23], s33 offen offset:3072 lds
    s_lshl_b32 s32, s24, 3
    s_add_u32 s32, s32, s51
    s_add_u32 m0, s24, 114688
    s_add_u32 s33, s32, 0
    buffer_load_dwordx4 v8, s[96:99], s33 offen lds
    s_add_u32 m0, s24, 115712
    s_add_u32 s33, s32, 8192
    buffer_load_dwordx4 v9, s[96:99], s33 offen lds
    s_add_u32 m0, s24, 116736
    s_add_u32 s33, s32, 16384
    buffer_load_dwordx4 v8, s[96:99], s33 offen lds
    s_add_u32 m0, s24, 117760
    s_add_u32 s33, s32, 24576
    buffer_load_dwordx4 v9, s[96:99], s33 offen lds
    s_add_u32 s1, s1, 1
    s_cmp_eq_u32 s1, 28
    s_cselect_b32 s1, 0, s1

    s_add_u32 s33, s1, 2
    s_cmp_eq_u32 s1, s4
    s_cselect_b32 s1, s33, s1
    s_cmp_eq_u32 s1, 28
    s_cselect_b32 s1, 0, s1

    s_lshl_b32 s50, s1, 14
    s_lshl_b32 s51, s1, 17
    s_add_u32 s50, s50, s48
    s_add_u32 s51, s51, s0

    s_waitcnt vmcnt(16) lgkmcnt(0)
    s_barrier
    s_lshl_b32 s37, s1, 1
    s_add_u32 s37, s37, s47
    s_bitcmp1_b64 s[38:39], s37
    s_cbranch_scc1 M_hc_25_ok
    s_mov_b32 s90, 0
M_hc_25:
    buffer_load_dword v27, v25, s[20:23], s49 offen sc1
    s_add_u32 s90, s90, 1
    s_waitcnt vmcnt(0)
    v_cmp_le_u32 vcc, 1, v27
    s_mov_b64 s[38:39], vcc
    s_bitcmp1_b64 s[38:39], s37
    s_cbranch_scc1 M_hc_25_ok
    s_sleep 4
    s_cmp_lt_u32 s90, 0x10000
    s_cbranch_scc1 M_hc_25
M_hc_25_ok:

    s_add_u32 m0, s24, 0
    s_add_u32 s33, s50, s24
    buffer_load_dwordx4 v10, s[20:23], s33 offen offset:0 lds
    buffer_load_dwordx4 v10, s[20:23], s33 offen offset:1024 lds
    buffer_load_dwordx4 v10, s[20:23], s33 offen offset:2048 lds
    buffer_load_dwordx4 v10, s[20:23], s33 offen offset:3072 lds
    s_lshl_b32 s32, s24, 3
    s_add_u32 s32, s32, s51
    s_add_u32 m0, s24, 16384
    s_add_u32 s33, s32, 0
    buffer_load_dwordx4 v8, s[96:99], s33 offen lds
    s_add_u32 m0, s24, 17408
    s_add_u32 s33, s32, 8192
    buffer_load_dwordx4 v9, s[96:99], s33 offen lds
    s_add_u32 m0, s24, 18432
    s_add_u32 s33, s32, 16384
    buffer_load_dwordx4 v8, s[96:99], s33 offen lds
    s_add_u32 m0, s24, 19456
    s_add_u32 s33, s32, 24576
    buffer_load_dwordx4 v9, s[96:99], s33 offen lds
    s_add_u32 s1, s1, 1
    s_lshl_b32 s50, s1, 14
    s_lshl_b32 s51, s1, 17
    s_add_u32 s50, s50, s48
    s_add_u32 s51, s51, s0

    s_waitcnt vmcnt(16) lgkmcnt(0)
    s_barrier
    s_lshl_b32 s37, s1, 1
    s_add_u32 s37, s37, s47
    s_bitcmp1_b64 s[38:39], s37
    s_cbranch_scc1 M_hc_26_ok
    s_mov_b32 s90, 0
M_hc_26:
    buffer_load_dword v27, v25, s[20:23], s49 offen sc1
    s_add_u32 s90, s90, 1
    s_waitcnt vmcnt(0)
    v_cmp_le_u32 vcc, 1, v27
    s_mov_b64 s[38:39], vcc
    s_bitcmp1_b64 s[38:39], s37
    s_cbranch_scc1 M_hc_26_ok
    s_sleep 4
    s_cmp_lt_u32 s90, 0x10000
    s_cbranch_scc1 M_hc_26
M_hc_26_ok:

    s_add_u32 m0, s24, 32768
    s_add_u32 s33, s50, s24
    buffer_load_dwordx4 v10, s[20:23], s33 offen offset:0 lds
    buffer_load_dwordx4 v10, s[20:23], s33 offen offset:1024 lds
    buffer_load_dwordx4 v10, s[20:23], s33 offen offset:2048 lds
    buffer_load_dwordx4 v10, s[20:23], s33 offen offset:3072 lds
    s_lshl_b32 s32, s24, 3
    s_add_u32 s32, s32, s51
    s_add_u32 m0, s24, 49152
    s_add_u32 s33, s32, 0
    buffer_load_dwordx4 v8, s[96:99], s33 offen lds
    s_add_u32 m0, s24, 50176
    s_add_u32 s33, s32, 8192
    buffer_load_dwordx4 v9, s[96:99], s33 offen lds
    s_add_u32 m0, s24, 51200
    s_add_u32 s33, s32, 16384
    buffer_load_dwordx4 v8, s[96:99], s33 offen lds
    s_add_u32 m0, s24, 52224
    s_add_u32 s33, s32, 24576
    buffer_load_dwordx4 v9, s[96:99], s33 offen lds
    s_add_u32 s1, s1, 1
    s_cmp_eq_u32 s1, 28
    s_cselect_b32 s1, 0, s1

    s_add_u32 s33, s1, 2
    s_cmp_eq_u32 s1, s4
    s_cselect_b32 s1, s33, s1
    s_cmp_eq_u32 s1, 28
    s_cselect_b32 s1, 0, s1

    s_lshl_b32 s50, s1, 14
    s_lshl_b32 s51, s1, 17
    s_add_u32 s50, s50, s48
    s_add_u32 s51, s51, s0

    buffer_load_dword v41, v40, s[92:95], 0 offen offset:32 sc1
    s_waitcnt vmcnt(17) lgkmcnt(0)
    s_barrier
    s_lshl_b32 s37, s1, 1
    s_add_u32 s37, s37, s47
    s_bitcmp1_b64 s[38:39], s37
    s_cbranch_scc1 M_hc_27_ok
    s_mov_b32 s90, 0
M_hc_27:
    buffer_load_dword v27, v25, s[20:23], s49 offen sc1
    s_add_u32 s90, s90, 1
    s_waitcnt vmcnt(0)
    v_cmp_le_u32 vcc, 1, v27
    s_mov_b64 s[38:39], vcc
    s_bitcmp1_b64 s[38:39], s37
    s_cbranch_scc1 M_hc_27_ok
    s_sleep 4
    s_cmp_lt_u32 s90, 0x10000
    s_cbranch_scc1 M_hc_27
M_hc_27_ok:

    s_add_u32 m0, s24, 65536
    s_add_u32 s33, s50, s24
    buffer_load_dwordx4 v10, s[20:23], s33 offen offset:0 lds
    buffer_load_dwordx4 v10, s[20:23], s33 offen offset:1024 lds
    buffer_load_dwordx4 v10, s[20:23], s33 offen offset:2048 lds
    buffer_load_dwordx4 v10, s[20:23], s33 offen offset:3072 lds
    s_lshl_b32 s32, s24, 3
    s_add_u32 s32, s32, s51
    s_add_u32 m0, s24, 81920
    s_add_u32 s33, s32, 0
    buffer_load_dwordx4 v8, s[96:99], s33 offen lds
    s_add_u32 m0, s24, 82944
    s_add_u32 s33, s32, 8192
    buffer_load_dwordx4 v9, s[96:99], s33 offen lds
    s_add_u32 m0, s24, 83968
    s_add_u32 s33, s32, 16384
    buffer_load_dwordx4 v8, s[96:99], s33 offen lds
    s_add_u32 m0, s24, 84992
    s_add_u32 s33, s32, 24576
    buffer_load_dwordx4 v9, s[96:99], s33 offen lds
    s_add_u32 s1, s1, 1
    s_lshl_b32 s50, s1, 14
    s_lshl_b32 s51, s1, 17
    s_add_u32 s50, s50, s48
    s_add_u32 s51, s51, s0

    s_waitcnt vmcnt(17) lgkmcnt(0)
    s_barrier
    s_lshl_b32 s37, s1, 1
    s_add_u32 s37, s37, s47
    s_bitcmp1_b64 s[38:39], s37
    s_cbranch_scc1 M_hc_28_ok
    s_mov_b32 s90, 0
M_hc_28:
    buffer_load_dword v27, v25, s[20:23], s49 offen sc1
    s_add_u32 s90, s90, 1
    s_waitcnt vmcnt(0)
    v_cmp_le_u32 vcc, 1, v27
    s_mov_b64 s[38:39], vcc
    s_bitcmp1_b64 s[38:39], s37
    s_cbranch_scc1 M_hc_28_ok
    s_sleep 4
    s_cmp_lt_u32 s90, 0x10000
    s_cbranch_scc1 M_hc_28
M_hc_28_ok:

    s_add_u32 m0, s24, 98304
    s_add_u32 s33, s50, s24
    buffer_load_dwordx4 v10, s[20:23], s33 offen offset:0 lds
    buffer_load_dwordx4 v10, s[20:23], s33 offen offset:1024 lds
    buffer_load_dwordx4 v10, s[20:23], s33 offen offset:2048 lds
    buffer_load_dwordx4 v10, s[20:23], s33 offen offset:3072 lds
    s_lshl_b32 s32, s24, 3
    s_add_u32 s32, s32, s51
    s_add_u32 m0, s24, 114688
    s_add_u32 s33, s32, 0
    buffer_load_dwordx4 v8, s[96:99], s33 offen lds
    s_add_u32 m0, s24, 115712
    s_add_u32 s33, s32, 8192
    buffer_load_dwordx4 v9, s[96:99], s33 offen lds
    s_add_u32 m0, s24, 116736
    s_add_u32 s33, s32, 16384
    buffer_load_dwordx4 v8, s[96:99], s33 offen lds
    s_add_u32 m0, s24, 117760
    s_add_u32 s33, s32, 24576
    buffer_load_dwordx4 v9, s[96:99], s33 offen lds
    s_add_u32 s1, s1, 1
    s_cmp_eq_u32 s1, 28
    s_cselect_b32 s1, 0, s1

    s_add_u32 s33, s1, 2
    s_cmp_eq_u32 s1, s4
    s_cselect_b32 s1, s33, s1
    s_cmp_eq_u32 s1, 28
    s_cselect_b32 s1, 0, s1

    s_lshl_b32 s50, s1, 14
    s_lshl_b32 s51, s1, 17
    s_add_u32 s50, s50, s48
    s_add_u32 s51, s51, s0

    s_waitcnt vmcnt(16) lgkmcnt(0)
    s_barrier
    s_lshl_b32 s37, s1, 1
    s_add_u32 s37, s37, s47
    s_bitcmp1_b64 s[38:39], s37
    s_cbranch_scc1 M_hc_29_ok
    s_mov_b32 s90, 0
M_hc_29:
    buffer_load_dword v27, v25, s[20:23], s49 offen sc1
    s_add_u32 s90, s90, 1
    s_waitcnt vmcnt(0)
    v_cmp_le_u32 vcc, 1, v27
    s_mov_b64 s[38:39], vcc
    s_bitcmp1_b64 s[38:39], s37
    s_cbranch_scc1 M_hc_29_ok
    s_sleep 4
    s_cmp_lt_u32 s90, 0x10000
    s_cbranch_scc1 M_hc_29
M_hc_29_ok:

    s_add_u32 m0, s24, 0
    s_add_u32 s33, s50, s24
    buffer_load_dwordx4 v10, s[20:23], s33 offen offset:0 lds
    buffer_load_dwordx4 v10, s[20:23], s33 offen offset:1024 lds
    buffer_load_dwordx4 v10, s[20:23], s33 offen offset:2048 lds
    buffer_load_dwordx4 v10, s[20:23], s33 offen offset:3072 lds
    s_lshl_b32 s32, s24, 3
    s_add_u32 s32, s32, s51
    s_add_u32 m0, s24, 16384
    s_add_u32 s33, s32, 0
    buffer_load_dwordx4 v8, s[96:99], s33 offen lds
    s_add_u32 m0, s24, 17408
    s_add_u32 s33, s32, 8192
    buffer_load_dwordx4 v9, s[96:99], s33 offen lds
    s_add_u32 m0, s24, 18432
    s_add_u32 s33, s32, 16384
    buffer_load_dwordx4 v8, s[96:99], s33 offen lds
    s_add_u32 m0, s24, 19456
    s_add_u32 s33, s32, 24576
    buffer_load_dwordx4 v9, s[96:99], s33 offen lds
    s_add_u32 s1, s1, 1
    s_lshl_b32 s50, s1, 14
    s_lshl_b32 s51, s1, 17
    s_add_u32 s50, s50, s48
    s_add_u32 s51, s51, s0

    v_cmp_le_u32 vcc, 64, v41
    s_cmp_eq_u64 vcc, -1
    s_cbranch_scc1 M_wz_ok
    v_add_u32 v40, 32, v40

    s_mov_b32 s90, 0
M_wz:
    buffer_load_dword v41, v40, s[92:95], 0 offen sc1
    s_add_u32 s90, s90, 1
    s_waitcnt vmcnt(0)
    v_cmp_le_u32 vcc, 64, v41
    s_cmp_eq_u64 vcc, -1
    s_cbranch_scc1 M_wz_ok
    s_sleep 8
    s_cmp_lt_u32 s90, 0x10000
    s_cbranch_scc1 M_wz
M_wz_ok:

    s_lshl_b32 s32, s2, 14
    s_add_u32 s32, s32, s24
    s_add_u32 m0, s24, 131072
    s_add_u32 s32, s32, 27262976

    buffer_load_dwordx4 v36, s[20:23], s32 offen offset:0 lds
    buffer_load_dwordx4 v37, s[20:23], s32 offen offset:1024 lds
    buffer_load_dwordx4 v38, s[20:23], s32 offen offset:2048 lds
    buffer_load_dwordx4 v39, s[20:23], s32 offen offset:3072 lds
    s_waitcnt vmcnt(20) lgkmcnt(0)
    s_barrier
    s_lshl_b32 s37, s1, 1
    s_add_u32 s37, s37, s47
    s_bitcmp1_b64 s[38:39], s37
    s_cbranch_scc1 M_hc_30_ok
    s_mov_b32 s90, 0
M_hc_30:
    buffer_load_dword v27, v25, s[20:23], s49 offen sc1
    s_add_u32 s90, s90, 1
    s_waitcnt vmcnt(0)
    v_cmp_le_u32 vcc, 1, v27
    s_mov_b64 s[38:39], vcc
    s_bitcmp1_b64 s[38:39], s37
    s_cbranch_scc1 M_hc_30_ok
    s_sleep 4
    s_cmp_lt_u32 s90, 0x10000
    s_cbranch_scc1 M_hc_30
M_hc_30_ok:

    s_add_u32 m0, s24, 32768
    s_add_u32 s33, s50, s24
    buffer_load_dwordx4 v10, s[20:23], s33 offen offset:0 lds
    buffer_load_dwordx4 v10, s[20:23], s33 offen offset:1024 lds
    buffer_load_dwordx4 v10, s[20:23], s33 offen offset:2048 lds
    buffer_load_dwordx4 v10, s[20:23], s33 offen offset:3072 lds
    s_lshl_b32 s32, s24, 3
    s_add_u32 s32, s32, s51
    s_add_u32 m0, s24, 49152
    s_add_u32 s33, s32, 0
    buffer_load_dwordx4 v8, s[96:99], s33 offen lds
    s_add_u32 m0, s24, 50176
    s_add_u32 s33, s32, 8192
    buffer_load_dwordx4 v9, s[96:99], s33 offen lds
    s_add_u32 m0, s24, 51200
    s_add_u32 s33, s32, 16384
    buffer_load_dwordx4 v8, s[96:99], s33 offen lds
    s_add_u32 m0, s24, 52224
    s_add_u32 s33, s32, 24576
    buffer_load_dwordx4 v9, s[96:99], s33 offen lds
    s_add_u32 s1, s1, 1
    s_cmp_eq_u32 s1, 28
    s_cselect_b32 s1, 0, s1

    s_add_u32 s33, s1, 2
    s_cmp_eq_u32 s1, s4
    s_cselect_b32 s1, s33, s1
    s_cmp_eq_u32 s1, 28
    s_cselect_b32 s1, 0, s1

    s_lshl_b32 s50, s1, 14
    s_lshl_b32 s51, s1, 17
    s_add_u32 s50, s50, s48
    s_add_u32 s51, s51, s0

    s_waitcnt vmcnt(20) lgkmcnt(0)
    s_barrier
    s_lshl_b32 s37, s1, 1
    s_add_u32 s37, s37, s47
    s_bitcmp1_b64 s[38:39], s37
    s_cbranch_scc1 M_hc_31_ok
    s_mov_b32 s90, 0
M_hc_31:
    buffer_load_dword v27, v25, s[20:23], s49 offen sc1
    s_add_u32 s90, s90, 1
    s_waitcnt vmcnt(0)
    v_cmp_le_u32 vcc, 1, v27
    s_mov_b64 s[38:39], vcc
    s_bitcmp1_b64 s[38:39], s37
    s_cbranch_scc1 M_hc_31_ok
    s_sleep 4
    s_cmp_lt_u32 s90, 0x10000
    s_cbranch_scc1 M_hc_31
M_hc_31_ok:

    s_add_u32 m0, s24, 65536
    s_add_u32 s33, s50, s24
    buffer_load_dwordx4 v10, s[20:23], s33 offen offset:0 lds
    buffer_load_dwordx4 v10, s[20:23], s33 offen offset:1024 lds
    buffer_load_dwordx4 v10, s[20:23], s33 offen offset:2048 lds
    buffer_load_dwordx4 v10, s[20:23], s33 offen offset:3072 lds
    s_lshl_b32 s32, s24, 3
    s_add_u32 s32, s32, s51
    s_add_u32 m0, s24, 81920
    s_add_u32 s33, s32, 0
    buffer_load_dwordx4 v8, s[96:99], s33 offen lds
    s_add_u32 m0, s24, 82944
    s_add_u32 s33, s32, 8192
    buffer_load_dwordx4 v9, s[96:99], s33 offen lds
    s_add_u32 m0, s24, 83968
    s_add_u32 s33, s32, 16384
    buffer_load_dwordx4 v8, s[96:99], s33 offen lds
    s_add_u32 m0, s24, 84992
    s_add_u32 s33, s32, 24576
    buffer_load_dwordx4 v9, s[96:99], s33 offen lds
    s_add_u32 s1, s1, 1
    s_lshl_b32 s50, s1, 14
    s_lshl_b32 s51, s1, 17
    s_add_u32 s50, s50, s48
    s_add_u32 s51, s51, s0

    s_waitcnt vmcnt(16) lgkmcnt(0)
    s_barrier
    s_lshl_b32 s37, s1, 1
    s_add_u32 s37, s37, s47
    s_bitcmp1_b64 s[38:39], s37
    s_cbranch_scc1 M_hc_32_ok
    s_mov_b32 s90, 0
M_hc_32:
    buffer_load_dword v27, v25, s[20:23], s49 offen sc1
    s_add_u32 s90, s90, 1
    s_waitcnt vmcnt(0)
    v_cmp_le_u32 vcc, 1, v27
    s_mov_b64 s[38:39], vcc
    s_bitcmp1_b64 s[38:39], s37
    s_cbranch_scc1 M_hc_32_ok
    s_sleep 4
    s_cmp_lt_u32 s90, 0x10000
    s_cbranch_scc1 M_hc_32
M_hc_32_ok:

    s_add_u32 m0, s24, 98304
    s_add_u32 s33, s50, s24
    buffer_load_dwordx4 v10, s[20:23], s33 offen offset:0 lds
    buffer_load_dwordx4 v10, s[20:23], s33 offen offset:1024 lds
    buffer_load_dwordx4 v10, s[20:23], s33 offen offset:2048 lds
    buffer_load_dwordx4 v10, s[20:23], s33 offen offset:3072 lds
    s_lshl_b32 s32, s24, 3
    s_add_u32 s32, s32, s51
    s_add_u32 m0, s24, 114688
    s_add_u32 s33, s32, 0
    buffer_load_dwordx4 v8, s[96:99], s33 offen lds
    s_add_u32 m0, s24, 115712
    s_add_u32 s33, s32, 8192
    buffer_load_dwordx4 v9, s[96:99], s33 offen lds
    s_add_u32 m0, s24, 116736
    s_add_u32 s33, s32, 16384
    buffer_load_dwordx4 v8, s[96:99], s33 offen lds
    s_add_u32 m0, s24, 117760
    s_add_u32 s33, s32, 24576
    buffer_load_dwordx4 v9, s[96:99], s33 offen lds
    s_add_u32 s1, s1, 1
    s_cmp_eq_u32 s1, 28
    s_cselect_b32 s1, 0, s1

    s_add_u32 s33, s1, 2
    s_cmp_eq_u32 s1, s4
    s_cselect_b32 s1, s33, s1
    s_cmp_eq_u32 s1, 28
    s_cselect_b32 s1, 0, s1

    s_lshl_b32 s50, s1, 14
    s_lshl_b32 s51, s1, 17
    s_add_u32 s50, s50, s48
    s_add_u32 s51, s51, s0

    s_waitcnt vmcnt(16) lgkmcnt(0)
    s_barrier
    s_setprio 3
    ds_read_b64_tr_b16 v[80:81], v28 offset:0
    ds_read_b64_tr_b16 v[82:83], v29 offset:0
    ds_read_b64_tr_b16 v[84:85], v30 offset:0
    ds_read_b64_tr_b16 v[86:87], v31 offset:0
    ds_read_b64_tr_b16 v[88:89], v32 offset:0
    ds_read_b64_tr_b16 v[90:91], v33 offset:0
    ds_read_b64_tr_b16 v[92:93], v34 offset:0
    ds_read_b64_tr_b16 v[94:95], v35 offset:0
    ds_read_b64_tr_b16 v[96:97], v28 offset:512
    ds_read_b64_tr_b16 v[98:99], v29 offset:512
    ds_read_b64_tr_b16 v[100:101], v30 offset:512
    ds_read_b64_tr_b16 v[102:103], v31 offset:512
    ds_read_b64_tr_b16 v[104:105], v32 offset:512
    ds_read_b64_tr_b16 v[106:107], v33 offset:512
    ds_read_b64_tr_b16 v[108:109], v34 offset:512
    ds_read_b64_tr_b16 v[110:111], v35 offset:512
    ds_read_b64 v[48:49], v5 offset:16
    buffer_load_dwordx4 v[52:55], v20, s[20:23], s31 offen
    s_waitcnt lgkmcnt(15)
    v_mfma_f32_16x16x32_bf16 v[112:115], v[80:83], v[12:15], 0
    v_mfma_f32_16x16x32_bf16 v[116:119], v[80:83], v[16:19], 0
    s_waitcnt lgkmcnt(13)
    v_mfma_f32_16x16x32_bf16 v[120:123], v[84:87], v[12:15], 0
    v_mfma_f32_16x16x32_bf16 v[124:127], v[84:87], v[16:19], 0
    s_waitcnt lgkmcnt(11)
    v_mfma_f32_16x16x32_bf16 v[128:131], v[88:91], v[12:15], 0
    v_mfma_f32_16x16x32_bf16 v[132:135], v[88:91], v[16:19], 0
    s_waitcnt lgkmcnt(9)
    v_mfma_f32_16x16x32_bf16 v[136:139], v[92:95], v[12:15], 0
    v_mfma_f32_16x16x32_bf16 v[140:143], v[92:95], v[16:19], 0
    s_waitcnt lgkmcnt(7)
    v_mfma_f32_16x16x32_bf16 v[144:147], v[96:99], v[12:15], 0
    v_mfma_f32_16x16x32_bf16 v[148:151], v[96:99], v[16:19], 0
    s_waitcnt lgkmcnt(5)
    v_mfma_f32_16x16x32_bf16 v[152:155], v[100:103], v[12:15], 0
    v_mfma_f32_16x16x32_bf16 v[156:159], v[100:103], v[16:19], 0
    s_waitcnt lgkmcnt(3)
    v_mfma_f32_16x16x32_bf16 v[160:163], v[104:107], v[12:15], 0
    v_mfma_f32_16x16x32_bf16 v[164:167], v[104:107], v[16:19], 0
    s_waitcnt lgkmcnt(1)
    v_mfma_f32_16x16x32_bf16 v[168:171], v[108:111], v[12:15], 0
    v_mfma_f32_16x16x32_bf16 v[172:175], v[108:111], v[16:19], 0
    s_waitcnt lgkmcnt(0)
    v_lshlrev_b32 v208, 16, v48
    v_and_b32 v212, 0xffff0000, v48
    v_lshlrev_b32 v216, 16, v49
    v_and_b32 v220, 0xffff0000, v49
    v_xor_b32 v209, 0x80000000, v208
    v_mov_b32 v210, v208
    v_xor_b32 v211, 0x80000000, v208
    v_xor_b32 v213, 0x80000000, v212
    v_mov_b32 v214, v212
    v_xor_b32 v215, 0x80000000, v212
    v_xor_b32 v217, 0x80000000, v216
    v_mov_b32 v218, v216
    v_xor_b32 v219, 0x80000000, v216
    v_xor_b32 v221, 0x80000000, v220
    v_mov_b32 v222, v220
    v_xor_b32 v223, 0x80000000, v220
    v_mul_f32 v50, v112, v225
    v_mul_f32 v112, v112, v224
    v_fma_f32 v112, -v116, v225, v112
    v_fma_f32 v116, v116, v224, v50
    v_mul_f32 v51, v113, v225
    v_mul_f32 v113, v113, v224
    v_fma_f32 v113, -v117, v225, v113
    v_fma_f32 v117, v117, v224, v51
    v_mul_f32 v50, v114, v225
    v_mul_f32 v114, v114, v224
    v_fma_f32 v114, -v118, v225, v114
    v_fma_f32 v118, v118, v224, v50
    v_mul_f32 v51, v115, v225
    s_waitcnt vmcnt(9) lgkmcnt(0)
    s_barrier
    v_mul_f32 v115, v115, v224
    v_fma_f32 v115, -v119, v225, v115
    v_fma_f32 v119, v119, v224, v51
    v_mul_f32 v50, v120, v227
    v_mul_f32 v120, v120, v226
    v_fma_f32 v120, -v124, v227, v120
    v_fma_f32 v124, v124, v226, v50
    v_mul_f32 v51, v121, v227
    v_mul_f32 v121, v121, v226
    v_fma_f32 v121, -v125, v227, v121
    v_fma_f32 v125, v125, v226, v51
    v_mul_f32 v50, v122, v227
    v_mul_f32 v122, v122, v226
    v_fma_f32 v122, -v126, v227, v122
    v_fma_f32 v126, v126, v226, v50
    v_mul_f32 v51, v123, v227
    v_mul_f32 v123, v123, v226
    v_fma_f32 v123, -v127, v227, v123
    v_fma_f32 v127, v127, v226, v51
    v_cvt_pk_bf16_f32 v176, v112, v120
    v_cvt_pk_bf16_f32 v180, v116, v124
    v_cvt_pk_bf16_f32 v184, v113, v121
    v_cvt_pk_bf16_f32 v188, v117, v125
    v_cvt_pk_bf16_f32 v192, v114, v122
    v_cvt_pk_bf16_f32 v196, v118, v126
    v_cvt_pk_bf16_f32 v200, v115, v123
    v_cvt_pk_bf16_f32 v204, v119, v127
    v_mul_f32 v50, v128, v229
    v_mul_f32 v128, v128, v228
    v_fma_f32 v128, -v132, v229, v128
    v_fma_f32 v132, v132, v228, v50
    v_mul_f32 v51, v129, v229
    v_mul_f32 v129, v129, v228
    v_fma_f32 v129, -v133, v229, v129
    v_fma_f32 v133, v133, v228, v51
    v_mul_f32 v50, v130, v229
    v_mul_f32 v130, v130, v228
    v_fma_f32 v130, -v134, v229, v130
    v_fma_f32 v134, v134, v228, v50
    v_mul_f32 v51, v131, v229
    v_mul_f32 v131, v131, v228
    v_fma_f32 v131, -v135, v229, v131
    v_fma_f32 v135, v135, v228, v51
    v_mul_f32 v50, v136, v231
    v_mul_f32 v136, v136, v230
    v_fma_f32 v136, -v140, v231, v136
    v_fma_f32 v140, v140, v230, v50
    v_mul_f32 v51, v137, v231
    v_mul_f32 v137, v137, v230
    v_fma_f32 v137, -v141, v231, v137
    v_fma_f32 v141, v141, v230, v51
    v_mul_f32 v50, v138, v231
    v_mul_f32 v138, v138, v230
    v_fma_f32 v138, -v142, v231, v138
    v_fma_f32 v142, v142, v230, v50
    v_mul_f32 v51, v139, v231
    v_mul_f32 v139, v139, v230
    v_fma_f32 v139, -v143, v231, v139
    v_fma_f32 v143, v143, v230, v51
    v_cvt_pk_bf16_f32 v177, v128, v136
    v_cvt_pk_bf16_f32 v181, v132, v140
    v_cvt_pk_bf16_f32 v185, v129, v137
    v_cvt_pk_bf16_f32 v189, v133, v141
    v_cvt_pk_bf16_f32 v193, v130, v138
    v_cvt_pk_bf16_f32 v197, v134, v142
    v_cvt_pk_bf16_f32 v201, v131, v139
    v_cvt_pk_bf16_f32 v205, v135, v143
    v_mul_f32 v50, v144, v233
    v_mul_f32 v144, v144, v232
    v_fma_f32 v144, -v148, v233, v144
    v_fma_f32 v148, v148, v232, v50
    v_mul_f32 v51, v145, v233
    v_mul_f32 v145, v145, v232
    v_fma_f32 v145, -v149, v233, v145
    v_fma_f32 v149, v149, v232, v51
    v_mul_f32 v50, v146, v233
    v_mul_f32 v146, v146, v232
    v_fma_f32 v146, -v150, v233, v146
    v_fma_f32 v150, v150, v232, v50
    v_mul_f32 v51, v147, v233
    v_mul_f32 v147, v147, v232
    v_fma_f32 v147, -v151, v233, v147
    v_fma_f32 v151, v151, v232, v51
    v_mul_f32 v50, v152, v235
    v_mul_f32 v152, v152, v234
    v_fma_f32 v152, -v156, v235, v152
    v_fma_f32 v156, v156, v234, v50
    v_mul_f32 v51, v153, v235
    v_mul_f32 v153, v153, v234
    v_fma_f32 v153, -v157, v235, v153
    v_fma_f32 v157, v157, v234, v51
    v_mul_f32 v50, v154, v235
    v_mul_f32 v154, v154, v234
    v_fma_f32 v154, -v158, v235, v154
    v_fma_f32 v158, v158, v234, v50
    v_mul_f32 v51, v155, v235
    v_mul_f32 v155, v155, v234
    v_fma_f32 v155, -v159, v235, v155
    v_fma_f32 v159, v159, v234, v51
    v_cvt_pk_bf16_f32 v178, v144, v152
    v_cvt_pk_bf16_f32 v182, v148, v156
    v_cvt_pk_bf16_f32 v186, v145, v153
    v_cvt_pk_bf16_f32 v190, v149, v157
    v_cvt_pk_bf16_f32 v194, v146, v154
    v_cvt_pk_bf16_f32 v198, v150, v158
    v_cvt_pk_bf16_f32 v202, v147, v155
    v_cvt_pk_bf16_f32 v206, v151, v159
    v_mul_f32 v50, v160, v237
    v_mul_f32 v160, v160, v236
    v_fma_f32 v160, -v164, v237, v160
    v_fma_f32 v164, v164, v236, v50
    v_mul_f32 v51, v161, v237
    v_mul_f32 v161, v161, v236
    v_fma_f32 v161, -v165, v237, v161
    v_fma_f32 v165, v165, v236, v51
    v_mul_f32 v50, v162, v237
    v_mul_f32 v162, v162, v236
    v_fma_f32 v162, -v166, v237, v162
    v_fma_f32 v166, v166, v236, v50
    v_mul_f32 v51, v163, v237
    s_waitcnt vmcnt(1) lgkmcnt(0)
    s_barrier
    v_mul_f32 v163, v163, v236
    v_fma_f32 v163, -v167, v237, v163
    v_fma_f32 v167, v167, v236, v51
    v_mul_f32 v50, v168, v239
    v_mul_f32 v168, v168, v238
    v_fma_f32 v168, -v172, v239, v168
    v_fma_f32 v172, v172, v238, v50
    v_mul_f32 v51, v169, v239
    v_mul_f32 v169, v169, v238
    v_fma_f32 v169, -v173, v239, v169
    v_fma_f32 v173, v173, v238, v51
    v_mul_f32 v50, v170, v239
    v_mul_f32 v170, v170, v238
    v_fma_f32 v170, -v174, v239, v170
    v_fma_f32 v174, v174, v238, v50
    v_mul_f32 v51, v171, v239
    v_mul_f32 v171, v171, v238
    v_fma_f32 v171, -v175, v239, v171
    v_fma_f32 v175, v175, v238, v51
    v_cvt_pk_bf16_f32 v179, v160, v168
    v_cvt_pk_bf16_f32 v183, v164, v172
    v_cvt_pk_bf16_f32 v187, v161, v169
    v_cvt_pk_bf16_f32 v191, v165, v173
    v_cvt_pk_bf16_f32 v195, v162, v170
    v_cvt_pk_bf16_f32 v199, v166, v174
    v_cvt_pk_bf16_f32 v203, v163, v171
    v_cvt_pk_bf16_f32 v207, v167, v175
    s_nop 1
    v_mfma_f32_16x16x32_bf16 v[112:115], v[176:179], v[56:59], v[208:211]
    v_mfma_f32_16x16x32_bf16 v[116:119], v[176:179], v[60:63], v[208:211]
    v_mfma_f32_16x16x32_bf16 v[120:123], v[184:187], v[56:59], v[212:215]
    v_mfma_f32_16x16x32_bf16 v[124:127], v[184:187], v[60:63], v[212:215]
    v_mfma_f32_16x16x32_bf16 v[128:131], v[192:195], v[56:59], v[216:219]
    v_mfma_f32_16x16x32_bf16 v[132:135], v[192:195], v[60:63], v[216:219]
    v_mfma_f32_16x16x32_bf16 v[136:139], v[200:203], v[56:59], v[220:223]
    v_mfma_f32_16x16x32_bf16 v[140:143], v[200:203], v[60:63], v[220:223]
    v_mfma_f32_16x16x32_bf16 v[112:115], v[180:183], v[64:67], v[112:115]
    v_mfma_f32_16x16x32_bf16 v[116:119], v[180:183], v[68:71], v[116:119]
    v_mfma_f32_16x16x32_bf16 v[120:123], v[188:191], v[64:67], v[120:123]
    v_mfma_f32_16x16x32_bf16 v[124:127], v[188:191], v[68:71], v[124:127]
    v_mfma_f32_16x16x32_bf16 v[128:131], v[196:199], v[64:67], v[128:131]
    v_mfma_f32_16x16x32_bf16 v[132:135], v[196:199], v[68:71], v[132:135]
    v_mfma_f32_16x16x32_bf16 v[136:139], v[204:207], v[64:67], v[136:139]
    v_mfma_f32_16x16x32_bf16 v[140:143], v[204:207], v[68:71], v[140:143]
    s_waitcnt vmcnt(0)
    s_nop 3
    v_mul_f32 v112, v52, v112
    v_mul_f32 v113, v52, v113
    v_mul_f32 v114, v52, v114
    v_mul_f32 v115, v52, v115
    v_mul_f32 v116, v52, v116
    v_mul_f32 v117, v52, v117
    v_mul_f32 v118, v52, v118
    v_mul_f32 v119, v52, v119
    v_cvt_pk_bf16_f32 v80, v112, v113
    v_cvt_pk_bf16_f32 v81, v114, v115
    v_cvt_pk_bf16_f32 v82, v116, v117
    v_cvt_pk_bf16_f32 v83, v118, v119
    s_nop 1
    v_permlane16_swap_b32 v80, v82
    v_permlane16_swap_b32 v81, v83
    buffer_store_dwordx4 v[80:83], v2, s[20:23], s34 offen offset:0 sc1
    v_mul_f32 v120, v53, v120
    v_mul_f32 v121, v53, v121
    v_mul_f32 v122, v53, v122
    v_mul_f32 v123, v53, v123
    v_mul_f32 v124, v53, v124
    v_mul_f32 v125, v53, v125
    v_mul_f32 v126, v53, v126
    v_mul_f32 v127, v53, v127
    v_cvt_pk_bf16_f32 v84, v120, v121
    v_cvt_pk_bf16_f32 v85, v122, v123
    v_cvt_pk_bf16_f32 v86, v124, v125
    v_cvt_pk_bf16_f32 v87, v126, v127
    s_nop 1
    v_permlane16_swap_b32 v84, v86
    v_permlane16_swap_b32 v85, v87
    buffer_store_dwordx4 v[84:87], v2, s[20:23], s34 offen offset:2048 sc1
    v_mul_f32 v128, v54, v128
    v_mul_f32 v129, v54, v129
    v_mul_f32 v130, v54, v130
    v_mul_f32 v131, v54, v131
    v_mul_f32 v132, v54, v132
    v_mul_f32 v133, v54, v133
    v_mul_f32 v134, v54, v134
    v_mul_f32 v135, v54, v135
    v_cvt_pk_bf16_f32 v88, v128, v129
    v_cvt_pk_bf16_f32 v89, v130, v131
    v_cvt_pk_bf16_f32 v90, v132, v133
    v_cvt_pk_bf16_f32 v91, v134, v135
    s_nop 1
    v_permlane16_swap_b32 v88, v90
    v_permlane16_swap_b32 v89, v91
    buffer_store_dwordx4 v[88:91], v2, s[20:23], s35 offen offset:0 sc1
    v_mul_f32 v136, v55, v136
    v_mul_f32 v137, v55, v137
    v_mul_f32 v138, v55, v138
    v_mul_f32 v139, v55, v139
    v_mul_f32 v140, v55, v140
    v_mul_f32 v141, v55, v141
    v_mul_f32 v142, v55, v142
    v_mul_f32 v143, v55, v143
    v_cvt_pk_bf16_f32 v92, v136, v137
    v_cvt_pk_bf16_f32 v93, v138, v139
    v_cvt_pk_bf16_f32 v94, v140, v141
    v_cvt_pk_bf16_f32 v95, v142, v143
    s_nop 1
    v_permlane16_swap_b32 v92, v94
    v_permlane16_swap_b32 v93, v95
    buffer_store_dwordx4 v[92:95], v2, s[20:23], s35 offen offset:2048 sc1
    s_endpgm
M_comp:
    s_setprio 2
    s_and_b32 s24, s3, 1
    s_lshr_b32 s25, s3, 1
    s_lshl_b32 s30, s24, 12
    v_add_u32 v2, s30, v10
    v_add_u32 v3, 65536, v2
    v_lshrrev_b32 v4, 2, v11
    v_lshlrev_b32 v5, 8, v4
    v_and_b32 v4, 7, v4
    s_lshl_b32 s30, s25, 2
    v_xor_b32 v4, s30, v4
    v_lshl_add_u32 v5, v4, 5, v5
    v_and_b32 v4, 3, v11
    v_lshl_add_u32 v12, v4, 3, v5

    v_xor_b32 v13, 32, v12
    v_xor_b32 v14, 64, v12
    v_xor_b32 v15, 96, v12
    v_add_u32 v16, 65536, v12
    v_add_u32 v17, 65536, v13
    v_add_u32 v18, 65536, v14
    v_add_u32 v19, 65536, v15
    s_lshl_b32 s34, s44, 3
    s_add_u32 s34, s34, s45
    s_lshl_b32 s50, s34, 15
    s_lshl_b32 s35, s3, 12
    s_add_u32 s50, s50, s35
    s_add_u32 s50, s50, 37748736
    s_lshl_b32 s35, s46, 14
    s_add_u32 s51, s50, s35
    s_xor_b32 s50, s51, 16384
    s_lshl_b32 s36, s44, 7
    s_lshl_b32 s35, s24, 6
    s_add_u32 s36, s36, s35
    s_lshl_b32 s35, s46, 5
    s_add_u32 s36, s36, s35
    v_and_b32 v4, 15, v11
    v_add_u32 v4, s36, v4
    v_lshlrev_b32 v5, 2, v4
    s_mov_b32 s35, 34611200
    buffer_load_dword v30, v5, s[20:23], s35 offen
    buffer_load_dword v31, v5, s[20:23], s35 offen offset:64
    v_lshlrev_b32 v4, 11, v4
    v_bfe_u32 v5, v11, 4, 1
    v_lshl_add_u32 v4, v5, 5, v4
    v_lshrrev_b32 v6, 5, v11
    v_lshl_add_u32 v4, v6, 4, v4
    s_lshl_b32 s37, s45, 8
    s_lshl_b32 s35, s25, 7
    s_add_u32 s37, s37, s35
    v_add_u32 v8, s37, v4
    s_lshr_b32 s37, s37, 1
    s_lshl_b32 s35, s36, 11
    s_add_u32 s37, s37, s35
    s_add_u32 s37, s37, 41943040
    v_bfe_u32 v4, v11, 2, 2
    v_lshlrev_b32 v4, 14, v4
    v_and_b32 v7, 3, v11
    v_lshl_add_u32 v4, v7, 11, v4
    v_lshl_add_u32 v4, v5, 10, v4
    v_lshl_add_u32 v9, v6, 4, v4

    s_mov_b32 s16, s6
    s_mov_b32 s17, s7
    s_mov_b32 s18, 4194304
    s_mov_b32 s19, 0x20000

    s_barrier

    ds_read_b128 v[128:131], v2 offset:0
    ds_read_b64_tr_b16 v[144:145], v12 offset:16384
    ds_read_b64_tr_b16 v[146:147], v12 offset:20480
    ds_read_b64_tr_b16 v[148:149], v13 offset:16384
    ds_read_b64_tr_b16 v[150:151], v13 offset:20480
    ds_read_b64_tr_b16 v[152:153], v14 offset:16384
    ds_read_b64_tr_b16 v[154:155], v14 offset:20480
    ds_read_b64_tr_b16 v[156:157], v15 offset:16384
    ds_read_b64_tr_b16 v[158:159], v15 offset:20480
    ds_read_b128 v[132:135], v2 offset:1024
    ds_read_b128 v[136:139], v2 offset:2048
    ds_read_b128 v[140:143], v2 offset:3072
    s_waitcnt lgkmcnt(0)
    v_mfma_f32_16x16x32_bf16 v[192:195], v[144:147], v[128:131], 0
    ds_read_b128 v[160:163], v2 offset:8192
    ds_read_b64_tr_b16 v[176:177], v12 offset:24576
    v_mfma_f32_16x16x32_bf16 v[196:199], v[148:151], v[128:131], 0
    ds_read_b64_tr_b16 v[178:179], v12 offset:28672
    ds_read_b64_tr_b16 v[180:181], v13 offset:24576
    v_mfma_f32_16x16x32_bf16 v[200:203], v[152:155], v[128:131], 0
    ds_read_b64_tr_b16 v[182:183], v13 offset:28672
    ds_read_b64_tr_b16 v[184:185], v14 offset:24576
    v_mfma_f32_16x16x32_bf16 v[204:207], v[156:159], v[128:131], 0
    ds_read_b64_tr_b16 v[186:187], v14 offset:28672
    ds_read_b64_tr_b16 v[188:189], v15 offset:24576
    v_mfma_f32_16x16x32_bf16 v[220:223], v[156:159], v[132:135], 0
    ds_read_b64_tr_b16 v[190:191], v15 offset:28672
    ds_read_b128 v[164:167], v2 offset:9216
    v_mfma_f32_16x16x32_bf16 v[216:219], v[152:155], v[132:135], 0
    ds_read_b128 v[168:171], v2 offset:10240
    ds_read_b128 v[172:175], v2 offset:11264
    v_mfma_f32_16x16x32_bf16 v[212:215], v[148:151], v[132:135], 0
    v_mfma_f32_16x16x32_bf16 v[208:211], v[144:147], v[132:135], 0
    v_mfma_f32_16x16x32_bf16 v[224:227], v[144:147], v[136:139], 0
    v_mfma_f32_16x16x32_bf16 v[228:231], v[148:151], v[136:139], 0
    v_mfma_f32_16x16x32_bf16 v[232:235], v[152:155], v[136:139], 0
    v_mfma_f32_16x16x32_bf16 v[236:239], v[156:159], v[136:139], 0
    v_mfma_f32_16x16x32_bf16 v[252:255], v[156:159], v[140:143], 0
    v_mfma_f32_16x16x32_bf16 v[248:251], v[152:155], v[140:143], 0
    v_mfma_f32_16x16x32_bf16 v[244:247], v[148:151], v[140:143], 0
    v_mfma_f32_16x16x32_bf16 v[240:243], v[144:147], v[140:143], 0
    s_waitcnt lgkmcnt(0)
    s_barrier
    v_mfma_f32_16x16x32_bf16 v[192:195], v[176:179], v[160:163], v[192:195]
    ds_read_b128 v[128:131], v2 offset:32768
    ds_read_b64_tr_b16 v[144:145], v12 offset:49152
    v_mfma_f32_16x16x32_bf16 v[196:199], v[180:183], v[160:163], v[196:199]
    ds_read_b64_tr_b16 v[146:147], v12 offset:53248
    ds_read_b64_tr_b16 v[148:149], v13 offset:49152
    v_mfma_f32_16x16x32_bf16 v[200:203], v[184:187], v[160:163], v[200:203]
    ds_read_b64_tr_b16 v[150:151], v13 offset:53248
    ds_read_b64_tr_b16 v[152:153], v14 offset:49152
    v_mfma_f32_16x16x32_bf16 v[204:207], v[188:191], v[160:163], v[204:207]
    ds_read_b64_tr_b16 v[154:155], v14 offset:53248
    ds_read_b64_tr_b16 v[156:157], v15 offset:49152
    v_mfma_f32_16x16x32_bf16 v[220:223], v[188:191], v[164:167], v[220:223]
    ds_read_b64_tr_b16 v[158:159], v15 offset:53248
    ds_read_b128 v[132:135], v2 offset:33792
    v_mfma_f32_16x16x32_bf16 v[216:219], v[184:187], v[164:167], v[216:219]
    ds_read_b128 v[136:139], v2 offset:34816
    ds_read_b128 v[140:143], v2 offset:35840
    v_mfma_f32_16x16x32_bf16 v[212:215], v[180:183], v[164:167], v[212:215]
    v_mfma_f32_16x16x32_bf16 v[208:211], v[176:179], v[164:167], v[208:211]
    v_mfma_f32_16x16x32_bf16 v[224:227], v[176:179], v[168:171], v[224:227]
    v_mfma_f32_16x16x32_bf16 v[228:231], v[180:183], v[168:171], v[228:231]
    v_mfma_f32_16x16x32_bf16 v[232:235], v[184:187], v[168:171], v[232:235]
    v_mfma_f32_16x16x32_bf16 v[236:239], v[188:191], v[168:171], v[236:239]
    v_mfma_f32_16x16x32_bf16 v[252:255], v[188:191], v[172:175], v[252:255]
    v_mfma_f32_16x16x32_bf16 v[248:251], v[184:187], v[172:175], v[248:251]
    v_mfma_f32_16x16x32_bf16 v[244:247], v[180:183], v[172:175], v[244:247]
    v_mfma_f32_16x16x32_bf16 v[240:243], v[176:179], v[172:175], v[240:243]
    s_waitcnt lgkmcnt(0)
    v_mfma_f32_16x16x32_bf16 v[192:195], v[144:147], v[128:131], v[192:195]
    ds_read_b128 v[160:163], v2 offset:40960
    ds_read_b64_tr_b16 v[176:177], v12 offset:57344
    v_mfma_f32_16x16x32_bf16 v[196:199], v[148:151], v[128:131], v[196:199]
    ds_read_b64_tr_b16 v[178:179], v12 offset:61440
    ds_read_b64_tr_b16 v[180:181], v13 offset:57344
    v_mfma_f32_16x16x32_bf16 v[200:203], v[152:155], v[128:131], v[200:203]
    ds_read_b64_tr_b16 v[182:183], v13 offset:61440
    ds_read_b64_tr_b16 v[184:185], v14 offset:57344
    v_mfma_f32_16x16x32_bf16 v[204:207], v[156:159], v[128:131], v[204:207]
    ds_read_b64_tr_b16 v[186:187], v14 offset:61440
    ds_read_b64_tr_b16 v[188:189], v15 offset:57344
    v_mfma_f32_16x16x32_bf16 v[220:223], v[156:159], v[132:135], v[220:223]
    ds_read_b64_tr_b16 v[190:191], v15 offset:61440
    ds_read_b128 v[164:167], v2 offset:41984
    v_mfma_f32_16x16x32_bf16 v[216:219], v[152:155], v[132:135], v[216:219]
    ds_read_b128 v[168:171], v2 offset:43008
    ds_read_b128 v[172:175], v2 offset:44032
    v_mfma_f32_16x16x32_bf16 v[212:215], v[148:151], v[132:135], v[212:215]
    v_mfma_f32_16x16x32_bf16 v[208:211], v[144:147], v[132:135], v[208:211]
    v_mfma_f32_16x16x32_bf16 v[224:227], v[144:147], v[136:139], v[224:227]
    v_mfma_f32_16x16x32_bf16 v[228:231], v[148:151], v[136:139], v[228:231]
    v_mfma_f32_16x16x32_bf16 v[232:235], v[152:155], v[136:139], v[232:235]
    v_mfma_f32_16x16x32_bf16 v[236:239], v[156:159], v[136:139], v[236:239]
    v_mfma_f32_16x16x32_bf16 v[252:255], v[156:159], v[140:143], v[252:255]
    v_mfma_f32_16x16x32_bf16 v[248:251], v[152:155], v[140:143], v[248:251]
    v_mfma_f32_16x16x32_bf16 v[244:247], v[148:151], v[140:143], v[244:247]
    v_mfma_f32_16x16x32_bf16 v[240:243], v[144:147], v[140:143], v[240:243]
    s_waitcnt lgkmcnt(0)
    s_barrier
    v_mfma_f32_16x16x32_bf16 v[192:195], v[176:179], v[160:163], v[192:195]
    ds_read_b128 v[128:131], v3 offset:0
    ds_read_b64_tr_b16 v[144:145], v16 offset:16384
    v_mfma_f32_16x16x32_bf16 v[196:199], v[180:183], v[160:163], v[196:199]
    ds_read_b64_tr_b16 v[146:147], v16 offset:20480
    ds_read_b64_tr_b16 v[148:149], v17 offset:16384
    v_mfma_f32_16x16x32_bf16 v[200:203], v[184:187], v[160:163], v[200:203]
    ds_read_b64_tr_b16 v[150:151], v17 offset:20480
    ds_read_b64_tr_b16 v[152:153], v18 offset:16384
    v_mfma_f32_16x16x32_bf16 v[204:207], v[188:191], v[160:163], v[204:207]
    ds_read_b64_tr_b16 v[154:155], v18 offset:20480
    ds_read_b64_tr_b16 v[156:157], v19 offset:16384
    v_mfma_f32_16x16x32_bf16 v[220:223], v[188:191], v[164:167], v[220:223]
    ds_read_b64_tr_b16 v[158:159], v19 offset:20480
    ds_read_b128 v[132:135], v3 offset:1024
    v_mfma_f32_16x16x32_bf16 v[216:219], v[184:187], v[164:167], v[216:219]
    ds_read_b128 v[136:139], v3 offset:2048
    ds_read_b128 v[140:143], v3 offset:3072
    v_mfma_f32_16x16x32_bf16 v[212:215], v[180:183], v[164:167], v[212:215]
    v_mfma_f32_16x16x32_bf16 v[208:211], v[176:179], v[164:167], v[208:211]
    v_mfma_f32_16x16x32_bf16 v[224:227], v[176:179], v[168:171], v[224:227]
    v_mfma_f32_16x16x32_bf16 v[228:231], v[180:183], v[168:171], v[228:231]
    v_mfma_f32_16x16x32_bf16 v[232:235], v[184:187], v[168:171], v[232:235]
    v_mfma_f32_16x16x32_bf16 v[236:239], v[188:191], v[168:171], v[236:239]
    v_mfma_f32_16x16x32_bf16 v[252:255], v[188:191], v[172:175], v[252:255]
    v_mfma_f32_16x16x32_bf16 v[248:251], v[184:187], v[172:175], v[248:251]
    v_mfma_f32_16x16x32_bf16 v[244:247], v[180:183], v[172:175], v[244:247]
    v_mfma_f32_16x16x32_bf16 v[240:243], v[176:179], v[172:175], v[240:243]
    s_waitcnt lgkmcnt(0)
    v_mfma_f32_16x16x32_bf16 v[192:195], v[144:147], v[128:131], v[192:195]
    ds_read_b128 v[160:163], v3 offset:8192
    ds_read_b64_tr_b16 v[176:177], v16 offset:24576
    v_mfma_f32_16x16x32_bf16 v[196:199], v[148:151], v[128:131], v[196:199]
    ds_read_b64_tr_b16 v[178:179], v16 offset:28672
    ds_read_b64_tr_b16 v[180:181], v17 offset:24576
    v_mfma_f32_16x16x32_bf16 v[200:203], v[152:155], v[128:131], v[200:203]
    ds_read_b64_tr_b16 v[182:183], v17 offset:28672
    ds_read_b64_tr_b16 v[184:185], v18 offset:24576
    v_mfma_f32_16x16x32_bf16 v[204:207], v[156:159], v[128:131], v[204:207]
    ds_read_b64_tr_b16 v[186:187], v18 offset:28672
    ds_read_b64_tr_b16 v[188:189], v19 offset:24576
    v_mfma_f32_16x16x32_bf16 v[220:223], v[156:159], v[132:135], v[220:223]
    ds_read_b64_tr_b16 v[190:191], v19 offset:28672
    ds_read_b128 v[164:167], v3 offset:9216
    v_mfma_f32_16x16x32_bf16 v[216:219], v[152:155], v[132:135], v[216:219]
    ds_read_b128 v[168:171], v3 offset:10240
    ds_read_b128 v[172:175], v3 offset:11264
    v_mfma_f32_16x16x32_bf16 v[212:215], v[148:151], v[132:135], v[212:215]
    v_mfma_f32_16x16x32_bf16 v[208:211], v[144:147], v[132:135], v[208:211]
    v_mfma_f32_16x16x32_bf16 v[224:227], v[144:147], v[136:139], v[224:227]
    v_mfma_f32_16x16x32_bf16 v[228:231], v[148:151], v[136:139], v[228:231]
    v_mfma_f32_16x16x32_bf16 v[232:235], v[152:155], v[136:139], v[232:235]
    v_mfma_f32_16x16x32_bf16 v[236:239], v[156:159], v[136:139], v[236:239]
    v_mfma_f32_16x16x32_bf16 v[252:255], v[156:159], v[140:143], v[252:255]
    v_mfma_f32_16x16x32_bf16 v[248:251], v[152:155], v[140:143], v[248:251]
    v_mfma_f32_16x16x32_bf16 v[244:247], v[148:151], v[140:143], v[244:247]
    v_mfma_f32_16x16x32_bf16 v[240:243], v[144:147], v[140:143], v[240:243]
    s_waitcnt lgkmcnt(0)
    s_barrier
    v_mfma_f32_16x16x32_bf16 v[192:195], v[176:179], v[160:163], v[192:195]
    ds_read_b128 v[128:131], v3 offset:32768
    ds_read_b64_tr_b16 v[144:145], v16 offset:49152
    v_mfma_f32_16x16x32_bf16 v[196:199], v[180:183], v[160:163], v[196:199]
    ds_read_b64_tr_b16 v[146:147], v16 offset:53248
    ds_read_b64_tr_b16 v[148:149], v17 offset:49152
    v_mfma_f32_16x16x32_bf16 v[200:203], v[184:187], v[160:163], v[200:203]
    ds_read_b64_tr_b16 v[150:151], v17 offset:53248
    ds_read_b64_tr_b16 v[152:153], v18 offset:49152
    v_mfma_f32_16x16x32_bf16 v[204:207], v[188:191], v[160:163], v[204:207]
    ds_read_b64_tr_b16 v[154:155], v18 offset:53248
    ds_read_b64_tr_b16 v[156:157], v19 offset:49152
    v_mfma_f32_16x16x32_bf16 v[220:223], v[188:191], v[164:167], v[220:223]
    ds_read_b64_tr_b16 v[158:159], v19 offset:53248
    ds_read_b128 v[132:135], v3 offset:33792
    v_mfma_f32_16x16x32_bf16 v[216:219], v[184:187], v[164:167], v[216:219]
    ds_read_b128 v[136:139], v3 offset:34816
    ds_read_b128 v[140:143], v3 offset:35840
    v_mfma_f32_16x16x32_bf16 v[212:215], v[180:183], v[164:167], v[212:215]
    v_mfma_f32_16x16x32_bf16 v[208:211], v[176:179], v[164:167], v[208:211]
    v_mfma_f32_16x16x32_bf16 v[224:227], v[176:179], v[168:171], v[224:227]
    v_mfma_f32_16x16x32_bf16 v[228:231], v[180:183], v[168:171], v[228:231]
    v_mfma_f32_16x16x32_bf16 v[232:235], v[184:187], v[168:171], v[232:235]
    v_mfma_f32_16x16x32_bf16 v[236:239], v[188:191], v[168:171], v[236:239]
    v_mfma_f32_16x16x32_bf16 v[252:255], v[188:191], v[172:175], v[252:255]
    v_mfma_f32_16x16x32_bf16 v[248:251], v[184:187], v[172:175], v[248:251]
    v_mfma_f32_16x16x32_bf16 v[244:247], v[180:183], v[172:175], v[244:247]
    v_mfma_f32_16x16x32_bf16 v[240:243], v[176:179], v[172:175], v[240:243]
    s_waitcnt lgkmcnt(0)
    v_mfma_f32_16x16x32_bf16 v[192:195], v[144:147], v[128:131], v[192:195]
    ds_read_b128 v[160:163], v3 offset:40960
    ds_read_b64_tr_b16 v[176:177], v16 offset:57344
    v_mfma_f32_16x16x32_bf16 v[196:199], v[148:151], v[128:131], v[196:199]
    ds_read_b64_tr_b16 v[178:179], v16 offset:61440
    ds_read_b64_tr_b16 v[180:181], v17 offset:57344
    v_mfma_f32_16x16x32_bf16 v[200:203], v[152:155], v[128:131], v[200:203]
    ds_read_b64_tr_b16 v[182:183], v17 offset:61440
    ds_read_b64_tr_b16 v[184:185], v18 offset:57344
    v_mfma_f32_16x16x32_bf16 v[204:207], v[156:159], v[128:131], v[204:207]
    ds_read_b64_tr_b16 v[186:187], v18 offset:61440
    ds_read_b64_tr_b16 v[188:189], v19 offset:57344
    v_mfma_f32_16x16x32_bf16 v[220:223], v[156:159], v[132:135], v[220:223]
    ds_read_b64_tr_b16 v[190:191], v19 offset:61440
    ds_read_b128 v[164:167], v3 offset:41984
    v_mfma_f32_16x16x32_bf16 v[216:219], v[152:155], v[132:135], v[216:219]
    ds_read_b128 v[168:171], v3 offset:43008
    ds_read_b128 v[172:175], v3 offset:44032
    v_mfma_f32_16x16x32_bf16 v[212:215], v[148:151], v[132:135], v[212:215]
    v_mfma_f32_16x16x32_bf16 v[208:211], v[144:147], v[132:135], v[208:211]
    v_mfma_f32_16x16x32_bf16 v[224:227], v[144:147], v[136:139], v[224:227]
    v_mfma_f32_16x16x32_bf16 v[228:231], v[148:151], v[136:139], v[228:231]
    v_mfma_f32_16x16x32_bf16 v[232:235], v[152:155], v[136:139], v[232:235]
    v_mfma_f32_16x16x32_bf16 v[236:239], v[156:159], v[136:139], v[236:239]
    v_mfma_f32_16x16x32_bf16 v[252:255], v[156:159], v[140:143], v[252:255]
    v_mfma_f32_16x16x32_bf16 v[248:251], v[152:155], v[140:143], v[248:251]
    v_mfma_f32_16x16x32_bf16 v[244:247], v[148:151], v[140:143], v[244:247]
    v_mfma_f32_16x16x32_bf16 v[240:243], v[144:147], v[140:143], v[240:243]
    s_waitcnt lgkmcnt(0)
    s_barrier
    v_mfma_f32_16x16x32_bf16 v[192:195], v[176:179], v[160:163], v[192:195]
    ds_read_b128 v[128:131], v2 offset:0
    ds_read_b64_tr_b16 v[144:145], v12 offset:16384
    v_mfma_f32_16x16x32_bf16 v[196:199], v[180:183], v[160:163], v[196:199]
    ds_read_b64_tr_b16 v[146:147], v12 offset:20480
    ds_read_b64_tr_b16 v[148:149], v13 offset:16384
    v_mfma_f32_16x16x32_bf16 v[200:203], v[184:187], v[160:163], v[200:203]
    ds_read_b64_tr_b16 v[150:151], v13 offset:20480
    ds_read_b64_tr_b16 v[152:153], v14 offset:16384
    v_mfma_f32_16x16x32_bf16 v[204:207], v[188:191], v[160:163], v[204:207]
    ds_read_b64_tr_b16 v[154:155], v14 offset:20480
    ds_read_b64_tr_b16 v[156:157], v15 offset:16384
    v_mfma_f32_16x16x32_bf16 v[220:223], v[188:191], v[164:167], v[220:223]
    ds_read_b64_tr_b16 v[158:159], v15 offset:20480
    ds_read_b128 v[132:135], v2 offset:1024
    v_mfma_f32_16x16x32_bf16 v[216:219], v[184:187], v[164:167], v[216:219]
    ds_read_b128 v[136:139], v2 offset:2048
    ds_read_b128 v[140:143], v2 offset:3072
    v_mfma_f32_16x16x32_bf16 v[212:215], v[180:183], v[164:167], v[212:215]
    v_mfma_f32_16x16x32_bf16 v[208:211], v[176:179], v[164:167], v[208:211]
    v_mfma_f32_16x16x32_bf16 v[224:227], v[176:179], v[168:171], v[224:227]
    v_mfma_f32_16x16x32_bf16 v[228:231], v[180:183], v[168:171], v[228:231]
    v_mfma_f32_16x16x32_bf16 v[232:235], v[184:187], v[168:171], v[232:235]
    v_mfma_f32_16x16x32_bf16 v[236:239], v[188:191], v[168:171], v[236:239]
    v_mfma_f32_16x16x32_bf16 v[252:255], v[188:191], v[172:175], v[252:255]
    v_mfma_f32_16x16x32_bf16 v[248:251], v[184:187], v[172:175], v[248:251]
    v_mfma_f32_16x16x32_bf16 v[244:247], v[180:183], v[172:175], v[244:247]
    v_mfma_f32_16x16x32_bf16 v[240:243], v[176:179], v[172:175], v[240:243]
    s_waitcnt lgkmcnt(0)
    v_mfma_f32_16x16x32_bf16 v[192:195], v[144:147], v[128:131], v[192:195]
    ds_read_b128 v[160:163], v2 offset:8192
    ds_read_b64_tr_b16 v[176:177], v12 offset:24576
    v_mfma_f32_16x16x32_bf16 v[196:199], v[148:151], v[128:131], v[196:199]
    ds_read_b64_tr_b16 v[178:179], v12 offset:28672
    ds_read_b64_tr_b16 v[180:181], v13 offset:24576
    v_mfma_f32_16x16x32_bf16 v[200:203], v[152:155], v[128:131], v[200:203]
    ds_read_b64_tr_b16 v[182:183], v13 offset:28672
    ds_read_b64_tr_b16 v[184:185], v14 offset:24576
    v_mfma_f32_16x16x32_bf16 v[204:207], v[156:159], v[128:131], v[204:207]
    ds_read_b64_tr_b16 v[186:187], v14 offset:28672
    ds_read_b64_tr_b16 v[188:189], v15 offset:24576
    v_mfma_f32_16x16x32_bf16 v[220:223], v[156:159], v[132:135], v[220:223]
    ds_read_b64_tr_b16 v[190:191], v15 offset:28672
    ds_read_b128 v[164:167], v2 offset:9216
    v_mfma_f32_16x16x32_bf16 v[216:219], v[152:155], v[132:135], v[216:219]
    ds_read_b128 v[168:171], v2 offset:10240
    ds_read_b128 v[172:175], v2 offset:11264
    v_mfma_f32_16x16x32_bf16 v[212:215], v[148:151], v[132:135], v[212:215]
    v_mfma_f32_16x16x32_bf16 v[208:211], v[144:147], v[132:135], v[208:211]
    v_mfma_f32_16x16x32_bf16 v[224:227], v[144:147], v[136:139], v[224:227]
    v_mfma_f32_16x16x32_bf16 v[228:231], v[148:151], v[136:139], v[228:231]
    v_mfma_f32_16x16x32_bf16 v[232:235], v[152:155], v[136:139], v[232:235]
    v_mfma_f32_16x16x32_bf16 v[236:239], v[156:159], v[136:139], v[236:239]
    v_mfma_f32_16x16x32_bf16 v[252:255], v[156:159], v[140:143], v[252:255]
    v_mfma_f32_16x16x32_bf16 v[248:251], v[152:155], v[140:143], v[248:251]
    v_mfma_f32_16x16x32_bf16 v[244:247], v[148:151], v[140:143], v[244:247]
    v_mfma_f32_16x16x32_bf16 v[240:243], v[144:147], v[140:143], v[240:243]
    s_waitcnt lgkmcnt(0)
    s_barrier
    v_mfma_f32_16x16x32_bf16 v[192:195], v[176:179], v[160:163], v[192:195]
    ds_read_b128 v[128:131], v2 offset:32768
    ds_read_b64_tr_b16 v[144:145], v12 offset:49152
    v_mfma_f32_16x16x32_bf16 v[196:199], v[180:183], v[160:163], v[196:199]
    ds_read_b64_tr_b16 v[146:147], v12 offset:53248
    ds_read_b64_tr_b16 v[148:149], v13 offset:49152
    v_mfma_f32_16x16x32_bf16 v[200:203], v[184:187], v[160:163], v[200:203]
    ds_read_b64_tr_b16 v[150:151], v13 offset:53248
    ds_read_b64_tr_b16 v[152:153], v14 offset:49152
    v_mfma_f32_16x16x32_bf16 v[204:207], v[188:191], v[160:163], v[204:207]
    ds_read_b64_tr_b16 v[154:155], v14 offset:53248
    ds_read_b64_tr_b16 v[156:157], v15 offset:49152
    v_mfma_f32_16x16x32_bf16 v[220:223], v[188:191], v[164:167], v[220:223]
    ds_read_b64_tr_b16 v[158:159], v15 offset:53248
    ds_read_b128 v[132:135], v2 offset:33792
    v_mfma_f32_16x16x32_bf16 v[216:219], v[184:187], v[164:167], v[216:219]
    ds_read_b128 v[136:139], v2 offset:34816
    ds_read_b128 v[140:143], v2 offset:35840
    v_mfma_f32_16x16x32_bf16 v[212:215], v[180:183], v[164:167], v[212:215]
    v_mfma_f32_16x16x32_bf16 v[208:211], v[176:179], v[164:167], v[208:211]
    v_mfma_f32_16x16x32_bf16 v[224:227], v[176:179], v[168:171], v[224:227]
    v_mfma_f32_16x16x32_bf16 v[228:231], v[180:183], v[168:171], v[228:231]
    v_mfma_f32_16x16x32_bf16 v[232:235], v[184:187], v[168:171], v[232:235]
    v_mfma_f32_16x16x32_bf16 v[236:239], v[188:191], v[168:171], v[236:239]
    v_mfma_f32_16x16x32_bf16 v[252:255], v[188:191], v[172:175], v[252:255]
    v_mfma_f32_16x16x32_bf16 v[248:251], v[184:187], v[172:175], v[248:251]
    v_mfma_f32_16x16x32_bf16 v[244:247], v[180:183], v[172:175], v[244:247]
    v_mfma_f32_16x16x32_bf16 v[240:243], v[176:179], v[172:175], v[240:243]
    s_waitcnt lgkmcnt(0)
    v_mfma_f32_16x16x32_bf16 v[192:195], v[144:147], v[128:131], v[192:195]
    ds_read_b128 v[160:163], v2 offset:40960
    ds_read_b64_tr_b16 v[176:177], v12 offset:57344
    v_mfma_f32_16x16x32_bf16 v[196:199], v[148:151], v[128:131], v[196:199]
    ds_read_b64_tr_b16 v[178:179], v12 offset:61440
    ds_read_b64_tr_b16 v[180:181], v13 offset:57344
    v_mfma_f32_16x16x32_bf16 v[200:203], v[152:155], v[128:131], v[200:203]
    ds_read_b64_tr_b16 v[182:183], v13 offset:61440
    ds_read_b64_tr_b16 v[184:185], v14 offset:57344
    v_mfma_f32_16x16x32_bf16 v[204:207], v[156:159], v[128:131], v[204:207]
    ds_read_b64_tr_b16 v[186:187], v14 offset:61440
    ds_read_b64_tr_b16 v[188:189], v15 offset:57344
    v_mfma_f32_16x16x32_bf16 v[220:223], v[156:159], v[132:135], v[220:223]
    ds_read_b64_tr_b16 v[190:191], v15 offset:61440
    ds_read_b128 v[164:167], v2 offset:41984
    v_mfma_f32_16x16x32_bf16 v[216:219], v[152:155], v[132:135], v[216:219]
    ds_read_b128 v[168:171], v2 offset:43008
    ds_read_b128 v[172:175], v2 offset:44032
    v_mfma_f32_16x16x32_bf16 v[212:215], v[148:151], v[132:135], v[212:215]
    v_mfma_f32_16x16x32_bf16 v[208:211], v[144:147], v[132:135], v[208:211]
    v_mfma_f32_16x16x32_bf16 v[224:227], v[144:147], v[136:139], v[224:227]
    v_mfma_f32_16x16x32_bf16 v[228:231], v[148:151], v[136:139], v[228:231]
    v_mfma_f32_16x16x32_bf16 v[232:235], v[152:155], v[136:139], v[232:235]
    v_mfma_f32_16x16x32_bf16 v[236:239], v[156:159], v[136:139], v[236:239]
    v_mfma_f32_16x16x32_bf16 v[252:255], v[156:159], v[140:143], v[252:255]
    v_mfma_f32_16x16x32_bf16 v[248:251], v[152:155], v[140:143], v[248:251]
    v_mfma_f32_16x16x32_bf16 v[244:247], v[148:151], v[140:143], v[244:247]
    v_mfma_f32_16x16x32_bf16 v[240:243], v[144:147], v[140:143], v[240:243]
    s_waitcnt lgkmcnt(0)
    s_barrier
    v_mfma_f32_16x16x32_bf16 v[192:195], v[176:179], v[160:163], v[192:195]
    ds_read_b128 v[128:131], v3 offset:0
    ds_read_b64_tr_b16 v[144:145], v16 offset:16384
    v_mfma_f32_16x16x32_bf16 v[196:199], v[180:183], v[160:163], v[196:199]
    ds_read_b64_tr_b16 v[146:147], v16 offset:20480
    ds_read_b64_tr_b16 v[148:149], v17 offset:16384
    v_mfma_f32_16x16x32_bf16 v[200:203], v[184:187], v[160:163], v[200:203]
    ds_read_b64_tr_b16 v[150:151], v17 offset:20480
    ds_read_b64_tr_b16 v[152:153], v18 offset:16384
    v_mfma_f32_16x16x32_bf16 v[204:207], v[188:191], v[160:163], v[204:207]
    ds_read_b64_tr_b16 v[154:155], v18 offset:20480
    ds_read_b64_tr_b16 v[156:157], v19 offset:16384
    v_mfma_f32_16x16x32_bf16 v[220:223], v[188:191], v[164:167], v[220:223]
    ds_read_b64_tr_b16 v[158:159], v19 offset:20480
    ds_read_b128 v[132:135], v3 offset:1024
    v_mfma_f32_16x16x32_bf16 v[216:219], v[184:187], v[164:167], v[216:219]
    ds_read_b128 v[136:139], v3 offset:2048
    ds_read_b128 v[140:143], v3 offset:3072
    v_mfma_f32_16x16x32_bf16 v[212:215], v[180:183], v[164:167], v[212:215]
    v_mfma_f32_16x16x32_bf16 v[208:211], v[176:179], v[164:167], v[208:211]
    v_mfma_f32_16x16x32_bf16 v[224:227], v[176:179], v[168:171], v[224:227]
    v_mfma_f32_16x16x32_bf16 v[228:231], v[180:183], v[168:171], v[228:231]
    v_mfma_f32_16x16x32_bf16 v[232:235], v[184:187], v[168:171], v[232:235]
    v_mfma_f32_16x16x32_bf16 v[236:239], v[188:191], v[168:171], v[236:239]
    v_mfma_f32_16x16x32_bf16 v[252:255], v[188:191], v[172:175], v[252:255]
    v_mfma_f32_16x16x32_bf16 v[248:251], v[184:187], v[172:175], v[248:251]
    v_mfma_f32_16x16x32_bf16 v[244:247], v[180:183], v[172:175], v[244:247]
    v_mfma_f32_16x16x32_bf16 v[240:243], v[176:179], v[172:175], v[240:243]
    s_waitcnt lgkmcnt(0)
    v_mfma_f32_16x16x32_bf16 v[192:195], v[144:147], v[128:131], v[192:195]
    ds_read_b128 v[160:163], v3 offset:8192
    ds_read_b64_tr_b16 v[176:177], v16 offset:24576
    v_mfma_f32_16x16x32_bf16 v[196:199], v[148:151], v[128:131], v[196:199]
    ds_read_b64_tr_b16 v[178:179], v16 offset:28672
    ds_read_b64_tr_b16 v[180:181], v17 offset:24576
    v_mfma_f32_16x16x32_bf16 v[200:203], v[152:155], v[128:131], v[200:203]
    ds_read_b64_tr_b16 v[182:183], v17 offset:28672
    ds_read_b64_tr_b16 v[184:185], v18 offset:24576
    v_mfma_f32_16x16x32_bf16 v[204:207], v[156:159], v[128:131], v[204:207]
    ds_read_b64_tr_b16 v[186:187], v18 offset:28672
    ds_read_b64_tr_b16 v[188:189], v19 offset:24576
    v_mfma_f32_16x16x32_bf16 v[220:223], v[156:159], v[132:135], v[220:223]
    ds_read_b64_tr_b16 v[190:191], v19 offset:28672
    ds_read_b128 v[164:167], v3 offset:9216
    v_mfma_f32_16x16x32_bf16 v[216:219], v[152:155], v[132:135], v[216:219]
    ds_read_b128 v[168:171], v3 offset:10240
    ds_read_b128 v[172:175], v3 offset:11264
    v_mfma_f32_16x16x32_bf16 v[212:215], v[148:151], v[132:135], v[212:215]
    v_mfma_f32_16x16x32_bf16 v[208:211], v[144:147], v[132:135], v[208:211]
    v_mfma_f32_16x16x32_bf16 v[224:227], v[144:147], v[136:139], v[224:227]
    v_mfma_f32_16x16x32_bf16 v[228:231], v[148:151], v[136:139], v[228:231]
    v_mfma_f32_16x16x32_bf16 v[232:235], v[152:155], v[136:139], v[232:235]
    v_mfma_f32_16x16x32_bf16 v[236:239], v[156:159], v[136:139], v[236:239]
    v_mfma_f32_16x16x32_bf16 v[252:255], v[156:159], v[140:143], v[252:255]
    v_mfma_f32_16x16x32_bf16 v[248:251], v[152:155], v[140:143], v[248:251]
    v_mfma_f32_16x16x32_bf16 v[244:247], v[148:151], v[140:143], v[244:247]
    v_mfma_f32_16x16x32_bf16 v[240:243], v[144:147], v[140:143], v[240:243]
    s_waitcnt lgkmcnt(0)
    s_barrier
    v_mfma_f32_16x16x32_bf16 v[192:195], v[176:179], v[160:163], v[192:195]
    ds_read_b128 v[128:131], v3 offset:32768
    ds_read_b64_tr_b16 v[144:145], v16 offset:49152
    v_mfma_f32_16x16x32_bf16 v[196:199], v[180:183], v[160:163], v[196:199]
    ds_read_b64_tr_b16 v[146:147], v16 offset:53248
    ds_read_b64_tr_b16 v[148:149], v17 offset:49152
    v_mfma_f32_16x16x32_bf16 v[200:203], v[184:187], v[160:163], v[200:203]
    ds_read_b64_tr_b16 v[150:151], v17 offset:53248
    ds_read_b64_tr_b16 v[152:153], v18 offset:49152
    v_mfma_f32_16x16x32_bf16 v[204:207], v[188:191], v[160:163], v[204:207]
    ds_read_b64_tr_b16 v[154:155], v18 offset:53248
    ds_read_b64_tr_b16 v[156:157], v19 offset:49152
    v_mfma_f32_16x16x32_bf16 v[220:223], v[188:191], v[164:167], v[220:223]
    ds_read_b64_tr_b16 v[158:159], v19 offset:53248
    ds_read_b128 v[132:135], v3 offset:33792
    v_mfma_f32_16x16x32_bf16 v[216:219], v[184:187], v[164:167], v[216:219]
    ds_read_b128 v[136:139], v3 offset:34816
    ds_read_b128 v[140:143], v3 offset:35840
    v_mfma_f32_16x16x32_bf16 v[212:215], v[180:183], v[164:167], v[212:215]
    v_mfma_f32_16x16x32_bf16 v[208:211], v[176:179], v[164:167], v[208:211]
    v_mfma_f32_16x16x32_bf16 v[224:227], v[176:179], v[168:171], v[224:227]
    v_mfma_f32_16x16x32_bf16 v[228:231], v[180:183], v[168:171], v[228:231]
    v_mfma_f32_16x16x32_bf16 v[232:235], v[184:187], v[168:171], v[232:235]
    v_mfma_f32_16x16x32_bf16 v[236:239], v[188:191], v[168:171], v[236:239]
    v_mfma_f32_16x16x32_bf16 v[252:255], v[188:191], v[172:175], v[252:255]
    v_mfma_f32_16x16x32_bf16 v[248:251], v[184:187], v[172:175], v[248:251]
    v_mfma_f32_16x16x32_bf16 v[244:247], v[180:183], v[172:175], v[244:247]
    v_mfma_f32_16x16x32_bf16 v[240:243], v[176:179], v[172:175], v[240:243]
    s_waitcnt lgkmcnt(0)
    v_mfma_f32_16x16x32_bf16 v[192:195], v[144:147], v[128:131], v[192:195]
    ds_read_b128 v[160:163], v3 offset:40960
    ds_read_b64_tr_b16 v[176:177], v16 offset:57344
    v_mfma_f32_16x16x32_bf16 v[196:199], v[148:151], v[128:131], v[196:199]
    ds_read_b64_tr_b16 v[178:179], v16 offset:61440
    ds_read_b64_tr_b16 v[180:181], v17 offset:57344
    v_mfma_f32_16x16x32_bf16 v[200:203], v[152:155], v[128:131], v[200:203]
    ds_read_b64_tr_b16 v[182:183], v17 offset:61440
    ds_read_b64_tr_b16 v[184:185], v18 offset:57344
    v_mfma_f32_16x16x32_bf16 v[204:207], v[156:159], v[128:131], v[204:207]
    ds_read_b64_tr_b16 v[186:187], v18 offset:61440
    ds_read_b64_tr_b16 v[188:189], v19 offset:57344
    v_mfma_f32_16x16x32_bf16 v[220:223], v[156:159], v[132:135], v[220:223]
    ds_read_b64_tr_b16 v[190:191], v19 offset:61440
    ds_read_b128 v[164:167], v3 offset:41984
    v_mfma_f32_16x16x32_bf16 v[216:219], v[152:155], v[132:135], v[216:219]
    ds_read_b128 v[168:171], v3 offset:43008
    ds_read_b128 v[172:175], v3 offset:44032
    v_mfma_f32_16x16x32_bf16 v[212:215], v[148:151], v[132:135], v[212:215]
    v_mfma_f32_16x16x32_bf16 v[208:211], v[144:147], v[132:135], v[208:211]
    v_mfma_f32_16x16x32_bf16 v[224:227], v[144:147], v[136:139], v[224:227]
    v_mfma_f32_16x16x32_bf16 v[228:231], v[148:151], v[136:139], v[228:231]
    v_mfma_f32_16x16x32_bf16 v[232:235], v[152:155], v[136:139], v[232:235]
    v_mfma_f32_16x16x32_bf16 v[236:239], v[156:159], v[136:139], v[236:239]
    v_mfma_f32_16x16x32_bf16 v[252:255], v[156:159], v[140:143], v[252:255]
    v_mfma_f32_16x16x32_bf16 v[248:251], v[152:155], v[140:143], v[248:251]
    v_mfma_f32_16x16x32_bf16 v[244:247], v[148:151], v[140:143], v[244:247]
    v_mfma_f32_16x16x32_bf16 v[240:243], v[144:147], v[140:143], v[240:243]
    s_waitcnt lgkmcnt(0)
    s_barrier
    v_mfma_f32_16x16x32_bf16 v[192:195], v[176:179], v[160:163], v[192:195]
    ds_read_b128 v[128:131], v2 offset:0
    ds_read_b64_tr_b16 v[144:145], v12 offset:16384
    v_mfma_f32_16x16x32_bf16 v[196:199], v[180:183], v[160:163], v[196:199]
    ds_read_b64_tr_b16 v[146:147], v12 offset:20480
    ds_read_b64_tr_b16 v[148:149], v13 offset:16384
    v_mfma_f32_16x16x32_bf16 v[200:203], v[184:187], v[160:163], v[200:203]
    ds_read_b64_tr_b16 v[150:151], v13 offset:20480
    ds_read_b64_tr_b16 v[152:153], v14 offset:16384
    v_mfma_f32_16x16x32_bf16 v[204:207], v[188:191], v[160:163], v[204:207]
    ds_read_b64_tr_b16 v[154:155], v14 offset:20480
    ds_read_b64_tr_b16 v[156:157], v15 offset:16384
    v_mfma_f32_16x16x32_bf16 v[220:223], v[188:191], v[164:167], v[220:223]
    ds_read_b64_tr_b16 v[158:159], v15 offset:20480
    ds_read_b128 v[132:135], v2 offset:1024
    v_mfma_f32_16x16x32_bf16 v[216:219], v[184:187], v[164:167], v[216:219]
    ds_read_b128 v[136:139], v2 offset:2048
    ds_read_b128 v[140:143], v2 offset:3072
    v_mfma_f32_16x16x32_bf16 v[212:215], v[180:183], v[164:167], v[212:215]
    v_mfma_f32_16x16x32_bf16 v[208:211], v[176:179], v[164:167], v[208:211]
    v_mfma_f32_16x16x32_bf16 v[224:227], v[176:179], v[168:171], v[224:227]
    v_mfma_f32_16x16x32_bf16 v[228:231], v[180:183], v[168:171], v[228:231]
    v_mfma_f32_16x16x32_bf16 v[232:235], v[184:187], v[168:171], v[232:235]
    v_mfma_f32_16x16x32_bf16 v[236:239], v[188:191], v[168:171], v[236:239]
    v_mfma_f32_16x16x32_bf16 v[252:255], v[188:191], v[172:175], v[252:255]
    v_mfma_f32_16x16x32_bf16 v[248:251], v[184:187], v[172:175], v[248:251]
    v_mfma_f32_16x16x32_bf16 v[244:247], v[180:183], v[172:175], v[244:247]
    v_mfma_f32_16x16x32_bf16 v[240:243], v[176:179], v[172:175], v[240:243]
    s_waitcnt lgkmcnt(0)
    v_mfma_f32_16x16x32_bf16 v[192:195], v[144:147], v[128:131], v[192:195]
    ds_read_b128 v[160:163], v2 offset:8192
    ds_read_b64_tr_b16 v[176:177], v12 offset:24576
    v_mfma_f32_16x16x32_bf16 v[196:199], v[148:151], v[128:131], v[196:199]
    ds_read_b64_tr_b16 v[178:179], v12 offset:28672
    ds_read_b64_tr_b16 v[180:181], v13 offset:24576
    v_mfma_f32_16x16x32_bf16 v[200:203], v[152:155], v[128:131], v[200:203]
    ds_read_b64_tr_b16 v[182:183], v13 offset:28672
    ds_read_b64_tr_b16 v[184:185], v14 offset:24576
    v_mfma_f32_16x16x32_bf16 v[204:207], v[156:159], v[128:131], v[204:207]
    ds_read_b64_tr_b16 v[186:187], v14 offset:28672
    ds_read_b64_tr_b16 v[188:189], v15 offset:24576
    v_mfma_f32_16x16x32_bf16 v[220:223], v[156:159], v[132:135], v[220:223]
    ds_read_b64_tr_b16 v[190:191], v15 offset:28672
    ds_read_b128 v[164:167], v2 offset:9216
    v_mfma_f32_16x16x32_bf16 v[216:219], v[152:155], v[132:135], v[216:219]
    ds_read_b128 v[168:171], v2 offset:10240
    ds_read_b128 v[172:175], v2 offset:11264
    v_mfma_f32_16x16x32_bf16 v[212:215], v[148:151], v[132:135], v[212:215]
    v_mfma_f32_16x16x32_bf16 v[208:211], v[144:147], v[132:135], v[208:211]
    v_mfma_f32_16x16x32_bf16 v[224:227], v[144:147], v[136:139], v[224:227]
    v_mfma_f32_16x16x32_bf16 v[228:231], v[148:151], v[136:139], v[228:231]
    v_mfma_f32_16x16x32_bf16 v[232:235], v[152:155], v[136:139], v[232:235]
    v_mfma_f32_16x16x32_bf16 v[236:239], v[156:159], v[136:139], v[236:239]
    v_mfma_f32_16x16x32_bf16 v[252:255], v[156:159], v[140:143], v[252:255]
    v_mfma_f32_16x16x32_bf16 v[248:251], v[152:155], v[140:143], v[248:251]
    v_mfma_f32_16x16x32_bf16 v[244:247], v[148:151], v[140:143], v[244:247]
    v_mfma_f32_16x16x32_bf16 v[240:243], v[144:147], v[140:143], v[240:243]
    s_waitcnt lgkmcnt(0)
    s_barrier
    v_mfma_f32_16x16x32_bf16 v[192:195], v[176:179], v[160:163], v[192:195]
    ds_read_b128 v[128:131], v2 offset:32768
    ds_read_b64_tr_b16 v[144:145], v12 offset:49152
    v_mfma_f32_16x16x32_bf16 v[196:199], v[180:183], v[160:163], v[196:199]
    ds_read_b64_tr_b16 v[146:147], v12 offset:53248
    ds_read_b64_tr_b16 v[148:149], v13 offset:49152
    v_mfma_f32_16x16x32_bf16 v[200:203], v[184:187], v[160:163], v[200:203]
    ds_read_b64_tr_b16 v[150:151], v13 offset:53248
    ds_read_b64_tr_b16 v[152:153], v14 offset:49152
    v_mfma_f32_16x16x32_bf16 v[204:207], v[188:191], v[160:163], v[204:207]
    ds_read_b64_tr_b16 v[154:155], v14 offset:53248
    ds_read_b64_tr_b16 v[156:157], v15 offset:49152
    v_mfma_f32_16x16x32_bf16 v[220:223], v[188:191], v[164:167], v[220:223]
    ds_read_b64_tr_b16 v[158:159], v15 offset:53248
    ds_read_b128 v[132:135], v2 offset:33792
    v_mfma_f32_16x16x32_bf16 v[216:219], v[184:187], v[164:167], v[216:219]
    ds_read_b128 v[136:139], v2 offset:34816
    ds_read_b128 v[140:143], v2 offset:35840
    v_mfma_f32_16x16x32_bf16 v[212:215], v[180:183], v[164:167], v[212:215]
    v_mfma_f32_16x16x32_bf16 v[208:211], v[176:179], v[164:167], v[208:211]
    v_mfma_f32_16x16x32_bf16 v[224:227], v[176:179], v[168:171], v[224:227]
    v_mfma_f32_16x16x32_bf16 v[228:231], v[180:183], v[168:171], v[228:231]
    v_mfma_f32_16x16x32_bf16 v[232:235], v[184:187], v[168:171], v[232:235]
    v_mfma_f32_16x16x32_bf16 v[236:239], v[188:191], v[168:171], v[236:239]
    v_mfma_f32_16x16x32_bf16 v[252:255], v[188:191], v[172:175], v[252:255]
    v_mfma_f32_16x16x32_bf16 v[248:251], v[184:187], v[172:175], v[248:251]
    v_mfma_f32_16x16x32_bf16 v[244:247], v[180:183], v[172:175], v[244:247]
    v_mfma_f32_16x16x32_bf16 v[240:243], v[176:179], v[172:175], v[240:243]
    s_waitcnt lgkmcnt(0)
    v_mfma_f32_16x16x32_bf16 v[192:195], v[144:147], v[128:131], v[192:195]
    ds_read_b128 v[160:163], v2 offset:40960
    ds_read_b64_tr_b16 v[176:177], v12 offset:57344
    v_mfma_f32_16x16x32_bf16 v[196:199], v[148:151], v[128:131], v[196:199]
    ds_read_b64_tr_b16 v[178:179], v12 offset:61440
    ds_read_b64_tr_b16 v[180:181], v13 offset:57344
    v_mfma_f32_16x16x32_bf16 v[200:203], v[152:155], v[128:131], v[200:203]
    ds_read_b64_tr_b16 v[182:183], v13 offset:61440
    ds_read_b64_tr_b16 v[184:185], v14 offset:57344
    v_mfma_f32_16x16x32_bf16 v[204:207], v[156:159], v[128:131], v[204:207]
    ds_read_b64_tr_b16 v[186:187], v14 offset:61440
    ds_read_b64_tr_b16 v[188:189], v15 offset:57344
    v_mfma_f32_16x16x32_bf16 v[220:223], v[156:159], v[132:135], v[220:223]
    ds_read_b64_tr_b16 v[190:191], v15 offset:61440
    ds_read_b128 v[164:167], v2 offset:41984
    v_mfma_f32_16x16x32_bf16 v[216:219], v[152:155], v[132:135], v[216:219]
    ds_read_b128 v[168:171], v2 offset:43008
    ds_read_b128 v[172:175], v2 offset:44032
    v_mfma_f32_16x16x32_bf16 v[212:215], v[148:151], v[132:135], v[212:215]
    v_mfma_f32_16x16x32_bf16 v[208:211], v[144:147], v[132:135], v[208:211]
    v_mfma_f32_16x16x32_bf16 v[224:227], v[144:147], v[136:139], v[224:227]
    v_mfma_f32_16x16x32_bf16 v[228:231], v[148:151], v[136:139], v[228:231]
    v_mfma_f32_16x16x32_bf16 v[232:235], v[152:155], v[136:139], v[232:235]
    v_mfma_f32_16x16x32_bf16 v[236:239], v[156:159], v[136:139], v[236:239]
    v_mfma_f32_16x16x32_bf16 v[252:255], v[156:159], v[140:143], v[252:255]
    v_mfma_f32_16x16x32_bf16 v[248:251], v[152:155], v[140:143], v[248:251]
    v_mfma_f32_16x16x32_bf16 v[244:247], v[148:151], v[140:143], v[244:247]
    v_mfma_f32_16x16x32_bf16 v[240:243], v[144:147], v[140:143], v[240:243]
    s_waitcnt lgkmcnt(0)
    s_barrier
    v_mfma_f32_16x16x32_bf16 v[192:195], v[176:179], v[160:163], v[192:195]
    ds_read_b128 v[128:131], v3 offset:0
    ds_read_b64_tr_b16 v[144:145], v16 offset:16384
    v_mfma_f32_16x16x32_bf16 v[196:199], v[180:183], v[160:163], v[196:199]
    ds_read_b64_tr_b16 v[146:147], v16 offset:20480
    ds_read_b64_tr_b16 v[148:149], v17 offset:16384
    v_mfma_f32_16x16x32_bf16 v[200:203], v[184:187], v[160:163], v[200:203]
    ds_read_b64_tr_b16 v[150:151], v17 offset:20480
    ds_read_b64_tr_b16 v[152:153], v18 offset:16384
    v_mfma_f32_16x16x32_bf16 v[204:207], v[188:191], v[160:163], v[204:207]
    ds_read_b64_tr_b16 v[154:155], v18 offset:20480
    ds_read_b64_tr_b16 v[156:157], v19 offset:16384
    v_mfma_f32_16x16x32_bf16 v[220:223], v[188:191], v[164:167], v[220:223]
    ds_read_b64_tr_b16 v[158:159], v19 offset:20480
    ds_read_b128 v[132:135], v3 offset:1024
    v_mfma_f32_16x16x32_bf16 v[216:219], v[184:187], v[164:167], v[216:219]
    ds_read_b128 v[136:139], v3 offset:2048
    ds_read_b128 v[140:143], v3 offset:3072
    v_mfma_f32_16x16x32_bf16 v[212:215], v[180:183], v[164:167], v[212:215]
    v_mfma_f32_16x16x32_bf16 v[208:211], v[176:179], v[164:167], v[208:211]
    v_mfma_f32_16x16x32_bf16 v[224:227], v[176:179], v[168:171], v[224:227]
    v_mfma_f32_16x16x32_bf16 v[228:231], v[180:183], v[168:171], v[228:231]
    v_mfma_f32_16x16x32_bf16 v[232:235], v[184:187], v[168:171], v[232:235]
    v_mfma_f32_16x16x32_bf16 v[236:239], v[188:191], v[168:171], v[236:239]
    v_mfma_f32_16x16x32_bf16 v[252:255], v[188:191], v[172:175], v[252:255]
    v_mfma_f32_16x16x32_bf16 v[248:251], v[184:187], v[172:175], v[248:251]
    v_mfma_f32_16x16x32_bf16 v[244:247], v[180:183], v[172:175], v[244:247]
    v_mfma_f32_16x16x32_bf16 v[240:243], v[176:179], v[172:175], v[240:243]
    s_waitcnt lgkmcnt(0)
    v_mfma_f32_16x16x32_bf16 v[192:195], v[144:147], v[128:131], v[192:195]
    ds_read_b128 v[160:163], v3 offset:8192
    ds_read_b64_tr_b16 v[176:177], v16 offset:24576
    v_mfma_f32_16x16x32_bf16 v[196:199], v[148:151], v[128:131], v[196:199]
    ds_read_b64_tr_b16 v[178:179], v16 offset:28672
    ds_read_b64_tr_b16 v[180:181], v17 offset:24576
    v_mfma_f32_16x16x32_bf16 v[200:203], v[152:155], v[128:131], v[200:203]
    ds_read_b64_tr_b16 v[182:183], v17 offset:28672
    ds_read_b64_tr_b16 v[184:185], v18 offset:24576
    v_mfma_f32_16x16x32_bf16 v[204:207], v[156:159], v[128:131], v[204:207]
    ds_read_b64_tr_b16 v[186:187], v18 offset:28672
    ds_read_b64_tr_b16 v[188:189], v19 offset:24576
    v_mfma_f32_16x16x32_bf16 v[220:223], v[156:159], v[132:135], v[220:223]
    ds_read_b64_tr_b16 v[190:191], v19 offset:28672
    ds_read_b128 v[164:167], v3 offset:9216
    v_mfma_f32_16x16x32_bf16 v[216:219], v[152:155], v[132:135], v[216:219]
    ds_read_b128 v[168:171], v3 offset:10240
    ds_read_b128 v[172:175], v3 offset:11264
    v_mfma_f32_16x16x32_bf16 v[212:215], v[148:151], v[132:135], v[212:215]
    v_mfma_f32_16x16x32_bf16 v[208:211], v[144:147], v[132:135], v[208:211]
    v_mfma_f32_16x16x32_bf16 v[224:227], v[144:147], v[136:139], v[224:227]
    v_mfma_f32_16x16x32_bf16 v[228:231], v[148:151], v[136:139], v[228:231]
    v_mfma_f32_16x16x32_bf16 v[232:235], v[152:155], v[136:139], v[232:235]
    v_mfma_f32_16x16x32_bf16 v[236:239], v[156:159], v[136:139], v[236:239]
    v_mfma_f32_16x16x32_bf16 v[252:255], v[156:159], v[140:143], v[252:255]
    v_mfma_f32_16x16x32_bf16 v[248:251], v[152:155], v[140:143], v[248:251]
    v_mfma_f32_16x16x32_bf16 v[244:247], v[148:151], v[140:143], v[244:247]
    v_mfma_f32_16x16x32_bf16 v[240:243], v[144:147], v[140:143], v[240:243]
    s_waitcnt lgkmcnt(0)
    s_barrier
    v_mfma_f32_16x16x32_bf16 v[192:195], v[176:179], v[160:163], v[192:195]
    ds_read_b128 v[128:131], v3 offset:32768
    ds_read_b64_tr_b16 v[144:145], v16 offset:49152
    v_mfma_f32_16x16x32_bf16 v[196:199], v[180:183], v[160:163], v[196:199]
    ds_read_b64_tr_b16 v[146:147], v16 offset:53248
    ds_read_b64_tr_b16 v[148:149], v17 offset:49152
    v_mfma_f32_16x16x32_bf16 v[200:203], v[184:187], v[160:163], v[200:203]
    ds_read_b64_tr_b16 v[150:151], v17 offset:53248
    ds_read_b64_tr_b16 v[152:153], v18 offset:49152
    v_mfma_f32_16x16x32_bf16 v[204:207], v[188:191], v[160:163], v[204:207]
    ds_read_b64_tr_b16 v[154:155], v18 offset:53248
    ds_read_b64_tr_b16 v[156:157], v19 offset:49152
    v_mfma_f32_16x16x32_bf16 v[220:223], v[188:191], v[164:167], v[220:223]
    ds_read_b64_tr_b16 v[158:159], v19 offset:53248
    ds_read_b128 v[132:135], v3 offset:33792
    v_mfma_f32_16x16x32_bf16 v[216:219], v[184:187], v[164:167], v[216:219]
    ds_read_b128 v[136:139], v3 offset:34816
    ds_read_b128 v[140:143], v3 offset:35840
    v_mfma_f32_16x16x32_bf16 v[212:215], v[180:183], v[164:167], v[212:215]
    v_mfma_f32_16x16x32_bf16 v[208:211], v[176:179], v[164:167], v[208:211]
    v_mfma_f32_16x16x32_bf16 v[224:227], v[176:179], v[168:171], v[224:227]
    v_mfma_f32_16x16x32_bf16 v[228:231], v[180:183], v[168:171], v[228:231]
    v_mfma_f32_16x16x32_bf16 v[232:235], v[184:187], v[168:171], v[232:235]
    v_mfma_f32_16x16x32_bf16 v[236:239], v[188:191], v[168:171], v[236:239]
    v_mfma_f32_16x16x32_bf16 v[252:255], v[188:191], v[172:175], v[252:255]
    v_mfma_f32_16x16x32_bf16 v[248:251], v[184:187], v[172:175], v[248:251]
    v_mfma_f32_16x16x32_bf16 v[244:247], v[180:183], v[172:175], v[244:247]
    v_mfma_f32_16x16x32_bf16 v[240:243], v[176:179], v[172:175], v[240:243]
    s_waitcnt lgkmcnt(0)
    v_mfma_f32_16x16x32_bf16 v[192:195], v[144:147], v[128:131], v[192:195]
    ds_read_b128 v[160:163], v3 offset:40960
    ds_read_b64_tr_b16 v[176:177], v16 offset:57344
    v_mfma_f32_16x16x32_bf16 v[196:199], v[148:151], v[128:131], v[196:199]
    ds_read_b64_tr_b16 v[178:179], v16 offset:61440
    ds_read_b64_tr_b16 v[180:181], v17 offset:57344
    v_mfma_f32_16x16x32_bf16 v[200:203], v[152:155], v[128:131], v[200:203]
    ds_read_b64_tr_b16 v[182:183], v17 offset:61440
    ds_read_b64_tr_b16 v[184:185], v18 offset:57344
    v_mfma_f32_16x16x32_bf16 v[204:207], v[156:159], v[128:131], v[204:207]
    ds_read_b64_tr_b16 v[186:187], v18 offset:61440
    ds_read_b64_tr_b16 v[188:189], v19 offset:57344
    v_mfma_f32_16x16x32_bf16 v[220:223], v[156:159], v[132:135], v[220:223]
    ds_read_b64_tr_b16 v[190:191], v19 offset:61440
    ds_read_b128 v[164:167], v3 offset:41984
    v_mfma_f32_16x16x32_bf16 v[216:219], v[152:155], v[132:135], v[216:219]
    ds_read_b128 v[168:171], v3 offset:43008
    ds_read_b128 v[172:175], v3 offset:44032
    v_mfma_f32_16x16x32_bf16 v[212:215], v[148:151], v[132:135], v[212:215]
    v_mfma_f32_16x16x32_bf16 v[208:211], v[144:147], v[132:135], v[208:211]
    v_mfma_f32_16x16x32_bf16 v[224:227], v[144:147], v[136:139], v[224:227]
    v_mfma_f32_16x16x32_bf16 v[228:231], v[148:151], v[136:139], v[228:231]
    v_mfma_f32_16x16x32_bf16 v[232:235], v[152:155], v[136:139], v[232:235]
    v_mfma_f32_16x16x32_bf16 v[236:239], v[156:159], v[136:139], v[236:239]
    v_mfma_f32_16x16x32_bf16 v[252:255], v[156:159], v[140:143], v[252:255]
    v_mfma_f32_16x16x32_bf16 v[248:251], v[152:155], v[140:143], v[248:251]
    v_mfma_f32_16x16x32_bf16 v[244:247], v[148:151], v[140:143], v[244:247]
    v_mfma_f32_16x16x32_bf16 v[240:243], v[144:147], v[140:143], v[240:243]
    s_waitcnt lgkmcnt(0)
    s_barrier
    v_mfma_f32_16x16x32_bf16 v[192:195], v[176:179], v[160:163], v[192:195]
    ds_read_b128 v[128:131], v2 offset:0
    ds_read_b64_tr_b16 v[144:145], v12 offset:16384
    v_mfma_f32_16x16x32_bf16 v[196:199], v[180:183], v[160:163], v[196:199]
    ds_read_b64_tr_b16 v[146:147], v12 offset:20480
    ds_read_b64_tr_b16 v[148:149], v13 offset:16384
    v_mfma_f32_16x16x32_bf16 v[200:203], v[184:187], v[160:163], v[200:203]
    ds_read_b64_tr_b16 v[150:151], v13 offset:20480
    ds_read_b64_tr_b16 v[152:153], v14 offset:16384
    v_mfma_f32_16x16x32_bf16 v[204:207], v[188:191], v[160:163], v[204:207]
    ds_read_b64_tr_b16 v[154:155], v14 offset:20480
    ds_read_b64_tr_b16 v[156:157], v15 offset:16384
    v_mfma_f32_16x16x32_bf16 v[220:223], v[188:191], v[164:167], v[220:223]
    ds_read_b64_tr_b16 v[158:159], v15 offset:20480
    ds_read_b128 v[132:135], v2 offset:1024
    v_mfma_f32_16x16x32_bf16 v[216:219], v[184:187], v[164:167], v[216:219]
    ds_read_b128 v[136:139], v2 offset:2048
    ds_read_b128 v[140:143], v2 offset:3072
    v_mfma_f32_16x16x32_bf16 v[212:215], v[180:183], v[164:167], v[212:215]
    v_mfma_f32_16x16x32_bf16 v[208:211], v[176:179], v[164:167], v[208:211]
    v_mfma_f32_16x16x32_bf16 v[224:227], v[176:179], v[168:171], v[224:227]
    v_mfma_f32_16x16x32_bf16 v[228:231], v[180:183], v[168:171], v[228:231]
    v_mfma_f32_16x16x32_bf16 v[232:235], v[184:187], v[168:171], v[232:235]
    v_mfma_f32_16x16x32_bf16 v[236:239], v[188:191], v[168:171], v[236:239]
    v_mfma_f32_16x16x32_bf16 v[252:255], v[188:191], v[172:175], v[252:255]
    v_mfma_f32_16x16x32_bf16 v[248:251], v[184:187], v[172:175], v[248:251]
    v_mfma_f32_16x16x32_bf16 v[244:247], v[180:183], v[172:175], v[244:247]
    v_mfma_f32_16x16x32_bf16 v[240:243], v[176:179], v[172:175], v[240:243]
    s_waitcnt lgkmcnt(0)
    v_mfma_f32_16x16x32_bf16 v[192:195], v[144:147], v[128:131], v[192:195]
    ds_read_b128 v[160:163], v2 offset:8192
    ds_read_b64_tr_b16 v[176:177], v12 offset:24576
    v_mfma_f32_16x16x32_bf16 v[196:199], v[148:151], v[128:131], v[196:199]
    ds_read_b64_tr_b16 v[178:179], v12 offset:28672
    ds_read_b64_tr_b16 v[180:181], v13 offset:24576
    v_mfma_f32_16x16x32_bf16 v[200:203], v[152:155], v[128:131], v[200:203]
    ds_read_b64_tr_b16 v[182:183], v13 offset:28672
    ds_read_b64_tr_b16 v[184:185], v14 offset:24576
    v_mfma_f32_16x16x32_bf16 v[204:207], v[156:159], v[128:131], v[204:207]
    ds_read_b64_tr_b16 v[186:187], v14 offset:28672
    ds_read_b64_tr_b16 v[188:189], v15 offset:24576
    v_mfma_f32_16x16x32_bf16 v[220:223], v[156:159], v[132:135], v[220:223]
    ds_read_b64_tr_b16 v[190:191], v15 offset:28672
    ds_read_b128 v[164:167], v2 offset:9216
    v_mfma_f32_16x16x32_bf16 v[216:219], v[152:155], v[132:135], v[216:219]
    ds_read_b128 v[168:171], v2 offset:10240
    ds_read_b128 v[172:175], v2 offset:11264
    v_mfma_f32_16x16x32_bf16 v[212:215], v[148:151], v[132:135], v[212:215]
    v_mfma_f32_16x16x32_bf16 v[208:211], v[144:147], v[132:135], v[208:211]
    v_mfma_f32_16x16x32_bf16 v[224:227], v[144:147], v[136:139], v[224:227]
    v_mfma_f32_16x16x32_bf16 v[228:231], v[148:151], v[136:139], v[228:231]
    v_mfma_f32_16x16x32_bf16 v[232:235], v[152:155], v[136:139], v[232:235]
    v_mfma_f32_16x16x32_bf16 v[236:239], v[156:159], v[136:139], v[236:239]
    v_mfma_f32_16x16x32_bf16 v[252:255], v[156:159], v[140:143], v[252:255]
    v_mfma_f32_16x16x32_bf16 v[248:251], v[152:155], v[140:143], v[248:251]
    v_mfma_f32_16x16x32_bf16 v[244:247], v[148:151], v[140:143], v[244:247]
    v_mfma_f32_16x16x32_bf16 v[240:243], v[144:147], v[140:143], v[240:243]
    s_waitcnt lgkmcnt(0)
    s_barrier
    v_mfma_f32_16x16x32_bf16 v[192:195], v[176:179], v[160:163], v[192:195]
    ds_read_b128 v[128:131], v2 offset:32768
    ds_read_b64_tr_b16 v[144:145], v12 offset:49152
    v_mfma_f32_16x16x32_bf16 v[196:199], v[180:183], v[160:163], v[196:199]
    ds_read_b64_tr_b16 v[146:147], v12 offset:53248
    ds_read_b64_tr_b16 v[148:149], v13 offset:49152
    v_mfma_f32_16x16x32_bf16 v[200:203], v[184:187], v[160:163], v[200:203]
    ds_read_b64_tr_b16 v[150:151], v13 offset:53248
    ds_read_b64_tr_b16 v[152:153], v14 offset:49152
    v_mfma_f32_16x16x32_bf16 v[204:207], v[188:191], v[160:163], v[204:207]
    ds_read_b64_tr_b16 v[154:155], v14 offset:53248
    ds_read_b64_tr_b16 v[156:157], v15 offset:49152
    v_mfma_f32_16x16x32_bf16 v[220:223], v[188:191], v[164:167], v[220:223]
    ds_read_b64_tr_b16 v[158:159], v15 offset:53248
    ds_read_b128 v[132:135], v2 offset:33792
    v_mfma_f32_16x16x32_bf16 v[216:219], v[184:187], v[164:167], v[216:219]
    ds_read_b128 v[136:139], v2 offset:34816
    ds_read_b128 v[140:143], v2 offset:35840
    v_mfma_f32_16x16x32_bf16 v[212:215], v[180:183], v[164:167], v[212:215]
    v_mfma_f32_16x16x32_bf16 v[208:211], v[176:179], v[164:167], v[208:211]
    v_mfma_f32_16x16x32_bf16 v[224:227], v[176:179], v[168:171], v[224:227]
    v_mfma_f32_16x16x32_bf16 v[228:231], v[180:183], v[168:171], v[228:231]
    v_mfma_f32_16x16x32_bf16 v[232:235], v[184:187], v[168:171], v[232:235]
    v_mfma_f32_16x16x32_bf16 v[236:239], v[188:191], v[168:171], v[236:239]
    v_mfma_f32_16x16x32_bf16 v[252:255], v[188:191], v[172:175], v[252:255]
    v_mfma_f32_16x16x32_bf16 v[248:251], v[184:187], v[172:175], v[248:251]
    v_mfma_f32_16x16x32_bf16 v[244:247], v[180:183], v[172:175], v[244:247]
    v_mfma_f32_16x16x32_bf16 v[240:243], v[176:179], v[172:175], v[240:243]
    s_waitcnt lgkmcnt(0)
    v_mfma_f32_16x16x32_bf16 v[192:195], v[144:147], v[128:131], v[192:195]
    ds_read_b128 v[160:163], v2 offset:40960
    ds_read_b64_tr_b16 v[176:177], v12 offset:57344
    v_mfma_f32_16x16x32_bf16 v[196:199], v[148:151], v[128:131], v[196:199]
    ds_read_b64_tr_b16 v[178:179], v12 offset:61440
    ds_read_b64_tr_b16 v[180:181], v13 offset:57344
    v_mfma_f32_16x16x32_bf16 v[200:203], v[152:155], v[128:131], v[200:203]
    ds_read_b64_tr_b16 v[182:183], v13 offset:61440
    ds_read_b64_tr_b16 v[184:185], v14 offset:57344
    v_mfma_f32_16x16x32_bf16 v[204:207], v[156:159], v[128:131], v[204:207]
    ds_read_b64_tr_b16 v[186:187], v14 offset:61440
    ds_read_b64_tr_b16 v[188:189], v15 offset:57344
    v_mfma_f32_16x16x32_bf16 v[220:223], v[156:159], v[132:135], v[220:223]
    ds_read_b64_tr_b16 v[190:191], v15 offset:61440
    ds_read_b128 v[164:167], v2 offset:41984
    v_mfma_f32_16x16x32_bf16 v[216:219], v[152:155], v[132:135], v[216:219]
    ds_read_b128 v[168:171], v2 offset:43008
    ds_read_b128 v[172:175], v2 offset:44032
    v_mfma_f32_16x16x32_bf16 v[212:215], v[148:151], v[132:135], v[212:215]
    v_mfma_f32_16x16x32_bf16 v[208:211], v[144:147], v[132:135], v[208:211]
    v_mfma_f32_16x16x32_bf16 v[224:227], v[144:147], v[136:139], v[224:227]
    v_mfma_f32_16x16x32_bf16 v[228:231], v[148:151], v[136:139], v[228:231]
    v_mfma_f32_16x16x32_bf16 v[232:235], v[152:155], v[136:139], v[232:235]
    v_mfma_f32_16x16x32_bf16 v[236:239], v[156:159], v[136:139], v[236:239]
    v_mfma_f32_16x16x32_bf16 v[252:255], v[156:159], v[140:143], v[252:255]
    v_mfma_f32_16x16x32_bf16 v[248:251], v[152:155], v[140:143], v[248:251]
    v_mfma_f32_16x16x32_bf16 v[244:247], v[148:151], v[140:143], v[244:247]
    v_mfma_f32_16x16x32_bf16 v[240:243], v[144:147], v[140:143], v[240:243]
    s_waitcnt lgkmcnt(0)
    s_barrier
    v_mfma_f32_16x16x32_bf16 v[192:195], v[176:179], v[160:163], v[192:195]
    ds_read_b128 v[128:131], v3 offset:0
    ds_read_b64_tr_b16 v[144:145], v16 offset:16384
    v_mfma_f32_16x16x32_bf16 v[196:199], v[180:183], v[160:163], v[196:199]
    ds_read_b64_tr_b16 v[146:147], v16 offset:20480
    ds_read_b64_tr_b16 v[148:149], v17 offset:16384
    v_mfma_f32_16x16x32_bf16 v[200:203], v[184:187], v[160:163], v[200:203]
    ds_read_b64_tr_b16 v[150:151], v17 offset:20480
    ds_read_b64_tr_b16 v[152:153], v18 offset:16384
    v_mfma_f32_16x16x32_bf16 v[204:207], v[188:191], v[160:163], v[204:207]
    ds_read_b64_tr_b16 v[154:155], v18 offset:20480
    ds_read_b64_tr_b16 v[156:157], v19 offset:16384
    v_mfma_f32_16x16x32_bf16 v[220:223], v[188:191], v[164:167], v[220:223]
    ds_read_b64_tr_b16 v[158:159], v19 offset:20480
    ds_read_b128 v[132:135], v3 offset:1024
    v_mfma_f32_16x16x32_bf16 v[216:219], v[184:187], v[164:167], v[216:219]
    ds_read_b128 v[136:139], v3 offset:2048
    ds_read_b128 v[140:143], v3 offset:3072
    v_mfma_f32_16x16x32_bf16 v[212:215], v[180:183], v[164:167], v[212:215]
    v_mfma_f32_16x16x32_bf16 v[208:211], v[176:179], v[164:167], v[208:211]
    v_mfma_f32_16x16x32_bf16 v[224:227], v[176:179], v[168:171], v[224:227]
    v_mfma_f32_16x16x32_bf16 v[228:231], v[180:183], v[168:171], v[228:231]
    v_mfma_f32_16x16x32_bf16 v[232:235], v[184:187], v[168:171], v[232:235]
    v_mfma_f32_16x16x32_bf16 v[236:239], v[188:191], v[168:171], v[236:239]
    v_mfma_f32_16x16x32_bf16 v[252:255], v[188:191], v[172:175], v[252:255]
    v_mfma_f32_16x16x32_bf16 v[248:251], v[184:187], v[172:175], v[248:251]
    v_mfma_f32_16x16x32_bf16 v[244:247], v[180:183], v[172:175], v[244:247]
    v_mfma_f32_16x16x32_bf16 v[240:243], v[176:179], v[172:175], v[240:243]
    s_waitcnt lgkmcnt(0)
    v_mfma_f32_16x16x32_bf16 v[192:195], v[144:147], v[128:131], v[192:195]
    ds_read_b128 v[160:163], v3 offset:8192
    ds_read_b64_tr_b16 v[176:177], v16 offset:24576
    v_mfma_f32_16x16x32_bf16 v[196:199], v[148:151], v[128:131], v[196:199]
    ds_read_b64_tr_b16 v[178:179], v16 offset:28672
    ds_read_b64_tr_b16 v[180:181], v17 offset:24576
    v_mfma_f32_16x16x32_bf16 v[200:203], v[152:155], v[128:131], v[200:203]
    ds_read_b64_tr_b16 v[182:183], v17 offset:28672
    ds_read_b64_tr_b16 v[184:185], v18 offset:24576
    v_mfma_f32_16x16x32_bf16 v[204:207], v[156:159], v[128:131], v[204:207]
    ds_read_b64_tr_b16 v[186:187], v18 offset:28672
    ds_read_b64_tr_b16 v[188:189], v19 offset:24576
    v_mfma_f32_16x16x32_bf16 v[220:223], v[156:159], v[132:135], v[220:223]
    ds_read_b64_tr_b16 v[190:191], v19 offset:28672
    ds_read_b128 v[164:167], v3 offset:9216
    v_mfma_f32_16x16x32_bf16 v[216:219], v[152:155], v[132:135], v[216:219]
    ds_read_b128 v[168:171], v3 offset:10240
    ds_read_b128 v[172:175], v3 offset:11264
    v_mfma_f32_16x16x32_bf16 v[212:215], v[148:151], v[132:135], v[212:215]
    v_mfma_f32_16x16x32_bf16 v[208:211], v[144:147], v[132:135], v[208:211]
    v_mfma_f32_16x16x32_bf16 v[224:227], v[144:147], v[136:139], v[224:227]
    v_mfma_f32_16x16x32_bf16 v[228:231], v[148:151], v[136:139], v[228:231]
    v_mfma_f32_16x16x32_bf16 v[232:235], v[152:155], v[136:139], v[232:235]
    v_mfma_f32_16x16x32_bf16 v[236:239], v[156:159], v[136:139], v[236:239]
    v_mfma_f32_16x16x32_bf16 v[252:255], v[156:159], v[140:143], v[252:255]
    v_mfma_f32_16x16x32_bf16 v[248:251], v[152:155], v[140:143], v[248:251]
    v_mfma_f32_16x16x32_bf16 v[244:247], v[148:151], v[140:143], v[244:247]
    v_mfma_f32_16x16x32_bf16 v[240:243], v[144:147], v[140:143], v[240:243]
    s_waitcnt lgkmcnt(0)
    s_barrier
    v_mfma_f32_16x16x32_bf16 v[192:195], v[176:179], v[160:163], v[192:195]
    ds_read_b128 v[128:131], v3 offset:32768
    ds_read_b64_tr_b16 v[144:145], v16 offset:49152
    v_mfma_f32_16x16x32_bf16 v[196:199], v[180:183], v[160:163], v[196:199]
    ds_read_b64_tr_b16 v[146:147], v16 offset:53248
    ds_read_b64_tr_b16 v[148:149], v17 offset:49152
    v_mfma_f32_16x16x32_bf16 v[200:203], v[184:187], v[160:163], v[200:203]
    ds_read_b64_tr_b16 v[150:151], v17 offset:53248
    ds_read_b64_tr_b16 v[152:153], v18 offset:49152
    v_mfma_f32_16x16x32_bf16 v[204:207], v[188:191], v[160:163], v[204:207]
    ds_read_b64_tr_b16 v[154:155], v18 offset:53248
    ds_read_b64_tr_b16 v[156:157], v19 offset:49152
    v_mfma_f32_16x16x32_bf16 v[220:223], v[188:191], v[164:167], v[220:223]
    ds_read_b64_tr_b16 v[158:159], v19 offset:53248
    ds_read_b128 v[132:135], v3 offset:33792
    v_mfma_f32_16x16x32_bf16 v[216:219], v[184:187], v[164:167], v[216:219]
    ds_read_b128 v[136:139], v3 offset:34816
    ds_read_b128 v[140:143], v3 offset:35840
    v_mfma_f32_16x16x32_bf16 v[212:215], v[180:183], v[164:167], v[212:215]
    v_mfma_f32_16x16x32_bf16 v[208:211], v[176:179], v[164:167], v[208:211]
    v_mfma_f32_16x16x32_bf16 v[224:227], v[176:179], v[168:171], v[224:227]
    v_mfma_f32_16x16x32_bf16 v[228:231], v[180:183], v[168:171], v[228:231]
    v_mfma_f32_16x16x32_bf16 v[232:235], v[184:187], v[168:171], v[232:235]
    v_mfma_f32_16x16x32_bf16 v[236:239], v[188:191], v[168:171], v[236:239]
    v_mfma_f32_16x16x32_bf16 v[252:255], v[188:191], v[172:175], v[252:255]
    v_mfma_f32_16x16x32_bf16 v[248:251], v[184:187], v[172:175], v[248:251]
    v_mfma_f32_16x16x32_bf16 v[244:247], v[180:183], v[172:175], v[244:247]
    v_mfma_f32_16x16x32_bf16 v[240:243], v[176:179], v[172:175], v[240:243]
    s_waitcnt lgkmcnt(0)
    v_mfma_f32_16x16x32_bf16 v[192:195], v[144:147], v[128:131], v[192:195]
    ds_read_b128 v[160:163], v3 offset:40960
    ds_read_b64_tr_b16 v[176:177], v16 offset:57344
    v_mfma_f32_16x16x32_bf16 v[196:199], v[148:151], v[128:131], v[196:199]
    ds_read_b64_tr_b16 v[178:179], v16 offset:61440
    ds_read_b64_tr_b16 v[180:181], v17 offset:57344
    v_mfma_f32_16x16x32_bf16 v[200:203], v[152:155], v[128:131], v[200:203]
    ds_read_b64_tr_b16 v[182:183], v17 offset:61440
    ds_read_b64_tr_b16 v[184:185], v18 offset:57344
    v_mfma_f32_16x16x32_bf16 v[204:207], v[156:159], v[128:131], v[204:207]
    ds_read_b64_tr_b16 v[186:187], v18 offset:61440
    ds_read_b64_tr_b16 v[188:189], v19 offset:57344
    v_mfma_f32_16x16x32_bf16 v[220:223], v[156:159], v[132:135], v[220:223]
    ds_read_b64_tr_b16 v[190:191], v19 offset:61440
    ds_read_b128 v[164:167], v3 offset:41984
    v_mfma_f32_16x16x32_bf16 v[216:219], v[152:155], v[132:135], v[216:219]
    ds_read_b128 v[168:171], v3 offset:43008
    ds_read_b128 v[172:175], v3 offset:44032
    v_mfma_f32_16x16x32_bf16 v[212:215], v[148:151], v[132:135], v[212:215]
    v_mfma_f32_16x16x32_bf16 v[208:211], v[144:147], v[132:135], v[208:211]
    v_mfma_f32_16x16x32_bf16 v[224:227], v[144:147], v[136:139], v[224:227]
    v_mfma_f32_16x16x32_bf16 v[228:231], v[148:151], v[136:139], v[228:231]
    v_mfma_f32_16x16x32_bf16 v[232:235], v[152:155], v[136:139], v[232:235]
    v_mfma_f32_16x16x32_bf16 v[236:239], v[156:159], v[136:139], v[236:239]
    v_mfma_f32_16x16x32_bf16 v[252:255], v[156:159], v[140:143], v[252:255]
    v_mfma_f32_16x16x32_bf16 v[248:251], v[152:155], v[140:143], v[248:251]
    v_mfma_f32_16x16x32_bf16 v[244:247], v[148:151], v[140:143], v[244:247]
    v_mfma_f32_16x16x32_bf16 v[240:243], v[144:147], v[140:143], v[240:243]
    s_waitcnt lgkmcnt(0)
    s_barrier
    v_mfma_f32_16x16x32_bf16 v[192:195], v[176:179], v[160:163], v[192:195]
    ds_read_b128 v[128:131], v2 offset:0
    ds_read_b64_tr_b16 v[144:145], v12 offset:16384
    v_mfma_f32_16x16x32_bf16 v[196:199], v[180:183], v[160:163], v[196:199]
    ds_read_b64_tr_b16 v[146:147], v12 offset:20480
    ds_read_b64_tr_b16 v[148:149], v13 offset:16384
    v_mfma_f32_16x16x32_bf16 v[200:203], v[184:187], v[160:163], v[200:203]
    ds_read_b64_tr_b16 v[150:151], v13 offset:20480
    ds_read_b64_tr_b16 v[152:153], v14 offset:16384
    v_mfma_f32_16x16x32_bf16 v[204:207], v[188:191], v[160:163], v[204:207]
    ds_read_b64_tr_b16 v[154:155], v14 offset:20480
    ds_read_b64_tr_b16 v[156:157], v15 offset:16384
    v_mfma_f32_16x16x32_bf16 v[220:223], v[188:191], v[164:167], v[220:223]
    ds_read_b64_tr_b16 v[158:159], v15 offset:20480
    ds_read_b128 v[132:135], v2 offset:1024
    v_mfma_f32_16x16x32_bf16 v[216:219], v[184:187], v[164:167], v[216:219]
    ds_read_b128 v[136:139], v2 offset:2048
    ds_read_b128 v[140:143], v2 offset:3072
    v_mfma_f32_16x16x32_bf16 v[212:215], v[180:183], v[164:167], v[212:215]
    v_mfma_f32_16x16x32_bf16 v[208:211], v[176:179], v[164:167], v[208:211]
    v_mfma_f32_16x16x32_bf16 v[224:227], v[176:179], v[168:171], v[224:227]
    v_mfma_f32_16x16x32_bf16 v[228:231], v[180:183], v[168:171], v[228:231]
    v_mfma_f32_16x16x32_bf16 v[232:235], v[184:187], v[168:171], v[232:235]
    v_mfma_f32_16x16x32_bf16 v[236:239], v[188:191], v[168:171], v[236:239]
    v_mfma_f32_16x16x32_bf16 v[252:255], v[188:191], v[172:175], v[252:255]
    v_mfma_f32_16x16x32_bf16 v[248:251], v[184:187], v[172:175], v[248:251]
    v_mfma_f32_16x16x32_bf16 v[244:247], v[180:183], v[172:175], v[244:247]
    v_mfma_f32_16x16x32_bf16 v[240:243], v[176:179], v[172:175], v[240:243]
    s_waitcnt lgkmcnt(0)
    v_mfma_f32_16x16x32_bf16 v[192:195], v[144:147], v[128:131], v[192:195]
    ds_read_b128 v[160:163], v2 offset:8192
    ds_read_b64_tr_b16 v[176:177], v12 offset:24576
    v_mfma_f32_16x16x32_bf16 v[196:199], v[148:151], v[128:131], v[196:199]
    ds_read_b64_tr_b16 v[178:179], v12 offset:28672
    ds_read_b64_tr_b16 v[180:181], v13 offset:24576
    v_mfma_f32_16x16x32_bf16 v[200:203], v[152:155], v[128:131], v[200:203]
    ds_read_b64_tr_b16 v[182:183], v13 offset:28672
    ds_read_b64_tr_b16 v[184:185], v14 offset:24576
    v_mfma_f32_16x16x32_bf16 v[204:207], v[156:159], v[128:131], v[204:207]
    ds_read_b64_tr_b16 v[186:187], v14 offset:28672
    ds_read_b64_tr_b16 v[188:189], v15 offset:24576
    v_mfma_f32_16x16x32_bf16 v[220:223], v[156:159], v[132:135], v[220:223]
    ds_read_b64_tr_b16 v[190:191], v15 offset:28672
    ds_read_b128 v[164:167], v2 offset:9216
    v_mfma_f32_16x16x32_bf16 v[216:219], v[152:155], v[132:135], v[216:219]
    ds_read_b128 v[168:171], v2 offset:10240
    ds_read_b128 v[172:175], v2 offset:11264
    v_mfma_f32_16x16x32_bf16 v[212:215], v[148:151], v[132:135], v[212:215]
    v_mfma_f32_16x16x32_bf16 v[208:211], v[144:147], v[132:135], v[208:211]
    v_mfma_f32_16x16x32_bf16 v[224:227], v[144:147], v[136:139], v[224:227]
    v_mfma_f32_16x16x32_bf16 v[228:231], v[148:151], v[136:139], v[228:231]
    v_mfma_f32_16x16x32_bf16 v[232:235], v[152:155], v[136:139], v[232:235]
    v_mfma_f32_16x16x32_bf16 v[236:239], v[156:159], v[136:139], v[236:239]
    v_mfma_f32_16x16x32_bf16 v[252:255], v[156:159], v[140:143], v[252:255]
    v_mfma_f32_16x16x32_bf16 v[248:251], v[152:155], v[140:143], v[248:251]
    v_mfma_f32_16x16x32_bf16 v[244:247], v[148:151], v[140:143], v[244:247]
    v_mfma_f32_16x16x32_bf16 v[240:243], v[144:147], v[140:143], v[240:243]
    s_waitcnt lgkmcnt(0)
    s_barrier
    v_mfma_f32_16x16x32_bf16 v[192:195], v[176:179], v[160:163], v[192:195]
    ds_read_b128 v[128:131], v2 offset:32768
    ds_read_b64_tr_b16 v[144:145], v12 offset:49152
    v_mfma_f32_16x16x32_bf16 v[196:199], v[180:183], v[160:163], v[196:199]
    ds_read_b64_tr_b16 v[146:147], v12 offset:53248
    ds_read_b64_tr_b16 v[148:149], v13 offset:49152
    v_mfma_f32_16x16x32_bf16 v[200:203], v[184:187], v[160:163], v[200:203]
    ds_read_b64_tr_b16 v[150:151], v13 offset:53248
    ds_read_b64_tr_b16 v[152:153], v14 offset:49152
    v_mfma_f32_16x16x32_bf16 v[204:207], v[188:191], v[160:163], v[204:207]
    ds_read_b64_tr_b16 v[154:155], v14 offset:53248
    ds_read_b64_tr_b16 v[156:157], v15 offset:49152
    v_mfma_f32_16x16x32_bf16 v[220:223], v[188:191], v[164:167], v[220:223]
    ds_read_b64_tr_b16 v[158:159], v15 offset:53248
    ds_read_b128 v[132:135], v2 offset:33792
    v_mfma_f32_16x16x32_bf16 v[216:219], v[184:187], v[164:167], v[216:219]
    ds_read_b128 v[136:139], v2 offset:34816
    ds_read_b128 v[140:143], v2 offset:35840
    v_mfma_f32_16x16x32_bf16 v[212:215], v[180:183], v[164:167], v[212:215]
    v_mfma_f32_16x16x32_bf16 v[208:211], v[176:179], v[164:167], v[208:211]
    v_mfma_f32_16x16x32_bf16 v[224:227], v[176:179], v[168:171], v[224:227]
    v_mfma_f32_16x16x32_bf16 v[228:231], v[180:183], v[168:171], v[228:231]
    v_mfma_f32_16x16x32_bf16 v[232:235], v[184:187], v[168:171], v[232:235]
    v_mfma_f32_16x16x32_bf16 v[236:239], v[188:191], v[168:171], v[236:239]
    v_mfma_f32_16x16x32_bf16 v[252:255], v[188:191], v[172:175], v[252:255]
    v_mfma_f32_16x16x32_bf16 v[248:251], v[184:187], v[172:175], v[248:251]
    v_mfma_f32_16x16x32_bf16 v[244:247], v[180:183], v[172:175], v[244:247]
    v_mfma_f32_16x16x32_bf16 v[240:243], v[176:179], v[172:175], v[240:243]
    s_waitcnt lgkmcnt(0)
    v_mfma_f32_16x16x32_bf16 v[192:195], v[144:147], v[128:131], v[192:195]
    ds_read_b128 v[160:163], v2 offset:40960
    ds_read_b64_tr_b16 v[176:177], v12 offset:57344
    v_mfma_f32_16x16x32_bf16 v[196:199], v[148:151], v[128:131], v[196:199]
    ds_read_b64_tr_b16 v[178:179], v12 offset:61440
    ds_read_b64_tr_b16 v[180:181], v13 offset:57344
    v_mfma_f32_16x16x32_bf16 v[200:203], v[152:155], v[128:131], v[200:203]
    ds_read_b64_tr_b16 v[182:183], v13 offset:61440
    ds_read_b64_tr_b16 v[184:185], v14 offset:57344
    v_mfma_f32_16x16x32_bf16 v[204:207], v[156:159], v[128:131], v[204:207]
    ds_read_b64_tr_b16 v[186:187], v14 offset:61440
    ds_read_b64_tr_b16 v[188:189], v15 offset:57344
    v_mfma_f32_16x16x32_bf16 v[220:223], v[156:159], v[132:135], v[220:223]
    ds_read_b64_tr_b16 v[190:191], v15 offset:61440
    ds_read_b128 v[164:167], v2 offset:41984
    v_mfma_f32_16x16x32_bf16 v[216:219], v[152:155], v[132:135], v[216:219]
    ds_read_b128 v[168:171], v2 offset:43008
    ds_read_b128 v[172:175], v2 offset:44032
    v_mfma_f32_16x16x32_bf16 v[212:215], v[148:151], v[132:135], v[212:215]
    v_mfma_f32_16x16x32_bf16 v[208:211], v[144:147], v[132:135], v[208:211]
    v_mfma_f32_16x16x32_bf16 v[224:227], v[144:147], v[136:139], v[224:227]
    v_mfma_f32_16x16x32_bf16 v[228:231], v[148:151], v[136:139], v[228:231]
    v_mfma_f32_16x16x32_bf16 v[232:235], v[152:155], v[136:139], v[232:235]
    v_mfma_f32_16x16x32_bf16 v[236:239], v[156:159], v[136:139], v[236:239]
    v_mfma_f32_16x16x32_bf16 v[252:255], v[156:159], v[140:143], v[252:255]
    v_mfma_f32_16x16x32_bf16 v[248:251], v[152:155], v[140:143], v[248:251]
    v_mfma_f32_16x16x32_bf16 v[244:247], v[148:151], v[140:143], v[244:247]
    v_mfma_f32_16x16x32_bf16 v[240:243], v[144:147], v[140:143], v[240:243]
    s_waitcnt lgkmcnt(0)
    s_barrier
    v_mfma_f32_16x16x32_bf16 v[192:195], v[176:179], v[160:163], v[192:195]
    ds_read_b128 v[128:131], v3 offset:0
    ds_read_b64_tr_b16 v[144:145], v16 offset:16384
    v_mfma_f32_16x16x32_bf16 v[196:199], v[180:183], v[160:163], v[196:199]
    ds_read_b64_tr_b16 v[146:147], v16 offset:20480
    ds_read_b64_tr_b16 v[148:149], v17 offset:16384
    v_mfma_f32_16x16x32_bf16 v[200:203], v[184:187], v[160:163], v[200:203]
    ds_read_b64_tr_b16 v[150:151], v17 offset:20480
    ds_read_b64_tr_b16 v[152:153], v18 offset:16384
    v_mfma_f32_16x16x32_bf16 v[204:207], v[188:191], v[160:163], v[204:207]
    ds_read_b64_tr_b16 v[154:155], v18 offset:20480
    ds_read_b64_tr_b16 v[156:157], v19 offset:16384
    v_mfma_f32_16x16x32_bf16 v[220:223], v[188:191], v[164:167], v[220:223]
    ds_read_b64_tr_b16 v[158:159], v19 offset:20480
    ds_read_b128 v[132:135], v3 offset:1024
    v_mfma_f32_16x16x32_bf16 v[216:219], v[184:187], v[164:167], v[216:219]
    ds_read_b128 v[136:139], v3 offset:2048
    ds_read_b128 v[140:143], v3 offset:3072
    v_mfma_f32_16x16x32_bf16 v[212:215], v[180:183], v[164:167], v[212:215]
    v_mfma_f32_16x16x32_bf16 v[208:211], v[176:179], v[164:167], v[208:211]
    v_mfma_f32_16x16x32_bf16 v[224:227], v[176:179], v[168:171], v[224:227]
    v_mfma_f32_16x16x32_bf16 v[228:231], v[180:183], v[168:171], v[228:231]
    v_mfma_f32_16x16x32_bf16 v[232:235], v[184:187], v[168:171], v[232:235]
    v_mfma_f32_16x16x32_bf16 v[236:239], v[188:191], v[168:171], v[236:239]
    v_mfma_f32_16x16x32_bf16 v[252:255], v[188:191], v[172:175], v[252:255]
    v_mfma_f32_16x16x32_bf16 v[248:251], v[184:187], v[172:175], v[248:251]
    v_mfma_f32_16x16x32_bf16 v[244:247], v[180:183], v[172:175], v[244:247]
    v_mfma_f32_16x16x32_bf16 v[240:243], v[176:179], v[172:175], v[240:243]
    s_waitcnt lgkmcnt(0)
    v_mfma_f32_16x16x32_bf16 v[192:195], v[144:147], v[128:131], v[192:195]
    ds_read_b128 v[160:163], v3 offset:8192
    ds_read_b64_tr_b16 v[176:177], v16 offset:24576
    v_mfma_f32_16x16x32_bf16 v[196:199], v[148:151], v[128:131], v[196:199]
    ds_read_b64_tr_b16 v[178:179], v16 offset:28672
    ds_read_b64_tr_b16 v[180:181], v17 offset:24576
    v_mfma_f32_16x16x32_bf16 v[200:203], v[152:155], v[128:131], v[200:203]
    ds_read_b64_tr_b16 v[182:183], v17 offset:28672
    ds_read_b64_tr_b16 v[184:185], v18 offset:24576
    v_mfma_f32_16x16x32_bf16 v[204:207], v[156:159], v[128:131], v[204:207]
    ds_read_b64_tr_b16 v[186:187], v18 offset:28672
    ds_read_b64_tr_b16 v[188:189], v19 offset:24576
    v_mfma_f32_16x16x32_bf16 v[220:223], v[156:159], v[132:135], v[220:223]
    ds_read_b64_tr_b16 v[190:191], v19 offset:28672
    ds_read_b128 v[164:167], v3 offset:9216
    v_mfma_f32_16x16x32_bf16 v[216:219], v[152:155], v[132:135], v[216:219]
    ds_read_b128 v[168:171], v3 offset:10240
    ds_read_b128 v[172:175], v3 offset:11264
    v_mfma_f32_16x16x32_bf16 v[212:215], v[148:151], v[132:135], v[212:215]
    v_mfma_f32_16x16x32_bf16 v[208:211], v[144:147], v[132:135], v[208:211]
    v_mfma_f32_16x16x32_bf16 v[224:227], v[144:147], v[136:139], v[224:227]
    v_mfma_f32_16x16x32_bf16 v[228:231], v[148:151], v[136:139], v[228:231]
    v_mfma_f32_16x16x32_bf16 v[232:235], v[152:155], v[136:139], v[232:235]
    v_mfma_f32_16x16x32_bf16 v[236:239], v[156:159], v[136:139], v[236:239]
    v_mfma_f32_16x16x32_bf16 v[252:255], v[156:159], v[140:143], v[252:255]
    v_mfma_f32_16x16x32_bf16 v[248:251], v[152:155], v[140:143], v[248:251]
    v_mfma_f32_16x16x32_bf16 v[244:247], v[148:151], v[140:143], v[244:247]
    v_mfma_f32_16x16x32_bf16 v[240:243], v[144:147], v[140:143], v[240:243]
    s_waitcnt lgkmcnt(0)
    s_barrier
    v_mfma_f32_16x16x32_bf16 v[192:195], v[176:179], v[160:163], v[192:195]
    ds_read_b128 v[128:131], v3 offset:32768
    ds_read_b64_tr_b16 v[144:145], v16 offset:49152
    v_mfma_f32_16x16x32_bf16 v[196:199], v[180:183], v[160:163], v[196:199]
    ds_read_b64_tr_b16 v[146:147], v16 offset:53248
    ds_read_b64_tr_b16 v[148:149], v17 offset:49152
    v_mfma_f32_16x16x32_bf16 v[200:203], v[184:187], v[160:163], v[200:203]
    ds_read_b64_tr_b16 v[150:151], v17 offset:53248
    ds_read_b64_tr_b16 v[152:153], v18 offset:49152
    v_mfma_f32_16x16x32_bf16 v[204:207], v[188:191], v[160:163], v[204:207]
    ds_read_b64_tr_b16 v[154:155], v18 offset:53248
    ds_read_b64_tr_b16 v[156:157], v19 offset:49152
    v_mfma_f32_16x16x32_bf16 v[220:223], v[188:191], v[164:167], v[220:223]
    ds_read_b64_tr_b16 v[158:159], v19 offset:53248
    ds_read_b128 v[132:135], v3 offset:33792
    v_mfma_f32_16x16x32_bf16 v[216:219], v[184:187], v[164:167], v[216:219]
    ds_read_b128 v[136:139], v3 offset:34816
    ds_read_b128 v[140:143], v3 offset:35840
    v_mfma_f32_16x16x32_bf16 v[212:215], v[180:183], v[164:167], v[212:215]
    v_mfma_f32_16x16x32_bf16 v[208:211], v[176:179], v[164:167], v[208:211]
    v_mfma_f32_16x16x32_bf16 v[224:227], v[176:179], v[168:171], v[224:227]
    v_mfma_f32_16x16x32_bf16 v[228:231], v[180:183], v[168:171], v[228:231]
    v_mfma_f32_16x16x32_bf16 v[232:235], v[184:187], v[168:171], v[232:235]
    v_mfma_f32_16x16x32_bf16 v[236:239], v[188:191], v[168:171], v[236:239]
    v_mfma_f32_16x16x32_bf16 v[252:255], v[188:191], v[172:175], v[252:255]
    v_mfma_f32_16x16x32_bf16 v[248:251], v[184:187], v[172:175], v[248:251]
    v_mfma_f32_16x16x32_bf16 v[244:247], v[180:183], v[172:175], v[244:247]
    v_mfma_f32_16x16x32_bf16 v[240:243], v[176:179], v[172:175], v[240:243]
    s_waitcnt lgkmcnt(0)
    v_mfma_f32_16x16x32_bf16 v[192:195], v[144:147], v[128:131], v[192:195]
    ds_read_b128 v[160:163], v3 offset:40960
    ds_read_b64_tr_b16 v[176:177], v16 offset:57344
    v_mfma_f32_16x16x32_bf16 v[196:199], v[148:151], v[128:131], v[196:199]
    ds_read_b64_tr_b16 v[178:179], v16 offset:61440
    ds_read_b64_tr_b16 v[180:181], v17 offset:57344
    v_mfma_f32_16x16x32_bf16 v[200:203], v[152:155], v[128:131], v[200:203]
    ds_read_b64_tr_b16 v[182:183], v17 offset:61440
    ds_read_b64_tr_b16 v[184:185], v18 offset:57344
    v_mfma_f32_16x16x32_bf16 v[204:207], v[156:159], v[128:131], v[204:207]
    ds_read_b64_tr_b16 v[186:187], v18 offset:61440
    ds_read_b64_tr_b16 v[188:189], v19 offset:57344
    v_mfma_f32_16x16x32_bf16 v[220:223], v[156:159], v[132:135], v[220:223]
    ds_read_b64_tr_b16 v[190:191], v19 offset:61440
    ds_read_b128 v[164:167], v3 offset:41984
    v_mfma_f32_16x16x32_bf16 v[216:219], v[152:155], v[132:135], v[216:219]
    ds_read_b128 v[168:171], v3 offset:43008
    ds_read_b128 v[172:175], v3 offset:44032
    v_mfma_f32_16x16x32_bf16 v[212:215], v[148:151], v[132:135], v[212:215]
    v_mfma_f32_16x16x32_bf16 v[208:211], v[144:147], v[132:135], v[208:211]
    v_mfma_f32_16x16x32_bf16 v[224:227], v[144:147], v[136:139], v[224:227]
    v_mfma_f32_16x16x32_bf16 v[228:231], v[148:151], v[136:139], v[228:231]
    v_mfma_f32_16x16x32_bf16 v[232:235], v[152:155], v[136:139], v[232:235]
    v_mfma_f32_16x16x32_bf16 v[236:239], v[156:159], v[136:139], v[236:239]
    v_mfma_f32_16x16x32_bf16 v[252:255], v[156:159], v[140:143], v[252:255]
    v_mfma_f32_16x16x32_bf16 v[248:251], v[152:155], v[140:143], v[248:251]
    v_mfma_f32_16x16x32_bf16 v[244:247], v[148:151], v[140:143], v[244:247]
    v_mfma_f32_16x16x32_bf16 v[240:243], v[144:147], v[140:143], v[240:243]
    s_waitcnt lgkmcnt(0)
    s_barrier
    v_mfma_f32_16x16x32_bf16 v[192:195], v[176:179], v[160:163], v[192:195]
    ds_read_b128 v[128:131], v2 offset:0
    ds_read_b64_tr_b16 v[144:145], v12 offset:16384
    v_mfma_f32_16x16x32_bf16 v[196:199], v[180:183], v[160:163], v[196:199]
    ds_read_b64_tr_b16 v[146:147], v12 offset:20480
    ds_read_b64_tr_b16 v[148:149], v13 offset:16384
    v_mfma_f32_16x16x32_bf16 v[200:203], v[184:187], v[160:163], v[200:203]
    ds_read_b64_tr_b16 v[150:151], v13 offset:20480
    ds_read_b64_tr_b16 v[152:153], v14 offset:16384
    v_mfma_f32_16x16x32_bf16 v[204:207], v[188:191], v[160:163], v[204:207]
    ds_read_b64_tr_b16 v[154:155], v14 offset:20480
    ds_read_b64_tr_b16 v[156:157], v15 offset:16384
    v_mfma_f32_16x16x32_bf16 v[220:223], v[188:191], v[164:167], v[220:223]
    ds_read_b64_tr_b16 v[158:159], v15 offset:20480
    ds_read_b128 v[132:135], v2 offset:1024
    v_mfma_f32_16x16x32_bf16 v[216:219], v[184:187], v[164:167], v[216:219]
    ds_read_b128 v[136:139], v2 offset:2048
    ds_read_b128 v[140:143], v2 offset:3072
    v_mfma_f32_16x16x32_bf16 v[212:215], v[180:183], v[164:167], v[212:215]
    v_mfma_f32_16x16x32_bf16 v[208:211], v[176:179], v[164:167], v[208:211]
    v_mfma_f32_16x16x32_bf16 v[224:227], v[176:179], v[168:171], v[224:227]
    v_mfma_f32_16x16x32_bf16 v[228:231], v[180:183], v[168:171], v[228:231]
    v_mfma_f32_16x16x32_bf16 v[232:235], v[184:187], v[168:171], v[232:235]
    v_mfma_f32_16x16x32_bf16 v[236:239], v[188:191], v[168:171], v[236:239]
    v_mfma_f32_16x16x32_bf16 v[252:255], v[188:191], v[172:175], v[252:255]
    v_mfma_f32_16x16x32_bf16 v[248:251], v[184:187], v[172:175], v[248:251]
    v_mfma_f32_16x16x32_bf16 v[244:247], v[180:183], v[172:175], v[244:247]
    v_mfma_f32_16x16x32_bf16 v[240:243], v[176:179], v[172:175], v[240:243]
    s_waitcnt lgkmcnt(0)
    v_mfma_f32_16x16x32_bf16 v[192:195], v[144:147], v[128:131], v[192:195]
    ds_read_b128 v[160:163], v2 offset:8192
    ds_read_b64_tr_b16 v[176:177], v12 offset:24576
    v_mfma_f32_16x16x32_bf16 v[196:199], v[148:151], v[128:131], v[196:199]
    ds_read_b64_tr_b16 v[178:179], v12 offset:28672
    ds_read_b64_tr_b16 v[180:181], v13 offset:24576
    v_mfma_f32_16x16x32_bf16 v[200:203], v[152:155], v[128:131], v[200:203]
    ds_read_b64_tr_b16 v[182:183], v13 offset:28672
    ds_read_b64_tr_b16 v[184:185], v14 offset:24576
    v_mfma_f32_16x16x32_bf16 v[204:207], v[156:159], v[128:131], v[204:207]
    ds_read_b64_tr_b16 v[186:187], v14 offset:28672
    ds_read_b64_tr_b16 v[188:189], v15 offset:24576
    v_mfma_f32_16x16x32_bf16 v[220:223], v[156:159], v[132:135], v[220:223]
    ds_read_b64_tr_b16 v[190:191], v15 offset:28672
    ds_read_b128 v[164:167], v2 offset:9216
    v_mfma_f32_16x16x32_bf16 v[216:219], v[152:155], v[132:135], v[216:219]
    ds_read_b128 v[168:171], v2 offset:10240
    ds_read_b128 v[172:175], v2 offset:11264
    v_mfma_f32_16x16x32_bf16 v[212:215], v[148:151], v[132:135], v[212:215]
    v_mfma_f32_16x16x32_bf16 v[208:211], v[144:147], v[132:135], v[208:211]
    v_mfma_f32_16x16x32_bf16 v[224:227], v[144:147], v[136:139], v[224:227]
    v_mfma_f32_16x16x32_bf16 v[228:231], v[148:151], v[136:139], v[228:231]
    v_mfma_f32_16x16x32_bf16 v[232:235], v[152:155], v[136:139], v[232:235]
    v_mfma_f32_16x16x32_bf16 v[236:239], v[156:159], v[136:139], v[236:239]
    v_mfma_f32_16x16x32_bf16 v[252:255], v[156:159], v[140:143], v[252:255]
    v_mfma_f32_16x16x32_bf16 v[248:251], v[152:155], v[140:143], v[248:251]
    v_mfma_f32_16x16x32_bf16 v[244:247], v[148:151], v[140:143], v[244:247]
    v_mfma_f32_16x16x32_bf16 v[240:243], v[144:147], v[140:143], v[240:243]
    s_waitcnt lgkmcnt(0)
    s_barrier
    v_mfma_f32_16x16x32_bf16 v[192:195], v[176:179], v[160:163], v[192:195]
    ds_read_b128 v[128:131], v2 offset:32768
    ds_read_b64_tr_b16 v[144:145], v12 offset:49152
    v_mfma_f32_16x16x32_bf16 v[196:199], v[180:183], v[160:163], v[196:199]
    ds_read_b64_tr_b16 v[146:147], v12 offset:53248
    ds_read_b64_tr_b16 v[148:149], v13 offset:49152
    v_mfma_f32_16x16x32_bf16 v[200:203], v[184:187], v[160:163], v[200:203]
    ds_read_b64_tr_b16 v[150:151], v13 offset:53248
    ds_read_b64_tr_b16 v[152:153], v14 offset:49152
    v_mfma_f32_16x16x32_bf16 v[204:207], v[188:191], v[160:163], v[204:207]
    ds_read_b64_tr_b16 v[154:155], v14 offset:53248
    ds_read_b64_tr_b16 v[156:157], v15 offset:49152
    v_mfma_f32_16x16x32_bf16 v[220:223], v[188:191], v[164:167], v[220:223]
    ds_read_b64_tr_b16 v[158:159], v15 offset:53248
    ds_read_b128 v[132:135], v2 offset:33792
    v_mfma_f32_16x16x32_bf16 v[216:219], v[184:187], v[164:167], v[216:219]
    ds_read_b128 v[136:139], v2 offset:34816
    ds_read_b128 v[140:143], v2 offset:35840
    v_mfma_f32_16x16x32_bf16 v[212:215], v[180:183], v[164:167], v[212:215]
    v_mfma_f32_16x16x32_bf16 v[208:211], v[176:179], v[164:167], v[208:211]
    v_mfma_f32_16x16x32_bf16 v[224:227], v[176:179], v[168:171], v[224:227]
    v_mfma_f32_16x16x32_bf16 v[228:231], v[180:183], v[168:171], v[228:231]
    v_mfma_f32_16x16x32_bf16 v[232:235], v[184:187], v[168:171], v[232:235]
    v_mfma_f32_16x16x32_bf16 v[236:239], v[188:191], v[168:171], v[236:239]
    v_mfma_f32_16x16x32_bf16 v[252:255], v[188:191], v[172:175], v[252:255]
    v_mfma_f32_16x16x32_bf16 v[248:251], v[184:187], v[172:175], v[248:251]
    v_mfma_f32_16x16x32_bf16 v[244:247], v[180:183], v[172:175], v[244:247]
    v_mfma_f32_16x16x32_bf16 v[240:243], v[176:179], v[172:175], v[240:243]
    s_waitcnt lgkmcnt(0)
    v_mfma_f32_16x16x32_bf16 v[192:195], v[144:147], v[128:131], v[192:195]
    ds_read_b128 v[160:163], v2 offset:40960
    ds_read_b64_tr_b16 v[176:177], v12 offset:57344
    v_mfma_f32_16x16x32_bf16 v[196:199], v[148:151], v[128:131], v[196:199]
    ds_read_b64_tr_b16 v[178:179], v12 offset:61440
    ds_read_b64_tr_b16 v[180:181], v13 offset:57344
    v_mfma_f32_16x16x32_bf16 v[200:203], v[152:155], v[128:131], v[200:203]
    ds_read_b64_tr_b16 v[182:183], v13 offset:61440
    ds_read_b64_tr_b16 v[184:185], v14 offset:57344
    v_mfma_f32_16x16x32_bf16 v[204:207], v[156:159], v[128:131], v[204:207]
    ds_read_b64_tr_b16 v[186:187], v14 offset:61440
    ds_read_b64_tr_b16 v[188:189], v15 offset:57344
    v_mfma_f32_16x16x32_bf16 v[220:223], v[156:159], v[132:135], v[220:223]
    ds_read_b64_tr_b16 v[190:191], v15 offset:61440
    ds_read_b128 v[164:167], v2 offset:41984
    v_mfma_f32_16x16x32_bf16 v[216:219], v[152:155], v[132:135], v[216:219]
    ds_read_b128 v[168:171], v2 offset:43008
    ds_read_b128 v[172:175], v2 offset:44032
    v_mfma_f32_16x16x32_bf16 v[212:215], v[148:151], v[132:135], v[212:215]
    v_mfma_f32_16x16x32_bf16 v[208:211], v[144:147], v[132:135], v[208:211]
    v_mfma_f32_16x16x32_bf16 v[224:227], v[144:147], v[136:139], v[224:227]
    v_mfma_f32_16x16x32_bf16 v[228:231], v[148:151], v[136:139], v[228:231]
    v_mfma_f32_16x16x32_bf16 v[232:235], v[152:155], v[136:139], v[232:235]
    v_mfma_f32_16x16x32_bf16 v[236:239], v[156:159], v[136:139], v[236:239]
    v_mfma_f32_16x16x32_bf16 v[252:255], v[156:159], v[140:143], v[252:255]
    v_mfma_f32_16x16x32_bf16 v[248:251], v[152:155], v[140:143], v[248:251]
    v_mfma_f32_16x16x32_bf16 v[244:247], v[148:151], v[140:143], v[244:247]
    v_mfma_f32_16x16x32_bf16 v[240:243], v[144:147], v[140:143], v[240:243]
    s_waitcnt lgkmcnt(0)
    s_barrier
    v_mfma_f32_16x16x32_bf16 v[192:195], v[176:179], v[160:163], v[192:195]
    ds_read_b128 v[128:131], v3 offset:0
    ds_read_b64_tr_b16 v[144:145], v16 offset:16384
    v_mfma_f32_16x16x32_bf16 v[196:199], v[180:183], v[160:163], v[196:199]
    ds_read_b64_tr_b16 v[146:147], v16 offset:20480
    ds_read_b64_tr_b16 v[148:149], v17 offset:16384
    v_mfma_f32_16x16x32_bf16 v[200:203], v[184:187], v[160:163], v[200:203]
    ds_read_b64_tr_b16 v[150:151], v17 offset:20480
    ds_read_b64_tr_b16 v[152:153], v18 offset:16384
    v_mfma_f32_16x16x32_bf16 v[204:207], v[188:191], v[160:163], v[204:207]
    ds_read_b64_tr_b16 v[154:155], v18 offset:20480
    ds_read_b64_tr_b16 v[156:157], v19 offset:16384
    v_mfma_f32_16x16x32_bf16 v[220:223], v[188:191], v[164:167], v[220:223]
    ds_read_b64_tr_b16 v[158:159], v19 offset:20480
    ds_read_b128 v[132:135], v3 offset:1024
    v_mfma_f32_16x16x32_bf16 v[216:219], v[184:187], v[164:167], v[216:219]
    ds_read_b128 v[136:139], v3 offset:2048
    ds_read_b128 v[140:143], v3 offset:3072
    v_mfma_f32_16x16x32_bf16 v[212:215], v[180:183], v[164:167], v[212:215]
    v_mfma_f32_16x16x32_bf16 v[208:211], v[176:179], v[164:167], v[208:211]
    v_mfma_f32_16x16x32_bf16 v[224:227], v[176:179], v[168:171], v[224:227]
    v_mfma_f32_16x16x32_bf16 v[228:231], v[180:183], v[168:171], v[228:231]
    v_mfma_f32_16x16x32_bf16 v[232:235], v[184:187], v[168:171], v[232:235]
    v_mfma_f32_16x16x32_bf16 v[236:239], v[188:191], v[168:171], v[236:239]
    v_mfma_f32_16x16x32_bf16 v[252:255], v[188:191], v[172:175], v[252:255]
    v_mfma_f32_16x16x32_bf16 v[248:251], v[184:187], v[172:175], v[248:251]
    v_mfma_f32_16x16x32_bf16 v[244:247], v[180:183], v[172:175], v[244:247]
    v_mfma_f32_16x16x32_bf16 v[240:243], v[176:179], v[172:175], v[240:243]
    s_waitcnt lgkmcnt(0)
    v_mfma_f32_16x16x32_bf16 v[192:195], v[144:147], v[128:131], v[192:195]
    ds_read_b128 v[160:163], v3 offset:8192
    ds_read_b64_tr_b16 v[176:177], v16 offset:24576
    v_mfma_f32_16x16x32_bf16 v[196:199], v[148:151], v[128:131], v[196:199]
    ds_read_b64_tr_b16 v[178:179], v16 offset:28672
    ds_read_b64_tr_b16 v[180:181], v17 offset:24576
    v_mfma_f32_16x16x32_bf16 v[200:203], v[152:155], v[128:131], v[200:203]
    ds_read_b64_tr_b16 v[182:183], v17 offset:28672
    ds_read_b64_tr_b16 v[184:185], v18 offset:24576
    v_mfma_f32_16x16x32_bf16 v[204:207], v[156:159], v[128:131], v[204:207]
    ds_read_b64_tr_b16 v[186:187], v18 offset:28672
    ds_read_b64_tr_b16 v[188:189], v19 offset:24576
    v_mfma_f32_16x16x32_bf16 v[220:223], v[156:159], v[132:135], v[220:223]
    ds_read_b64_tr_b16 v[190:191], v19 offset:28672
    ds_read_b128 v[164:167], v3 offset:9216
    v_mfma_f32_16x16x32_bf16 v[216:219], v[152:155], v[132:135], v[216:219]
    ds_read_b128 v[168:171], v3 offset:10240
    ds_read_b128 v[172:175], v3 offset:11264
    v_mfma_f32_16x16x32_bf16 v[212:215], v[148:151], v[132:135], v[212:215]
    v_mfma_f32_16x16x32_bf16 v[208:211], v[144:147], v[132:135], v[208:211]
    v_mfma_f32_16x16x32_bf16 v[224:227], v[144:147], v[136:139], v[224:227]
    v_mfma_f32_16x16x32_bf16 v[228:231], v[148:151], v[136:139], v[228:231]
    v_mfma_f32_16x16x32_bf16 v[232:235], v[152:155], v[136:139], v[232:235]
    v_mfma_f32_16x16x32_bf16 v[236:239], v[156:159], v[136:139], v[236:239]
    v_mfma_f32_16x16x32_bf16 v[252:255], v[156:159], v[140:143], v[252:255]
    v_mfma_f32_16x16x32_bf16 v[248:251], v[152:155], v[140:143], v[248:251]
    v_mfma_f32_16x16x32_bf16 v[244:247], v[148:151], v[140:143], v[244:247]
    v_mfma_f32_16x16x32_bf16 v[240:243], v[144:147], v[140:143], v[240:243]
    s_waitcnt lgkmcnt(0)
    s_barrier
    v_mfma_f32_16x16x32_bf16 v[192:195], v[176:179], v[160:163], v[192:195]
    ds_read_b128 v[128:131], v3 offset:32768
    ds_read_b64_tr_b16 v[144:145], v16 offset:49152
    v_mfma_f32_16x16x32_bf16 v[196:199], v[180:183], v[160:163], v[196:199]
    ds_read_b64_tr_b16 v[146:147], v16 offset:53248
    ds_read_b64_tr_b16 v[148:149], v17 offset:49152
    v_mfma_f32_16x16x32_bf16 v[200:203], v[184:187], v[160:163], v[200:203]
    ds_read_b64_tr_b16 v[150:151], v17 offset:53248
    ds_read_b64_tr_b16 v[152:153], v18 offset:49152
    v_mfma_f32_16x16x32_bf16 v[204:207], v[188:191], v[160:163], v[204:207]
    ds_read_b64_tr_b16 v[154:155], v18 offset:53248
    ds_read_b64_tr_b16 v[156:157], v19 offset:49152
    v_mfma_f32_16x16x32_bf16 v[220:223], v[188:191], v[164:167], v[220:223]
    ds_read_b64_tr_b16 v[158:159], v19 offset:53248
    ds_read_b128 v[132:135], v3 offset:33792
    v_mfma_f32_16x16x32_bf16 v[216:219], v[184:187], v[164:167], v[216:219]
    ds_read_b128 v[136:139], v3 offset:34816
    ds_read_b128 v[140:143], v3 offset:35840
    v_mfma_f32_16x16x32_bf16 v[212:215], v[180:183], v[164:167], v[212:215]
    v_mfma_f32_16x16x32_bf16 v[208:211], v[176:179], v[164:167], v[208:211]
    v_mfma_f32_16x16x32_bf16 v[224:227], v[176:179], v[168:171], v[224:227]
    v_mfma_f32_16x16x32_bf16 v[228:231], v[180:183], v[168:171], v[228:231]
    v_mfma_f32_16x16x32_bf16 v[232:235], v[184:187], v[168:171], v[232:235]
    v_mfma_f32_16x16x32_bf16 v[236:239], v[188:191], v[168:171], v[236:239]
    v_mfma_f32_16x16x32_bf16 v[252:255], v[188:191], v[172:175], v[252:255]
    v_mfma_f32_16x16x32_bf16 v[248:251], v[184:187], v[172:175], v[248:251]
    v_mfma_f32_16x16x32_bf16 v[244:247], v[180:183], v[172:175], v[244:247]
    v_mfma_f32_16x16x32_bf16 v[240:243], v[176:179], v[172:175], v[240:243]
    s_waitcnt lgkmcnt(0)
    v_mfma_f32_16x16x32_bf16 v[192:195], v[144:147], v[128:131], v[192:195]
    ds_read_b128 v[160:163], v3 offset:40960
    ds_read_b64_tr_b16 v[176:177], v16 offset:57344
    v_mfma_f32_16x16x32_bf16 v[196:199], v[148:151], v[128:131], v[196:199]
    ds_read_b64_tr_b16 v[178:179], v16 offset:61440
    ds_read_b64_tr_b16 v[180:181], v17 offset:57344
    v_mfma_f32_16x16x32_bf16 v[200:203], v[152:155], v[128:131], v[200:203]
    ds_read_b64_tr_b16 v[182:183], v17 offset:61440
    ds_read_b64_tr_b16 v[184:185], v18 offset:57344
    v_mfma_f32_16x16x32_bf16 v[204:207], v[156:159], v[128:131], v[204:207]
    ds_read_b64_tr_b16 v[186:187], v18 offset:61440
    ds_read_b64_tr_b16 v[188:189], v19 offset:57344
    v_mfma_f32_16x16x32_bf16 v[220:223], v[156:159], v[132:135], v[220:223]
    ds_read_b64_tr_b16 v[190:191], v19 offset:61440
    ds_read_b128 v[164:167], v3 offset:41984
    v_mfma_f32_16x16x32_bf16 v[216:219], v[152:155], v[132:135], v[216:219]
    ds_read_b128 v[168:171], v3 offset:43008
    ds_read_b128 v[172:175], v3 offset:44032
    v_mfma_f32_16x16x32_bf16 v[212:215], v[148:151], v[132:135], v[212:215]
    v_mfma_f32_16x16x32_bf16 v[208:211], v[144:147], v[132:135], v[208:211]
    v_mfma_f32_16x16x32_bf16 v[224:227], v[144:147], v[136:139], v[224:227]
    v_mfma_f32_16x16x32_bf16 v[228:231], v[148:151], v[136:139], v[228:231]
    v_mfma_f32_16x16x32_bf16 v[232:235], v[152:155], v[136:139], v[232:235]
    v_mfma_f32_16x16x32_bf16 v[236:239], v[156:159], v[136:139], v[236:239]
    v_mfma_f32_16x16x32_bf16 v[252:255], v[156:159], v[140:143], v[252:255]
    v_mfma_f32_16x16x32_bf16 v[248:251], v[152:155], v[140:143], v[248:251]
    v_mfma_f32_16x16x32_bf16 v[244:247], v[148:151], v[140:143], v[244:247]
    v_mfma_f32_16x16x32_bf16 v[240:243], v[144:147], v[140:143], v[240:243]
    s_waitcnt lgkmcnt(0)
    s_barrier
    v_mfma_f32_16x16x32_bf16 v[192:195], v[176:179], v[160:163], v[192:195]
    ds_read_b128 v[128:131], v2 offset:0
    ds_read_b64_tr_b16 v[144:145], v12 offset:16384
    v_mfma_f32_16x16x32_bf16 v[196:199], v[180:183], v[160:163], v[196:199]
    ds_read_b64_tr_b16 v[146:147], v12 offset:20480
    ds_read_b64_tr_b16 v[148:149], v13 offset:16384
    v_mfma_f32_16x16x32_bf16 v[200:203], v[184:187], v[160:163], v[200:203]
    ds_read_b64_tr_b16 v[150:151], v13 offset:20480
    ds_read_b64_tr_b16 v[152:153], v14 offset:16384
    v_mfma_f32_16x16x32_bf16 v[204:207], v[188:191], v[160:163], v[204:207]
    ds_read_b64_tr_b16 v[154:155], v14 offset:20480
    ds_read_b64_tr_b16 v[156:157], v15 offset:16384
    v_mfma_f32_16x16x32_bf16 v[220:223], v[188:191], v[164:167], v[220:223]
    ds_read_b64_tr_b16 v[158:159], v15 offset:20480
    ds_read_b128 v[132:135], v2 offset:1024
    v_mfma_f32_16x16x32_bf16 v[216:219], v[184:187], v[164:167], v[216:219]
    ds_read_b128 v[136:139], v2 offset:2048
    ds_read_b128 v[140:143], v2 offset:3072
    v_mfma_f32_16x16x32_bf16 v[212:215], v[180:183], v[164:167], v[212:215]
    v_mfma_f32_16x16x32_bf16 v[208:211], v[176:179], v[164:167], v[208:211]
    v_mfma_f32_16x16x32_bf16 v[224:227], v[176:179], v[168:171], v[224:227]
    v_mfma_f32_16x16x32_bf16 v[228:231], v[180:183], v[168:171], v[228:231]
    v_mfma_f32_16x16x32_bf16 v[232:235], v[184:187], v[168:171], v[232:235]
    v_mfma_f32_16x16x32_bf16 v[236:239], v[188:191], v[168:171], v[236:239]
    v_mfma_f32_16x16x32_bf16 v[252:255], v[188:191], v[172:175], v[252:255]
    v_mfma_f32_16x16x32_bf16 v[248:251], v[184:187], v[172:175], v[248:251]
    v_mfma_f32_16x16x32_bf16 v[244:247], v[180:183], v[172:175], v[244:247]
    v_mfma_f32_16x16x32_bf16 v[240:243], v[176:179], v[172:175], v[240:243]
    s_waitcnt lgkmcnt(0)
    v_mfma_f32_16x16x32_bf16 v[192:195], v[144:147], v[128:131], v[192:195]
    ds_read_b128 v[160:163], v2 offset:8192
    ds_read_b64_tr_b16 v[176:177], v12 offset:24576
    v_mfma_f32_16x16x32_bf16 v[196:199], v[148:151], v[128:131], v[196:199]
    ds_read_b64_tr_b16 v[178:179], v12 offset:28672
    ds_read_b64_tr_b16 v[180:181], v13 offset:24576
    v_mfma_f32_16x16x32_bf16 v[200:203], v[152:155], v[128:131], v[200:203]
    ds_read_b64_tr_b16 v[182:183], v13 offset:28672
    ds_read_b64_tr_b16 v[184:185], v14 offset:24576
    v_mfma_f32_16x16x32_bf16 v[204:207], v[156:159], v[128:131], v[204:207]
    ds_read_b64_tr_b16 v[186:187], v14 offset:28672
    ds_read_b64_tr_b16 v[188:189], v15 offset:24576
    v_mfma_f32_16x16x32_bf16 v[220:223], v[156:159], v[132:135], v[220:223]
    ds_read_b64_tr_b16 v[190:191], v15 offset:28672
    ds_read_b128 v[164:167], v2 offset:9216
    v_mfma_f32_16x16x32_bf16 v[216:219], v[152:155], v[132:135], v[216:219]
    ds_read_b128 v[168:171], v2 offset:10240
    ds_read_b128 v[172:175], v2 offset:11264
    v_mfma_f32_16x16x32_bf16 v[212:215], v[148:151], v[132:135], v[212:215]
    v_mfma_f32_16x16x32_bf16 v[208:211], v[144:147], v[132:135], v[208:211]
    v_mfma_f32_16x16x32_bf16 v[224:227], v[144:147], v[136:139], v[224:227]
    v_mfma_f32_16x16x32_bf16 v[228:231], v[148:151], v[136:139], v[228:231]
    v_mfma_f32_16x16x32_bf16 v[232:235], v[152:155], v[136:139], v[232:235]
    v_mfma_f32_16x16x32_bf16 v[236:239], v[156:159], v[136:139], v[236:239]
    v_mfma_f32_16x16x32_bf16 v[252:255], v[156:159], v[140:143], v[252:255]
    v_mfma_f32_16x16x32_bf16 v[248:251], v[152:155], v[140:143], v[248:251]
    v_mfma_f32_16x16x32_bf16 v[244:247], v[148:151], v[140:143], v[244:247]
    v_mfma_f32_16x16x32_bf16 v[240:243], v[144:147], v[140:143], v[240:243]
    s_waitcnt lgkmcnt(0)
    s_barrier
    v_mfma_f32_16x16x32_bf16 v[192:195], v[176:179], v[160:163], v[192:195]
    ds_read_b128 v[128:131], v2 offset:32768
    ds_read_b64_tr_b16 v[144:145], v12 offset:49152
    v_mfma_f32_16x16x32_bf16 v[196:199], v[180:183], v[160:163], v[196:199]
    ds_read_b64_tr_b16 v[146:147], v12 offset:53248
    ds_read_b64_tr_b16 v[148:149], v13 offset:49152
    v_mfma_f32_16x16x32_bf16 v[200:203], v[184:187], v[160:163], v[200:203]
    ds_read_b64_tr_b16 v[150:151], v13 offset:53248
    ds_read_b64_tr_b16 v[152:153], v14 offset:49152
    v_mfma_f32_16x16x32_bf16 v[204:207], v[188:191], v[160:163], v[204:207]
    ds_read_b64_tr_b16 v[154:155], v14 offset:53248
    ds_read_b64_tr_b16 v[156:157], v15 offset:49152
    v_mfma_f32_16x16x32_bf16 v[220:223], v[188:191], v[164:167], v[220:223]
    ds_read_b64_tr_b16 v[158:159], v15 offset:53248
    ds_read_b128 v[132:135], v2 offset:33792
    v_mfma_f32_16x16x32_bf16 v[216:219], v[184:187], v[164:167], v[216:219]
    ds_read_b128 v[136:139], v2 offset:34816
    ds_read_b128 v[140:143], v2 offset:35840
    v_mfma_f32_16x16x32_bf16 v[212:215], v[180:183], v[164:167], v[212:215]
    v_mfma_f32_16x16x32_bf16 v[208:211], v[176:179], v[164:167], v[208:211]
    v_mfma_f32_16x16x32_bf16 v[224:227], v[176:179], v[168:171], v[224:227]
    v_mfma_f32_16x16x32_bf16 v[228:231], v[180:183], v[168:171], v[228:231]
    v_mfma_f32_16x16x32_bf16 v[232:235], v[184:187], v[168:171], v[232:235]
    v_mfma_f32_16x16x32_bf16 v[236:239], v[188:191], v[168:171], v[236:239]
    v_mfma_f32_16x16x32_bf16 v[252:255], v[188:191], v[172:175], v[252:255]
    v_mfma_f32_16x16x32_bf16 v[248:251], v[184:187], v[172:175], v[248:251]
    v_mfma_f32_16x16x32_bf16 v[244:247], v[180:183], v[172:175], v[244:247]
    v_mfma_f32_16x16x32_bf16 v[240:243], v[176:179], v[172:175], v[240:243]
    s_waitcnt lgkmcnt(0)
    v_mfma_f32_16x16x32_bf16 v[192:195], v[144:147], v[128:131], v[192:195]
    ds_read_b128 v[160:163], v2 offset:40960
    ds_read_b64_tr_b16 v[176:177], v12 offset:57344
    v_mfma_f32_16x16x32_bf16 v[196:199], v[148:151], v[128:131], v[196:199]
    ds_read_b64_tr_b16 v[178:179], v12 offset:61440
    ds_read_b64_tr_b16 v[180:181], v13 offset:57344
    v_mfma_f32_16x16x32_bf16 v[200:203], v[152:155], v[128:131], v[200:203]
    ds_read_b64_tr_b16 v[182:183], v13 offset:61440
    ds_read_b64_tr_b16 v[184:185], v14 offset:57344
    v_mfma_f32_16x16x32_bf16 v[204:207], v[156:159], v[128:131], v[204:207]
    ds_read_b64_tr_b16 v[186:187], v14 offset:61440
    ds_read_b64_tr_b16 v[188:189], v15 offset:57344
    v_mfma_f32_16x16x32_bf16 v[220:223], v[156:159], v[132:135], v[220:223]
    ds_read_b64_tr_b16 v[190:191], v15 offset:61440
    ds_read_b128 v[164:167], v2 offset:41984
    v_mfma_f32_16x16x32_bf16 v[216:219], v[152:155], v[132:135], v[216:219]
    ds_read_b128 v[168:171], v2 offset:43008
    ds_read_b128 v[172:175], v2 offset:44032
    v_mfma_f32_16x16x32_bf16 v[212:215], v[148:151], v[132:135], v[212:215]
    v_mfma_f32_16x16x32_bf16 v[208:211], v[144:147], v[132:135], v[208:211]
    v_mfma_f32_16x16x32_bf16 v[224:227], v[144:147], v[136:139], v[224:227]
    v_mfma_f32_16x16x32_bf16 v[228:231], v[148:151], v[136:139], v[228:231]
    v_mfma_f32_16x16x32_bf16 v[232:235], v[152:155], v[136:139], v[232:235]
    v_mfma_f32_16x16x32_bf16 v[236:239], v[156:159], v[136:139], v[236:239]
    v_mfma_f32_16x16x32_bf16 v[252:255], v[156:159], v[140:143], v[252:255]
    v_mfma_f32_16x16x32_bf16 v[248:251], v[152:155], v[140:143], v[248:251]
    v_mfma_f32_16x16x32_bf16 v[244:247], v[148:151], v[140:143], v[244:247]
    v_mfma_f32_16x16x32_bf16 v[240:243], v[144:147], v[140:143], v[240:243]
    s_waitcnt lgkmcnt(0)
    s_barrier
    v_mfma_f32_16x16x32_bf16 v[192:195], v[176:179], v[160:163], v[192:195]
    ds_read_b128 v[128:131], v3 offset:0
    ds_read_b64_tr_b16 v[144:145], v16 offset:16384
    v_mfma_f32_16x16x32_bf16 v[196:199], v[180:183], v[160:163], v[196:199]
    ds_read_b64_tr_b16 v[146:147], v16 offset:20480
    ds_read_b64_tr_b16 v[148:149], v17 offset:16384
    v_mfma_f32_16x16x32_bf16 v[200:203], v[184:187], v[160:163], v[200:203]
    ds_read_b64_tr_b16 v[150:151], v17 offset:20480
    ds_read_b64_tr_b16 v[152:153], v18 offset:16384
    v_mfma_f32_16x16x32_bf16 v[204:207], v[188:191], v[160:163], v[204:207]
    ds_read_b64_tr_b16 v[154:155], v18 offset:20480
    ds_read_b64_tr_b16 v[156:157], v19 offset:16384
    v_mfma_f32_16x16x32_bf16 v[220:223], v[188:191], v[164:167], v[220:223]
    ds_read_b64_tr_b16 v[158:159], v19 offset:20480
    ds_read_b128 v[132:135], v3 offset:1024
    v_mfma_f32_16x16x32_bf16 v[216:219], v[184:187], v[164:167], v[216:219]
    ds_read_b128 v[136:139], v3 offset:2048
    ds_read_b128 v[140:143], v3 offset:3072
    v_mfma_f32_16x16x32_bf16 v[212:215], v[180:183], v[164:167], v[212:215]
    v_mfma_f32_16x16x32_bf16 v[208:211], v[176:179], v[164:167], v[208:211]
    v_mfma_f32_16x16x32_bf16 v[224:227], v[176:179], v[168:171], v[224:227]
    v_mfma_f32_16x16x32_bf16 v[228:231], v[180:183], v[168:171], v[228:231]
    v_mfma_f32_16x16x32_bf16 v[232:235], v[184:187], v[168:171], v[232:235]
    v_mfma_f32_16x16x32_bf16 v[236:239], v[188:191], v[168:171], v[236:239]
    v_mfma_f32_16x16x32_bf16 v[252:255], v[188:191], v[172:175], v[252:255]
    v_mfma_f32_16x16x32_bf16 v[248:251], v[184:187], v[172:175], v[248:251]
    v_mfma_f32_16x16x32_bf16 v[244:247], v[180:183], v[172:175], v[244:247]
    v_mfma_f32_16x16x32_bf16 v[240:243], v[176:179], v[172:175], v[240:243]
    s_waitcnt lgkmcnt(0)
    v_mfma_f32_16x16x32_bf16 v[192:195], v[144:147], v[128:131], v[192:195]
    ds_read_b128 v[160:163], v3 offset:8192
    ds_read_b64_tr_b16 v[176:177], v16 offset:24576
    v_mfma_f32_16x16x32_bf16 v[196:199], v[148:151], v[128:131], v[196:199]
    ds_read_b64_tr_b16 v[178:179], v16 offset:28672
    ds_read_b64_tr_b16 v[180:181], v17 offset:24576
    v_mfma_f32_16x16x32_bf16 v[200:203], v[152:155], v[128:131], v[200:203]
    ds_read_b64_tr_b16 v[182:183], v17 offset:28672
    ds_read_b64_tr_b16 v[184:185], v18 offset:24576
    v_mfma_f32_16x16x32_bf16 v[204:207], v[156:159], v[128:131], v[204:207]
    ds_read_b64_tr_b16 v[186:187], v18 offset:28672
    ds_read_b64_tr_b16 v[188:189], v19 offset:24576
    v_mfma_f32_16x16x32_bf16 v[220:223], v[156:159], v[132:135], v[220:223]
    ds_read_b64_tr_b16 v[190:191], v19 offset:28672
    ds_read_b128 v[164:167], v3 offset:9216
    v_mfma_f32_16x16x32_bf16 v[216:219], v[152:155], v[132:135], v[216:219]
    ds_read_b128 v[168:171], v3 offset:10240
    ds_read_b128 v[172:175], v3 offset:11264
    v_mfma_f32_16x16x32_bf16 v[212:215], v[148:151], v[132:135], v[212:215]
    v_mfma_f32_16x16x32_bf16 v[208:211], v[144:147], v[132:135], v[208:211]
    v_mfma_f32_16x16x32_bf16 v[224:227], v[144:147], v[136:139], v[224:227]
    v_mfma_f32_16x16x32_bf16 v[228:231], v[148:151], v[136:139], v[228:231]
    v_mfma_f32_16x16x32_bf16 v[232:235], v[152:155], v[136:139], v[232:235]
    v_mfma_f32_16x16x32_bf16 v[236:239], v[156:159], v[136:139], v[236:239]
    v_mfma_f32_16x16x32_bf16 v[252:255], v[156:159], v[140:143], v[252:255]
    v_mfma_f32_16x16x32_bf16 v[248:251], v[152:155], v[140:143], v[248:251]
    v_mfma_f32_16x16x32_bf16 v[244:247], v[148:151], v[140:143], v[244:247]
    v_mfma_f32_16x16x32_bf16 v[240:243], v[144:147], v[140:143], v[240:243]
    s_waitcnt lgkmcnt(0)
    s_barrier
    v_mfma_f32_16x16x32_bf16 v[192:195], v[176:179], v[160:163], v[192:195]
    ds_read_b128 v[128:131], v3 offset:32768
    ds_read_b64_tr_b16 v[144:145], v16 offset:49152
    v_mfma_f32_16x16x32_bf16 v[196:199], v[180:183], v[160:163], v[196:199]
    ds_read_b64_tr_b16 v[146:147], v16 offset:53248
    ds_read_b64_tr_b16 v[148:149], v17 offset:49152
    v_mfma_f32_16x16x32_bf16 v[200:203], v[184:187], v[160:163], v[200:203]
    ds_read_b64_tr_b16 v[150:151], v17 offset:53248
    ds_read_b64_tr_b16 v[152:153], v18 offset:49152
    v_mfma_f32_16x16x32_bf16 v[204:207], v[188:191], v[160:163], v[204:207]
    ds_read_b64_tr_b16 v[154:155], v18 offset:53248
    ds_read_b64_tr_b16 v[156:157], v19 offset:49152
    v_mfma_f32_16x16x32_bf16 v[220:223], v[188:191], v[164:167], v[220:223]
    ds_read_b64_tr_b16 v[158:159], v19 offset:53248
    ds_read_b128 v[132:135], v3 offset:33792
    v_mfma_f32_16x16x32_bf16 v[216:219], v[184:187], v[164:167], v[216:219]
    ds_read_b128 v[136:139], v3 offset:34816
    ds_read_b128 v[140:143], v3 offset:35840
    v_mfma_f32_16x16x32_bf16 v[212:215], v[180:183], v[164:167], v[212:215]
    v_mfma_f32_16x16x32_bf16 v[208:211], v[176:179], v[164:167], v[208:211]
    v_mfma_f32_16x16x32_bf16 v[224:227], v[176:179], v[168:171], v[224:227]
    v_mfma_f32_16x16x32_bf16 v[228:231], v[180:183], v[168:171], v[228:231]
    v_mfma_f32_16x16x32_bf16 v[232:235], v[184:187], v[168:171], v[232:235]
    v_mfma_f32_16x16x32_bf16 v[236:239], v[188:191], v[168:171], v[236:239]
    v_mfma_f32_16x16x32_bf16 v[252:255], v[188:191], v[172:175], v[252:255]
    v_mfma_f32_16x16x32_bf16 v[248:251], v[184:187], v[172:175], v[248:251]
    v_mfma_f32_16x16x32_bf16 v[244:247], v[180:183], v[172:175], v[244:247]
    v_mfma_f32_16x16x32_bf16 v[240:243], v[176:179], v[172:175], v[240:243]
    s_waitcnt lgkmcnt(0)
    v_mfma_f32_16x16x32_bf16 v[192:195], v[144:147], v[128:131], v[192:195]
    ds_read_b128 v[160:163], v3 offset:40960
    ds_read_b64_tr_b16 v[176:177], v16 offset:57344
    v_mfma_f32_16x16x32_bf16 v[196:199], v[148:151], v[128:131], v[196:199]
    ds_read_b64_tr_b16 v[178:179], v16 offset:61440
    ds_read_b64_tr_b16 v[180:181], v17 offset:57344
    v_mfma_f32_16x16x32_bf16 v[200:203], v[152:155], v[128:131], v[200:203]
    ds_read_b64_tr_b16 v[182:183], v17 offset:61440
    ds_read_b64_tr_b16 v[184:185], v18 offset:57344
    v_mfma_f32_16x16x32_bf16 v[204:207], v[156:159], v[128:131], v[204:207]
    ds_read_b64_tr_b16 v[186:187], v18 offset:61440
    ds_read_b64_tr_b16 v[188:189], v19 offset:57344
    v_mfma_f32_16x16x32_bf16 v[220:223], v[156:159], v[132:135], v[220:223]
    ds_read_b64_tr_b16 v[190:191], v19 offset:61440
    ds_read_b128 v[164:167], v3 offset:41984
    v_mfma_f32_16x16x32_bf16 v[216:219], v[152:155], v[132:135], v[216:219]
    ds_read_b128 v[168:171], v3 offset:43008
    ds_read_b128 v[172:175], v3 offset:44032
    v_mfma_f32_16x16x32_bf16 v[212:215], v[148:151], v[132:135], v[212:215]
    v_mfma_f32_16x16x32_bf16 v[208:211], v[144:147], v[132:135], v[208:211]
    v_mfma_f32_16x16x32_bf16 v[224:227], v[144:147], v[136:139], v[224:227]
    v_mfma_f32_16x16x32_bf16 v[228:231], v[148:151], v[136:139], v[228:231]
    v_mfma_f32_16x16x32_bf16 v[232:235], v[152:155], v[136:139], v[232:235]
    v_mfma_f32_16x16x32_bf16 v[236:239], v[156:159], v[136:139], v[236:239]
    v_mfma_f32_16x16x32_bf16 v[252:255], v[156:159], v[140:143], v[252:255]
    v_mfma_f32_16x16x32_bf16 v[248:251], v[152:155], v[140:143], v[248:251]
    v_mfma_f32_16x16x32_bf16 v[244:247], v[148:151], v[140:143], v[244:247]
    v_mfma_f32_16x16x32_bf16 v[240:243], v[144:147], v[140:143], v[240:243]
    s_waitcnt lgkmcnt(0)
    s_cmp_eq_u32 s46, 0
    s_cbranch_scc1 M_x0
    v_mfma_f32_16x16x32_bf16 v[192:195], v[176:179], v[160:163], v[192:195]
    v_mfma_f32_16x16x32_bf16 v[196:199], v[180:183], v[160:163], v[196:199]
    v_mfma_f32_16x16x32_bf16 v[200:203], v[184:187], v[160:163], v[200:203]
    v_mfma_f32_16x16x32_bf16 v[204:207], v[188:191], v[160:163], v[204:207]
    v_mfma_f32_16x16x32_bf16 v[220:223], v[188:191], v[164:167], v[220:223]
    v_mfma_f32_16x16x32_bf16 v[216:219], v[184:187], v[164:167], v[216:219]
    v_mfma_f32_16x16x32_bf16 v[212:215], v[180:183], v[164:167], v[212:215]
    v_mfma_f32_16x16x32_bf16 v[208:211], v[176:179], v[164:167], v[208:211]
    v_mfma_f32_16x16x32_bf16 v[224:227], v[176:179], v[168:171], v[224:227]
    v_mfma_f32_16x16x32_bf16 v[228:231], v[180:183], v[168:171], v[228:231]
    v_mfma_f32_16x16x32_bf16 v[232:235], v[184:187], v[168:171], v[232:235]
    v_mfma_f32_16x16x32_bf16 v[236:239], v[188:191], v[168:171], v[236:239]
    v_cvt_pk_bf16_f32 v192, v192, v193
    v_cvt_pk_bf16_f32 v193, v194, v195
    v_cvt_pk_bf16_f32 v194, v196, v197
    v_cvt_pk_bf16_f32 v195, v198, v199
    s_nop 1
    v_permlane16_swap_b32 v192, v194
    v_permlane16_swap_b32 v193, v195
    buffer_store_dwordx4 v[192:195], v10, s[20:23], s51 offen offset:0 sc1
    v_mfma_f32_16x16x32_bf16 v[252:255], v[188:191], v[172:175], v[252:255]
    v_cvt_pk_bf16_f32 v200, v200, v201
    v_cvt_pk_bf16_f32 v201, v202, v203
    v_cvt_pk_bf16_f32 v202, v204, v205
    v_cvt_pk_bf16_f32 v203, v206, v207
    s_nop 1
    v_permlane16_swap_b32 v200, v202
    v_permlane16_swap_b32 v201, v203
    buffer_store_dwordx4 v[200:203], v10, s[20:23], s51 offen offset:1024 sc1
    v_mfma_f32_16x16x32_bf16 v[248:251], v[184:187], v[172:175], v[248:251]
    v_cvt_pk_bf16_f32 v208, v208, v209
    v_cvt_pk_bf16_f32 v209, v210, v211
    v_cvt_pk_bf16_f32 v210, v212, v213
    v_cvt_pk_bf16_f32 v211, v214, v215
    s_nop 1
    v_permlane16_swap_b32 v208, v210
    v_permlane16_swap_b32 v209, v211
    buffer_store_dwordx4 v[208:211], v10, s[20:23], s51 offen offset:2048 sc1
    v_mfma_f32_16x16x32_bf16 v[244:247], v[180:183], v[172:175], v[244:247]
    v_cvt_pk_bf16_f32 v216, v216, v217
    v_cvt_pk_bf16_f32 v217, v218, v219
    v_cvt_pk_bf16_f32 v218, v220, v221
    v_cvt_pk_bf16_f32 v219, v222, v223
    s_nop 1
    v_permlane16_swap_b32 v216, v218
    v_permlane16_swap_b32 v217, v219
    buffer_store_dwordx4 v[216:219], v10, s[20:23], s51 offen offset:3072 sc1
    v_mfma_f32_16x16x32_bf16 v[240:243], v[176:179], v[172:175], v[240:243]
    s_waitcnt vmcnt(4)
    v_mov_b32 v26, v31
    v_mov_b32 v27, v31
    v_mov_b32 v31, v30
    s_nop 4
    v_permlane16_swap_b32 v224, v228
    v_permlane16_swap_b32 v225, v229
    v_permlane16_swap_b32 v226, v230
    v_permlane16_swap_b32 v227, v231
    v_pk_mul_f32 v[224:225], v[224:225], v[30:31]
    v_pk_mul_f32 v[226:227], v[226:227], v[30:31]
    v_pk_mul_f32 v[228:229], v[228:229], v[30:31]
    v_pk_mul_f32 v[230:231], v[230:231], v[30:31]
    v_permlane16_swap_b32 v232, v236
    v_permlane16_swap_b32 v233, v237
    v_permlane16_swap_b32 v234, v238
    v_permlane16_swap_b32 v235, v239
    v_pk_mul_f32 v[232:233], v[232:233], v[30:31]
    v_pk_mul_f32 v[234:235], v[234:235], v[30:31]
    v_pk_mul_f32 v[236:237], v[236:237], v[30:31]
    v_pk_mul_f32 v[238:239], v[238:239], v[30:31]
    v_permlane16_swap_b32 v240, v244
    v_permlane16_swap_b32 v241, v245
    v_permlane16_swap_b32 v242, v246
    v_permlane16_swap_b32 v243, v247
    v_pk_mul_f32 v[240:241], v[240:241], v[26:27]
    v_pk_mul_f32 v[242:243], v[242:243], v[26:27]
    v_pk_mul_f32 v[244:245], v[244:245], v[26:27]
    v_pk_mul_f32 v[246:247], v[246:247], v[26:27]
    v_permlane16_swap_b32 v248, v252
    v_permlane16_swap_b32 v249, v253
    v_permlane16_swap_b32 v250, v254
    v_permlane16_swap_b32 v251, v255
    v_pk_mul_f32 v[248:249], v[248:249], v[26:27]
    v_pk_mul_f32 v[250:251], v[250:251], v[26:27]
    v_pk_mul_f32 v[252:253], v[252:253], v[26:27]
    v_pk_mul_f32 v[254:255], v[254:255], v[26:27]
    s_waitcnt vmcnt(0)
    s_add_u32 s38, s37, 8192
    s_mov_b32 s90, 0
M_rt1:
    buffer_load_dwordx4 v[32:35], v10, s[20:23], s50 offen offset:0 sc1
    buffer_load_dwordx4 v[48:51], v9, s[20:23], s37 offen offset:0 sc1
    buffer_load_dwordx4 v[36:39], v10, s[20:23], s50 offen offset:1024 sc1
    buffer_load_dwordx4 v[52:55], v9, s[20:23], s37 offen offset:32 sc1
    buffer_load_dwordx4 v[40:43], v10, s[20:23], s50 offen offset:2048 sc1
    buffer_load_dwordx4 v[56:59], v9, s[20:23], s38 offen offset:0 sc1
    buffer_load_dwordx4 v[44:47], v10, s[20:23], s50 offen offset:3072 sc1
    buffer_load_dwordx4 v[60:63], v9, s[20:23], s38 offen offset:32 sc1
    s_add_u32 s90, s90, 1
    s_waitcnt vmcnt(0)
    v_max3_u32 v28, v32, v33, v34
    v_max3_u32 v29, v35, v36, v37
    v_max3_u32 v29, v29, v38, v39
    v_max3_u32 v28, v28, v40, v41
    v_max3_u32 v29, v29, v42, v43
    v_max3_u32 v28, v28, v44, v45
    v_max3_u32 v29, v29, v46, v47
    v_max3_u32 v28, v28, v48, v49
    v_max3_u32 v29, v29, v50, v51
    v_max3_u32 v28, v28, v52, v53
    v_max3_u32 v29, v29, v54, v55
    v_max3_u32 v28, v28, v56, v57
    v_max3_u32 v29, v29, v58, v59
    v_max3_u32 v28, v28, v60, v61
    v_max3_u32 v29, v29, v62, v63
    v_max_u32 v28, v28, v29
    v_cmp_eq_u32 vcc, -1, v28
    s_cmp_ge_u32 s90, 0x8000
    s_cbranch_scc1 M_rt1_ok
    s_cbranch_vccz M_rt1_ok
    s_sleep 2
    s_branch M_rt1
M_rt1_ok:

    s_mov_b32 s33, 32768
    v_lshlrev_b32 v64, 16, v32
    v_and_b32 v65, 0xffff0000, v32
    v_lshlrev_b32 v66, 16, v33
    v_and_b32 v67, 0xffff0000, v33
    v_lshlrev_b32 v68, 16, v34
    v_and_b32 v69, 0xffff0000, v34
    v_lshlrev_b32 v70, 16, v35
    v_and_b32 v71, 0xffff0000, v35
    v_pk_fma_f32 v[224:225], v[64:65], v[30:31], v[224:225]
    v_pk_fma_f32 v[226:227], v[66:67], v[30:31], v[226:227]
    v_pk_fma_f32 v[228:229], v[68:69], v[30:31], v[228:229]
    v_pk_fma_f32 v[230:231], v[70:71], v[30:31], v[230:231]
    v_lshlrev_b32 v64, 16, v48
    v_and_b32 v65, 0xffff0000, v48
    v_lshlrev_b32 v66, 16, v49
    v_and_b32 v67, 0xffff0000, v49
    v_lshlrev_b32 v68, 16, v50
    v_and_b32 v69, 0xffff0000, v50
    v_lshlrev_b32 v70, 16, v51
    v_and_b32 v71, 0xffff0000, v51
    v_pk_add_f32 v[224:225], v[224:225], v[64:65]
    v_pk_add_f32 v[226:227], v[226:227], v[66:67]
    v_pk_add_f32 v[228:229], v[228:229], v[68:69]
    v_pk_add_f32 v[230:231], v[230:231], v[70:71]
    v_cvt_pk_bf16_f32 v48, v224, v225
    v_cvt_pk_bf16_f32 v49, v226, v227
    v_cvt_pk_bf16_f32 v50, v228, v229
    v_cvt_pk_bf16_f32 v51, v230, v231
    buffer_store_dwordx4 v[48:51], v8, s[16:19], 0 offen offset:0 nt
    v_lshlrev_b32 v72, 16, v36
    v_and_b32 v73, 0xffff0000, v36
    v_lshlrev_b32 v74, 16, v37
    v_and_b32 v75, 0xffff0000, v37
    v_lshlrev_b32 v76, 16, v38
    v_and_b32 v77, 0xffff0000, v38
    v_lshlrev_b32 v78, 16, v39
    v_and_b32 v79, 0xffff0000, v39
    v_pk_fma_f32 v[232:233], v[72:73], v[30:31], v[232:233]
    v_pk_fma_f32 v[234:235], v[74:75], v[30:31], v[234:235]
    v_pk_fma_f32 v[236:237], v[76:77], v[30:31], v[236:237]
    v_pk_fma_f32 v[238:239], v[78:79], v[30:31], v[238:239]
    v_lshlrev_b32 v72, 16, v52
    v_and_b32 v73, 0xffff0000, v52
    v_lshlrev_b32 v74, 16, v53
    v_and_b32 v75, 0xffff0000, v53
    v_lshlrev_b32 v76, 16, v54
    v_and_b32 v77, 0xffff0000, v54
    v_lshlrev_b32 v78, 16, v55
    v_and_b32 v79, 0xffff0000, v55
    v_pk_add_f32 v[232:233], v[232:233], v[72:73]
    v_pk_add_f32 v[234:235], v[234:235], v[74:75]
    v_pk_add_f32 v[236:237], v[236:237], v[76:77]
    v_pk_add_f32 v[238:239], v[238:239], v[78:79]
    v_cvt_pk_bf16_f32 v52, v232, v233
    v_cvt_pk_bf16_f32 v53, v234, v235
    v_cvt_pk_bf16_f32 v54, v236, v237
    v_cvt_pk_bf16_f32 v55, v238, v239
    buffer_store_dwordx4 v[52:55], v8, s[16:19], 0 offen offset:64 nt
    v_lshlrev_b32 v64, 16, v40
    v_and_b32 v65, 0xffff0000, v40
    v_lshlrev_b32 v66, 16, v41
    v_and_b32 v67, 0xffff0000, v41
    v_lshlrev_b32 v68, 16, v42
    v_and_b32 v69, 0xffff0000, v42
    v_lshlrev_b32 v70, 16, v43
    v_and_b32 v71, 0xffff0000, v43
    v_pk_fma_f32 v[240:241], v[64:65], v[26:27], v[240:241]
    v_pk_fma_f32 v[242:243], v[66:67], v[26:27], v[242:243]
    v_pk_fma_f32 v[244:245], v[68:69], v[26:27], v[244:245]
    v_pk_fma_f32 v[246:247], v[70:71], v[26:27], v[246:247]
    v_lshlrev_b32 v64, 16, v56
    v_and_b32 v65, 0xffff0000, v56
    v_lshlrev_b32 v66, 16, v57
    v_and_b32 v67, 0xffff0000, v57
    v_lshlrev_b32 v68, 16, v58
    v_and_b32 v69, 0xffff0000, v58
    v_lshlrev_b32 v70, 16, v59
    v_and_b32 v71, 0xffff0000, v59
    v_pk_add_f32 v[240:241], v[240:241], v[64:65]
    v_pk_add_f32 v[242:243], v[242:243], v[66:67]
    v_pk_add_f32 v[244:245], v[244:245], v[68:69]
    v_pk_add_f32 v[246:247], v[246:247], v[70:71]
    v_cvt_pk_bf16_f32 v56, v240, v241
    v_cvt_pk_bf16_f32 v57, v242, v243
    v_cvt_pk_bf16_f32 v58, v244, v245
    v_cvt_pk_bf16_f32 v59, v246, v247
    buffer_store_dwordx4 v[56:59], v8, s[16:19], s33 offen offset:0 nt
    v_lshlrev_b32 v72, 16, v44
    v_and_b32 v73, 0xffff0000, v44
    v_lshlrev_b32 v74, 16, v45
    v_and_b32 v75, 0xffff0000, v45
    v_lshlrev_b32 v76, 16, v46
    v_and_b32 v77, 0xffff0000, v46
    v_lshlrev_b32 v78, 16, v47
    v_and_b32 v79, 0xffff0000, v47
    v_pk_fma_f32 v[248:249], v[72:73], v[26:27], v[248:249]
    v_pk_fma_f32 v[250:251], v[74:75], v[26:27], v[250:251]
    v_pk_fma_f32 v[252:253], v[76:77], v[26:27], v[252:253]
    v_pk_fma_f32 v[254:255], v[78:79], v[26:27], v[254:255]
    v_lshlrev_b32 v72, 16, v60
    v_and_b32 v73, 0xffff0000, v60
    v_lshlrev_b32 v74, 16, v61
    v_and_b32 v75, 0xffff0000, v61
    v_lshlrev_b32 v76, 16, v62
    v_and_b32 v77, 0xffff0000, v62
    v_lshlrev_b32 v78, 16, v63
    v_and_b32 v79, 0xffff0000, v63
    v_pk_add_f32 v[248:249], v[248:249], v[72:73]
    v_pk_add_f32 v[250:251], v[250:251], v[74:75]
    v_pk_add_f32 v[252:253], v[252:253], v[76:77]
    v_pk_add_f32 v[254:255], v[254:255], v[78:79]
    v_cvt_pk_bf16_f32 v60, v248, v249
    v_cvt_pk_bf16_f32 v61, v250, v251
    v_cvt_pk_bf16_f32 v62, v252, v253
    v_cvt_pk_bf16_f32 v63, v254, v255
    buffer_store_dwordx4 v[60:63], v8, s[16:19], s33 offen offset:64 nt
    s_endpgm
M_x0:
    v_mfma_f32_16x16x32_bf16 v[224:227], v[176:179], v[168:171], v[224:227]
    v_mfma_f32_16x16x32_bf16 v[228:231], v[180:183], v[168:171], v[228:231]
    v_mfma_f32_16x16x32_bf16 v[232:235], v[184:187], v[168:171], v[232:235]
    v_mfma_f32_16x16x32_bf16 v[236:239], v[188:191], v[168:171], v[236:239]
    v_mfma_f32_16x16x32_bf16 v[252:255], v[188:191], v[172:175], v[252:255]
    v_mfma_f32_16x16x32_bf16 v[248:251], v[184:187], v[172:175], v[248:251]
    v_mfma_f32_16x16x32_bf16 v[244:247], v[180:183], v[172:175], v[244:247]
    v_mfma_f32_16x16x32_bf16 v[240:243], v[176:179], v[172:175], v[240:243]
    v_mfma_f32_16x16x32_bf16 v[192:195], v[176:179], v[160:163], v[192:195]
    v_mfma_f32_16x16x32_bf16 v[196:199], v[180:183], v[160:163], v[196:199]
    v_mfma_f32_16x16x32_bf16 v[200:203], v[184:187], v[160:163], v[200:203]
    v_mfma_f32_16x16x32_bf16 v[204:207], v[188:191], v[160:163], v[204:207]
    v_cvt_pk_bf16_f32 v224, v224, v225
    v_cvt_pk_bf16_f32 v225, v226, v227
    v_cvt_pk_bf16_f32 v226, v228, v229
    v_cvt_pk_bf16_f32 v227, v230, v231
    s_nop 1
    v_permlane16_swap_b32 v224, v226
    v_permlane16_swap_b32 v225, v227
    buffer_store_dwordx4 v[224:227], v10, s[20:23], s51 offen offset:0 sc1
    v_mfma_f32_16x16x32_bf16 v[220:223], v[188:191], v[164:167], v[220:223]
    v_cvt_pk_bf16_f32 v232, v232, v233
    v_cvt_pk_bf16_f32 v233, v234, v235
    v_cvt_pk_bf16_f32 v234, v236, v237
    v_cvt_pk_bf16_f32 v235, v238, v239
    s_nop 1
    v_permlane16_swap_b32 v232, v234
    v_permlane16_swap_b32 v233, v235
    buffer_store_dwordx4 v[232:235], v10, s[20:23], s51 offen offset:1024 sc1
    v_mfma_f32_16x16x32_bf16 v[216:219], v[184:187], v[164:167], v[216:219]
    v_cvt_pk_bf16_f32 v240, v240, v241
    v_cvt_pk_bf16_f32 v241, v242, v243
    v_cvt_pk_bf16_f32 v242, v244, v245
    v_cvt_pk_bf16_f32 v243, v246, v247
    s_nop 1
    v_permlane16_swap_b32 v240, v242
    v_permlane16_swap_b32 v241, v243
    buffer_store_dwordx4 v[240:243], v10, s[20:23], s51 offen offset:2048 sc1
    v_mfma_f32_16x16x32_bf16 v[212:215], v[180:183], v[164:167], v[212:215]
    v_cvt_pk_bf16_f32 v248, v248, v249
    v_cvt_pk_bf16_f32 v249, v250, v251
    v_cvt_pk_bf16_f32 v250, v252, v253
    v_cvt_pk_bf16_f32 v251, v254, v255
    s_nop 1
    v_permlane16_swap_b32 v248, v250
    v_permlane16_swap_b32 v249, v251
    buffer_store_dwordx4 v[248:251], v10, s[20:23], s51 offen offset:3072 sc1
    v_mfma_f32_16x16x32_bf16 v[208:211], v[176:179], v[164:167], v[208:211]
    s_waitcnt vmcnt(4)
    v_mov_b32 v26, v31
    v_mov_b32 v27, v31
    v_mov_b32 v31, v30
    s_nop 4
    v_permlane16_swap_b32 v192, v196
    v_permlane16_swap_b32 v193, v197
    v_permlane16_swap_b32 v194, v198
    v_permlane16_swap_b32 v195, v199
    v_pk_mul_f32 v[192:193], v[192:193], v[30:31]
    v_pk_mul_f32 v[194:195], v[194:195], v[30:31]
    v_pk_mul_f32 v[196:197], v[196:197], v[30:31]
    v_pk_mul_f32 v[198:199], v[198:199], v[30:31]
    v_permlane16_swap_b32 v200, v204
    v_permlane16_swap_b32 v201, v205
    v_permlane16_swap_b32 v202, v206
    v_permlane16_swap_b32 v203, v207
    v_pk_mul_f32 v[200:201], v[200:201], v[30:31]
    v_pk_mul_f32 v[202:203], v[202:203], v[30:31]
    v_pk_mul_f32 v[204:205], v[204:205], v[30:31]
    v_pk_mul_f32 v[206:207], v[206:207], v[30:31]
    v_permlane16_swap_b32 v208, v212
    v_permlane16_swap_b32 v209, v213
    v_permlane16_swap_b32 v210, v214
    v_permlane16_swap_b32 v211, v215
    v_pk_mul_f32 v[208:209], v[208:209], v[26:27]
    v_pk_mul_f32 v[210:211], v[210:211], v[26:27]
    v_pk_mul_f32 v[212:213], v[212:213], v[26:27]
    v_pk_mul_f32 v[214:215], v[214:215], v[26:27]
    v_permlane16_swap_b32 v216, v220
    v_permlane16_swap_b32 v217, v221
    v_permlane16_swap_b32 v218, v222
    v_permlane16_swap_b32 v219, v223
    v_pk_mul_f32 v[216:217], v[216:217], v[26:27]
    v_pk_mul_f32 v[218:219], v[218:219], v[26:27]
    v_pk_mul_f32 v[220:221], v[220:221], v[26:27]
    v_pk_mul_f32 v[222:223], v[222:223], v[26:27]
    s_waitcnt vmcnt(0)
    s_add_u32 s38, s37, 8192
    s_mov_b32 s90, 0
M_rt0:
    buffer_load_dwordx4 v[32:35], v10, s[20:23], s50 offen offset:0 sc1
    buffer_load_dwordx4 v[48:51], v9, s[20:23], s37 offen offset:0 sc1
    buffer_load_dwordx4 v[36:39], v10, s[20:23], s50 offen offset:1024 sc1
    buffer_load_dwordx4 v[52:55], v9, s[20:23], s37 offen offset:32 sc1
    buffer_load_dwordx4 v[40:43], v10, s[20:23], s50 offen offset:2048 sc1
    buffer_load_dwordx4 v[56:59], v9, s[20:23], s38 offen offset:0 sc1
    buffer_load_dwordx4 v[44:47], v10, s[20:23], s50 offen offset:3072 sc1
    buffer_load_dwordx4 v[60:63], v9, s[20:23], s38 offen offset:32 sc1
    s_add_u32 s90, s90, 1
    s_waitcnt vmcnt(0)
    v_max3_u32 v28, v32, v33, v34
    v_max3_u32 v29, v35, v36, v37
    v_max3_u32 v29, v29, v38, v39
    v_max3_u32 v28, v28, v40, v41
    v_max3_u32 v29, v29, v42, v43
    v_max3_u32 v28, v28, v44, v45
    v_max3_u32 v29, v29, v46, v47
    v_max3_u32 v28, v28, v48, v49
    v_max3_u32 v29, v29, v50, v51
    v_max3_u32 v28, v28, v52, v53
    v_max3_u32 v29, v29, v54, v55
    v_max3_u32 v28, v28, v56, v57
    v_max3_u32 v29, v29, v58, v59
    v_max3_u32 v28, v28, v60, v61
    v_max3_u32 v29, v29, v62, v63
    v_max_u32 v28, v28, v29
    v_cmp_eq_u32 vcc, -1, v28
    s_cmp_ge_u32 s90, 0x8000
    s_cbranch_scc1 M_rt0_ok
    s_cbranch_vccz M_rt0_ok
    s_sleep 2
    s_branch M_rt0
M_rt0_ok:

    s_mov_b32 s33, 32768
    v_lshlrev_b32 v64, 16, v32
    v_and_b32 v65, 0xffff0000, v32
    v_lshlrev_b32 v66, 16, v33
    v_and_b32 v67, 0xffff0000, v33
    v_lshlrev_b32 v68, 16, v34
    v_and_b32 v69, 0xffff0000, v34
    v_lshlrev_b32 v70, 16, v35
    v_and_b32 v71, 0xffff0000, v35
    v_pk_fma_f32 v[192:193], v[64:65], v[30:31], v[192:193]
    v_pk_fma_f32 v[194:195], v[66:67], v[30:31], v[194:195]
    v_pk_fma_f32 v[196:197], v[68:69], v[30:31], v[196:197]
    v_pk_fma_f32 v[198:199], v[70:71], v[30:31], v[198:199]
    v_lshlrev_b32 v64, 16, v48
    v_and_b32 v65, 0xffff0000, v48
    v_lshlrev_b32 v66, 16, v49
    v_and_b32 v67, 0xffff0000, v49
    v_lshlrev_b32 v68, 16, v50
    v_and_b32 v69, 0xffff0000, v50
    v_lshlrev_b32 v70, 16, v51
    v_and_b32 v71, 0xffff0000, v51
    v_pk_add_f32 v[192:193], v[192:193], v[64:65]
    v_pk_add_f32 v[194:195], v[194:195], v[66:67]
    v_pk_add_f32 v[196:197], v[196:197], v[68:69]
    v_pk_add_f32 v[198:199], v[198:199], v[70:71]
    v_cvt_pk_bf16_f32 v48, v192, v193
    v_cvt_pk_bf16_f32 v49, v194, v195
    v_cvt_pk_bf16_f32 v50, v196, v197
    v_cvt_pk_bf16_f32 v51, v198, v199
    buffer_store_dwordx4 v[48:51], v8, s[16:19], 0 offen offset:0 nt
    v_lshlrev_b32 v72, 16, v36
    v_and_b32 v73, 0xffff0000, v36
    v_lshlrev_b32 v74, 16, v37
    v_and_b32 v75, 0xffff0000, v37
    v_lshlrev_b32 v76, 16, v38
    v_and_b32 v77, 0xffff0000, v38
    v_lshlrev_b32 v78, 16, v39
    v_and_b32 v79, 0xffff0000, v39
    v_pk_fma_f32 v[200:201], v[72:73], v[30:31], v[200:201]
    v_pk_fma_f32 v[202:203], v[74:75], v[30:31], v[202:203]
    v_pk_fma_f32 v[204:205], v[76:77], v[30:31], v[204:205]
    v_pk_fma_f32 v[206:207], v[78:79], v[30:31], v[206:207]
    v_lshlrev_b32 v72, 16, v52
    v_and_b32 v73, 0xffff0000, v52
    v_lshlrev_b32 v74, 16, v53
    v_and_b32 v75, 0xffff0000, v53
    v_lshlrev_b32 v76, 16, v54
    v_and_b32 v77, 0xffff0000, v54
    v_lshlrev_b32 v78, 16, v55
    v_and_b32 v79, 0xffff0000, v55
    v_pk_add_f32 v[200:201], v[200:201], v[72:73]
    v_pk_add_f32 v[202:203], v[202:203], v[74:75]
    v_pk_add_f32 v[204:205], v[204:205], v[76:77]
    v_pk_add_f32 v[206:207], v[206:207], v[78:79]
    v_cvt_pk_bf16_f32 v52, v200, v201
    v_cvt_pk_bf16_f32 v53, v202, v203
    v_cvt_pk_bf16_f32 v54, v204, v205
    v_cvt_pk_bf16_f32 v55, v206, v207
    buffer_store_dwordx4 v[52:55], v8, s[16:19], 0 offen offset:64 nt
    v_lshlrev_b32 v64, 16, v40
    v_and_b32 v65, 0xffff0000, v40
    v_lshlrev_b32 v66, 16, v41
    v_and_b32 v67, 0xffff0000, v41
    v_lshlrev_b32 v68, 16, v42
    v_and_b32 v69, 0xffff0000, v42
    v_lshlrev_b32 v70, 16, v43
    v_and_b32 v71, 0xffff0000, v43
    v_pk_fma_f32 v[208:209], v[64:65], v[26:27], v[208:209]
    v_pk_fma_f32 v[210:211], v[66:67], v[26:27], v[210:211]
    v_pk_fma_f32 v[212:213], v[68:69], v[26:27], v[212:213]
    v_pk_fma_f32 v[214:215], v[70:71], v[26:27], v[214:215]
    v_lshlrev_b32 v64, 16, v56
    v_and_b32 v65, 0xffff0000, v56
    v_lshlrev_b32 v66, 16, v57
    v_and_b32 v67, 0xffff0000, v57
    v_lshlrev_b32 v68, 16, v58
    v_and_b32 v69, 0xffff0000, v58
    v_lshlrev_b32 v70, 16, v59
    v_and_b32 v71, 0xffff0000, v59
    v_pk_add_f32 v[208:209], v[208:209], v[64:65]
    v_pk_add_f32 v[210:211], v[210:211], v[66:67]
    v_pk_add_f32 v[212:213], v[212:213], v[68:69]
    v_pk_add_f32 v[214:215], v[214:215], v[70:71]
    v_cvt_pk_bf16_f32 v56, v208, v209
    v_cvt_pk_bf16_f32 v57, v210, v211
    v_cvt_pk_bf16_f32 v58, v212, v213
    v_cvt_pk_bf16_f32 v59, v214, v215
    buffer_store_dwordx4 v[56:59], v8, s[16:19], s33 offen offset:0 nt
    v_lshlrev_b32 v72, 16, v44
    v_and_b32 v73, 0xffff0000, v44
    v_lshlrev_b32 v74, 16, v45
    v_and_b32 v75, 0xffff0000, v45
    v_lshlrev_b32 v76, 16, v46
    v_and_b32 v77, 0xffff0000, v46
    v_lshlrev_b32 v78, 16, v47
    v_and_b32 v79, 0xffff0000, v47
    v_pk_fma_f32 v[216:217], v[72:73], v[26:27], v[216:217]
    v_pk_fma_f32 v[218:219], v[74:75], v[26:27], v[218:219]
    v_pk_fma_f32 v[220:221], v[76:77], v[26:27], v[220:221]
    v_pk_fma_f32 v[222:223], v[78:79], v[26:27], v[222:223]
    v_lshlrev_b32 v72, 16, v60
    v_and_b32 v73, 0xffff0000, v60
    v_lshlrev_b32 v74, 16, v61
    v_and_b32 v75, 0xffff0000, v61
    v_lshlrev_b32 v76, 16, v62
    v_and_b32 v77, 0xffff0000, v62
    v_lshlrev_b32 v78, 16, v63
    v_and_b32 v79, 0xffff0000, v63
    v_pk_add_f32 v[216:217], v[216:217], v[72:73]
    v_pk_add_f32 v[218:219], v[218:219], v[74:75]
    v_pk_add_f32 v[220:221], v[220:221], v[76:77]
    v_pk_add_f32 v[222:223], v[222:223], v[78:79]
    v_cvt_pk_bf16_f32 v60, v216, v217
    v_cvt_pk_bf16_f32 v61, v218, v219
    v_cvt_pk_bf16_f32 v62, v220, v221
    v_cvt_pk_bf16_f32 v63, v222, v223
    buffer_store_dwordx4 v[60:63], v8, s[16:19], s33 offen offset:64 nt
    s_endpgm
P2_packed:
    s_cmp_ge_u32 s3, 4
    s_cbranch_scc1 P2_pk_other
    s_add_u32 s58, s84, 8192
    buffer_load_dwordx4 v[128:131], v10, s[20:23], s58 offen
    buffer_load_dwordx4 v[132:135], v10, s[20:23], s58 offen offset:1024
    v_and_b32 v6, 15, v11
    v_lshl_add_u32 v6, v5, 8, v6
    s_lshl_b32 s58, s86, 4
    v_add_u32 v6, s58, v6
    v_lshlrev_b32 v7, 2, v6
    v_add_u32 v7, 131072, v7
    v_sub_u32 v6, 832, v6
    v_lshlrev_b32 v6, 2, v6
    v_add_u32 v6, 131072, v6

    ds_write_b32 v7, v160 offset:0
    ds_write_b32 v7, v164 offset:8192
    ds_write_b32 v7, v161 offset:256
    ds_write_b32 v7, v165 offset:8448
    ds_write_b32 v7, v162 offset:512
    ds_write_b32 v7, v166 offset:8704
    ds_write_b32 v7, v163 offset:768
    ds_write_b32 v7, v167 offset:8960
    ds_write_b32 v7, v168 offset:4096
    ds_write_b32 v7, v172 offset:12288
    ds_write_b32 v7, v169 offset:4352
    ds_write_b32 v7, v173 offset:12544
    ds_write_b32 v7, v170 offset:4608
    ds_write_b32 v7, v174 offset:12800
    ds_write_b32 v7, v171 offset:4864
    ds_write_b32 v7, v175 offset:13056
    s_waitcnt lgkmcnt(0)
    s_barrier

    ds_read_b32 v136, v6 offset:4864
    ds_read_b32 v144, v6 offset:13056
    ds_read_b32 v137, v6 offset:4608
    ds_read_b32 v145, v6 offset:12800
    ds_read_b32 v138, v6 offset:4352
    ds_read_b32 v146, v6 offset:12544
    ds_read_b32 v139, v6 offset:4096
    ds_read_b32 v147, v6 offset:12288
    ds_read_b32 v140, v6 offset:768
    ds_read_b32 v148, v6 offset:8960
    ds_read_b32 v141, v6 offset:512
    ds_read_b32 v149, v6 offset:8704
    ds_read_b32 v142, v6 offset:256
    ds_read_b32 v150, v6 offset:8448
    ds_read_b32 v143, v6 offset:0
    ds_read_b32 v151, v6 offset:8192
    s_waitcnt vmcnt(0) lgkmcnt(0)
    s_cmp_lg_u32 s3, 0
    s_cbranch_scc1 P2_pk_n0
    s_mov_b64 exec, 1
    v_mov_b32 v136, v160
    v_mov_b32 v144, v164
    s_mov_b64 exec, -1
P2_pk_n0:

    v_lshlrev_b32 v244, 16, v12
    v_lshlrev_b32 v245, 16, v13
    v_and_b32 v246, 0xffff0000, v12
    v_and_b32 v247, 0xffff0000, v13
    v_lshlrev_b32 v248, 16, v128
    v_lshlrev_b32 v249, 16, v129
    v_and_b32 v250, 0xffff0000, v128
    v_and_b32 v251, 0xffff0000, v129
    v_pk_mul_f32 v[240:241], v[160:161], v[244:245]
    v_pk_mul_f32 v[160:161], v[160:161], v[246:247]
    v_pk_fma_f32 v[240:241], v[164:165], v[246:247], v[240:241] neg_lo:[1,0,0] neg_hi:[1,0,0]
    v_pk_fma_f32 v[160:161], v[164:165], v[244:245], v[160:161]
    v_pk_fma_f32 v[240:241], v[136:137], v[248:249], v[240:241]
    v_pk_fma_f32 v[160:161], v[136:137], v[250:251], v[160:161]
    v_pk_fma_f32 v[240:241], v[144:145], v[250:251], v[240:241]
    v_pk_fma_f32 v[160:161], v[144:145], v[248:249], v[160:161] neg_lo:[1,0,0] neg_hi:[1,0,0]
    v_cvt_pk_bf16_f32 v176, v240, v241
    v_cvt_pk_bf16_f32 v180, v160, v161

    v_lshlrev_b32 v244, 16, v14
    v_lshlrev_b32 v245, 16, v15
    v_and_b32 v246, 0xffff0000, v14
    v_and_b32 v247, 0xffff0000, v15
    v_lshlrev_b32 v248, 16, v130
    v_lshlrev_b32 v249, 16, v131
    v_and_b32 v250, 0xffff0000, v130
    v_and_b32 v251, 0xffff0000, v131
    v_pk_mul_f32 v[240:241], v[162:163], v[244:245]
    v_pk_mul_f32 v[162:163], v[162:163], v[246:247]
    v_pk_fma_f32 v[240:241], v[166:167], v[246:247], v[240:241] neg_lo:[1,0,0] neg_hi:[1,0,0]
    v_pk_fma_f32 v[162:163], v[166:167], v[244:245], v[162:163]
    v_pk_fma_f32 v[240:241], v[138:139], v[248:249], v[240:241]
    v_pk_fma_f32 v[162:163], v[138:139], v[250:251], v[162:163]
    v_pk_fma_f32 v[240:241], v[146:147], v[250:251], v[240:241]
    v_pk_fma_f32 v[162:163], v[146:147], v[248:249], v[162:163] neg_lo:[1,0,0] neg_hi:[1,0,0]
    v_cvt_pk_bf16_f32 v177, v240, v241
    v_cvt_pk_bf16_f32 v181, v162, v163

    v_lshlrev_b32 v244, 16, v16
    v_lshlrev_b32 v245, 16, v17
    v_and_b32 v246, 0xffff0000, v16
    v_and_b32 v247, 0xffff0000, v17
    v_lshlrev_b32 v248, 16, v132
    v_lshlrev_b32 v249, 16, v133
    v_and_b32 v250, 0xffff0000, v132
    v_and_b32 v251, 0xffff0000, v133
    v_pk_mul_f32 v[240:241], v[168:169], v[244:245]
    v_pk_mul_f32 v[168:169], v[168:169], v[246:247]
    v_pk_fma_f32 v[240:241], v[172:173], v[246:247], v[240:241] neg_lo:[1,0,0] neg_hi:[1,0,0]
    v_pk_fma_f32 v[168:169], v[172:173], v[244:245], v[168:169]
    v_pk_fma_f32 v[240:241], v[140:141], v[248:249], v[240:241]
    v_pk_fma_f32 v[168:169], v[140:141], v[250:251], v[168:169]
    v_pk_fma_f32 v[240:241], v[148:149], v[250:251], v[240:241]
    v_pk_fma_f32 v[168:169], v[148:149], v[248:249], v[168:169] neg_lo:[1,0,0] neg_hi:[1,0,0]
    v_cvt_pk_bf16_f32 v178, v240, v241
    v_cvt_pk_bf16_f32 v182, v168, v169

    v_lshlrev_b32 v244, 16, v18
    v_lshlrev_b32 v245, 16, v19
    v_and_b32 v246, 0xffff0000, v18
    v_and_b32 v247, 0xffff0000, v19
    v_lshlrev_b32 v248, 16, v134
    v_lshlrev_b32 v249, 16, v135
    v_and_b32 v250, 0xffff0000, v134
    v_and_b32 v251, 0xffff0000, v135
    v_pk_mul_f32 v[240:241], v[170:171], v[244:245]
    v_pk_mul_f32 v[170:171], v[170:171], v[246:247]
    v_pk_fma_f32 v[240:241], v[174:175], v[246:247], v[240:241] neg_lo:[1,0,0] neg_hi:[1,0,0]
    v_pk_fma_f32 v[170:171], v[174:175], v[244:245], v[170:171]
    v_pk_fma_f32 v[240:241], v[142:143], v[248:249], v[240:241]
    v_pk_fma_f32 v[170:171], v[142:143], v[250:251], v[170:171]
    v_pk_fma_f32 v[240:241], v[150:151], v[250:251], v[240:241]
    v_pk_fma_f32 v[170:171], v[150:151], v[248:249], v[170:171] neg_lo:[1,0,0] neg_hi:[1,0,0]
    v_cvt_pk_bf16_f32 v179, v240, v241
    v_cvt_pk_bf16_f32 v183, v170, v171

    s_branch P2_wdone
P2_pk_other:
    s_barrier
    s_branch P2_wmul

M_fft:
    s_mov_b64 exec, 3
    buffer_store_dword v20, v21, s[20:23], 0 offen sc1
    s_mov_b64 exec, -1
    v_readlane_b32 s90, v21, 1

    v_mov_b32 v12, -1
    v_mov_b32 v13, -1
    v_mov_b32 v14, -1
    v_mov_b32 v15, -1
    s_lshl_b32 s40, s44, 3
    s_add_u32 s40, s40, s45
    s_lshl_b32 s40, s40, 1
    s_add_u32 s40, s40, s46
    s_lshl_b32 s40, s40, 14
    s_lshl_b32 s41, s3, 11
    s_add_u32 s40, s40, s41
    s_add_u32 s40, s40, 37748736
    s_lshl_b32 s43, s2, 14
    s_add_u32 s41, s41, s43
    s_add_u32 s41, s41, 41943040
    buffer_store_dwordx4 v[12:15], v10, s[20:23], s40 offen offset:0 sc1
    buffer_store_dwordx4 v[12:15], v10, s[20:23], s40 offen offset:1024 sc1
    buffer_store_dwordx4 v[12:15], v10, s[20:23], s41 offen offset:0 sc1
    buffer_store_dwordx4 v[12:15], v10, s[20:23], s41 offen offset:1024 sc1

    s_mov_b32 s76, s36
    s_mov_b32 s77, s37
    s_mov_b32 s78, 2101248
    s_mov_b32 s79, 0x20000

    s_mov_b32 s80, s38
    s_mov_b32 s81, s39
    s_mov_b32 s82, 2101248
    s_mov_b32 s83, 0x20000

    s_lshl_b32 s25, s28, 2
    s_add_u32 s25, s25, s29
    s_sub_u32 s25, s25, 28
    s_lshr_b32 s30, s25, 4
    s_bfe_u32 s31, s25, 0x20002
    s_lshl_b32 s40, s30, 5
    s_lshl_b32 s41, s31, 2
    s_add_u32 s40, s40, s41
    s_lshl_b32 s40, s40, 5
    s_and_b32 s41, s25, 3
    s_lshl_b32 s41, s41, 3
    s_add_u32 s40, s40, s41
    s_add_u32 s40, s40, s3
    s_lshl_b32 s40, s40, 11
    s_lshl_b32 s41, s3, 14

    s_add_u32 m0, s41, 0
    s_add_u32 s56, s40, 0
    buffer_load_dwordx4 v10, s[8:11], s56 offen offset:0 lds
    s_add_u32 m0, s41, 0
    s_add_u32 s56, s40, 0
    buffer_load_dwordx4 v10, s[8:11], s56 offen offset:1024 lds
    s_add_u32 m0, s41, 2048
    s_add_u32 s56, s40, 65536
    buffer_load_dwordx4 v10, s[8:11], s56 offen offset:0 lds
    s_add_u32 m0, s41, 2048
    s_add_u32 s56, s40, 65536
    buffer_load_dwordx4 v10, s[8:11], s56 offen offset:1024 lds
    v_lshrrev_b32 v5, 5, v11
    v_lshlrev_b32 v5, 2, v5
    v_and_b32 v9, 31, v11
    v_add_u32 v6, 0, v5
    v_mul_u32_u24 v6, v6, v9
    v_cvt_f32_u32 v6, v6
    v_mul_f32 v6, 0x3d000000, v6
    v_cos_f32 v188, v6
    v_sin_f32 v190, -v6
    v_add_u32 v6, 1, v5
    v_mul_u32_u24 v6, v6, v9
    v_cvt_f32_u32 v6, v6
    v_mul_f32 v6, 0x3d000000, v6
    v_cos_f32 v189, v6
    v_sin_f32 v191, -v6
    s_nop 0
    v_cvt_pk_bf16_f32 v12, v188, v189
    v_cvt_pk_bf16_f32 v20, v190, v191
    v_add_u32 v6, 2, v5
    v_mul_u32_u24 v6, v6, v9
    v_cvt_f32_u32 v6, v6
    v_mul_f32 v6, 0x3d000000, v6
    v_cos_f32 v188, v6
    v_sin_f32 v190, -v6
    v_add_u32 v6, 3, v5
    v_mul_u32_u24 v6, v6, v9
    s_add_u32 m0, s41, 4096
    s_add_u32 s56, s40, 131072
    buffer_load_dwordx4 v10, s[8:11], s56 offen offset:0 lds
    v_cvt_f32_u32 v6, v6
    v_mul_f32 v6, 0x3d000000, v6
    v_cos_f32 v189, v6
    v_sin_f32 v191, -v6
    s_nop 0
    v_cvt_pk_bf16_f32 v13, v188, v189
    v_cvt_pk_bf16_f32 v21, v190, v191
    v_add_u32 v6, 8, v5
    v_mul_u32_u24 v6, v6, v9
    v_cvt_f32_u32 v6, v6
    v_mul_f32 v6, 0x3d000000, v6
    v_cos_f32 v188, v6
    v_sin_f32 v190, -v6
    v_add_u32 v6, 9, v5
    v_mul_u32_u24 v6, v6, v9
    v_cvt_f32_u32 v6, v6
    v_mul_f32 v6, 0x3d000000, v6
    v_cos_f32 v189, v6
    v_sin_f32 v191, -v6
    s_nop 0
    v_cvt_pk_bf16_f32 v14, v188, v189
    v_cvt_pk_bf16_f32 v22, v190, v191
    v_add_u32 v6, 10, v5
    v_mul_u32_u24 v6, v6, v9
    v_cvt_f32_u32 v6, v6
    v_mul_f32 v6, 0x3d000000, v6
    s_add_u32 m0, s41, 4096
    s_add_u32 s56, s40, 131072
    buffer_load_dwordx4 v10, s[8:11], s56 offen offset:1024 lds
    v_cos_f32 v188, v6
    v_sin_f32 v190, -v6
    v_add_u32 v6, 11, v5
    v_mul_u32_u24 v6, v6, v9
    v_cvt_f32_u32 v6, v6
    v_mul_f32 v6, 0x3d000000, v6
    v_cos_f32 v189, v6
    v_sin_f32 v191, -v6
    s_nop 0
    v_cvt_pk_bf16_f32 v15, v188, v189
    v_cvt_pk_bf16_f32 v23, v190, v191
    v_add_u32 v6, 16, v5
    v_mul_u32_u24 v6, v6, v9
    v_cvt_f32_u32 v6, v6
    v_mul_f32 v6, 0x3d000000, v6
    v_cos_f32 v188, v6
    v_sin_f32 v190, -v6
    v_add_u32 v6, 17, v5
    v_mul_u32_u24 v6, v6, v9
    v_cvt_f32_u32 v6, v6
    v_mul_f32 v6, 0x3d000000, v6
    v_cos_f32 v189, v6
    v_sin_f32 v191, -v6
    s_nop 0
    v_cvt_pk_bf16_f32 v16, v188, v189
    v_cvt_pk_bf16_f32 v24, v190, v191
    s_add_u32 m0, s41, 6144
    s_add_u32 s56, s40, 196608
    buffer_load_dwordx4 v10, s[8:11], s56 offen offset:0 lds
    v_add_u32 v6, 18, v5
    v_mul_u32_u24 v6, v6, v9
    v_cvt_f32_u32 v6, v6
    v_mul_f32 v6, 0x3d000000, v6
    v_cos_f32 v188, v6
    v_sin_f32 v190, -v6
    v_add_u32 v6, 19, v5
    v_mul_u32_u24 v6, v6, v9
    v_cvt_f32_u32 v6, v6
    v_mul_f32 v6, 0x3d000000, v6
    v_cos_f32 v189, v6
    v_sin_f32 v191, -v6
    s_nop 0
    v_cvt_pk_bf16_f32 v17, v188, v189
    v_cvt_pk_bf16_f32 v25, v190, v191
    v_add_u32 v6, 24, v5
    v_mul_u32_u24 v6, v6, v9
    v_cvt_f32_u32 v6, v6
    v_mul_f32 v6, 0x3d000000, v6
    v_cos_f32 v188, v6
    v_sin_f32 v190, -v6
    v_add_u32 v6, 25, v5
    v_mul_u32_u24 v6, v6, v9
    v_cvt_f32_u32 v6, v6
    v_mul_f32 v6, 0x3d000000, v6
    v_cos_f32 v189, v6
    s_add_u32 m0, s41, 6144
    s_add_u32 s56, s40, 196608
    buffer_load_dwordx4 v10, s[8:11], s56 offen offset:1024 lds
    v_sin_f32 v191, -v6
    s_nop 0
    v_cvt_pk_bf16_f32 v18, v188, v189
    v_cvt_pk_bf16_f32 v26, v190, v191
    v_add_u32 v6, 26, v5
    v_mul_u32_u24 v6, v6, v9
    v_cvt_f32_u32 v6, v6
    v_mul_f32 v6, 0x3d000000, v6
    v_cos_f32 v188, v6
    v_sin_f32 v190, -v6
    v_add_u32 v6, 27, v5
    v_mul_u32_u24 v6, v6, v9
    v_cvt_f32_u32 v6, v6
    v_mul_f32 v6, 0x3d000000, v6
    v_cos_f32 v189, v6
    v_sin_f32 v191, -v6
    s_nop 0
    v_cvt_pk_bf16_f32 v19, v188, v189
    v_cvt_pk_bf16_f32 v27, v190, v191
    v_add_u32 v6, 0, v5
    v_mul_u32_u24 v6, v6, v9
    v_cvt_f32_u32 v6, v6
    v_mul_f32 v6, 0x3a800000, v6
    v_cos_f32 v44, v6
    v_sin_f32 v60, -v6
    v_add_u32 v6, 1, v5
    s_add_u32 m0, s41, 8192
    s_add_u32 s56, s40, 1048576
    buffer_load_dwordx4 v10, s[8:11], s56 offen offset:0 lds
    v_mul_u32_u24 v6, v6, v9
    v_cvt_f32_u32 v6, v6
    v_mul_f32 v6, 0x3a800000, v6
    v_cos_f32 v45, v6
    v_sin_f32 v61, -v6
    v_add_u32 v6, 2, v5
    v_mul_u32_u24 v6, v6, v9
    v_cvt_f32_u32 v6, v6
    v_mul_f32 v6, 0x3a800000, v6
    v_cos_f32 v46, v6
    v_sin_f32 v62, -v6
    v_add_u32 v6, 3, v5
    v_mul_u32_u24 v6, v6, v9
    v_cvt_f32_u32 v6, v6
    v_mul_f32 v6, 0x3a800000, v6
    v_cos_f32 v47, v6
    v_sin_f32 v63, -v6
    v_add_u32 v6, 8, v5
    v_mul_u32_u24 v6, v6, v9
    v_cvt_f32_u32 v6, v6
    v_mul_f32 v6, 0x3a800000, v6
    v_cos_f32 v48, v6
    v_sin_f32 v64, -v6
    v_add_u32 v6, 9, v5
    v_mul_u32_u24 v6, v6, v9
    v_cvt_f32_u32 v6, v6
    s_add_u32 m0, s41, 8192
    s_add_u32 s56, s40, 1048576
    buffer_load_dwordx4 v10, s[8:11], s56 offen offset:1024 lds
    v_mul_f32 v6, 0x3a800000, v6
    v_cos_f32 v49, v6
    v_sin_f32 v65, -v6
    v_add_u32 v6, 10, v5
    v_mul_u32_u24 v6, v6, v9
    v_cvt_f32_u32 v6, v6
    v_mul_f32 v6, 0x3a800000, v6
    v_cos_f32 v50, v6
    v_sin_f32 v66, -v6
    v_add_u32 v6, 11, v5
    v_mul_u32_u24 v6, v6, v9
    v_cvt_f32_u32 v6, v6
    v_mul_f32 v6, 0x3a800000, v6
    v_cos_f32 v51, v6
    v_sin_f32 v67, -v6
    v_add_u32 v6, 16, v5
    v_mul_u32_u24 v6, v6, v9
    v_cvt_f32_u32 v6, v6
    v_mul_f32 v6, 0x3a800000, v6
    v_cos_f32 v52, v6
    v_sin_f32 v68, -v6
    v_add_u32 v6, 17, v5
    v_mul_u32_u24 v6, v6, v9
    v_cvt_f32_u32 v6, v6
    v_mul_f32 v6, 0x3a800000, v6
    v_cos_f32 v53, v6
    s_add_u32 m0, s41, 10240
    s_add_u32 s56, s40, 1114112
    buffer_load_dwordx4 v10, s[8:11], s56 offen offset:0 lds
    v_sin_f32 v69, -v6
    v_add_u32 v6, 18, v5
    v_mul_u32_u24 v6, v6, v9
    v_cvt_f32_u32 v6, v6
    v_mul_f32 v6, 0x3a800000, v6
    v_cos_f32 v54, v6
    v_sin_f32 v70, -v6
    v_add_u32 v6, 19, v5
    v_mul_u32_u24 v6, v6, v9
    v_cvt_f32_u32 v6, v6
    v_mul_f32 v6, 0x3a800000, v6
    v_cos_f32 v55, v6
    v_sin_f32 v71, -v6
    v_add_u32 v6, 24, v5
    v_mul_u32_u24 v6, v6, v9
    v_cvt_f32_u32 v6, v6
    v_mul_f32 v6, 0x3a800000, v6
    v_cos_f32 v56, v6
    v_sin_f32 v72, -v6
    v_add_u32 v6, 25, v5
    v_mul_u32_u24 v6, v6, v9
    v_cvt_f32_u32 v6, v6
    v_mul_f32 v6, 0x3a800000, v6
    v_cos_f32 v57, v6
    v_sin_f32 v73, -v6
    v_add_u32 v6, 26, v5
    s_add_u32 m0, s41, 10240
    s_add_u32 s56, s40, 1114112
    buffer_load_dwordx4 v10, s[8:11], s56 offen offset:1024 lds
    v_mul_u32_u24 v6, v6, v9
    v_cvt_f32_u32 v6, v6
    v_mul_f32 v6, 0x3a800000, v6
    v_cos_f32 v58, v6
    v_sin_f32 v74, -v6
    v_add_u32 v6, 27, v5
    v_mul_u32_u24 v6, v6, v9
    v_cvt_f32_u32 v6, v6
    v_mul_f32 v6, 0x3a800000, v6
    v_cos_f32 v59, v6
    v_sin_f32 v75, -v6
    v_bfe_u32 v7, v11, 4, 1
    v_cvt_f32_u32 v7, v7
    v_mul_f32 v7, 0x3e800000, v7
    v_and_b32 v8, 15, v11
    v_add_u32 v6, 0, v5
    v_mul_u32_u24 v6, v6, v8
    v_cvt_f32_u32 v6, v6
    v_fmamk_f32 v6, v6, 0x3d000000, v7
    v_cos_f32 v188, v6
    v_sin_f32 v190, v6
    v_add_u32 v6, 1, v5
    v_mul_u32_u24 v6, v6, v8
    v_cvt_f32_u32 v6, v6
    v_fmamk_f32 v6, v6, 0x3d000000, v7
    v_cos_f32 v189, v6
    s_add_u32 m0, s41, 12288
    s_add_u32 s56, s40, 1179648
    buffer_load_dwordx4 v10, s[8:11], s56 offen offset:0 lds
    v_sin_f32 v191, v6
    s_nop 0
    v_cvt_pk_bf16_f32 v28, v188, v189
    v_cvt_pk_bf16_f32 v36, v190, v191
    v_add_u32 v6, 2, v5
    v_mul_u32_u24 v6, v6, v8
    v_cvt_f32_u32 v6, v6
    v_fmamk_f32 v6, v6, 0x3d000000, v7
    v_cos_f32 v188, v6
    v_sin_f32 v190, v6
    v_add_u32 v6, 3, v5
    v_mul_u32_u24 v6, v6, v8
    v_cvt_f32_u32 v6, v6
    v_fmamk_f32 v6, v6, 0x3d000000, v7
    v_cos_f32 v189, v6
    v_sin_f32 v191, v6
    s_nop 0
    v_cvt_pk_bf16_f32 v29, v188, v189
    v_cvt_pk_bf16_f32 v37, v190, v191
    v_add_u32 v6, 8, v5
    v_mul_u32_u24 v6, v6, v8
    v_cvt_f32_u32 v6, v6
    v_fmamk_f32 v6, v6, 0x3d000000, v7
    v_cos_f32 v188, v6
    v_sin_f32 v190, v6
    v_add_u32 v6, 9, v5
    s_add_u32 m0, s41, 12288
    s_add_u32 s56, s40, 1179648
    buffer_load_dwordx4 v10, s[8:11], s56 offen offset:1024 lds
    v_mul_u32_u24 v6, v6, v8
    v_cvt_f32_u32 v6, v6
    v_fmamk_f32 v6, v6, 0x3d000000, v7
    v_cos_f32 v189, v6
    v_sin_f32 v191, v6
    s_nop 0
    v_cvt_pk_bf16_f32 v30, v188, v189
    v_cvt_pk_bf16_f32 v38, v190, v191
    v_add_u32 v6, 10, v5
    v_mul_u32_u24 v6, v6, v8
    v_cvt_f32_u32 v6, v6
    v_fmamk_f32 v6, v6, 0x3d000000, v7
    v_cos_f32 v188, v6
    v_sin_f32 v190, v6
    v_add_u32 v6, 11, v5
    v_mul_u32_u24 v6, v6, v8
    v_cvt_f32_u32 v6, v6
    v_fmamk_f32 v6, v6, 0x3d000000, v7
    v_cos_f32 v189, v6
    v_sin_f32 v191, v6
    s_nop 0
    v_cvt_pk_bf16_f32 v31, v188, v189
    v_cvt_pk_bf16_f32 v39, v190, v191
    v_add_u32 v6, 16, v5
    v_mul_u32_u24 v6, v6, v8
    v_cvt_f32_u32 v6, v6
    s_add_u32 m0, s41, 14336
    s_add_u32 s56, s40, 1245184
    buffer_load_dwordx4 v10, s[8:11], s56 offen offset:0 lds
    v_fmamk_f32 v6, v6, 0x3d000000, v7
    v_cos_f32 v188, v6
    v_sin_f32 v190, v6
    v_add_u32 v6, 17, v5
    v_mul_u32_u24 v6, v6, v8
    v_cvt_f32_u32 v6, v6
    v_fmamk_f32 v6, v6, 0x3d000000, v7
    v_cos_f32 v189, v6
    v_sin_f32 v191, v6
    s_nop 0
    v_cvt_pk_bf16_f32 v32, v188, v189
    v_cvt_pk_bf16_f32 v40, v190, v191
    v_add_u32 v6, 18, v5
    v_mul_u32_u24 v6, v6, v8
    v_cvt_f32_u32 v6, v6
    v_fmamk_f32 v6, v6, 0x3d000000, v7
    v_cos_f32 v188, v6
    v_sin_f32 v190, v6
    v_add_u32 v6, 19, v5
    v_mul_u32_u24 v6, v6, v8
    v_cvt_f32_u32 v6, v6
    v_fmamk_f32 v6, v6, 0x3d000000, v7
    v_cos_f32 v189, v6
    v_sin_f32 v191, v6
    s_nop 0
    v_cvt_pk_bf16_f32 v33, v188, v189
    s_add_u32 m0, s41, 14336
    s_add_u32 s56, s40, 1245184
    buffer_load_dwordx4 v10, s[8:11], s56 offen offset:1024 lds
    v_cvt_pk_bf16_f32 v41, v190, v191
    v_add_u32 v6, 24, v5
    v_mul_u32_u24 v6, v6, v8
    v_cvt_f32_u32 v6, v6
    v_fmamk_f32 v6, v6, 0x3d000000, v7
    v_cos_f32 v188, v6
    v_sin_f32 v190, v6
    v_add_u32 v6, 25, v5
    v_mul_u32_u24 v6, v6, v8
    v_cvt_f32_u32 v6, v6
    v_fmamk_f32 v6, v6, 0x3d000000, v7
    v_cos_f32 v189, v6
    v_sin_f32 v191, v6
    s_nop 0
    v_cvt_pk_bf16_f32 v34, v188, v189
    v_cvt_pk_bf16_f32 v42, v190, v191
    v_add_u32 v6, 26, v5
    v_mul_u32_u24 v6, v6, v8
    v_cvt_f32_u32 v6, v6
    v_fmamk_f32 v6, v6, 0x3d000000, v7
    v_cos_f32 v188, v6
    v_sin_f32 v190, v6
    v_add_u32 v6, 27, v5
    v_mul_u32_u24 v6, v6, v8
    v_cvt_f32_u32 v6, v6
    v_fmamk_f32 v6, v6, 0x3d000000, v7
    v_cos_f32 v189, v6
    v_sin_f32 v191, v6
    s_nop 0
    v_cvt_pk_bf16_f32 v35, v188, v189
    v_cvt_pk_bf16_f32 v43, v190, v191
    s_cmp_ge_u32 s25, 4
    s_cbranch_scc1 F_notab
    v_and_b32 v8, 15, v11
    v_lshrrev_b32 v7, 4, v11
    v_lshlrev_b32 v7, 2, v7
    s_mul_i32 s56, s25, 10240
    s_add_u32 s56, s56, 34670592
    s_cmp_ge_u32 s3, 4
    s_cbranch_scc1 F_tw
    s_cmp_ge_u32 s3, 2
    s_cbranch_scc1 F_tdone
    s_lshl_b32 s58, s25, 4
    s_mov_b32 s89, 0x3c800000
    s_cmp_eq_u32 s3, 1
    s_cselect_b32 s58, 0, s58
    s_cselect_b32 s89, 0x3d000000, s89
    s_cselect_b32 s56, 34668544, s56
    v_add_u32 v8, s58, v8

    v_add_u32 v6, 0, v7
    v_mul_u32_u24 v6, v6, v8
    v_cvt_f32_u32 v6, v6
    v_mul_f32 v6, s89, v6
    v_cos_f32 v188, v6
    v_sin_f32 v190, -v6

    v_add_u32 v6, 1, v7
    v_mul_u32_u24 v6, v6, v8
    v_cvt_f32_u32 v6, v6
    v_mul_f32 v6, s89, v6
    v_cos_f32 v189, v6
    v_sin_f32 v191, -v6

    s_nop 0
    v_cvt_pk_bf16_f32 v76, v188, v189
    v_cvt_pk_bf16_f32 v80, v190, v191

    v_add_u32 v6, 2, v7
    v_mul_u32_u24 v6, v6, v8
    v_cvt_f32_u32 v6, v6
    v_mul_f32 v6, s89, v6
    v_cos_f32 v188, v6
    v_sin_f32 v190, -v6

    v_add_u32 v6, 3, v7
    v_mul_u32_u24 v6, v6, v8
    v_cvt_f32_u32 v6, v6
    v_mul_f32 v6, s89, v6
    v_cos_f32 v189, v6
    v_sin_f32 v191, -v6

    s_nop 0
    v_cvt_pk_bf16_f32 v77, v188, v189
    v_cvt_pk_bf16_f32 v81, v190, v191

    v_add_u32 v6, 16, v7
    v_mul_u32_u24 v6, v6, v8
    v_cvt_f32_u32 v6, v6
    v_mul_f32 v6, s89, v6
    v_cos_f32 v188, v6
    v_sin_f32 v190, -v6

    v_add_u32 v6, 17, v7
    v_mul_u32_u24 v6, v6, v8
    v_cvt_f32_u32 v6, v6
    v_mul_f32 v6, s89, v6
    v_cos_f32 v189, v6
    v_sin_f32 v191, -v6

    s_nop 0
    v_cvt_pk_bf16_f32 v78, v188, v189
    v_cvt_pk_bf16_f32 v82, v190, v191

    v_add_u32 v6, 18, v7
    v_mul_u32_u24 v6, v6, v8
    v_cvt_f32_u32 v6, v6
    v_mul_f32 v6, s89, v6
    v_cos_f32 v188, v6
    v_sin_f32 v190, -v6

    v_add_u32 v6, 19, v7
    v_mul_u32_u24 v6, v6, v8
    v_cvt_f32_u32 v6, v6
    v_mul_f32 v6, s89, v6
    v_cos_f32 v189, v6
    v_sin_f32 v191, -v6

    s_nop 0
    v_cvt_pk_bf16_f32 v79, v188, v189
    v_cvt_pk_bf16_f32 v83, v190, v191

    buffer_store_dwordx4 v[76:79], v10, s[20:23], s56 offen sc1
    buffer_store_dwordx4 v[80:83], v10, s[20:23], s56 offen offset:1024 sc1
    s_branch F_tdone
F_tw:
    s_bfe_u32 s57, s3, 0x10001
    s_lshl_b32 s57, s57, 4
    s_and_b32 s58, s3, 1
    s_lshl_b32 s58, s58, 1
    s_lshl_b32 s59, s25, 4
    s_and_b32 s88, s3, 3
    s_lshl_b32 s88, s88, 10
    s_add_u32 s56, s56, s88
    s_add_u32 s56, s56, 2048
    s_mov_b32 s89, 0x35800000
    v_add_u32 v7, s58, v7

    v_add_u32 v6, s57, v7
    v_add_u32 v6, 0, v6
    v_add_u32 v9, s59, v8
    v_mul_u32_u24 v6, v6, v9
    v_cvt_f32_u32 v6, v6
    v_mul_f32 v6, 0x3a000000, v6
    v_cos_f32 v76, v6
    v_sin_f32 v78, -v6
    v_add_u32 v6, s59, v7
    v_add_u32 v6, 0, v6
    v_add_u32 v9, s57, v8
    v_mul_u32_u24 v6, v6, v9
    v_cvt_f32_u32 v6, v6
    v_mul_f32 v6, 0x3a000000, v6
    v_cos_f32 v80, v6
    v_sin_f32 v82, v6
    s_nop 0
    v_mul_f32 v80, s89, v80
    v_mul_f32 v82, s89, v82

    v_add_u32 v6, s57, v7
    v_add_u32 v6, 1, v6
    v_add_u32 v9, s59, v8
    v_mul_u32_u24 v6, v6, v9
    v_cvt_f32_u32 v6, v6
    v_mul_f32 v6, 0x3a000000, v6
    v_cos_f32 v77, v6
    v_sin_f32 v79, -v6
    v_add_u32 v6, s59, v7
    v_add_u32 v6, 1, v6
    v_add_u32 v9, s57, v8
    v_mul_u32_u24 v6, v6, v9
    v_cvt_f32_u32 v6, v6
    v_mul_f32 v6, 0x3a000000, v6
    v_cos_f32 v81, v6
    v_sin_f32 v83, v6
    s_nop 0
    v_mul_f32 v81, s89, v81
    v_mul_f32 v83, s89, v83

    s_add_u32 s57, s56, 4096
    buffer_store_dwordx4 v[76:79], v10, s[20:23], s56 offen sc1
    buffer_store_dwordx4 v[80:83], v10, s[20:23], s57 offen sc1
F_tdone:

F_notab:
    v_bfe_u32 v6, v11, 2, 2
    v_add_u32 v6, v6, v5
    v_lshlrev_b32 v6, 6, v6
    v_bfe_u32 v7, v11, 4, 1
    v_lshl_add_u32 v6, v7, 5, v6
    v_and_b32 v7, 3, v11
    v_lshl_add_u32 v6, v7, 3, v6
    v_add_u32 v9, s41, v6
    s_mov_b64 s[34:35], 1

    s_waitcnt vmcnt(12)
    ds_read_b64_tr_b16 v[76:77], v9 offset:0
    ds_read_b64_tr_b16 v[78:79], v9 offset:512
    ds_read_b64_tr_b16 v[80:81], v9 offset:1024
    ds_read_b64_tr_b16 v[82:83], v9 offset:1536
    ds_read_b64_tr_b16 v[84:85], v9 offset:2048
    ds_read_b64_tr_b16 v[86:87], v9 offset:2560
    ds_read_b64_tr_b16 v[88:89], v9 offset:3072
    ds_read_b64_tr_b16 v[90:91], v9 offset:3584
    s_waitcnt lgkmcnt(0)
    v_mfma_f32_32x32x16_bf16 v[92:107], v[76:79], v[12:15], 0
    v_mfma_f32_32x32x16_bf16 v[108:123], v[76:79], v[20:23], 0
    v_mfma_f32_32x32x16_bf16 v[92:107], v[80:83], v[16:19], v[92:107]
    v_mfma_f32_32x32x16_bf16 v[108:123], v[80:83], v[24:27], v[108:123]
    v_mfma_f32_32x32x16_bf16 v[124:139], v[84:87], v[12:15], 0
    v_mfma_f32_32x32x16_bf16 v[140:155], v[84:87], v[20:23], 0
    v_mfma_f32_32x32x16_bf16 v[124:139], v[88:91], v[16:19], v[124:139]
    v_mfma_f32_32x32x16_bf16 v[140:155], v[88:91], v[24:27], v[140:155]
    s_nop 7
    v_pk_add_f32 v[6:7], v[92:93], v[94:95]
    v_pk_add_f32 v[6:7], v[6:7], v[96:97]
    v_pk_add_f32 v[6:7], v[6:7], v[98:99]
    v_pk_add_f32 v[6:7], v[6:7], v[100:101]
    v_pk_add_f32 v[6:7], v[6:7], v[102:103]
    v_pk_add_f32 v[6:7], v[6:7], v[104:105]
    v_pk_add_f32 v[6:7], v[6:7], v[106:107]
    v_sub_f32 v6, v6, v7
    s_nop 0
    v_readlane_b32 s58, v6, 0
    v_readlane_b32 s59, v6, 32

    v_pk_mul_f32 v[188:189], v[92:93], v[44:45]
    v_pk_mul_f32 v[92:93], v[92:93], v[60:61]
    v_pk_fma_f32 v[188:189], v[108:109], v[60:61], v[188:189] neg_lo:[1,0,0] neg_hi:[1,0,0]
    v_pk_fma_f32 v[92:93], v[108:109], v[44:45], v[92:93]
    v_cvt_pk_bf16_f32 v76, v188, v189
    v_cvt_pk_bf16_f32 v84, v92, v93
    v_pk_mul_f32 v[190:191], v[94:95], v[46:47]
    v_pk_mul_f32 v[94:95], v[94:95], v[62:63]
    v_pk_fma_f32 v[190:191], v[110:111], v[62:63], v[190:191] neg_lo:[1,0,0] neg_hi:[1,0,0]
    v_pk_fma_f32 v[94:95], v[110:111], v[46:47], v[94:95]
    v_cvt_pk_bf16_f32 v77, v190, v191
    v_cvt_pk_bf16_f32 v85, v94, v95
    v_pk_mul_f32 v[188:189], v[96:97], v[48:49]
    v_pk_mul_f32 v[96:97], v[96:97], v[64:65]
    v_pk_fma_f32 v[188:189], v[112:113], v[64:65], v[188:189] neg_lo:[1,0,0] neg_hi:[1,0,0]
    v_pk_fma_f32 v[96:97], v[112:113], v[48:49], v[96:97]
    v_cvt_pk_bf16_f32 v78, v188, v189
    v_cvt_pk_bf16_f32 v86, v96, v97
    v_pk_mul_f32 v[190:191], v[98:99], v[50:51]
    v_pk_mul_f32 v[98:99], v[98:99], v[66:67]
    v_pk_fma_f32 v[190:191], v[114:115], v[66:67], v[190:191] neg_lo:[1,0,0] neg_hi:[1,0,0]
    v_pk_fma_f32 v[98:99], v[114:115], v[50:51], v[98:99]
    v_cvt_pk_bf16_f32 v79, v190, v191
    v_cvt_pk_bf16_f32 v87, v98, v99
    v_pk_mul_f32 v[188:189], v[100:101], v[52:53]
    v_pk_mul_f32 v[100:101], v[100:101], v[68:69]
    v_pk_fma_f32 v[188:189], v[116:117], v[68:69], v[188:189] neg_lo:[1,0,0] neg_hi:[1,0,0]
    v_pk_fma_f32 v[100:101], v[116:117], v[52:53], v[100:101]
    v_cvt_pk_bf16_f32 v80, v188, v189
    v_cvt_pk_bf16_f32 v88, v100, v101
    v_pk_mul_f32 v[190:191], v[102:103], v[54:55]
    v_pk_mul_f32 v[102:103], v[102:103], v[70:71]
    v_pk_fma_f32 v[190:191], v[118:119], v[70:71], v[190:191] neg_lo:[1,0,0] neg_hi:[1,0,0]
    v_pk_fma_f32 v[102:103], v[118:119], v[54:55], v[102:103]
    v_cvt_pk_bf16_f32 v81, v190, v191
    v_cvt_pk_bf16_f32 v89, v102, v103
    v_pk_mul_f32 v[188:189], v[104:105], v[56:57]
    v_pk_mul_f32 v[104:105], v[104:105], v[72:73]
    v_pk_fma_f32 v[188:189], v[120:121], v[72:73], v[188:189] neg_lo:[1,0,0] neg_hi:[1,0,0]
    v_pk_fma_f32 v[104:105], v[120:121], v[56:57], v[104:105]
    v_cvt_pk_bf16_f32 v82, v188, v189
    v_cvt_pk_bf16_f32 v90, v104, v105
    v_pk_mul_f32 v[190:191], v[106:107], v[58:59]
    v_pk_mul_f32 v[106:107], v[106:107], v[74:75]
    v_pk_fma_f32 v[190:191], v[122:123], v[74:75], v[190:191] neg_lo:[1,0,0] neg_hi:[1,0,0]
    v_pk_fma_f32 v[106:107], v[122:123], v[58:59], v[106:107]
    v_cvt_pk_bf16_f32 v83, v190, v191
    v_cvt_pk_bf16_f32 v91, v106, v107
    v_mov_b32 v2, s58
    v_add_f32 v2, s59, v2
    v_mfma_f32_32x32x16_bf16 v[156:171], v[28:31], v[76:79], 0
    v_mfma_f32_32x32x16_bf16 v[156:171], v[36:39], v[84:87], v[156:171]
    v_mfma_f32_32x32x16_bf16 v[156:171], v[32:35], v[80:83], v[156:171]
    v_mfma_f32_32x32x16_bf16 v[156:171], v[40:43], v[88:91], v[156:171]
    v_pk_add_f32 v[6:7], v[124:125], v[126:127]
    v_pk_add_f32 v[6:7], v[6:7], v[128:129]
    v_pk_add_f32 v[6:7], v[6:7], v[130:131]
    v_pk_add_f32 v[6:7], v[6:7], v[132:133]
    v_pk_add_f32 v[6:7], v[6:7], v[134:135]
    v_pk_add_f32 v[6:7], v[6:7], v[136:137]
    v_pk_add_f32 v[6:7], v[6:7], v[138:139]
    v_sub_f32 v6, v6, v7
    s_nop 0
    v_readlane_b32 s58, v6, 0
    v_readlane_b32 s59, v6, 32

    v_pk_mul_f32 v[188:189], v[124:125], v[44:45]
    v_pk_mul_f32 v[124:125], v[124:125], v[60:61]
    v_pk_fma_f32 v[188:189], v[140:141], v[60:61], v[188:189] neg_lo:[1,0,0] neg_hi:[1,0,0]
    v_pk_fma_f32 v[124:125], v[140:141], v[44:45], v[124:125]
    v_cvt_pk_bf16_f32 v76, v188, v189
    v_cvt_pk_bf16_f32 v84, v124, v125
    v_pk_mul_f32 v[190:191], v[126:127], v[46:47]
    v_pk_mul_f32 v[126:127], v[126:127], v[62:63]
    v_pk_fma_f32 v[190:191], v[142:143], v[62:63], v[190:191] neg_lo:[1,0,0] neg_hi:[1,0,0]
    v_pk_fma_f32 v[126:127], v[142:143], v[46:47], v[126:127]
    v_cvt_pk_bf16_f32 v77, v190, v191
    v_cvt_pk_bf16_f32 v85, v126, v127
    v_pk_mul_f32 v[188:189], v[128:129], v[48:49]
    v_pk_mul_f32 v[128:129], v[128:129], v[64:65]
    v_pk_fma_f32 v[188:189], v[144:145], v[64:65], v[188:189] neg_lo:[1,0,0] neg_hi:[1,0,0]
    v_pk_fma_f32 v[128:129], v[144:145], v[48:49], v[128:129]
    v_cvt_pk_bf16_f32 v78, v188, v189
    v_cvt_pk_bf16_f32 v86, v128, v129
    v_pk_mul_f32 v[190:191], v[130:131], v[50:51]
    v_pk_mul_f32 v[130:131], v[130:131], v[66:67]
    v_pk_fma_f32 v[190:191], v[146:147], v[66:67], v[190:191] neg_lo:[1,0,0] neg_hi:[1,0,0]
    v_pk_fma_f32 v[130:131], v[146:147], v[50:51], v[130:131]
    v_cvt_pk_bf16_f32 v79, v190, v191
    v_cvt_pk_bf16_f32 v87, v130, v131
    v_pk_mul_f32 v[188:189], v[132:133], v[52:53]
    v_pk_mul_f32 v[132:133], v[132:133], v[68:69]
    v_pk_fma_f32 v[188:189], v[148:149], v[68:69], v[188:189] neg_lo:[1,0,0] neg_hi:[1,0,0]
    v_pk_fma_f32 v[132:133], v[148:149], v[52:53], v[132:133]
    v_cvt_pk_bf16_f32 v80, v188, v189
    v_cvt_pk_bf16_f32 v88, v132, v133
    v_pk_mul_f32 v[190:191], v[134:135], v[54:55]
    v_pk_mul_f32 v[134:135], v[134:135], v[70:71]
    v_pk_fma_f32 v[190:191], v[150:151], v[70:71], v[190:191] neg_lo:[1,0,0] neg_hi:[1,0,0]
    v_pk_fma_f32 v[134:135], v[150:151], v[54:55], v[134:135]
    v_cvt_pk_bf16_f32 v81, v190, v191
    v_cvt_pk_bf16_f32 v89, v134, v135
    v_pk_mul_f32 v[188:189], v[136:137], v[56:57]
    v_pk_mul_f32 v[136:137], v[136:137], v[72:73]
    v_pk_fma_f32 v[188:189], v[152:153], v[72:73], v[188:189] neg_lo:[1,0,0] neg_hi:[1,0,0]
    v_pk_fma_f32 v[136:137], v[152:153], v[56:57], v[136:137]
    v_cvt_pk_bf16_f32 v82, v188, v189
    v_cvt_pk_bf16_f32 v90, v136, v137
    v_pk_mul_f32 v[190:191], v[138:139], v[58:59]
    v_pk_mul_f32 v[138:139], v[138:139], v[74:75]
    v_pk_fma_f32 v[190:191], v[154:155], v[74:75], v[190:191] neg_lo:[1,0,0] neg_hi:[1,0,0]
    v_pk_fma_f32 v[138:139], v[154:155], v[58:59], v[138:139]
    v_cvt_pk_bf16_f32 v83, v190, v191
    v_cvt_pk_bf16_f32 v91, v138, v139
    v_mov_b32 v3, s58
    v_add_f32 v3, s59, v3
    v_mfma_f32_32x32x16_bf16 v[172:187], v[28:31], v[76:79], 0
    v_mfma_f32_32x32x16_bf16 v[172:187], v[36:39], v[84:87], v[172:187]
    v_mfma_f32_32x32x16_bf16 v[172:187], v[32:35], v[80:83], v[172:187]
    v_mfma_f32_32x32x16_bf16 v[172:187], v[40:43], v[88:91], v[172:187]
    s_waitcnt vmcnt(8)
    ds_read_b64_tr_b16 v[76:77], v9 offset:4096
    ds_read_b64_tr_b16 v[78:79], v9 offset:4608
    ds_read_b64_tr_b16 v[80:81], v9 offset:5120
    ds_read_b64_tr_b16 v[82:83], v9 offset:5632
    ds_read_b64_tr_b16 v[84:85], v9 offset:6144
    ds_read_b64_tr_b16 v[86:87], v9 offset:6656
    ds_read_b64_tr_b16 v[88:89], v9 offset:7168
    ds_read_b64_tr_b16 v[90:91], v9 offset:7680
    s_waitcnt lgkmcnt(0)
    v_mfma_f32_32x32x16_bf16 v[92:107], v[76:79], v[12:15], 0
    v_mfma_f32_32x32x16_bf16 v[108:123], v[76:79], v[20:23], 0
    v_mfma_f32_32x32x16_bf16 v[92:107], v[80:83], v[16:19], v[92:107]
    v_mfma_f32_32x32x16_bf16 v[108:123], v[80:83], v[24:27], v[108:123]
    v_mfma_f32_32x32x16_bf16 v[124:139], v[84:87], v[12:15], 0
    v_mfma_f32_32x32x16_bf16 v[140:155], v[84:87], v[20:23], 0
    v_mfma_f32_32x32x16_bf16 v[124:139], v[88:91], v[16:19], v[124:139]
    v_mfma_f32_32x32x16_bf16 v[140:155], v[88:91], v[24:27], v[140:155]
    v_cndmask_b32 v164, v164, v2, s[34:35]
    v_cndmask_b32 v180, v180, v3, s[34:35]
    v_cvt_pk_bf16_f32 v192, v156, v172
    v_cvt_pk_bf16_f32 v196, v157, v173
    v_cvt_pk_bf16_f32 v200, v158, v174
    v_cvt_pk_bf16_f32 v204, v159, v175
    v_cvt_pk_bf16_f32 v208, v160, v176
    v_cvt_pk_bf16_f32 v212, v161, v177
    v_cvt_pk_bf16_f32 v216, v162, v178
    v_cvt_pk_bf16_f32 v220, v163, v179
    v_cvt_pk_bf16_f32 v224, v164, v180
    v_cvt_pk_bf16_f32 v228, v165, v181
    v_cvt_pk_bf16_f32 v232, v166, v182
    v_cvt_pk_bf16_f32 v236, v167, v183
    v_cvt_pk_bf16_f32 v240, v168, v184
    v_cvt_pk_bf16_f32 v244, v169, v185
    v_cvt_pk_bf16_f32 v248, v170, v186
    v_cvt_pk_bf16_f32 v252, v171, v187
    v_pk_add_f32 v[6:7], v[92:93], v[94:95]
    v_pk_add_f32 v[6:7], v[6:7], v[96:97]
    v_pk_add_f32 v[6:7], v[6:7], v[98:99]
    v_pk_add_f32 v[6:7], v[6:7], v[100:101]
    v_pk_add_f32 v[6:7], v[6:7], v[102:103]
    v_pk_add_f32 v[6:7], v[6:7], v[104:105]
    v_pk_add_f32 v[6:7], v[6:7], v[106:107]
    v_sub_f32 v6, v6, v7
    s_nop 0
    v_readlane_b32 s58, v6, 0
    v_readlane_b32 s59, v6, 32

    v_pk_mul_f32 v[188:189], v[92:93], v[44:45]
    v_pk_mul_f32 v[92:93], v[92:93], v[60:61]
    v_pk_fma_f32 v[188:189], v[108:109], v[60:61], v[188:189] neg_lo:[1,0,0] neg_hi:[1,0,0]
    v_pk_fma_f32 v[92:93], v[108:109], v[44:45], v[92:93]
    v_cvt_pk_bf16_f32 v76, v188, v189
    v_cvt_pk_bf16_f32 v84, v92, v93
    v_pk_mul_f32 v[190:191], v[94:95], v[46:47]
    v_pk_mul_f32 v[94:95], v[94:95], v[62:63]
    v_pk_fma_f32 v[190:191], v[110:111], v[62:63], v[190:191] neg_lo:[1,0,0] neg_hi:[1,0,0]
    v_pk_fma_f32 v[94:95], v[110:111], v[46:47], v[94:95]
    v_cvt_pk_bf16_f32 v77, v190, v191
    v_cvt_pk_bf16_f32 v85, v94, v95
    v_pk_mul_f32 v[188:189], v[96:97], v[48:49]
    v_pk_mul_f32 v[96:97], v[96:97], v[64:65]
    v_pk_fma_f32 v[188:189], v[112:113], v[64:65], v[188:189] neg_lo:[1,0,0] neg_hi:[1,0,0]
    v_pk_fma_f32 v[96:97], v[112:113], v[48:49], v[96:97]
    v_cvt_pk_bf16_f32 v78, v188, v189
    v_cvt_pk_bf16_f32 v86, v96, v97
    v_pk_mul_f32 v[190:191], v[98:99], v[50:51]
    v_pk_mul_f32 v[98:99], v[98:99], v[66:67]
    v_pk_fma_f32 v[190:191], v[114:115], v[66:67], v[190:191] neg_lo:[1,0,0] neg_hi:[1,0,0]
    v_pk_fma_f32 v[98:99], v[114:115], v[50:51], v[98:99]
    v_cvt_pk_bf16_f32 v79, v190, v191
    v_cvt_pk_bf16_f32 v87, v98, v99
    v_pk_mul_f32 v[188:189], v[100:101], v[52:53]
    v_pk_mul_f32 v[100:101], v[100:101], v[68:69]
    v_pk_fma_f32 v[188:189], v[116:117], v[68:69], v[188:189] neg_lo:[1,0,0] neg_hi:[1,0,0]
    v_pk_fma_f32 v[100:101], v[116:117], v[52:53], v[100:101]
    v_cvt_pk_bf16_f32 v80, v188, v189
    v_cvt_pk_bf16_f32 v88, v100, v101
    v_pk_mul_f32 v[190:191], v[102:103], v[54:55]
    v_pk_mul_f32 v[102:103], v[102:103], v[70:71]
    v_pk_fma_f32 v[190:191], v[118:119], v[70:71], v[190:191] neg_lo:[1,0,0] neg_hi:[1,0,0]
    v_pk_fma_f32 v[102:103], v[118:119], v[54:55], v[102:103]
    v_cvt_pk_bf16_f32 v81, v190, v191
    v_cvt_pk_bf16_f32 v89, v102, v103
    v_pk_mul_f32 v[188:189], v[104:105], v[56:57]
    v_pk_mul_f32 v[104:105], v[104:105], v[72:73]
    v_pk_fma_f32 v[188:189], v[120:121], v[72:73], v[188:189] neg_lo:[1,0,0] neg_hi:[1,0,0]
    v_pk_fma_f32 v[104:105], v[120:121], v[56:57], v[104:105]
    v_cvt_pk_bf16_f32 v82, v188, v189
    v_cvt_pk_bf16_f32 v90, v104, v105
    v_pk_mul_f32 v[190:191], v[106:107], v[58:59]
    v_pk_mul_f32 v[106:107], v[106:107], v[74:75]
    v_pk_fma_f32 v[190:191], v[122:123], v[74:75], v[190:191] neg_lo:[1,0,0] neg_hi:[1,0,0]
    v_pk_fma_f32 v[106:107], v[122:123], v[58:59], v[106:107]
    v_cvt_pk_bf16_f32 v83, v190, v191
    v_cvt_pk_bf16_f32 v91, v106, v107
    v_mov_b32 v2, s58
    v_add_f32 v2, s59, v2
    v_mfma_f32_32x32x16_bf16 v[156:171], v[28:31], v[76:79], 0
    v_mfma_f32_32x32x16_bf16 v[156:171], v[36:39], v[84:87], v[156:171]
    v_mfma_f32_32x32x16_bf16 v[156:171], v[32:35], v[80:83], v[156:171]
    v_mfma_f32_32x32x16_bf16 v[156:171], v[40:43], v[88:91], v[156:171]
    v_pk_add_f32 v[6:7], v[124:125], v[126:127]
    v_pk_add_f32 v[6:7], v[6:7], v[128:129]
    v_pk_add_f32 v[6:7], v[6:7], v[130:131]
    v_pk_add_f32 v[6:7], v[6:7], v[132:133]
    v_pk_add_f32 v[6:7], v[6:7], v[134:135]
    v_pk_add_f32 v[6:7], v[6:7], v[136:137]
    v_pk_add_f32 v[6:7], v[6:7], v[138:139]
    v_sub_f32 v6, v6, v7
    s_nop 0
    v_readlane_b32 s58, v6, 0
    v_readlane_b32 s59, v6, 32

    v_pk_mul_f32 v[188:189], v[124:125], v[44:45]
    v_pk_mul_f32 v[124:125], v[124:125], v[60:61]
    v_pk_fma_f32 v[188:189], v[140:141], v[60:61], v[188:189] neg_lo:[1,0,0] neg_hi:[1,0,0]
    v_pk_fma_f32 v[124:125], v[140:141], v[44:45], v[124:125]
    v_cvt_pk_bf16_f32 v76, v188, v189
    v_cvt_pk_bf16_f32 v84, v124, v125
    v_pk_mul_f32 v[190:191], v[126:127], v[46:47]
    v_pk_mul_f32 v[126:127], v[126:127], v[62:63]
    v_pk_fma_f32 v[190:191], v[142:143], v[62:63], v[190:191] neg_lo:[1,0,0] neg_hi:[1,0,0]
    v_pk_fma_f32 v[126:127], v[142:143], v[46:47], v[126:127]
    v_cvt_pk_bf16_f32 v77, v190, v191
    v_cvt_pk_bf16_f32 v85, v126, v127
    v_pk_mul_f32 v[188:189], v[128:129], v[48:49]
    v_pk_mul_f32 v[128:129], v[128:129], v[64:65]
    v_pk_fma_f32 v[188:189], v[144:145], v[64:65], v[188:189] neg_lo:[1,0,0] neg_hi:[1,0,0]
    v_pk_fma_f32 v[128:129], v[144:145], v[48:49], v[128:129]
    v_cvt_pk_bf16_f32 v78, v188, v189
    v_cvt_pk_bf16_f32 v86, v128, v129
    v_pk_mul_f32 v[190:191], v[130:131], v[50:51]
    v_pk_mul_f32 v[130:131], v[130:131], v[66:67]
    v_pk_fma_f32 v[190:191], v[146:147], v[66:67], v[190:191] neg_lo:[1,0,0] neg_hi:[1,0,0]
    v_pk_fma_f32 v[130:131], v[146:147], v[50:51], v[130:131]
    v_cvt_pk_bf16_f32 v79, v190, v191
    v_cvt_pk_bf16_f32 v87, v130, v131
    v_pk_mul_f32 v[188:189], v[132:133], v[52:53]
    v_pk_mul_f32 v[132:133], v[132:133], v[68:69]
    v_pk_fma_f32 v[188:189], v[148:149], v[68:69], v[188:189] neg_lo:[1,0,0] neg_hi:[1,0,0]
    v_pk_fma_f32 v[132:133], v[148:149], v[52:53], v[132:133]
    v_cvt_pk_bf16_f32 v80, v188, v189
    v_cvt_pk_bf16_f32 v88, v132, v133
    v_pk_mul_f32 v[190:191], v[134:135], v[54:55]
    v_pk_mul_f32 v[134:135], v[134:135], v[70:71]
    v_pk_fma_f32 v[190:191], v[150:151], v[70:71], v[190:191] neg_lo:[1,0,0] neg_hi:[1,0,0]
    v_pk_fma_f32 v[134:135], v[150:151], v[54:55], v[134:135]
    v_cvt_pk_bf16_f32 v81, v190, v191
    v_cvt_pk_bf16_f32 v89, v134, v135
    v_pk_mul_f32 v[188:189], v[136:137], v[56:57]
    v_pk_mul_f32 v[136:137], v[136:137], v[72:73]
    v_pk_fma_f32 v[188:189], v[152:153], v[72:73], v[188:189] neg_lo:[1,0,0] neg_hi:[1,0,0]
    v_pk_fma_f32 v[136:137], v[152:153], v[56:57], v[136:137]
    v_cvt_pk_bf16_f32 v82, v188, v189
    v_cvt_pk_bf16_f32 v90, v136, v137
    v_pk_mul_f32 v[190:191], v[138:139], v[58:59]
    v_pk_mul_f32 v[138:139], v[138:139], v[74:75]
    v_pk_fma_f32 v[190:191], v[154:155], v[74:75], v[190:191] neg_lo:[1,0,0] neg_hi:[1,0,0]
    v_pk_fma_f32 v[138:139], v[154:155], v[58:59], v[138:139]
    v_cvt_pk_bf16_f32 v83, v190, v191
    v_cvt_pk_bf16_f32 v91, v138, v139
    v_mov_b32 v3, s58
    v_add_f32 v3, s59, v3
    v_mfma_f32_32x32x16_bf16 v[172:187], v[28:31], v[76:79], 0
    v_mfma_f32_32x32x16_bf16 v[172:187], v[36:39], v[84:87], v[172:187]
    v_mfma_f32_32x32x16_bf16 v[172:187], v[32:35], v[80:83], v[172:187]
    v_mfma_f32_32x32x16_bf16 v[172:187], v[40:43], v[88:91], v[172:187]
    s_waitcnt vmcnt(4)
    ds_read_b64_tr_b16 v[76:77], v9 offset:8192
    ds_read_b64_tr_b16 v[78:79], v9 offset:8704
    ds_read_b64_tr_b16 v[80:81], v9 offset:9216
    ds_read_b64_tr_b16 v[82:83], v9 offset:9728
    ds_read_b64_tr_b16 v[84:85], v9 offset:10240
    ds_read_b64_tr_b16 v[86:87], v9 offset:10752
    ds_read_b64_tr_b16 v[88:89], v9 offset:11264
    ds_read_b64_tr_b16 v[90:91], v9 offset:11776
    s_waitcnt lgkmcnt(0)
    v_mfma_f32_32x32x16_bf16 v[92:107], v[76:79], v[12:15], 0
    v_mfma_f32_32x32x16_bf16 v[108:123], v[76:79], v[20:23], 0
    v_mfma_f32_32x32x16_bf16 v[92:107], v[80:83], v[16:19], v[92:107]
    v_mfma_f32_32x32x16_bf16 v[108:123], v[80:83], v[24:27], v[108:123]
    v_mfma_f32_32x32x16_bf16 v[124:139], v[84:87], v[12:15], 0
    v_mfma_f32_32x32x16_bf16 v[140:155], v[84:87], v[20:23], 0
    v_mfma_f32_32x32x16_bf16 v[124:139], v[88:91], v[16:19], v[124:139]
    v_mfma_f32_32x32x16_bf16 v[140:155], v[88:91], v[24:27], v[140:155]
    v_cndmask_b32 v164, v164, v2, s[34:35]
    v_cndmask_b32 v180, v180, v3, s[34:35]
    v_cvt_pk_bf16_f32 v193, v156, v172
    v_cvt_pk_bf16_f32 v197, v157, v173
    v_cvt_pk_bf16_f32 v201, v158, v174
    v_cvt_pk_bf16_f32 v205, v159, v175
    v_cvt_pk_bf16_f32 v209, v160, v176
    v_cvt_pk_bf16_f32 v213, v161, v177
    v_cvt_pk_bf16_f32 v217, v162, v178
    v_cvt_pk_bf16_f32 v221, v163, v179
    v_cvt_pk_bf16_f32 v225, v164, v180
    v_cvt_pk_bf16_f32 v229, v165, v181
    v_cvt_pk_bf16_f32 v233, v166, v182
    v_cvt_pk_bf16_f32 v237, v167, v183
    v_cvt_pk_bf16_f32 v241, v168, v184
    v_cvt_pk_bf16_f32 v245, v169, v185
    v_cvt_pk_bf16_f32 v249, v170, v186
    v_cvt_pk_bf16_f32 v253, v171, v187
    v_pk_add_f32 v[6:7], v[92:93], v[94:95]
    v_pk_add_f32 v[6:7], v[6:7], v[96:97]
    v_pk_add_f32 v[6:7], v[6:7], v[98:99]
    v_pk_add_f32 v[6:7], v[6:7], v[100:101]
    v_pk_add_f32 v[6:7], v[6:7], v[102:103]
    v_pk_add_f32 v[6:7], v[6:7], v[104:105]
    v_pk_add_f32 v[6:7], v[6:7], v[106:107]
    v_sub_f32 v6, v6, v7
    s_nop 0
    v_readlane_b32 s58, v6, 0
    v_readlane_b32 s59, v6, 32

    v_pk_mul_f32 v[188:189], v[92:93], v[44:45]
    v_pk_mul_f32 v[92:93], v[92:93], v[60:61]
    v_pk_fma_f32 v[188:189], v[108:109], v[60:61], v[188:189] neg_lo:[1,0,0] neg_hi:[1,0,0]
    v_pk_fma_f32 v[92:93], v[108:109], v[44:45], v[92:93]
    v_cvt_pk_bf16_f32 v76, v188, v189
    v_cvt_pk_bf16_f32 v84, v92, v93
    v_pk_mul_f32 v[190:191], v[94:95], v[46:47]
    v_pk_mul_f32 v[94:95], v[94:95], v[62:63]
    v_pk_fma_f32 v[190:191], v[110:111], v[62:63], v[190:191] neg_lo:[1,0,0] neg_hi:[1,0,0]
    v_pk_fma_f32 v[94:95], v[110:111], v[46:47], v[94:95]
    v_cvt_pk_bf16_f32 v77, v190, v191
    v_cvt_pk_bf16_f32 v85, v94, v95
    v_pk_mul_f32 v[188:189], v[96:97], v[48:49]
    v_pk_mul_f32 v[96:97], v[96:97], v[64:65]
    v_pk_fma_f32 v[188:189], v[112:113], v[64:65], v[188:189] neg_lo:[1,0,0] neg_hi:[1,0,0]
    v_pk_fma_f32 v[96:97], v[112:113], v[48:49], v[96:97]
    v_cvt_pk_bf16_f32 v78, v188, v189
    v_cvt_pk_bf16_f32 v86, v96, v97
    v_pk_mul_f32 v[190:191], v[98:99], v[50:51]
    v_pk_mul_f32 v[98:99], v[98:99], v[66:67]
    v_pk_fma_f32 v[190:191], v[114:115], v[66:67], v[190:191] neg_lo:[1,0,0] neg_hi:[1,0,0]
    v_pk_fma_f32 v[98:99], v[114:115], v[50:51], v[98:99]
    v_cvt_pk_bf16_f32 v79, v190, v191
    v_cvt_pk_bf16_f32 v87, v98, v99
    v_pk_mul_f32 v[188:189], v[100:101], v[52:53]
    v_pk_mul_f32 v[100:101], v[100:101], v[68:69]
    v_pk_fma_f32 v[188:189], v[116:117], v[68:69], v[188:189] neg_lo:[1,0,0] neg_hi:[1,0,0]
    v_pk_fma_f32 v[100:101], v[116:117], v[52:53], v[100:101]
    v_cvt_pk_bf16_f32 v80, v188, v189
    v_cvt_pk_bf16_f32 v88, v100, v101
    v_pk_mul_f32 v[190:191], v[102:103], v[54:55]
    v_pk_mul_f32 v[102:103], v[102:103], v[70:71]
    v_pk_fma_f32 v[190:191], v[118:119], v[70:71], v[190:191] neg_lo:[1,0,0] neg_hi:[1,0,0]
    v_pk_fma_f32 v[102:103], v[118:119], v[54:55], v[102:103]
    v_cvt_pk_bf16_f32 v81, v190, v191
    v_cvt_pk_bf16_f32 v89, v102, v103
    v_pk_mul_f32 v[188:189], v[104:105], v[56:57]
    v_pk_mul_f32 v[104:105], v[104:105], v[72:73]
    v_pk_fma_f32 v[188:189], v[120:121], v[72:73], v[188:189] neg_lo:[1,0,0] neg_hi:[1,0,0]
    v_pk_fma_f32 v[104:105], v[120:121], v[56:57], v[104:105]
    v_cvt_pk_bf16_f32 v82, v188, v189
    v_cvt_pk_bf16_f32 v90, v104, v105
    v_pk_mul_f32 v[190:191], v[106:107], v[58:59]
    v_pk_mul_f32 v[106:107], v[106:107], v[74:75]
    v_pk_fma_f32 v[190:191], v[122:123], v[74:75], v[190:191] neg_lo:[1,0,0] neg_hi:[1,0,0]
    v_pk_fma_f32 v[106:107], v[122:123], v[58:59], v[106:107]
    v_cvt_pk_bf16_f32 v83, v190, v191
    v_cvt_pk_bf16_f32 v91, v106, v107
    v_mov_b32 v2, s58
    v_add_f32 v2, s59, v2
    v_mfma_f32_32x32x16_bf16 v[156:171], v[28:31], v[76:79], 0
    v_mfma_f32_32x32x16_bf16 v[156:171], v[36:39], v[84:87], v[156:171]
    v_mfma_f32_32x32x16_bf16 v[156:171], v[32:35], v[80:83], v[156:171]
    v_mfma_f32_32x32x16_bf16 v[156:171], v[40:43], v[88:91], v[156:171]
    v_pk_add_f32 v[6:7], v[124:125], v[126:127]
    v_pk_add_f32 v[6:7], v[6:7], v[128:129]
    v_pk_add_f32 v[6:7], v[6:7], v[130:131]
    v_pk_add_f32 v[6:7], v[6:7], v[132:133]
    v_pk_add_f32 v[6:7], v[6:7], v[134:135]
    v_pk_add_f32 v[6:7], v[6:7], v[136:137]
    v_pk_add_f32 v[6:7], v[6:7], v[138:139]
    v_sub_f32 v6, v6, v7
    s_nop 0
    v_readlane_b32 s58, v6, 0
    v_readlane_b32 s59, v6, 32

    v_pk_mul_f32 v[188:189], v[124:125], v[44:45]
    v_pk_mul_f32 v[124:125], v[124:125], v[60:61]
    v_pk_fma_f32 v[188:189], v[140:141], v[60:61], v[188:189] neg_lo:[1,0,0] neg_hi:[1,0,0]
    v_pk_fma_f32 v[124:125], v[140:141], v[44:45], v[124:125]
    v_cvt_pk_bf16_f32 v76, v188, v189
    v_cvt_pk_bf16_f32 v84, v124, v125
    v_pk_mul_f32 v[190:191], v[126:127], v[46:47]
    v_pk_mul_f32 v[126:127], v[126:127], v[62:63]
    v_pk_fma_f32 v[190:191], v[142:143], v[62:63], v[190:191] neg_lo:[1,0,0] neg_hi:[1,0,0]
    v_pk_fma_f32 v[126:127], v[142:143], v[46:47], v[126:127]
    v_cvt_pk_bf16_f32 v77, v190, v191
    v_cvt_pk_bf16_f32 v85, v126, v127
    v_pk_mul_f32 v[188:189], v[128:129], v[48:49]
    v_pk_mul_f32 v[128:129], v[128:129], v[64:65]
    v_pk_fma_f32 v[188:189], v[144:145], v[64:65], v[188:189] neg_lo:[1,0,0] neg_hi:[1,0,0]
    v_pk_fma_f32 v[128:129], v[144:145], v[48:49], v[128:129]
    v_cvt_pk_bf16_f32 v78, v188, v189
    v_cvt_pk_bf16_f32 v86, v128, v129
    v_pk_mul_f32 v[190:191], v[130:131], v[50:51]
    v_pk_mul_f32 v[130:131], v[130:131], v[66:67]
    v_pk_fma_f32 v[190:191], v[146:147], v[66:67], v[190:191] neg_lo:[1,0,0] neg_hi:[1,0,0]
    v_pk_fma_f32 v[130:131], v[146:147], v[50:51], v[130:131]
    v_cvt_pk_bf16_f32 v79, v190, v191
    v_cvt_pk_bf16_f32 v87, v130, v131
    v_pk_mul_f32 v[188:189], v[132:133], v[52:53]
    v_pk_mul_f32 v[132:133], v[132:133], v[68:69]
    v_pk_fma_f32 v[188:189], v[148:149], v[68:69], v[188:189] neg_lo:[1,0,0] neg_hi:[1,0,0]
    v_pk_fma_f32 v[132:133], v[148:149], v[52:53], v[132:133]
    v_cvt_pk_bf16_f32 v80, v188, v189
    v_cvt_pk_bf16_f32 v88, v132, v133
    v_pk_mul_f32 v[190:191], v[134:135], v[54:55]
    v_pk_mul_f32 v[134:135], v[134:135], v[70:71]
    v_pk_fma_f32 v[190:191], v[150:151], v[70:71], v[190:191] neg_lo:[1,0,0] neg_hi:[1,0,0]
    v_pk_fma_f32 v[134:135], v[150:151], v[54:55], v[134:135]
    v_cvt_pk_bf16_f32 v81, v190, v191
    v_cvt_pk_bf16_f32 v89, v134, v135
    v_pk_mul_f32 v[188:189], v[136:137], v[56:57]
    v_pk_mul_f32 v[136:137], v[136:137], v[72:73]
    v_pk_fma_f32 v[188:189], v[152:153], v[72:73], v[188:189] neg_lo:[1,0,0] neg_hi:[1,0,0]
    v_pk_fma_f32 v[136:137], v[152:153], v[56:57], v[136:137]
    v_cvt_pk_bf16_f32 v82, v188, v189
    v_cvt_pk_bf16_f32 v90, v136, v137
    v_pk_mul_f32 v[190:191], v[138:139], v[58:59]
    v_pk_mul_f32 v[138:139], v[138:139], v[74:75]
    v_pk_fma_f32 v[190:191], v[154:155], v[74:75], v[190:191] neg_lo:[1,0,0] neg_hi:[1,0,0]
    v_pk_fma_f32 v[138:139], v[154:155], v[58:59], v[138:139]
    v_cvt_pk_bf16_f32 v83, v190, v191
    v_cvt_pk_bf16_f32 v91, v138, v139
    v_mov_b32 v3, s58
    v_add_f32 v3, s59, v3
    v_mfma_f32_32x32x16_bf16 v[172:187], v[28:31], v[76:79], 0
    v_mfma_f32_32x32x16_bf16 v[172:187], v[36:39], v[84:87], v[172:187]
    v_mfma_f32_32x32x16_bf16 v[172:187], v[32:35], v[80:83], v[172:187]
    v_mfma_f32_32x32x16_bf16 v[172:187], v[40:43], v[88:91], v[172:187]
    s_waitcnt vmcnt(0)
    ds_read_b64_tr_b16 v[76:77], v9 offset:12288
    ds_read_b64_tr_b16 v[78:79], v9 offset:12800
    ds_read_b64_tr_b16 v[80:81], v9 offset:13312
    ds_read_b64_tr_b16 v[82:83], v9 offset:13824
    ds_read_b64_tr_b16 v[84:85], v9 offset:14336
    ds_read_b64_tr_b16 v[86:87], v9 offset:14848
    ds_read_b64_tr_b16 v[88:89], v9 offset:15360
    ds_read_b64_tr_b16 v[90:91], v9 offset:15872
    s_waitcnt lgkmcnt(0)
    v_mfma_f32_32x32x16_bf16 v[92:107], v[76:79], v[12:15], 0
    v_mfma_f32_32x32x16_bf16 v[108:123], v[76:79], v[20:23], 0
    v_mfma_f32_32x32x16_bf16 v[92:107], v[80:83], v[16:19], v[92:107]
    v_mfma_f32_32x32x16_bf16 v[108:123], v[80:83], v[24:27], v[108:123]
    v_mfma_f32_32x32x16_bf16 v[124:139], v[84:87], v[12:15], 0
    v_mfma_f32_32x32x16_bf16 v[140:155], v[84:87], v[20:23], 0
    v_mfma_f32_32x32x16_bf16 v[124:139], v[88:91], v[16:19], v[124:139]
    v_mfma_f32_32x32x16_bf16 v[140:155], v[88:91], v[24:27], v[140:155]
    v_cndmask_b32 v164, v164, v2, s[34:35]
    v_cndmask_b32 v180, v180, v3, s[34:35]
    v_cvt_pk_bf16_f32 v194, v156, v172
    v_cvt_pk_bf16_f32 v198, v157, v173
    v_cvt_pk_bf16_f32 v202, v158, v174
    v_cvt_pk_bf16_f32 v206, v159, v175
    v_cvt_pk_bf16_f32 v210, v160, v176
    v_cvt_pk_bf16_f32 v214, v161, v177
    v_cvt_pk_bf16_f32 v218, v162, v178
    v_cvt_pk_bf16_f32 v222, v163, v179
    v_cvt_pk_bf16_f32 v226, v164, v180
    v_cvt_pk_bf16_f32 v230, v165, v181
    v_cvt_pk_bf16_f32 v234, v166, v182
    v_cvt_pk_bf16_f32 v238, v167, v183
    v_cvt_pk_bf16_f32 v242, v168, v184
    v_cvt_pk_bf16_f32 v246, v169, v185
    v_cvt_pk_bf16_f32 v250, v170, v186
    v_cvt_pk_bf16_f32 v254, v171, v187
    v_pk_add_f32 v[6:7], v[92:93], v[94:95]
    v_pk_add_f32 v[6:7], v[6:7], v[96:97]
    v_pk_add_f32 v[6:7], v[6:7], v[98:99]
    v_pk_add_f32 v[6:7], v[6:7], v[100:101]
    v_pk_add_f32 v[6:7], v[6:7], v[102:103]
    v_pk_add_f32 v[6:7], v[6:7], v[104:105]
    v_pk_add_f32 v[6:7], v[6:7], v[106:107]
    v_sub_f32 v6, v6, v7
    s_nop 0
    v_readlane_b32 s58, v6, 0
    v_readlane_b32 s59, v6, 32

    v_pk_mul_f32 v[188:189], v[92:93], v[44:45]
    v_pk_mul_f32 v[92:93], v[92:93], v[60:61]
    v_pk_fma_f32 v[188:189], v[108:109], v[60:61], v[188:189] neg_lo:[1,0,0] neg_hi:[1,0,0]
    v_pk_fma_f32 v[92:93], v[108:109], v[44:45], v[92:93]
    v_cvt_pk_bf16_f32 v76, v188, v189
    v_cvt_pk_bf16_f32 v84, v92, v93
    v_pk_mul_f32 v[190:191], v[94:95], v[46:47]
    v_pk_mul_f32 v[94:95], v[94:95], v[62:63]
    v_pk_fma_f32 v[190:191], v[110:111], v[62:63], v[190:191] neg_lo:[1,0,0] neg_hi:[1,0,0]
    v_pk_fma_f32 v[94:95], v[110:111], v[46:47], v[94:95]
    v_cvt_pk_bf16_f32 v77, v190, v191
    v_cvt_pk_bf16_f32 v85, v94, v95
    v_pk_mul_f32 v[188:189], v[96:97], v[48:49]
    v_pk_mul_f32 v[96:97], v[96:97], v[64:65]
    v_pk_fma_f32 v[188:189], v[112:113], v[64:65], v[188:189] neg_lo:[1,0,0] neg_hi:[1,0,0]
    v_pk_fma_f32 v[96:97], v[112:113], v[48:49], v[96:97]
    v_cvt_pk_bf16_f32 v78, v188, v189
    v_cvt_pk_bf16_f32 v86, v96, v97
    v_pk_mul_f32 v[190:191], v[98:99], v[50:51]
    v_pk_mul_f32 v[98:99], v[98:99], v[66:67]
    v_pk_fma_f32 v[190:191], v[114:115], v[66:67], v[190:191] neg_lo:[1,0,0] neg_hi:[1,0,0]
    v_pk_fma_f32 v[98:99], v[114:115], v[50:51], v[98:99]
    v_cvt_pk_bf16_f32 v79, v190, v191
    v_cvt_pk_bf16_f32 v87, v98, v99
    v_pk_mul_f32 v[188:189], v[100:101], v[52:53]
    v_pk_mul_f32 v[100:101], v[100:101], v[68:69]
    v_pk_fma_f32 v[188:189], v[116:117], v[68:69], v[188:189] neg_lo:[1,0,0] neg_hi:[1,0,0]
    v_pk_fma_f32 v[100:101], v[116:117], v[52:53], v[100:101]
    v_cvt_pk_bf16_f32 v80, v188, v189
    v_cvt_pk_bf16_f32 v88, v100, v101
    v_pk_mul_f32 v[190:191], v[102:103], v[54:55]
    v_pk_mul_f32 v[102:103], v[102:103], v[70:71]
    v_pk_fma_f32 v[190:191], v[118:119], v[70:71], v[190:191] neg_lo:[1,0,0] neg_hi:[1,0,0]
    v_pk_fma_f32 v[102:103], v[118:119], v[54:55], v[102:103]
    v_cvt_pk_bf16_f32 v81, v190, v191
    v_cvt_pk_bf16_f32 v89, v102, v103
    v_pk_mul_f32 v[188:189], v[104:105], v[56:57]
    v_pk_mul_f32 v[104:105], v[104:105], v[72:73]
    v_pk_fma_f32 v[188:189], v[120:121], v[72:73], v[188:189] neg_lo:[1,0,0] neg_hi:[1,0,0]
    v_pk_fma_f32 v[104:105], v[120:121], v[56:57], v[104:105]
    v_cvt_pk_bf16_f32 v82, v188, v189
    v_cvt_pk_bf16_f32 v90, v104, v105
    v_pk_mul_f32 v[190:191], v[106:107], v[58:59]
    v_pk_mul_f32 v[106:107], v[106:107], v[74:75]
    v_pk_fma_f32 v[190:191], v[122:123], v[74:75], v[190:191] neg_lo:[1,0,0] neg_hi:[1,0,0]
    v_pk_fma_f32 v[106:107], v[122:123], v[58:59], v[106:107]
    v_cvt_pk_bf16_f32 v83, v190, v191
    v_cvt_pk_bf16_f32 v91, v106, v107
    v_mov_b32 v2, s58
    v_add_f32 v2, s59, v2
    v_mfma_f32_32x32x16_bf16 v[156:171], v[28:31], v[76:79], 0
    v_mfma_f32_32x32x16_bf16 v[156:171], v[36:39], v[84:87], v[156:171]
    v_mfma_f32_32x32x16_bf16 v[156:171], v[32:35], v[80:83], v[156:171]
    v_mfma_f32_32x32x16_bf16 v[156:171], v[40:43], v[88:91], v[156:171]
    v_pk_add_f32 v[6:7], v[124:125], v[126:127]
    v_pk_add_f32 v[6:7], v[6:7], v[128:129]
    v_pk_add_f32 v[6:7], v[6:7], v[130:131]
    v_pk_add_f32 v[6:7], v[6:7], v[132:133]
    v_pk_add_f32 v[6:7], v[6:7], v[134:135]
    v_pk_add_f32 v[6:7], v[6:7], v[136:137]
    v_pk_add_f32 v[6:7], v[6:7], v[138:139]
    v_sub_f32 v6, v6, v7
    s_nop 0
    v_readlane_b32 s58, v6, 0
    v_readlane_b32 s59, v6, 32

    v_pk_mul_f32 v[188:189], v[124:125], v[44:45]
    v_pk_mul_f32 v[124:125], v[124:125], v[60:61]
    v_pk_fma_f32 v[188:189], v[140:141], v[60:61], v[188:189] neg_lo:[1,0,0] neg_hi:[1,0,0]
    v_pk_fma_f32 v[124:125], v[140:141], v[44:45], v[124:125]
    v_cvt_pk_bf16_f32 v76, v188, v189
    v_cvt_pk_bf16_f32 v84, v124, v125
    v_pk_mul_f32 v[190:191], v[126:127], v[46:47]
    v_pk_mul_f32 v[126:127], v[126:127], v[62:63]
    v_pk_fma_f32 v[190:191], v[142:143], v[62:63], v[190:191] neg_lo:[1,0,0] neg_hi:[1,0,0]
    v_pk_fma_f32 v[126:127], v[142:143], v[46:47], v[126:127]
    v_cvt_pk_bf16_f32 v77, v190, v191
    v_cvt_pk_bf16_f32 v85, v126, v127
    v_pk_mul_f32 v[188:189], v[128:129], v[48:49]
    v_pk_mul_f32 v[128:129], v[128:129], v[64:65]
    v_pk_fma_f32 v[188:189], v[144:145], v[64:65], v[188:189] neg_lo:[1,0,0] neg_hi:[1,0,0]
    v_pk_fma_f32 v[128:129], v[144:145], v[48:49], v[128:129]
    v_cvt_pk_bf16_f32 v78, v188, v189
    v_cvt_pk_bf16_f32 v86, v128, v129
    v_pk_mul_f32 v[190:191], v[130:131], v[50:51]
    v_pk_mul_f32 v[130:131], v[130:131], v[66:67]
    v_pk_fma_f32 v[190:191], v[146:147], v[66:67], v[190:191] neg_lo:[1,0,0] neg_hi:[1,0,0]
    v_pk_fma_f32 v[130:131], v[146:147], v[50:51], v[130:131]
    v_cvt_pk_bf16_f32 v79, v190, v191
    v_cvt_pk_bf16_f32 v87, v130, v131
    v_pk_mul_f32 v[188:189], v[132:133], v[52:53]
    v_pk_mul_f32 v[132:133], v[132:133], v[68:69]
    v_pk_fma_f32 v[188:189], v[148:149], v[68:69], v[188:189] neg_lo:[1,0,0] neg_hi:[1,0,0]
    v_pk_fma_f32 v[132:133], v[148:149], v[52:53], v[132:133]
    v_cvt_pk_bf16_f32 v80, v188, v189
    v_cvt_pk_bf16_f32 v88, v132, v133
    v_pk_mul_f32 v[190:191], v[134:135], v[54:55]
    v_pk_mul_f32 v[134:135], v[134:135], v[70:71]
    v_pk_fma_f32 v[190:191], v[150:151], v[70:71], v[190:191] neg_lo:[1,0,0] neg_hi:[1,0,0]
    v_pk_fma_f32 v[134:135], v[150:151], v[54:55], v[134:135]
    v_cvt_pk_bf16_f32 v81, v190, v191
    v_cvt_pk_bf16_f32 v89, v134, v135
    v_pk_mul_f32 v[188:189], v[136:137], v[56:57]
    v_pk_mul_f32 v[136:137], v[136:137], v[72:73]
    v_pk_fma_f32 v[188:189], v[152:153], v[72:73], v[188:189] neg_lo:[1,0,0] neg_hi:[1,0,0]
    v_pk_fma_f32 v[136:137], v[152:153], v[56:57], v[136:137]
    v_cvt_pk_bf16_f32 v82, v188, v189
    v_cvt_pk_bf16_f32 v90, v136, v137
    v_pk_mul_f32 v[190:191], v[138:139], v[58:59]
    v_pk_mul_f32 v[138:139], v[138:139], v[74:75]
    v_pk_fma_f32 v[190:191], v[154:155], v[74:75], v[190:191] neg_lo:[1,0,0] neg_hi:[1,0,0]
    v_pk_fma_f32 v[138:139], v[154:155], v[58:59], v[138:139]
    v_cvt_pk_bf16_f32 v83, v190, v191
    v_cvt_pk_bf16_f32 v91, v138, v139
    v_mov_b32 v3, s58
    v_add_f32 v3, s59, v3
    v_mfma_f32_32x32x16_bf16 v[172:187], v[28:31], v[76:79], 0
    v_mfma_f32_32x32x16_bf16 v[172:187], v[36:39], v[84:87], v[172:187]
    v_mfma_f32_32x32x16_bf16 v[172:187], v[32:35], v[80:83], v[172:187]
    v_mfma_f32_32x32x16_bf16 v[172:187], v[40:43], v[88:91], v[172:187]
    s_nop 11
    v_cndmask_b32 v164, v164, v2, s[34:35]
    v_cndmask_b32 v180, v180, v3, s[34:35]
    v_cvt_pk_bf16_f32 v195, v156, v172
    v_cvt_pk_bf16_f32 v199, v157, v173
    v_cvt_pk_bf16_f32 v203, v158, v174
    v_cvt_pk_bf16_f32 v207, v159, v175
    v_cvt_pk_bf16_f32 v211, v160, v176
    v_cvt_pk_bf16_f32 v215, v161, v177
    v_cvt_pk_bf16_f32 v219, v162, v178
    v_cvt_pk_bf16_f32 v223, v163, v179
    v_cvt_pk_bf16_f32 v227, v164, v180
    v_cvt_pk_bf16_f32 v231, v165, v181
    v_cvt_pk_bf16_f32 v235, v166, v182
    v_cvt_pk_bf16_f32 v239, v167, v183
    v_cvt_pk_bf16_f32 v243, v168, v184
    v_cvt_pk_bf16_f32 v247, v169, v185
    v_cvt_pk_bf16_f32 v251, v170, v186
    v_cvt_pk_bf16_f32 v255, v171, v187
    s_lshr_b32 s84, s25, 2
    s_and_b32 s85, s25, 3
    s_lshl_b32 s86, s84, 8
    s_lshl_b32 s87, s85, 4
    s_add_u32 s86, s86, s87
    s_and_b32 s87, s3, 3
    s_lshl_b32 s87, s87, 2
    s_add_u32 s86, s86, s87
    v_lshrrev_b32 v2, 4, v11
    v_add_u32 v3, s86, v2
    v_mul_u32_u24 v3, 1026, v3
    v_and_b32 v4, 15, v11
    v_lshl_add_u32 v9, v4, 4, v3
    s_lshr_b32 s87, s3, 2
    s_lshl_b32 s87, s87, 9

    v_lshlrev_b32 v4, 11, v4
    v_lshl_add_u32 v8, v2, 4, v4

    s_lshl_b32 s56, s25, 6
    v_lshrrev_b32 v177, 3, v0
    v_and_b32 v177, 0x38, v177
    v_and_or_b32 v177, v0, 7, v177
    v_add_u32 v176, s56, v177
    v_sub_u32 v177, 2048, v176
    v_and_b32 v177, 2047, v177
    v_mul_u32_u24 v178, 1026, v176
    v_mul_u32_u24 v177, 1026, v177
    buffer_load_ushort v180, v178, s[76:79], 0 offen
    buffer_load_ushort v181, v177, s[76:79], 0 offen
    buffer_load_ushort v182, v178, s[76:79], 0 offen offset:1024
    buffer_load_ushort v183, v177, s[76:79], 0 offen offset:1024
    buffer_load_ushort v184, v178, s[80:83], 0 offen
    buffer_load_ushort v185, v177, s[80:83], 0 offen
    buffer_load_ushort v186, v178, s[80:83], 0 offen offset:1024
    buffer_load_ushort v187, v177, s[80:83], 0 offen offset:1024
F_noab0:

    v_lshlrev_b32 v108, 1, v10
    buffer_load_dwordx4 v[76:79], v108, s[52:55], 0 offen
    buffer_load_dwordx4 v[80:83], v108, s[52:55], 0 offen offset:16

    s_add_u32 s56, s87, 0
    buffer_load_dwordx4 v[12:15], v9, s[76:79], s56 offen offset:0
    s_add_u32 s56, s87, 0
    buffer_load_dwordx4 v[28:31], v9, s[80:83], s56 offen offset:0
    s_add_u32 s56, s87, 65664
    buffer_load_dwordx4 v[16:19], v9, s[76:79], s56 offen offset:0
    s_add_u32 s56, s87, 65664
    buffer_load_dwordx4 v[32:35], v9, s[80:83], s56 offen offset:0
    s_add_u32 s56, s87, 131328
    buffer_load_dwordx4 v[20:23], v9, s[76:79], s56 offen offset:0
    s_add_u32 s56, s87, 131328
    buffer_load_dwordx4 v[36:39], v9, s[80:83], s56 offen offset:0
    s_add_u32 s56, s87, 196992
    buffer_load_dwordx4 v[24:27], v9, s[76:79], s56 offen offset:0
    s_add_u32 s56, s87, 196992
    buffer_load_dwordx4 v[40:43], v9, s[80:83], s56 offen offset:0
    s_add_u32 s56, s87, 0
    buffer_load_dwordx4 v[44:47], v9, s[76:79], s56 offen offset:256
    s_add_u32 s56, s87, 0
    buffer_load_dwordx4 v[60:63], v9, s[80:83], s56 offen offset:256
    s_add_u32 s56, s87, 65664
    buffer_load_dwordx4 v[48:51], v9, s[76:79], s56 offen offset:256
    s_add_u32 s56, s87, 65664
    buffer_load_dwordx4 v[64:67], v9, s[80:83], s56 offen offset:256
    s_add_u32 s56, s87, 131328
    buffer_load_dwordx4 v[52:55], v9, s[76:79], s56 offen offset:256
    s_add_u32 s56, s87, 131328
    buffer_load_dwordx4 v[68:71], v9, s[80:83], s56 offen offset:256
    s_add_u32 s56, s87, 196992
    buffer_load_dwordx4 v[56:59], v9, s[76:79], s56 offen offset:256
    s_add_u32 s56, s87, 196992
    buffer_load_dwordx4 v[72:75], v9, s[80:83], s56 offen offset:256
    v_add_u32 v108, s41, v108
    ds_read_b128 v[112:115], v108
    ds_read_b128 v[116:119], v108 offset:16
    v_mov_b32 v109, 0x3f803f80
    v_mov_b32 v110, 0xffff0000
    s_waitcnt vmcnt(16)

    v_lshlrev_b32 v92, 16, v76
    v_and_b32 v100, v110, v76
    v_lshlrev_b32 v93, 16, v77
    v_and_b32 v101, v110, v77
    v_lshlrev_b32 v94, 16, v78
    v_and_b32 v102, v110, v78
    v_lshlrev_b32 v95, 16, v79
    v_and_b32 v103, v110, v79
    v_lshlrev_b32 v96, 16, v80
    v_and_b32 v104, v110, v80
    v_lshlrev_b32 v97, 16, v81
    v_and_b32 v105, v110, v81
    v_lshlrev_b32 v98, 16, v82
    v_and_b32 v106, v110, v82
    v_lshlrev_b32 v99, 16, v83
    v_and_b32 v107, v110, v83
    ds_read_b128 v[120:123], v108 offset:2048
    ds_read_b128 v[124:127], v108 offset:2064
    s_waitcnt lgkmcnt(2)
    v_lshlrev_b32 v128, 16, v112
    v_and_b32 v129, v110, v112
    v_mul_f32 v128, v128, v92
    v_mul_f32 v129, v129, v100
    v_cvt_pk_bf16_f32 v112, v128, v129

    v_lshlrev_b32 v130, 16, v113
    v_and_b32 v131, v110, v113
    v_mul_f32 v130, v130, v93
    v_mul_f32 v131, v131, v101
    v_cvt_pk_bf16_f32 v113, v130, v131

    v_lshlrev_b32 v128, 16, v114
    v_and_b32 v129, v110, v114
    v_mul_f32 v128, v128, v94
    v_mul_f32 v129, v129, v102
    v_cvt_pk_bf16_f32 v114, v128, v129

    v_lshlrev_b32 v130, 16, v115
    v_and_b32 v131, v110, v115
    v_mul_f32 v130, v130, v95
    v_mul_f32 v131, v131, v103
    v_cvt_pk_bf16_f32 v115, v130, v131

    v_lshlrev_b32 v128, 16, v116
    v_and_b32 v129, v110, v116
    v_mul_f32 v128, v128, v96
    v_mul_f32 v129, v129, v104
    v_cvt_pk_bf16_f32 v116, v128, v129

    v_lshlrev_b32 v130, 16, v117
    v_and_b32 v131, v110, v117
    v_mul_f32 v130, v130, v97
    v_mul_f32 v131, v131, v105
    v_cvt_pk_bf16_f32 v117, v130, v131

    v_lshlrev_b32 v128, 16, v118
    v_and_b32 v129, v110, v118
    v_mul_f32 v128, v128, v98
    v_mul_f32 v129, v129, v106
    v_cvt_pk_bf16_f32 v118, v128, v129

    v_lshlrev_b32 v130, 16, v119
    v_and_b32 v131, v110, v119
    v_mul_f32 v130, v130, v99
    v_mul_f32 v131, v131, v107
    v_cvt_pk_bf16_f32 v119, v130, v131

    v_dot2_f32_bf16 v132, v112, v109, 0
    v_dot2_f32_bf16 v132, v113, v109, v132
    v_dot2_f32_bf16 v132, v114, v109, v132
    v_dot2_f32_bf16 v132, v115, v109, v132
    v_dot2_f32_bf16 v132, v116, v109, v132
    v_dot2_f32_bf16 v132, v117, v109, v132
    v_dot2_f32_bf16 v132, v118, v109, v132
    v_dot2_f32_bf16 v132, v119, v109, v132
    ds_read_b128 v[112:115], v108 offset:4096
    ds_read_b128 v[116:119], v108 offset:4112
    s_waitcnt lgkmcnt(2)
    v_lshlrev_b32 v128, 16, v120
    v_and_b32 v129, v110, v120
    v_mul_f32 v128, v128, v92
    v_mul_f32 v129, v129, v100
    v_cvt_pk_bf16_f32 v120, v128, v129

    v_lshlrev_b32 v130, 16, v121
    v_and_b32 v131, v110, v121
    v_mul_f32 v130, v130, v93
    v_mul_f32 v131, v131, v101
    v_cvt_pk_bf16_f32 v121, v130, v131

    v_lshlrev_b32 v128, 16, v122
    v_and_b32 v129, v110, v122
    v_mul_f32 v128, v128, v94
    v_mul_f32 v129, v129, v102
    v_cvt_pk_bf16_f32 v122, v128, v129

    v_lshlrev_b32 v130, 16, v123
    v_and_b32 v131, v110, v123
    v_mul_f32 v130, v130, v95
    v_mul_f32 v131, v131, v103
    v_cvt_pk_bf16_f32 v123, v130, v131

    v_lshlrev_b32 v128, 16, v124
    v_and_b32 v129, v110, v124
    v_mul_f32 v128, v128, v96
    v_mul_f32 v129, v129, v104
    v_cvt_pk_bf16_f32 v124, v128, v129

    v_lshlrev_b32 v130, 16, v125
    v_and_b32 v131, v110, v125
    v_mul_f32 v130, v130, v97
    v_mul_f32 v131, v131, v105
    v_cvt_pk_bf16_f32 v125, v130, v131

    v_lshlrev_b32 v128, 16, v126
    v_and_b32 v129, v110, v126
    v_mul_f32 v128, v128, v98
    v_mul_f32 v129, v129, v106
    v_cvt_pk_bf16_f32 v126, v128, v129

    v_lshlrev_b32 v130, 16, v127
    v_and_b32 v131, v110, v127
    v_mul_f32 v130, v130, v99
    v_mul_f32 v131, v131, v107
    v_cvt_pk_bf16_f32 v127, v130, v131

    v_dot2_f32_bf16 v133, v120, v109, 0
    v_dot2_f32_bf16 v133, v121, v109, v133
    v_dot2_f32_bf16 v133, v122, v109, v133
    v_dot2_f32_bf16 v133, v123, v109, v133
    v_dot2_f32_bf16 v133, v124, v109, v133
    v_dot2_f32_bf16 v133, v125, v109, v133
    v_dot2_f32_bf16 v133, v126, v109, v133
    v_dot2_f32_bf16 v133, v127, v109, v133
    ds_read_b128 v[120:123], v108 offset:6144
    ds_read_b128 v[124:127], v108 offset:6160
    s_waitcnt lgkmcnt(2)
    v_lshlrev_b32 v128, 16, v112
    v_and_b32 v129, v110, v112
    v_mul_f32 v128, v128, v92
    v_mul_f32 v129, v129, v100
    v_cvt_pk_bf16_f32 v112, v128, v129

    v_lshlrev_b32 v130, 16, v113
    v_and_b32 v131, v110, v113
    v_mul_f32 v130, v130, v93
    v_mul_f32 v131, v131, v101
    v_cvt_pk_bf16_f32 v113, v130, v131

    v_lshlrev_b32 v128, 16, v114
    v_and_b32 v129, v110, v114
    v_mul_f32 v128, v128, v94
    v_mul_f32 v129, v129, v102
    v_cvt_pk_bf16_f32 v114, v128, v129

    v_lshlrev_b32 v130, 16, v115
    v_and_b32 v131, v110, v115
    v_mul_f32 v130, v130, v95
    v_mul_f32 v131, v131, v103
    v_cvt_pk_bf16_f32 v115, v130, v131

    v_lshlrev_b32 v128, 16, v116
    v_and_b32 v129, v110, v116
    v_mul_f32 v128, v128, v96
    v_mul_f32 v129, v129, v104
    v_cvt_pk_bf16_f32 v116, v128, v129

    v_lshlrev_b32 v130, 16, v117
    v_and_b32 v131, v110, v117
    v_mul_f32 v130, v130, v97
    v_mul_f32 v131, v131, v105
    v_cvt_pk_bf16_f32 v117, v130, v131

    v_lshlrev_b32 v128, 16, v118
    v_and_b32 v129, v110, v118
    v_mul_f32 v128, v128, v98
    v_mul_f32 v129, v129, v106
    v_cvt_pk_bf16_f32 v118, v128, v129

    v_lshlrev_b32 v130, 16, v119
    v_and_b32 v131, v110, v119
    v_mul_f32 v130, v130, v99
    v_mul_f32 v131, v131, v107
    v_cvt_pk_bf16_f32 v119, v130, v131

    v_dot2_f32_bf16 v134, v112, v109, 0
    v_dot2_f32_bf16 v134, v113, v109, v134
    v_dot2_f32_bf16 v134, v114, v109, v134
    v_dot2_f32_bf16 v134, v115, v109, v134
    v_dot2_f32_bf16 v134, v116, v109, v134
    v_dot2_f32_bf16 v134, v117, v109, v134
    v_dot2_f32_bf16 v134, v118, v109, v134
    v_dot2_f32_bf16 v134, v119, v109, v134
    ds_read_b128 v[112:115], v108 offset:8192
    ds_read_b128 v[116:119], v108 offset:8208
    s_waitcnt lgkmcnt(2)
    v_lshlrev_b32 v128, 16, v120
    v_and_b32 v129, v110, v120
    v_mul_f32 v128, v128, v92
    v_mul_f32 v129, v129, v100
    v_cvt_pk_bf16_f32 v120, v128, v129

    v_lshlrev_b32 v130, 16, v121
    v_and_b32 v131, v110, v121
    v_mul_f32 v130, v130, v93
    v_mul_f32 v131, v131, v101
    v_cvt_pk_bf16_f32 v121, v130, v131

    v_lshlrev_b32 v128, 16, v122
    v_and_b32 v129, v110, v122
    v_mul_f32 v128, v128, v94
    v_mul_f32 v129, v129, v102
    v_cvt_pk_bf16_f32 v122, v128, v129

    v_lshlrev_b32 v130, 16, v123
    v_and_b32 v131, v110, v123
    v_mul_f32 v130, v130, v95
    v_mul_f32 v131, v131, v103
    v_cvt_pk_bf16_f32 v123, v130, v131

    v_lshlrev_b32 v128, 16, v124
    v_and_b32 v129, v110, v124
    v_mul_f32 v128, v128, v96
    v_mul_f32 v129, v129, v104
    v_cvt_pk_bf16_f32 v124, v128, v129

    v_lshlrev_b32 v130, 16, v125
    v_and_b32 v131, v110, v125
    v_mul_f32 v130, v130, v97
    v_mul_f32 v131, v131, v105
    v_cvt_pk_bf16_f32 v125, v130, v131

    v_lshlrev_b32 v128, 16, v126
    v_and_b32 v129, v110, v126
    v_mul_f32 v128, v128, v98
    v_mul_f32 v129, v129, v106
    v_cvt_pk_bf16_f32 v126, v128, v129

    v_lshlrev_b32 v130, 16, v127
    v_and_b32 v131, v110, v127
    v_mul_f32 v130, v130, v99
    v_mul_f32 v131, v131, v107
    v_cvt_pk_bf16_f32 v127, v130, v131

    v_dot2_f32_bf16 v135, v120, v109, 0
    v_dot2_f32_bf16 v135, v121, v109, v135
    v_dot2_f32_bf16 v135, v122, v109, v135
    v_dot2_f32_bf16 v135, v123, v109, v135
    v_dot2_f32_bf16 v135, v124, v109, v135
    v_dot2_f32_bf16 v135, v125, v109, v135
    v_dot2_f32_bf16 v135, v126, v109, v135
    v_dot2_f32_bf16 v135, v127, v109, v135
    ds_read_b128 v[120:123], v108 offset:10240
    ds_read_b128 v[124:127], v108 offset:10256
    s_waitcnt lgkmcnt(2)
    v_lshlrev_b32 v128, 16, v112
    v_and_b32 v129, v110, v112
    v_mul_f32 v128, v128, v92
    v_mul_f32 v129, v129, v100
    v_cvt_pk_bf16_f32 v112, v128, v129

    v_lshlrev_b32 v130, 16, v113
    v_and_b32 v131, v110, v113
    v_mul_f32 v130, v130, v93
    v_mul_f32 v131, v131, v101
    v_cvt_pk_bf16_f32 v113, v130, v131

    v_lshlrev_b32 v128, 16, v114
    v_and_b32 v129, v110, v114
    v_mul_f32 v128, v128, v94
    v_mul_f32 v129, v129, v102
    v_cvt_pk_bf16_f32 v114, v128, v129

    v_lshlrev_b32 v130, 16, v115
    v_and_b32 v131, v110, v115
    v_mul_f32 v130, v130, v95
    v_mul_f32 v131, v131, v103
    v_cvt_pk_bf16_f32 v115, v130, v131

    v_lshlrev_b32 v128, 16, v116
    v_and_b32 v129, v110, v116
    v_mul_f32 v128, v128, v96
    v_mul_f32 v129, v129, v104
    v_cvt_pk_bf16_f32 v116, v128, v129

    v_lshlrev_b32 v130, 16, v117
    v_and_b32 v131, v110, v117
    v_mul_f32 v130, v130, v97
    v_mul_f32 v131, v131, v105
    v_cvt_pk_bf16_f32 v117, v130, v131

    v_lshlrev_b32 v128, 16, v118
    v_and_b32 v129, v110, v118
    v_mul_f32 v128, v128, v98
    v_mul_f32 v129, v129, v106
    v_cvt_pk_bf16_f32 v118, v128, v129

    v_lshlrev_b32 v130, 16, v119
    v_and_b32 v131, v110, v119
    v_mul_f32 v130, v130, v99
    v_mul_f32 v131, v131, v107
    v_cvt_pk_bf16_f32 v119, v130, v131

    v_dot2_f32_bf16 v136, v112, v109, 0
    v_dot2_f32_bf16 v136, v113, v109, v136
    v_dot2_f32_bf16 v136, v114, v109, v136
    v_dot2_f32_bf16 v136, v115, v109, v136
    v_dot2_f32_bf16 v136, v116, v109, v136
    v_dot2_f32_bf16 v136, v117, v109, v136
    v_dot2_f32_bf16 v136, v118, v109, v136
    v_dot2_f32_bf16 v136, v119, v109, v136
    ds_read_b128 v[112:115], v108 offset:12288
    ds_read_b128 v[116:119], v108 offset:12304
    s_waitcnt lgkmcnt(2)
    v_lshlrev_b32 v128, 16, v120
    v_and_b32 v129, v110, v120
    v_mul_f32 v128, v128, v92
    v_mul_f32 v129, v129, v100
    v_cvt_pk_bf16_f32 v120, v128, v129

    v_lshlrev_b32 v130, 16, v121
    v_and_b32 v131, v110, v121
    v_mul_f32 v130, v130, v93
    v_mul_f32 v131, v131, v101
    v_cvt_pk_bf16_f32 v121, v130, v131

    v_lshlrev_b32 v128, 16, v122
    v_and_b32 v129, v110, v122
    v_mul_f32 v128, v128, v94
    v_mul_f32 v129, v129, v102
    v_cvt_pk_bf16_f32 v122, v128, v129

    v_lshlrev_b32 v130, 16, v123
    v_and_b32 v131, v110, v123
    v_mul_f32 v130, v130, v95
    v_mul_f32 v131, v131, v103
    v_cvt_pk_bf16_f32 v123, v130, v131

    v_lshlrev_b32 v128, 16, v124
    v_and_b32 v129, v110, v124
    v_mul_f32 v128, v128, v96
    v_mul_f32 v129, v129, v104
    v_cvt_pk_bf16_f32 v124, v128, v129

    v_lshlrev_b32 v130, 16, v125
    v_and_b32 v131, v110, v125
    v_mul_f32 v130, v130, v97
    v_mul_f32 v131, v131, v105
    v_cvt_pk_bf16_f32 v125, v130, v131

    v_lshlrev_b32 v128, 16, v126
    v_and_b32 v129, v110, v126
    v_mul_f32 v128, v128, v98
    v_mul_f32 v129, v129, v106
    v_cvt_pk_bf16_f32 v126, v128, v129

    v_lshlrev_b32 v130, 16, v127
    v_and_b32 v131, v110, v127
    v_mul_f32 v130, v130, v99
    v_mul_f32 v131, v131, v107
    v_cvt_pk_bf16_f32 v127, v130, v131

    v_dot2_f32_bf16 v137, v120, v109, 0
    v_dot2_f32_bf16 v137, v121, v109, v137
    v_dot2_f32_bf16 v137, v122, v109, v137
    v_dot2_f32_bf16 v137, v123, v109, v137
    v_dot2_f32_bf16 v137, v124, v109, v137
    v_dot2_f32_bf16 v137, v125, v109, v137
    v_dot2_f32_bf16 v137, v126, v109, v137
    v_dot2_f32_bf16 v137, v127, v109, v137
    ds_read_b128 v[120:123], v108 offset:14336
    ds_read_b128 v[124:127], v108 offset:14352
    s_waitcnt lgkmcnt(2)
    v_lshlrev_b32 v128, 16, v112
    v_and_b32 v129, v110, v112
    v_mul_f32 v128, v128, v92
    v_mul_f32 v129, v129, v100
    v_cvt_pk_bf16_f32 v112, v128, v129

    v_lshlrev_b32 v130, 16, v113
    v_and_b32 v131, v110, v113
    v_mul_f32 v130, v130, v93
    v_mul_f32 v131, v131, v101
    v_cvt_pk_bf16_f32 v113, v130, v131

    v_lshlrev_b32 v128, 16, v114
    v_and_b32 v129, v110, v114
    v_mul_f32 v128, v128, v94
    v_mul_f32 v129, v129, v102
    v_cvt_pk_bf16_f32 v114, v128, v129

    v_lshlrev_b32 v130, 16, v115
    v_and_b32 v131, v110, v115
    v_mul_f32 v130, v130, v95
    v_mul_f32 v131, v131, v103
    v_cvt_pk_bf16_f32 v115, v130, v131

    v_lshlrev_b32 v128, 16, v116
    v_and_b32 v129, v110, v116
    v_mul_f32 v128, v128, v96
    v_mul_f32 v129, v129, v104
    v_cvt_pk_bf16_f32 v116, v128, v129

    v_lshlrev_b32 v130, 16, v117
    v_and_b32 v131, v110, v117
    v_mul_f32 v130, v130, v97
    v_mul_f32 v131, v131, v105
    v_cvt_pk_bf16_f32 v117, v130, v131

    v_lshlrev_b32 v128, 16, v118
    v_and_b32 v129, v110, v118
    v_mul_f32 v128, v128, v98
    v_mul_f32 v129, v129, v106
    v_cvt_pk_bf16_f32 v118, v128, v129

    v_lshlrev_b32 v130, 16, v119
    v_and_b32 v131, v110, v119
    v_mul_f32 v130, v130, v99
    v_mul_f32 v131, v131, v107
    v_cvt_pk_bf16_f32 v119, v130, v131

    v_dot2_f32_bf16 v138, v112, v109, 0
    v_dot2_f32_bf16 v138, v113, v109, v138
    v_dot2_f32_bf16 v138, v114, v109, v138
    v_dot2_f32_bf16 v138, v115, v109, v138
    v_dot2_f32_bf16 v138, v116, v109, v138
    v_dot2_f32_bf16 v138, v117, v109, v138
    v_dot2_f32_bf16 v138, v118, v109, v138
    v_dot2_f32_bf16 v138, v119, v109, v138
    s_waitcnt lgkmcnt(0)
    v_lshlrev_b32 v128, 16, v120
    v_and_b32 v129, v110, v120
    v_mul_f32 v128, v128, v92
    v_mul_f32 v129, v129, v100
    v_cvt_pk_bf16_f32 v120, v128, v129

    v_lshlrev_b32 v130, 16, v121
    v_and_b32 v131, v110, v121
    v_mul_f32 v130, v130, v93
    v_mul_f32 v131, v131, v101
    v_cvt_pk_bf16_f32 v121, v130, v131

    v_lshlrev_b32 v128, 16, v122
    v_and_b32 v129, v110, v122
    v_mul_f32 v128, v128, v94
    v_mul_f32 v129, v129, v102
    v_cvt_pk_bf16_f32 v122, v128, v129

    v_lshlrev_b32 v130, 16, v123
    v_and_b32 v131, v110, v123
    v_mul_f32 v130, v130, v95
    v_mul_f32 v131, v131, v103
    v_cvt_pk_bf16_f32 v123, v130, v131

    v_lshlrev_b32 v128, 16, v124
    v_and_b32 v129, v110, v124
    v_mul_f32 v128, v128, v96
    v_mul_f32 v129, v129, v104
    v_cvt_pk_bf16_f32 v124, v128, v129

    v_lshlrev_b32 v130, 16, v125
    v_and_b32 v131, v110, v125
    v_mul_f32 v130, v130, v97
    v_mul_f32 v131, v131, v105
    v_cvt_pk_bf16_f32 v125, v130, v131

    v_lshlrev_b32 v128, 16, v126
    v_and_b32 v129, v110, v126
    v_mul_f32 v128, v128, v98
    v_mul_f32 v129, v129, v106
    v_cvt_pk_bf16_f32 v126, v128, v129

    v_lshlrev_b32 v130, 16, v127
    v_and_b32 v131, v110, v127
    v_mul_f32 v130, v130, v99
    v_mul_f32 v131, v131, v107
    v_cvt_pk_bf16_f32 v127, v130, v131

    v_dot2_f32_bf16 v139, v120, v109, 0
    v_dot2_f32_bf16 v139, v121, v109, v139
    v_dot2_f32_bf16 v139, v122, v109, v139
    v_dot2_f32_bf16 v139, v123, v109, v139
    v_dot2_f32_bf16 v139, v124, v109, v139
    v_dot2_f32_bf16 v139, v125, v109, v139
    v_dot2_f32_bf16 v139, v126, v109, v139
    v_dot2_f32_bf16 v139, v127, v109, v139
    s_nop 2
    v_add_f32_dpp v132, v132, v132 row_shr:1 row_mask:0xf bank_mask:0xf bound_ctrl:0
    v_add_f32_dpp v133, v133, v133 row_shr:1 row_mask:0xf bank_mask:0xf bound_ctrl:0
    v_add_f32_dpp v134, v134, v134 row_shr:1 row_mask:0xf bank_mask:0xf bound_ctrl:0
    v_add_f32_dpp v135, v135, v135 row_shr:1 row_mask:0xf bank_mask:0xf bound_ctrl:0
    v_add_f32_dpp v136, v136, v136 row_shr:1 row_mask:0xf bank_mask:0xf bound_ctrl:0
    v_add_f32_dpp v137, v137, v137 row_shr:1 row_mask:0xf bank_mask:0xf bound_ctrl:0
    v_add_f32_dpp v138, v138, v138 row_shr:1 row_mask:0xf bank_mask:0xf bound_ctrl:0
    v_add_f32_dpp v139, v139, v139 row_shr:1 row_mask:0xf bank_mask:0xf bound_ctrl:0
    v_add_f32_dpp v132, v132, v132 row_shr:2 row_mask:0xf bank_mask:0xf bound_ctrl:0
    v_add_f32_dpp v133, v133, v133 row_shr:2 row_mask:0xf bank_mask:0xf bound_ctrl:0
    v_add_f32_dpp v134, v134, v134 row_shr:2 row_mask:0xf bank_mask:0xf bound_ctrl:0
    v_add_f32_dpp v135, v135, v135 row_shr:2 row_mask:0xf bank_mask:0xf bound_ctrl:0
    v_add_f32_dpp v136, v136, v136 row_shr:2 row_mask:0xf bank_mask:0xf bound_ctrl:0
    v_add_f32_dpp v137, v137, v137 row_shr:2 row_mask:0xf bank_mask:0xf bound_ctrl:0
    v_add_f32_dpp v138, v138, v138 row_shr:2 row_mask:0xf bank_mask:0xf bound_ctrl:0
    v_add_f32_dpp v139, v139, v139 row_shr:2 row_mask:0xf bank_mask:0xf bound_ctrl:0
    v_add_f32_dpp v132, v132, v132 row_shr:4 row_mask:0xf bank_mask:0xf bound_ctrl:0
    v_add_f32_dpp v133, v133, v133 row_shr:4 row_mask:0xf bank_mask:0xf bound_ctrl:0
    v_add_f32_dpp v134, v134, v134 row_shr:4 row_mask:0xf bank_mask:0xf bound_ctrl:0
    v_add_f32_dpp v135, v135, v135 row_shr:4 row_mask:0xf bank_mask:0xf bound_ctrl:0
    v_add_f32_dpp v136, v136, v136 row_shr:4 row_mask:0xf bank_mask:0xf bound_ctrl:0
    v_add_f32_dpp v137, v137, v137 row_shr:4 row_mask:0xf bank_mask:0xf bound_ctrl:0
    v_add_f32_dpp v138, v138, v138 row_shr:4 row_mask:0xf bank_mask:0xf bound_ctrl:0
    v_add_f32_dpp v139, v139, v139 row_shr:4 row_mask:0xf bank_mask:0xf bound_ctrl:0
    v_add_f32_dpp v132, v132, v132 row_shr:8 row_mask:0xf bank_mask:0xf bound_ctrl:0
    v_add_f32_dpp v133, v133, v133 row_shr:8 row_mask:0xf bank_mask:0xf bound_ctrl:0
    v_add_f32_dpp v134, v134, v134 row_shr:8 row_mask:0xf bank_mask:0xf bound_ctrl:0
    v_add_f32_dpp v135, v135, v135 row_shr:8 row_mask:0xf bank_mask:0xf bound_ctrl:0
    v_add_f32_dpp v136, v136, v136 row_shr:8 row_mask:0xf bank_mask:0xf bound_ctrl:0
    v_add_f32_dpp v137, v137, v137 row_shr:8 row_mask:0xf bank_mask:0xf bound_ctrl:0
    v_add_f32_dpp v138, v138, v138 row_shr:8 row_mask:0xf bank_mask:0xf bound_ctrl:0
    v_add_f32_dpp v139, v139, v139 row_shr:8 row_mask:0xf bank_mask:0xf bound_ctrl:0
    v_add_f32_dpp v132, v132, v132 row_bcast:15 row_mask:0xa bank_mask:0xf
    v_add_f32_dpp v133, v133, v133 row_bcast:15 row_mask:0xa bank_mask:0xf
    v_add_f32_dpp v134, v134, v134 row_bcast:15 row_mask:0xa bank_mask:0xf
    v_add_f32_dpp v135, v135, v135 row_bcast:15 row_mask:0xa bank_mask:0xf
    v_add_f32_dpp v136, v136, v136 row_bcast:15 row_mask:0xa bank_mask:0xf
    v_add_f32_dpp v137, v137, v137 row_bcast:15 row_mask:0xa bank_mask:0xf
    v_add_f32_dpp v138, v138, v138 row_bcast:15 row_mask:0xa bank_mask:0xf
    v_add_f32_dpp v139, v139, v139 row_bcast:15 row_mask:0xa bank_mask:0xf
    v_add_f32_dpp v132, v132, v132 row_bcast:31 row_mask:0xc bank_mask:0xf
    v_add_f32_dpp v133, v133, v133 row_bcast:31 row_mask:0xc bank_mask:0xf
    v_add_f32_dpp v134, v134, v134 row_bcast:31 row_mask:0xc bank_mask:0xf
    v_add_f32_dpp v135, v135, v135 row_bcast:31 row_mask:0xc bank_mask:0xf
    v_add_f32_dpp v136, v136, v136 row_bcast:31 row_mask:0xc bank_mask:0xf
    v_add_f32_dpp v137, v137, v137 row_bcast:31 row_mask:0xc bank_mask:0xf
    v_add_f32_dpp v138, v138, v138 row_bcast:31 row_mask:0xc bank_mask:0xf
    v_add_f32_dpp v139, v139, v139 row_bcast:31 row_mask:0xc bank_mask:0xf
    v_mov_b32 v128, 0
    v_readlane_b32 s58, v132, 63
    s_nop 1
    v_writelane_b32 v128, s58, 0
    v_readlane_b32 s58, v133, 63
    s_nop 1
    v_writelane_b32 v128, s58, 1
    v_readlane_b32 s58, v134, 63
    s_nop 1
    v_writelane_b32 v128, s58, 2
    v_readlane_b32 s58, v135, 63
    s_nop 1
    v_writelane_b32 v128, s58, 3
    v_readlane_b32 s58, v136, 63
    s_nop 1
    v_writelane_b32 v128, s58, 4
    v_readlane_b32 s58, v137, 63
    s_nop 1
    v_writelane_b32 v128, s58, 5
    v_readlane_b32 s58, v138, 63
    s_nop 1
    v_writelane_b32 v128, s58, 6
    v_readlane_b32 s58, v139, 63
    s_nop 1
    v_writelane_b32 v128, s58, 7
    s_nop 0
    v_cvt_pk_bf16_f32 v128, v128, v128
    v_and_b32 v128, v110, v128
    v_mul_f32 v128, 0xbfb8aa3b, v128
    v_exp_f32 v128, v128
    v_lshrrev_b32 v130, 2, v11
    v_add_f32 v128, 1.0, v128
    v_rcp_f32 v128, v128
    v_lshlrev_b32 v130, 11, v130
    v_cvt_pk_bf16_f32 v128, v128, v128
    v_and_b32 v128, v110, v128
    v_sub_f32 v129, 1.0, v128
    v_cvt_pk_bf16_f32 v129, v129, v129
    v_and_b32 v129, v110, v129
    v_and_b32 v131, 3, v11
    v_lshl_add_u32 v130, v131, 7, v130
    s_lshr_b32 s58, s40, 9
    s_add_u32 s58, s58, 34603008
    s_add_u32 s59, s58, 8192
    s_mov_b64 exec, 0xff
    buffer_store_dword v128, v130, s[20:23], s58 offen sc1
    buffer_store_dword v129, v130, s[20:23], s59 offen sc1
    s_mov_b64 exec, -1

    s_barrier
    v_and_b32 v6, 31, v11
    v_lshl_add_u32 v6, v5, 5, v6
    v_lshlrev_b32 v6, 8, v6
    v_and_b32 v7, 7, v11
    v_xor_b32 v7, s3, v7
    v_lshl_add_u32 v6, v7, 4, v6
    v_add_u32 v7, 65536, v6

    ds_write_b128 v6, v[192:195] offset:0
    ds_write_b128 v6, v[196:199] offset:8192
    ds_write_b128 v6, v[200:203] offset:16384
    ds_write_b128 v6, v[204:207] offset:24576
    ds_write_b128 v7, v[208:211] offset:0
    ds_write_b128 v7, v[212:215] offset:8192
    ds_write_b128 v7, v[216:219] offset:16384
    ds_write_b128 v7, v[220:223] offset:24576
    ds_write_b128 v6, v[224:227] offset:128
    ds_write_b128 v6, v[228:231] offset:8320
    ds_write_b128 v6, v[232:235] offset:16512
    ds_write_b128 v6, v[236:239] offset:24704
    ds_write_b128 v7, v[240:243] offset:128
    ds_write_b128 v7, v[244:247] offset:8320
    ds_write_b128 v7, v[248:251] offset:16512
    ds_write_b128 v7, v[252:255] offset:24704
    s_waitcnt lgkmcnt(0)
    s_barrier
    v_lshlrev_b32 v6, 4, v0
    v_add_u32 v7, 65536, v6

    ds_read_b128 v[192:195], v6 offset:0
    ds_read_b128 v[196:199], v6 offset:8192
    ds_read_b128 v[200:203], v6 offset:16384
    ds_read_b128 v[204:207], v6 offset:24576
    ds_read_b128 v[208:211], v6 offset:32768
    ds_read_b128 v[212:215], v6 offset:40960
    ds_read_b128 v[216:219], v6 offset:49152
    ds_read_b128 v[220:223], v6 offset:57344
    ds_read_b128 v[224:227], v7 offset:0
    ds_read_b128 v[228:231], v7 offset:8192
    ds_read_b128 v[232:235], v7 offset:16384
    ds_read_b128 v[236:239], v7 offset:24576
    ds_read_b128 v[240:243], v7 offset:32768
    ds_read_b128 v[244:247], v7 offset:40960
    ds_read_b128 v[248:251], v7 offset:49152
    ds_read_b128 v[252:255], v7 offset:57344

    v_lshrrev_b32 v2, 4, v0
    v_xor_b32 v3, v2, v0
    v_and_b32 v3, 7, v3
    v_and_b32 v2, 0x1f8, v0
    v_or_b32 v2, v2, v3
    v_lshlrev_b32 v2, 4, v2
    s_lshl_b32 s58, s25, 17
    s_add_u32 s58, s58, 16777216

    s_waitcnt lgkmcnt(15)
    buffer_store_dwordx4 v[192:195], v2, s[20:23], s58 offen sc1
    s_add_u32 s58, s58, 8192
    s_waitcnt lgkmcnt(14)
    buffer_store_dwordx4 v[196:199], v2, s[20:23], s58 offen sc1
    s_add_u32 s58, s58, 8192
    s_waitcnt lgkmcnt(13)
    buffer_store_dwordx4 v[200:203], v2, s[20:23], s58 offen sc1
    s_add_u32 s58, s58, 8192
    s_waitcnt lgkmcnt(12)
    buffer_store_dwordx4 v[204:207], v2, s[20:23], s58 offen sc1
    s_add_u32 s58, s58, 8192
    s_waitcnt lgkmcnt(11)
    buffer_store_dwordx4 v[208:211], v2, s[20:23], s58 offen sc1
    s_add_u32 s58, s58, 8192
    s_waitcnt lgkmcnt(10)
    buffer_store_dwordx4 v[212:215], v2, s[20:23], s58 offen sc1
    s_add_u32 s58, s58, 8192
    s_waitcnt lgkmcnt(9)
    buffer_store_dwordx4 v[216:219], v2, s[20:23], s58 offen sc1
    s_add_u32 s58, s58, 8192
    s_waitcnt lgkmcnt(8)
    buffer_store_dwordx4 v[220:223], v2, s[20:23], s58 offen sc1
    s_add_u32 s58, s58, 8192
    s_waitcnt lgkmcnt(7)
    buffer_store_dwordx4 v[224:227], v2, s[20:23], s58 offen sc1
    s_add_u32 s58, s58, 8192
    s_waitcnt lgkmcnt(6)
    buffer_store_dwordx4 v[228:231], v2, s[20:23], s58 offen sc1
    s_add_u32 s58, s58, 8192
    s_waitcnt lgkmcnt(5)
    buffer_store_dwordx4 v[232:235], v2, s[20:23], s58 offen sc1
    s_add_u32 s58, s58, 8192
    s_waitcnt lgkmcnt(4)
    buffer_store_dwordx4 v[236:239], v2, s[20:23], s58 offen sc1
    s_add_u32 s58, s58, 8192
    s_waitcnt lgkmcnt(3)
    buffer_store_dwordx4 v[240:243], v2, s[20:23], s58 offen sc1
    s_add_u32 s58, s58, 8192
    s_waitcnt lgkmcnt(2)
    buffer_store_dwordx4 v[244:247], v2, s[20:23], s58 offen sc1
    s_add_u32 s58, s58, 8192
    s_waitcnt lgkmcnt(1)
    buffer_store_dwordx4 v[248:251], v2, s[20:23], s58 offen sc1
    s_add_u32 s58, s58, 8192
    s_waitcnt lgkmcnt(0)
    buffer_store_dwordx4 v[252:255], v2, s[20:23], s58 offen sc1
    s_add_u32 s58, s58, 8192
    s_lshr_b32 s58, s3, 2
    s_lshl_b32 s58, s58, 16
    s_lshl_b32 s59, s85, 17
    s_add_u32 s58, s58, s59
    s_lshl_b32 s59, s84, 19
    s_add_u32 s58, s58, s59
    s_and_b32 s59, s3, 3
    s_lshl_b32 s59, s59, 6
    s_add_u32 s58, s58, s59
    s_add_u32 s58, s58, 20971520
    s_mov_b32 s88, 0x05040100
    s_mov_b32 s89, 0x07060302

    s_waitcnt vmcnt(24)
    v_perm_b32 v92, v28, v12, s88
    v_perm_b32 v93, v32, v16, s88
    v_perm_b32 v94, v36, v20, s88
    v_perm_b32 v95, v40, v24, s88
    s_add_u32 s59, s58, 0
    buffer_store_dwordx4 v[92:95], v8, s[20:23], s59 offen sc1
    v_perm_b32 v96, v28, v12, s89
    v_perm_b32 v97, v32, v16, s89
    v_perm_b32 v98, v36, v20, s89
    v_perm_b32 v99, v40, v24, s89
    s_add_u32 s59, s58, 256
    buffer_store_dwordx4 v[96:99], v8, s[20:23], s59 offen sc1
    v_perm_b32 v100, v29, v13, s88
    v_perm_b32 v101, v33, v17, s88
    v_perm_b32 v102, v37, v21, s88
    v_perm_b32 v103, v41, v25, s88
    s_add_u32 s59, s58, 512
    buffer_store_dwordx4 v[100:103], v8, s[20:23], s59 offen sc1
    v_perm_b32 v104, v29, v13, s89
    v_perm_b32 v105, v33, v17, s89
    v_perm_b32 v106, v37, v21, s89
    v_perm_b32 v107, v41, v25, s89
    s_add_u32 s59, s58, 768
    buffer_store_dwordx4 v[104:107], v8, s[20:23], s59 offen sc1
    v_perm_b32 v108, v30, v14, s88
    v_perm_b32 v109, v34, v18, s88
    v_perm_b32 v110, v38, v22, s88
    v_perm_b32 v111, v42, v26, s88
    s_add_u32 s59, s58, 1024
    buffer_store_dwordx4 v[108:111], v8, s[20:23], s59 offen sc1
    v_perm_b32 v112, v30, v14, s89
    v_perm_b32 v113, v34, v18, s89
    v_perm_b32 v114, v38, v22, s89
    v_perm_b32 v115, v42, v26, s89
    s_add_u32 s59, s58, 1280
    buffer_store_dwordx4 v[112:115], v8, s[20:23], s59 offen sc1
    v_perm_b32 v116, v31, v15, s88
    v_perm_b32 v117, v35, v19, s88
    v_perm_b32 v118, v39, v23, s88
    v_perm_b32 v119, v43, v27, s88
    s_add_u32 s59, s58, 1536
    buffer_store_dwordx4 v[116:119], v8, s[20:23], s59 offen sc1
    v_perm_b32 v120, v31, v15, s89
    v_perm_b32 v121, v35, v19, s89
    v_perm_b32 v122, v39, v23, s89
    v_perm_b32 v123, v43, v27, s89
    s_add_u32 s59, s58, 1792
    buffer_store_dwordx4 v[120:123], v8, s[20:23], s59 offen sc1
    s_waitcnt vmcnt(24)
    v_perm_b32 v124, v60, v44, s88
    v_perm_b32 v125, v64, v48, s88
    v_perm_b32 v126, v68, v52, s88
    v_perm_b32 v127, v72, v56, s88
    s_add_u32 s59, s58, 32768
    buffer_store_dwordx4 v[124:127], v8, s[20:23], s59 offen sc1
    v_perm_b32 v128, v60, v44, s89
    v_perm_b32 v129, v64, v48, s89
    v_perm_b32 v130, v68, v52, s89
    v_perm_b32 v131, v72, v56, s89
    s_add_u32 s59, s58, 33024
    buffer_store_dwordx4 v[128:131], v8, s[20:23], s59 offen sc1
    v_perm_b32 v132, v61, v45, s88
    v_perm_b32 v133, v65, v49, s88
    v_perm_b32 v134, v69, v53, s88
    v_perm_b32 v135, v73, v57, s88
    s_add_u32 s59, s58, 33280
    buffer_store_dwordx4 v[132:135], v8, s[20:23], s59 offen sc1
    v_perm_b32 v136, v61, v45, s89
    v_perm_b32 v137, v65, v49, s89
    v_perm_b32 v138, v69, v53, s89
    v_perm_b32 v139, v73, v57, s89
    s_add_u32 s59, s58, 33536
    buffer_store_dwordx4 v[136:139], v8, s[20:23], s59 offen sc1
    v_perm_b32 v140, v62, v46, s88
    v_perm_b32 v141, v66, v50, s88
    v_perm_b32 v142, v70, v54, s88
    v_perm_b32 v143, v74, v58, s88
    s_add_u32 s59, s58, 33792
    buffer_store_dwordx4 v[140:143], v8, s[20:23], s59 offen sc1
    v_perm_b32 v144, v62, v46, s89
    v_perm_b32 v145, v66, v50, s89
    v_perm_b32 v146, v70, v54, s89
    v_perm_b32 v147, v74, v58, s89
    s_add_u32 s59, s58, 34048
    buffer_store_dwordx4 v[144:147], v8, s[20:23], s59 offen sc1
    v_perm_b32 v148, v63, v47, s88
    v_perm_b32 v149, v67, v51, s88
    v_perm_b32 v150, v71, v55, s88
    v_perm_b32 v151, v75, v59, s88
    s_add_u32 s59, s58, 34304
    buffer_store_dwordx4 v[148:151], v8, s[20:23], s59 offen sc1
    v_perm_b32 v152, v63, v47, s89
    v_perm_b32 v153, v67, v51, s89
    v_perm_b32 v154, v71, v55, s89
    v_perm_b32 v155, v75, v59, s89
    s_add_u32 s59, s58, 34560
    buffer_store_dwordx4 v[152:155], v8, s[20:23], s59 offen sc1
    s_waitcnt vmcnt(18)
    v_lshlrev_b32 v180, 16, v180
    v_lshlrev_b32 v181, 16, v181
    v_lshlrev_b32 v182, 16, v182
    v_lshlrev_b32 v183, 16, v183
    v_lshlrev_b32 v184, 16, v184
    v_lshlrev_b32 v185, 16, v185
    v_lshlrev_b32 v186, 16, v186
    v_lshlrev_b32 v187, 16, v187
    v_add_f32 v180, v180, v181
    v_add_f32 v182, v182, v183
    v_sub_f32 v184, v184, v185
    v_sub_f32 v186, v186, v187
    v_add_f32 v181, v180, v182
    v_sub_f32 v183, v180, v182
    v_add_f32 v185, v184, v186
    v_sub_f32 v187, v184, v186
    v_mul_f32 v181, 0x3e000000, v181
    v_mul_f32 v183, 0x3e000000, v183
    v_mul_f32 v185, 0x3e000000, v185
    v_mul_f32 v187, 0x3e000000, v187
    v_cvt_pk_bf16_f32 v180, v181, v185
    v_cvt_pk_bf16_f32 v182, v183, v187
    v_and_b32 v177, 15, v176
    v_bfe_u32 v178, v176, 8, 2
    v_lshl_add_u32 v177, v178, 4, v177
    v_bfe_u32 v178, v176, 10, 1
    v_lshl_add_u32 v177, v178, 6, v177
    v_bfe_u32 v178, v176, 4, 2
    v_lshl_add_u32 v177, v178, 7, v177
    v_bfe_u32 v178, v176, 6, 2
    v_lshl_add_u32 v177, v177, 2, v178
    v_lshlrev_b32 v177, 2, v177
    s_mov_b32 s58, 25174016
    s_mov_b32 s59, 25182208
    buffer_store_dword v180, v177, s[20:23], s58 offen sc1
    buffer_store_dword v182, v177, s[20:23], s59 offen sc1

    v_mov_b32 v20, 0
    v_mov_b32 v21, s90
    v_and_b32 v23, 3, v11
    v_lshlrev_b32 v23, 6, v23
    v_mov_b32 v24, 1
    v_lshlrev_b32 v25, 2, v11
    s_waitcnt vmcnt(0)
    s_barrier
    s_cmp_lg_u32 s3, 0
    s_cbranch_scc1 M_tr
    s_and_b32 s58, s2, 3
    s_lshl_b32 s58, s58, 6
    s_mov_b64 exec, 1
    buffer_atomic_add v24, v20, s[92:95], s58 offen sc1
    s_mov_b64 exec, -1
    s_branch M_tr

M_end:
    s_endpgm
.section .rodata,"a"
.p2align 6
.amdhsa_kernel gated_mix__spectral_gfnet__swiglu_ffn__prompt_kernel
  .amdhsa_next_free_vgpr 256
  .amdhsa_next_free_sgpr 102
  .amdhsa_accum_offset 256
  .amdhsa_group_segment_fixed_size 0
  .amdhsa_kernarg_size 88
  .amdhsa_user_sgpr_count 2
  .amdhsa_user_sgpr_kernarg_segment_ptr 1
  .amdhsa_system_sgpr_workgroup_id_x 1
  .amdhsa_float_denorm_mode_32 3
  .amdhsa_float_denorm_mode_16_64 3
.end_amdhsa_kernel
```
